```python
import torch

def _softmax(x, axis=-1):
    return torch.softmax(x, dim=axis)
def _gelu(x):
    return torch.nn.functional.gelu(x, approximate="tanh")
def _silu(x):
    return torch.nn.functional.silu(x)
def _sigmoid(x):
    return torch.sigmoid(x)
def _layernorm(x, axis=-1, eps=1e-5):
    m = x.mean(dim=axis, keepdim=True)
    v = x.var(dim=axis, keepdim=True, unbiased=False)
    return (x - m) / torch.sqrt(v + eps)
def _scatter_add(tgt, idx, src, axis=0):
    return tgt.clone().index_add_(axis, idx, src)
def _segment_sum(src, seg, n):
    out = torch.zeros((n,) + src.shape[1:], dtype=src.dtype)
    return out.index_add_(0, seg, src)
def _pad(x, pw):
    flat = tuple(v for pair in reversed(pw) for v in pair)
    return torch.nn.functional.pad(x, flat)

kernel_name = 'interleave_layers__sliding_local_dilated__sliding_local_dilated__prompt'

def setup_inputs():

    _w = (lambda a: (lambda t: t.to(torch.bfloat16) if t.is_floating_point() else t)(torch.as_tensor(a)))
    def _A_setup():
        B, S, D = 1, 2048, 512
        return {
            "x": _w((lambda *s: torch.randn(*s, dtype=torch.bfloat16) * 0.05)(B, S, D)),
            "wqkv": _w((lambda *s: torch.randn(*s, dtype=torch.bfloat16) * 0.05)(D, 3 * D)),
            "wo": _w((lambda *s: torch.randn(*s, dtype=torch.bfloat16) * 0.05)(D, D)),
        }
    _A_in = _A_setup()

    def _B_setup():
        B, S, D = 1, 2048, 512
        return {
            "x": _w((lambda *s: torch.randn(*s, dtype=torch.bfloat16) * 0.05)(B, S, D)),
            "wqkv": _w((lambda *s: torch.randn(*s, dtype=torch.bfloat16) * 0.05)(D, 3 * D)),
            "wo": _w((lambda *s: torch.randn(*s, dtype=torch.bfloat16) * 0.05)(D, D)),
        }
    _B_in = _B_setup()

    return {
        "A_x": _A_in["x"],
        "A_wqkv": _A_in["wqkv"],
        "A_wo": _A_in["wo"],
        "B_x": _B_in["x"],
        "B_wqkv": _B_in["wqkv"],
        "B_wo": _B_in["wo"],
    }

def reference(A_x, A_wqkv, A_wo, B_x, B_wqkv, B_wo):
    def _A_ref(x, wqkv, wo):
        B, S, D = x.shape
        H = 32; Dh = D // H
        W, dil = 8, 2
        qkv = (lambda x, *d: x.permute(*d))((x @ wqkv).reshape(B, S, 3, H, Dh), 2, 0, 3, 1, 4)
        q, k, v = qkv[0], qkv[1], qkv[2]
        scale = Dh ** -0.5
        pos = torch.arange(S)
        off = torch.arange(W) * dil
        idx = pos[:, None] - off[None, :]
        mask = idx >= 0
        idx_c = torch.where(mask, idx, 0).reshape(-1)
        kg = k[:, :, idx_c, :].reshape(B, H, S, W, Dh)
        vg = v[:, :, idx_c, :].reshape(B, H, S, W, Dh)
        logits = torch.einsum("bhsd,bhswd->bhsw", q, kg) * scale
        logits = torch.where(mask[None, None, :, :], logits, -1e9)
        attn = _softmax(logits, axis=-1)
        o = torch.einsum("bhsw,bhswd->bhsd", attn, vg)
        return (lambda x, *d: x.permute(*d))(o, 0, 2, 1, 3).reshape(B, S, D) @ wo

    def _B_ref(x, wqkv, wo):
        B, S, D = x.shape
        H = 32; Dh = D // H
        W, dil = 8, 2
        qkv = (lambda x, *d: x.permute(*d))((x @ wqkv).reshape(B, S, 3, H, Dh), 2, 0, 3, 1, 4)
        q, k, v = qkv[0], qkv[1], qkv[2]
        scale = Dh ** -0.5
        pos = torch.arange(S)
        off = torch.arange(W) * dil
        idx = pos[:, None] - off[None, :]
        mask = idx >= 0
        idx_c = torch.where(mask, idx, 0).reshape(-1)
        kg = k[:, :, idx_c, :].reshape(B, H, S, W, Dh)
        vg = v[:, :, idx_c, :].reshape(B, H, S, W, Dh)
        logits = torch.einsum("bhsd,bhswd->bhsw", q, kg) * scale
        logits = torch.where(mask[None, None, :, :], logits, -1e9)
        attn = _softmax(logits, axis=-1)
        o = torch.einsum("bhsw,bhswd->bhsd", attn, vg)
        return (lambda x, *d: x.permute(*d))(o, 0, 2, 1, 3).reshape(B, S, D) @ wo

    x = A_x
    x = x + _A_ref(_layernorm(x, axis=-1), A_wqkv, A_wo)
    x = x + _B_ref(_layernorm(x, axis=-1), B_wqkv, B_wo)
    x = x + _A_ref(_layernorm(x, axis=-1), A_wqkv, A_wo)
    x = x + _B_ref(_layernorm(x, axis=-1), B_wqkv, B_wo)
    return x
```

```asm
; @launch grid=(256,1,1) block=(256,1,1) lds=163840
.amdgcn_target "amdgcn-amd-amdhsa--gfx950"
.text
.globl interleave_layers__sliding_local_dilated__sliding_local_dilated__prompt_kernel
.p2align 8
.type interleave_layers__sliding_local_dilated__sliding_local_dilated__prompt_kernel,@function
interleave_layers__sliding_local_dilated__sliding_local_dilated__prompt_kernel:
    s_load_dwordx4 s[76:79], s[0:1], 0
    s_load_dwordx2 s[82:83], s[0:1], 64
    s_load_dwordx2 s[80:81], s[0:1], 16
    s_load_dwordx4 s[84:87], s[0:1], 32
    s_load_dwordx2 s[88:89], s[0:1], 48
    s_cmp_ge_u32 s2, 256
    s_cbranch_scc1 L_end
    v_lshrrev_b32 v1, 6, v0
    v_and_b32 v0, 63, v0
    v_readfirstlane_b32 s36, v1
    s_lshr_b32 s3, s2, 3
    s_getpc_b64 s[96:97]
L_pc:
    s_mov_b32 s98, L_slow-L_pc
    s_mov_b32 s99, 0x00020000
    s_lshl_b32 s94, s3, 11
    s_cmp_eq_u32 s36, 2
    s_cbranch_scc0 L_nocp
    v_lshlrev_b32 v1, 5, v0
    buffer_load_dword v96, v1, s[96:99], s94 offen
L_nocp:
    s_add_u32 s37, s3, 0
    s_and_b32 s37, s37, 7
    s_lshr_b32 s3, s3, 3
    s_and_b32 s38, s2, 7
    s_lshl_b32 s38, s38, 2
    s_add_u32 s38, s38, s3
    s_and_b32 s39, s38, 15
    s_and_b32 s94, s2, 3
    s_lshl_b32 s40, s94, 2
    v_and_b32 v2, 15, v0
    v_lshrrev_b32 v3, 4, v0
    v_lshlrev_b32 v6, 4, v0
    s_lshl_b32 s94, s36, 2
    v_add_u32 v1, s94, v3
    v_xor_b32 v4, v1, v2
    v_lshlrev_b32 v4, 4, v4
    v_lshl_add_u32 v250, v1, 11, v4
    s_lshl_b32 s52, s39, 7
    s_lshr_b32 s95, s38, 4
    s_add_u32 s52, s52, s95
    s_lshl_b32 s52, s52, 10
    s_lshl_b32 s94, s36, 3
    v_lshrrev_b32 v1, 3, v0
    v_add_u32 v251, s94, v1
    v_and_b32 v4, 1, v3
    v_lshlrev_b32 v4, 1, v4
    s_and_b32 s94, s36, 1
    s_lshl_b32 s94, s94, 2
    v_or_b32 v4, s94, v4
    v_and_b32 v5, 7, v0
    v_xor_b32 v4, v4, v5
    v_lshlrev_b32 v4, 4, v4
    s_lshl_b32 s95, s37, 7
    v_mul_u32_u24 v254, 3072, v251
    v_add3_u32 v254, v254, v4, s95
    s_mul_i32 s59, s36, 3072
    s_lshl_b32 s4, s36, 10
    s_mul_i32 s60, s38, 299008
    s_add_u32 s60, s60, 557056
    s_lshl_b32 s71, s36, 14
    s_add_u32 s66, s60, s71
    s_lshl_b32 s3, s37, 1
    s_sub_u32 s74, s3, s40
    s_and_b32 s74, s74, 15
    s_lshl_b32 s74, s74, 10
    s_add_u32 s63, s66, s74
    s_lshl_b32 s3, s3, 10
    s_add_u32 s64, s66, s3
    s_lshl_b32 s74, s37, 2
    s_add_u32 s74, s74, s36
    s_lshl_b32 s75, s74, 10
    s_add_u32 s62, s60, s75
    s_add_u32 s62, s62, 131072
    s_lshl_b32 s101, s74, 7
    s_add_u32 s101, s101, s60
    s_add_u32 s101, s101, 294912
    s_add_u32 s72, s64, 65536
    s_add_u32 s73, s62, 0x8000
    v_lshlrev_b32 v10, 1, v0
    v_mov_b32 v56, -1
    v_mov_b32 v57, -1
    v_mov_b32 v58, -1
    v_mov_b32 v59, -1
    s_lshl_b32 s94, s37, 14
    s_add_u32 s94, s94, s52
    s_mul_i32 s95, s2, 6144
    s_lshl_b32 s100, s2, 11
    s_movk_i32 s74, 96
    s_cmp_eq_u32 s36, 2
    s_cselect_b32 s95, s100, s95
    s_cselect_b32 s74, 32, s74
    s_cmp_eq_u32 s36, 3
    s_cselect_b32 s94, s94, s95
    s_cselect_b32 s74, 128, s74
    s_cselect_b32 s75, 1024, 0
    v_mul_u32_u24 v1, s75, v1
    v_mul_u32_u24 v4, s74, v0
    v_add_u32 v1, v1, v4
    s_mov_b32 s18, 0x200000
    s_mov_b32 s19, 0x00020000
    s_mov_b32 s22, 0x180000
    s_mov_b32 s23, 0x00020000
    s_mov_b32 s10, 10125312
    s_mov_b32 s11, 0x00020000
    s_mov_b32 s14, 0x200000
    s_mov_b32 s15, 0x00020000
    s_waitcnt lgkmcnt(0)
    s_mov_b64 s[16:17], s[76:77]
    s_mov_b64 s[20:21], s[78:79]
    s_add_u32 s82, s82, 0
    s_addc_u32 s83, s83, 0
    s_mov_b64 s[8:9], s[82:83]
    s_cmp_eq_u32 s36, 1
    s_cselect_b64 s[96:97], s[84:85], s[78:79]
    s_mov_b32 s98, 0x180000
    s_cmp_eq_u32 s36, 2
    s_cselect_b64 s[96:97], s[80:81], s[96:97]
    s_cselect_b32 s98, 0x80000, s98
    s_cmp_eq_u32 s36, 3
    s_cselect_b64 s[96:97], s[76:77], s[96:97]
    s_cselect_b32 s98, 0x200000, s98
    buffer_load_dword v96, v1, s[96:99], s94 offen
    buffer_store_dwordx4 v[56:59], v6, s[8:11], s72 offen sc1
    buffer_store_dwordx4 v[56:59], v6, s[8:11], s72 offen offset:1024 sc1
    buffer_store_short v56, v10, s[8:11], s101 offen sc1
    s_lshl_b32 s73, s40, 6
    s_add_u32 s73, s73, 0
    s_and_b32 s73, s73, 1023
    s_add_u32 s73, s73, s52
    s_add_u32 m0, s4, 98304
    s_nop 0
    buffer_load_dwordx4 v250, s[16:19], s73 offen lds
    s_add_u32 s73, s73, 32768
    s_add_u32 m0, s4, 102400
    s_nop 0
    buffer_load_dwordx4 v250, s[16:19], s73 offen lds
    s_add_u32 s73, s73, 32768
    s_add_u32 m0, s4, 106496
    s_nop 0
    buffer_load_dwordx4 v250, s[16:19], s73 offen lds
    s_add_u32 s73, s73, 32768
    s_add_u32 m0, s4, 110592
    s_nop 0
    buffer_load_dwordx4 v250, s[16:19], s73 offen lds
    s_add_u32 s72, s40, 0
    s_and_b32 s72, s72, 15
    s_mul_i32 s72, s72, 98304
    s_add_u32 m0, s59, 24576
    s_nop 0
    buffer_load_dwordx4 v254, s[20:23], s72 offen offset:0 lds
    buffer_load_dwordx4 v254, s[20:23], s72 offen offset:1024 lds
    buffer_load_dwordx4 v254, s[20:23], s72 offen offset:2048 lds
    s_lshr_b32 s94, s96, 7
    s_sub_u32 s94, 3, s94
    s_and_b32 s94, s94, 7
    s_lshl_b32 s94, s94, 7
    s_lshr_b32 s95, s2, 3
    s_cmp_eq_u32 s36, 2
    s_cselect_b32 s74, 15, 47
    s_add_u32 s75, s74, 1
    s_mul_i32 s95, s95, s75
    s_lshl_b32 s95, s95, 10
    s_add_u32 s94, s94, s95
    s_cmp_eq_u32 s36, 3
    s_cselect_b64 s[96:97], s[86:87], s[96:97]
    s_cselect_b32 s98, 0x80000, s98
    s_cselect_b32 s94, s100, s94
    s_cselect_b32 s74, 15, s74
    s_cselect_b32 s75, 7, 10
    s_cmp_eq_u32 s36, 9
    s_cselect_b32 s98, 0, s98
    v_min_u32 v1, s74, v0
    v_lshlrev_b32 v1, s75, v1
    buffer_load_dword v96, v1, s[96:99], s94 offen
    s_add_u32 s82, s82, 540672
    s_addc_u32 s83, s83, 0
    s_load_dword s5, s[82:83], 0
    s_add_u32 s72, s40, 1
    s_and_b32 s72, s72, 15
    s_mul_i32 s72, s72, 98304
    s_add_u32 m0, s59, 12288
    s_nop 0
    buffer_load_dwordx4 v254, s[20:23], s72 offen offset:0 lds
    buffer_load_dwordx4 v254, s[20:23], s72 offen offset:1024 lds
    buffer_load_dwordx4 v254, s[20:23], s72 offen offset:2048 lds
    s_mov_b64 s[12:13], s[88:89]
    s_mov_b64 s[44:45], s[86:87]
    s_mov_b32 s46, 0x80000
    s_mov_b32 s47, 0x00020000
    s_mov_b64 s[24:25], s[80:81]
    s_mov_b32 s26, 0x80000
    s_mov_b32 s27, 0x00020000
    s_mov_b64 s[50:51], s[84:85]
    v_lshlrev_b32 v1, 8, v2
    v_add_u32 v1, 98304, v1
    s_lshl_b32 s3, s36, 12
    v_or_b32 v4, 0, v3
    v_xor_b32 v4, v4, v2
    v_lshl_add_u32 v240, v4, 4, v1
    v_add_u32 v244, s3, v240
    v_mov_b32 v236, 0x3f803f80
    v_or_b32 v4, 4, v3
    v_xor_b32 v4, v4, v2
    v_lshl_add_u32 v241, v4, 4, v1
    v_add_u32 v245, s3, v241
    v_mov_b32 v237, 0x3f803f80
    v_or_b32 v4, 8, v3
    v_xor_b32 v4, v4, v2
    v_lshl_add_u32 v242, v4, 4, v1
    v_add_u32 v246, s3, v242
    v_mov_b32 v238, 0x3f803f80
    v_or_b32 v4, 12, v3
    v_xor_b32 v4, v4, v2
    v_lshl_add_u32 v243, v4, 4, v1
    v_add_u32 v247, s3, v243
    v_mov_b32 v239, 0x3f803f80
    v_bfe_u32 v1, v0, 2, 2
    v_lshrrev_b32 v4, 1, v1
    v_and_b32 v5, 1, v3
    v_lshl_or_b32 v4, v5, 1, v4
    v_xor_b32 v4, s36, v4
    v_lshlrev_b32 v4, 5, v4
    v_and_b32 v5, 3, v0
    v_lshl_add_u32 v4, v5, 3, v4
    v_lshl_add_u32 v4, v1, 7, v4
    v_mul_u32_u24 v248, 3072, v3
    v_add_u32 v248, v4, v248
    v_add_u32 v249, 49152, v248
    s_waitcnt lgkmcnt(0)
    s_lshl_b32 s74, s37, 3
    s_add_u32 s3, s4, s74
    v_lshlrev_b32 v1, 6, v2
    v_add_u32 v1, s3, v1
    v_mov_b32 v4, 0x7ffffff0
    s_mov_b32 s74, 0x00f0000f
    s_mov_b32 s75, 0xf0000f00
    v_cndmask_b32 v10, v4, v1, s[74:75]
    v_mov_b32 v4, 0x3f80
    v_and_b32 v1, 1, v0
    v_lshlrev_b32 v1, 4, v1
    v_lshlrev_b32 v1, v1, v4
    s_and_b32 s76, s74, 0x33333333
    s_and_b32 s77, s75, 0x33333333
    v_cndmask_b32 v14, 0, v1, s[76:77]
    s_xor_b64 s[76:77], s[76:77], s[74:75]
    v_cndmask_b32 v15, 0, v1, s[76:77]
    s_mul_i32 s5, s5, 0x9e3779b1
    s_add_u32 s5, s5, 0x7f4a7c15
    s_mul_i32 s6, s5, 0x85ebca6b
    s_and_b32 s6, s6, 0xffffff00
    s_getreg_b32 s3, hwreg(HW_REG_XCC_ID, 0, 4)
    s_or_b32 s6, s6, s3
    v_mov_b32 v60, s5
    v_mov_b32 v61, s6
    s_lshl_b32 s7, s38, 3
    s_add_u32 s7, s7, s37
    s_lshl_b32 s7, s7, 4
    s_add_u32 s7, s7, 524288
    s_cmp_eq_u32 s36, 3
    s_cselect_b32 s7, s7, 0x7f000000
    v_and_b32 v71, 0x70, v6
    v_and_b32 v1, 1, v3
    v_lshlrev_b32 v1, 2, v1
    v_and_b32 v4, 7, v0
    v_xor_b32 v1, v1, v4
    v_lshlrev_b32 v1, 4, v1
    v_lshrrev_b32 v4, 3, v0
    v_lshlrev_b32 v4, 10, v4
    s_lshl_b32 s3, s37, 7
    v_add3_u32 v253, v4, v1, s3
    v_bfe_u32 v1, v0, 2, 2
    v_lshl_add_u32 v1, v3, 3, v1
    v_lshlrev_b32 v1, 7, v1
    v_and_b32 v4, 3, v0
    v_lshl_add_u32 v1, v4, 4, v1
    v_bfe_u32 v4, v0, 3, 1
    v_lshl_add_u32 v1, v4, 6, v1
    s_lshl_b32 s3, s36, 12
    v_add_u32 v7, s3, v6
    s_add_u32 s3, s3, 32768
    v_add_u32 v97, s3, v1
    v_xor_b32 v98, 64, v97
    v_add_u32 v99, 32768, v7
    s_lshr_b32 s3, s36, 1
    s_lshl_b32 s3, s3, 6
    s_and_b32 s74, s36, 1
    s_lshl_b32 s75, s74, 3
    v_and_b32 v4, 1, v3
    v_xor_b32 v4, 1, v4
    s_add_u32 s72, s40, 2
    s_and_b32 s72, s72, 15
    s_mul_i32 s72, s72, 98304
    s_add_u32 m0, s59, 86016
    s_nop 0
    buffer_load_dwordx4 v254, s[20:23], s72 offen offset:0 lds
    buffer_load_dwordx4 v254, s[20:23], s72 offen offset:1024 lds
    buffer_load_dwordx4 v254, s[20:23], s72 offen offset:2048 lds
    v_lshlrev_b32 v4, 14, v4
    v_lshl_add_u32 v4, v2, 4, v4
    v_lshrrev_b32 v5, 1, v3
    v_lshl_add_u32 v4, v5, 8, v4
    s_lshl_b32 s76, s74, 9
    v_add_u32 v8, s76, v4
    s_add_u32 s3, s3, s75
    v_xor_b32 v252, s3, v1
    s_lshl_b32 s53, s39, 2
    s_add_u32 s53, s53, s36
    s_lshl_b32 s56, s37, 6
    s_add_u32 s56, s56, s53
    s_lshl_b32 s53, s53, 13
    s_lshl_b32 s93, s56, 3
    s_add_u32 s93, s93, 532480
    s_lshl_b32 s56, s56, 10
    s_lshr_b32 s3, s38, 4
    s_lshr_b32 s75, s36, 1
    s_cmp_eq_u32 s3, s75
    s_cselect_b32 s56, s56, 0x7f000000
    s_cselect_b32 s93, s93, 0x7f000000
    s_lshl_b32 s68, s74, 13
    s_add_u32 s67, s60, s68
    s_mov_b32 s41, 0x20000
    s_mov_b32 s43, 0x3eb8aa3b
    s_lshl_b32 s74, s37, 2
    s_add_u32 s74, s74, s36
    s_cmp_eq_u32 s39, 0
    s_cselect_b32 s42, 0xff800000, 0
    s_cselect_b32 s3, 0, 299008
    s_sub_u32 s61, s62, s3
    s_lshr_b32 s3, s74, 1
    s_lshl_b32 s3, s3, 10
    s_add_u32 s65, s60, s3
    s_cmp_eq_u32 s36, 3
    s_cselect_b32 s69, 0x10000, s71
    s_lshl_b32 s70, s37, 16
    s_add_u32 s70, s70, s71
    s_lshl_b32 s3, s36, 15
    s_add_u32 s3, s3, s52
    s_lshl_b32 s74, s37, 7
    s_add_u32 s3, s3, s74
    v_lshlrev_b32 v1, 11, v2
    v_lshlrev_b32 v4, 4, v3
    v_add3_u32 v11, v1, v4, s3
    v_and_b32 v1, 31, v0
    v_lshrrev_b32 v4, 5, v0
    v_lshlrev_b32 v1, 6, v1
    v_lshl_add_u32 v9, v4, 5, v1
    v_lshlrev_b32 v1, 2, v3
    v_sub_u32 v1, v2, v1
    v_mov_b32 v5, 0xff800000
    v_mov_b32 v22, 0x3f803f80
    v_mov_b32 v23, 0x3f803f80
    v_cmp_le_i32 s[28:29], 0, v1
    v_subrev_u32 v4, 0, v1
    v_cmp_gt_u32 s[74:75], 8, v4
    v_cmp_gt_i32 s[76:77], -8, v4
    s_nop 0
    s_or_b64 s[74:75], s[76:77], s[74:75]
    v_cndmask_b32_e64 v16, v5, 0, s[74:75]
    v_cmp_le_i32 s[30:31], 1, v1
    v_subrev_u32 v4, 1, v1
    v_cmp_gt_u32 s[74:75], 8, v4
    v_cmp_gt_i32 s[76:77], -8, v4
    s_nop 0
    s_or_b64 s[74:75], s[76:77], s[74:75]
    v_cndmask_b32_e64 v17, v5, 0, s[74:75]
    v_cmp_le_i32 s[32:33], 2, v1
    v_subrev_u32 v4, 2, v1
    v_cmp_gt_u32 s[74:75], 8, v4
    v_cmp_gt_i32 s[76:77], -8, v4
    s_nop 0
    s_or_b64 s[74:75], s[76:77], s[74:75]
    v_cndmask_b32_e64 v18, v5, 0, s[74:75]
    v_cmp_le_i32 s[34:35], 3, v1
    v_subrev_u32 v4, 3, v1
    v_cmp_gt_u32 s[74:75], 8, v4
    v_cmp_gt_i32 s[76:77], -8, v4
    s_nop 0
    s_or_b64 s[74:75], s[76:77], s[74:75]
    v_cndmask_b32_e64 v19, v5, 0, s[74:75]
    v_mov_b32 v4, 0xffff
    v_mov_b32 v5, 0xffff0000
    v_cndmask_b32 v20, 0, v4, s[28:29]
    v_cndmask_b32 v1, 0, v5, s[30:31]
    v_or_b32 v20, v20, v1
    v_cndmask_b32 v21, 0, v4, s[32:33]
    v_cndmask_b32 v1, 0, v5, s[34:35]
    v_or_b32 v21, v21, v1
    v_mov_b32 v74, s5
    v_mov_b32 v75, s5
    v_mov_b32 v76, s5
    v_mov_b32 v77, s5
    v_mov_b32 v80, 0
    v_mov_b32 v81, 0
    v_mov_b32 v82, s5
    v_mov_b32 v84, s5
    v_mov_b32 v86, 0
    v_mov_b32 v87, 0
    v_lshlrev_b32 v68, 3, v2
    s_lshl_b32 s3, s36, 7
    v_add_u32 v69, s3, v68
    v_and_b32 v4, 0x18, v68
    v_lshl_add_u32 v70, v3, 5, v4
    v_mov_b32 v0, v254
    v_add_u32 v1, 98304, v248
    v_mov_b32 v2, v248
    s_add_u32 s72, s40, 3
    s_and_b32 s72, s72, 15
    s_mul_i32 s72, s72, 98304
    s_add_u32 m0, s59, 73728
    s_nop 0
    buffer_load_dwordx4 v254, s[20:23], s72 offen offset:0 lds
    buffer_load_dwordx4 v254, s[20:23], s72 offen offset:1024 lds
    buffer_load_dwordx4 v254, s[20:23], s72 offen offset:2048 lds
    s_waitcnt vmcnt(10)
    s_barrier
    ds_read_b64_tr_b16 a[0:1], v248 offset:24576
    ds_read_b64_tr_b16 a[2:3], v248 offset:25088
    ds_read_b64_tr_b16 a[4:5], v248 offset:25600
    ds_read_b64_tr_b16 a[6:7], v248 offset:26112
    ds_read_b64_tr_b16 a[8:9], v248 offset:26624
    ds_read_b64_tr_b16 a[10:11], v248 offset:27136
    ds_read_b128 v[176:179], v240 offset:0
    ds_read_b128 v[180:183], v240 offset:4096
    ds_read_b128 v[184:187], v240 offset:8192
    ds_read_b128 v[188:191], v240 offset:12288
    ds_read_b128 v[192:195], v244 offset:0
    s_add_u32 s72, s40, 4
    s_and_b32 s72, s72, 15
    s_mul_i32 s72, s72, 98304
    s_add_u32 m0, s59, 61440
    s_nop 0
    buffer_load_dwordx4 v254, s[20:23], s72 offen offset:0 lds
    buffer_load_dwordx4 v254, s[20:23], s72 offen offset:1024 lds
    buffer_load_dwordx4 v254, s[20:23], s72 offen offset:2048 lds
    s_lshl_b32 s73, s40, 6
    s_add_u32 s73, s73, 256
    s_and_b32 s73, s73, 1023
    s_add_u32 s73, s73, s52
    s_add_u32 m0, s4, 114688
    s_nop 0
    buffer_load_dwordx4 v250, s[16:19], s73 offen lds
    s_add_u32 s73, s73, 32768
    s_add_u32 m0, s4, 118784
    s_nop 0
    buffer_load_dwordx4 v250, s[16:19], s73 offen lds
    s_add_u32 s73, s73, 32768
    s_add_u32 m0, s4, 122880
    s_nop 0
    buffer_load_dwordx4 v250, s[16:19], s73 offen lds
    s_add_u32 s73, s73, 32768
    s_add_u32 m0, s4, 126976
    s_nop 0
    buffer_load_dwordx4 v250, s[16:19], s73 offen lds
    s_waitcnt lgkmcnt(0)
    v_mfma_f32_16x16x32_bf16 v[216:219], a[0:3], v[236:239], 0
    v_mfma_f32_16x16x32_bf16 v[220:223], a[4:7], v[236:239], 0
    s_waitcnt vmcnt(13)
    s_barrier
    ds_read_b64_tr_b16 a[12:13], v248 offset:12288
    v_mfma_f32_16x16x32_bf16 v[224:227], v[236:239], a[8:11], 0
    ds_read_b64_tr_b16 a[14:15], v248 offset:12800
    v_mfma_f32_16x16x32_bf16 v[128:131], a[0:3], v[176:179], 0
    ds_read_b64_tr_b16 a[16:17], v248 offset:13312
    v_mfma_f32_16x16x32_bf16 v[132:135], a[4:7], v[176:179], 0
    ds_read_b64_tr_b16 a[18:19], v248 offset:13824
    v_mfma_f32_16x16x32_bf16 v[136:139], v[176:179], a[8:11], 0
    ds_read_b64_tr_b16 a[20:21], v248 offset:14336
    v_mfma_f32_16x16x32_bf16 v[140:143], a[0:3], v[180:183], 0
    ds_read_b64_tr_b16 a[22:23], v248 offset:14848
    v_mfma_f32_16x16x32_bf16 v[144:147], a[4:7], v[180:183], 0
    ds_read_b128 v[196:199], v241 offset:0
    v_mfma_f32_16x16x32_bf16 v[148:151], v[180:183], a[8:11], 0
    ds_read_b128 v[200:203], v241 offset:4096
    v_mfma_f32_16x16x32_bf16 v[152:155], a[0:3], v[184:187], 0
    ds_read_b128 v[204:207], v241 offset:8192
    v_mfma_f32_16x16x32_bf16 v[156:159], a[4:7], v[184:187], 0
    ds_read_b128 v[208:211], v241 offset:12288
    v_mfma_f32_16x16x32_bf16 v[160:163], v[184:187], a[8:11], 0
    ds_read_b128 v[212:215], v245 offset:0
    v_mfma_f32_16x16x32_bf16 v[164:167], a[0:3], v[188:191], 0
    s_add_u32 s72, s40, 5
    s_and_b32 s72, s72, 15
    s_mul_i32 s72, s72, 98304
    s_add_u32 m0, s59, 49152
    s_nop 0
    buffer_load_dwordx4 v254, s[20:23], s72 offen offset:0 lds
    v_mfma_f32_16x16x32_bf16 v[168:171], a[4:7], v[188:191], 0
    buffer_load_dwordx4 v254, s[20:23], s72 offen offset:1024 lds
    v_mfma_f32_16x16x32_bf16 v[172:175], v[188:191], a[8:11], 0
    buffer_load_dwordx4 v254, s[20:23], s72 offen offset:2048 lds
    v_mfma_f32_16x16x32_bf16 v[228:231], v[192:195], v[192:195], 0
    v_mfma_f32_16x16x32_bf16 v[232:235], v[236:239], v[192:195], 0
    s_waitcnt lgkmcnt(0)
    v_mfma_f32_16x16x32_bf16 v[216:219], a[12:15], v[236:239], v[216:219]
    v_mfma_f32_16x16x32_bf16 v[220:223], a[16:19], v[236:239], v[220:223]
    s_waitcnt vmcnt(13)
    s_barrier
    ds_read_b64_tr_b16 a[24:25], v249 offset:36864
    v_mfma_f32_16x16x32_bf16 v[224:227], v[236:239], a[20:23], v[224:227]
    ds_read_b64_tr_b16 a[26:27], v249 offset:37376
    v_mfma_f32_16x16x32_bf16 v[128:131], a[12:15], v[196:199], v[128:131]
    ds_read_b64_tr_b16 a[28:29], v249 offset:37888
    v_mfma_f32_16x16x32_bf16 v[132:135], a[16:19], v[196:199], v[132:135]
    ds_read_b64_tr_b16 a[30:31], v249 offset:38400
    v_mfma_f32_16x16x32_bf16 v[136:139], v[196:199], a[20:23], v[136:139]
    ds_read_b64_tr_b16 a[32:33], v249 offset:38912
    v_mfma_f32_16x16x32_bf16 v[140:143], a[12:15], v[200:203], v[140:143]
    ds_read_b64_tr_b16 a[34:35], v249 offset:39424
    v_mfma_f32_16x16x32_bf16 v[144:147], a[16:19], v[200:203], v[144:147]
    ds_read_b128 v[176:179], v242 offset:0
    v_mfma_f32_16x16x32_bf16 v[148:151], v[200:203], a[20:23], v[148:151]
    ds_read_b128 v[180:183], v242 offset:4096
    v_mfma_f32_16x16x32_bf16 v[152:155], a[12:15], v[204:207], v[152:155]
    ds_read_b128 v[184:187], v242 offset:8192
    v_mfma_f32_16x16x32_bf16 v[156:159], a[16:19], v[204:207], v[156:159]
    ds_read_b128 v[188:191], v242 offset:12288
    v_mfma_f32_16x16x32_bf16 v[160:163], v[204:207], a[20:23], v[160:163]
    ds_read_b128 v[192:195], v246 offset:0
    v_mfma_f32_16x16x32_bf16 v[164:167], a[12:15], v[208:211], v[164:167]
    s_add_u32 s72, s40, 6
    s_and_b32 s72, s72, 15
    s_mul_i32 s72, s72, 98304
    s_add_u32 m0, s59, 36864
    s_nop 0
    buffer_load_dwordx4 v254, s[20:23], s72 offen offset:0 lds
    v_mfma_f32_16x16x32_bf16 v[168:171], a[16:19], v[208:211], v[168:171]
    buffer_load_dwordx4 v254, s[20:23], s72 offen offset:1024 lds
    v_mfma_f32_16x16x32_bf16 v[172:175], v[208:211], a[20:23], v[172:175]
    buffer_load_dwordx4 v254, s[20:23], s72 offen offset:2048 lds
    v_mfma_f32_16x16x32_bf16 v[228:231], v[212:215], v[212:215], v[228:231]
    v_mfma_f32_16x16x32_bf16 v[232:235], v[236:239], v[212:215], v[232:235]
    s_waitcnt lgkmcnt(0)
    v_mfma_f32_16x16x32_bf16 v[216:219], a[24:27], v[236:239], v[216:219]
    v_mfma_f32_16x16x32_bf16 v[220:223], a[28:31], v[236:239], v[220:223]
    s_waitcnt vmcnt(13)
    s_barrier
    ds_read_b64_tr_b16 a[36:37], v249 offset:24576
    v_mfma_f32_16x16x32_bf16 v[224:227], v[236:239], a[32:35], v[224:227]
    ds_read_b64_tr_b16 a[38:39], v249 offset:25088
    v_mfma_f32_16x16x32_bf16 v[128:131], a[24:27], v[176:179], v[128:131]
    ds_read_b64_tr_b16 a[40:41], v249 offset:25600
    v_mfma_f32_16x16x32_bf16 v[132:135], a[28:31], v[176:179], v[132:135]
    ds_read_b64_tr_b16 a[42:43], v249 offset:26112
    v_mfma_f32_16x16x32_bf16 v[136:139], v[176:179], a[32:35], v[136:139]
    ds_read_b64_tr_b16 a[44:45], v249 offset:26624
    v_mfma_f32_16x16x32_bf16 v[140:143], a[24:27], v[180:183], v[140:143]
    ds_read_b64_tr_b16 a[46:47], v249 offset:27136
    v_mfma_f32_16x16x32_bf16 v[144:147], a[28:31], v[180:183], v[144:147]
    ds_read_b128 v[196:199], v243 offset:0
    v_mfma_f32_16x16x32_bf16 v[148:151], v[180:183], a[32:35], v[148:151]
    ds_read_b128 v[200:203], v243 offset:4096
    v_mfma_f32_16x16x32_bf16 v[152:155], a[24:27], v[184:187], v[152:155]
    ds_read_b128 v[204:207], v243 offset:8192
    v_mfma_f32_16x16x32_bf16 v[156:159], a[28:31], v[184:187], v[156:159]
    ds_read_b128 v[208:211], v243 offset:12288
    v_mfma_f32_16x16x32_bf16 v[160:163], v[184:187], a[32:35], v[160:163]
    ds_read_b128 v[212:215], v247 offset:0
    v_mfma_f32_16x16x32_bf16 v[164:167], a[24:27], v[188:191], v[164:167]
    s_add_u32 s72, s40, 7
    s_and_b32 s72, s72, 15
    s_mul_i32 s72, s72, 98304
    s_add_u32 m0, s59, 24576
    s_nop 0
    buffer_load_dwordx4 v254, s[20:23], s72 offen offset:0 lds
    v_mfma_f32_16x16x32_bf16 v[168:171], a[28:31], v[188:191], v[168:171]
    buffer_load_dwordx4 v254, s[20:23], s72 offen offset:1024 lds
    v_mfma_f32_16x16x32_bf16 v[172:175], v[188:191], a[32:35], v[172:175]
    buffer_load_dwordx4 v254, s[20:23], s72 offen offset:2048 lds
    v_mfma_f32_16x16x32_bf16 v[228:231], v[192:195], v[192:195], v[228:231]
    v_mfma_f32_16x16x32_bf16 v[232:235], v[236:239], v[192:195], v[232:235]
    s_waitcnt lgkmcnt(0)
    v_mfma_f32_16x16x32_bf16 v[216:219], a[36:39], v[236:239], v[216:219]
    v_mfma_f32_16x16x32_bf16 v[220:223], a[40:43], v[236:239], v[220:223]
    s_waitcnt vmcnt(9)
    s_barrier
    ds_read_b64_tr_b16 a[48:49], v249 offset:12288
    ds_read_b64_tr_b16 a[50:51], v249 offset:12800
    v_mfma_f32_16x16x32_bf16 v[224:227], v[236:239], a[44:47], v[224:227]
    ds_read_b64_tr_b16 a[52:53], v249 offset:13312
    ds_read_b64_tr_b16 a[54:55], v249 offset:13824
    v_mfma_f32_16x16x32_bf16 v[128:131], a[36:39], v[196:199], v[128:131]
    ds_read_b64_tr_b16 a[56:57], v249 offset:14336
    v_mfma_f32_16x16x32_bf16 v[132:135], a[40:43], v[196:199], v[132:135]
    ds_read_b64_tr_b16 a[58:59], v249 offset:14848
    v_mfma_f32_16x16x32_bf16 v[136:139], v[196:199], a[44:47], v[136:139]
    ds_read_b128 v[176:179], v240 offset:16384
    v_mfma_f32_16x16x32_bf16 v[140:143], a[36:39], v[200:203], v[140:143]
    ds_read_b128 v[180:183], v240 offset:20480
    v_mfma_f32_16x16x32_bf16 v[144:147], a[40:43], v[200:203], v[144:147]
    ds_read_b128 v[184:187], v240 offset:24576
    v_mfma_f32_16x16x32_bf16 v[148:151], v[200:203], a[44:47], v[148:151]
    ds_read_b128 v[188:191], v240 offset:28672
    v_mfma_f32_16x16x32_bf16 v[152:155], a[36:39], v[204:207], v[152:155]
    ds_read_b128 v[192:195], v244 offset:16384
    v_mfma_f32_16x16x32_bf16 v[156:159], a[40:43], v[204:207], v[156:159]
    s_add_u32 s72, s40, 8
    s_and_b32 s72, s72, 15
    s_mul_i32 s72, s72, 98304
    s_add_u32 m0, s59, 12288
    s_nop 0
    buffer_load_dwordx4 v254, s[20:23], s72 offen offset:0 lds
    v_mfma_f32_16x16x32_bf16 v[160:163], v[204:207], a[44:47], v[160:163]
    buffer_load_dwordx4 v254, s[20:23], s72 offen offset:1024 lds
    v_mfma_f32_16x16x32_bf16 v[164:167], a[36:39], v[208:211], v[164:167]
    buffer_load_dwordx4 v254, s[20:23], s72 offen offset:2048 lds
    v_mfma_f32_16x16x32_bf16 v[168:171], a[40:43], v[208:211], v[168:171]
    s_lshl_b32 s73, s40, 6
    s_add_u32 s73, s73, 512
    s_and_b32 s73, s73, 1023
    s_add_u32 s73, s73, s52
    s_add_u32 m0, s4, 131072
    s_nop 0
    buffer_load_dwordx4 v250, s[16:19], s73 offen lds
    v_mfma_f32_16x16x32_bf16 v[172:175], v[208:211], a[44:47], v[172:175]
    s_add_u32 s73, s73, 32768
    s_add_u32 m0, s4, 135168
    s_nop 0
    buffer_load_dwordx4 v250, s[16:19], s73 offen lds
    v_mfma_f32_16x16x32_bf16 v[228:231], v[212:215], v[212:215], v[228:231]
    s_add_u32 s73, s73, 32768
    s_add_u32 m0, s4, 139264
    s_nop 0
    buffer_load_dwordx4 v250, s[16:19], s73 offen lds
    v_mfma_f32_16x16x32_bf16 v[232:235], v[236:239], v[212:215], v[232:235]
    s_add_u32 s73, s73, 32768
    s_add_u32 m0, s4, 143360
    s_nop 0
    buffer_load_dwordx4 v250, s[16:19], s73 offen lds
    s_waitcnt lgkmcnt(0)
    v_mfma_f32_16x16x32_bf16 v[216:219], a[48:51], v[236:239], v[216:219]
    v_mfma_f32_16x16x32_bf16 v[220:223], a[52:55], v[236:239], v[220:223]
    s_waitcnt vmcnt(13)
    s_barrier
    ds_read_b64_tr_b16 a[60:61], v249 offset:0
    v_mfma_f32_16x16x32_bf16 v[224:227], v[236:239], a[56:59], v[224:227]
    ds_read_b64_tr_b16 a[62:63], v249 offset:512
    v_mfma_f32_16x16x32_bf16 v[128:131], a[48:51], v[176:179], v[128:131]
    ds_read_b64_tr_b16 a[64:65], v249 offset:1024
    v_mfma_f32_16x16x32_bf16 v[132:135], a[52:55], v[176:179], v[132:135]
    ds_read_b64_tr_b16 a[66:67], v249 offset:1536
    v_mfma_f32_16x16x32_bf16 v[136:139], v[176:179], a[56:59], v[136:139]
    ds_read_b64_tr_b16 a[68:69], v249 offset:2048
    v_mfma_f32_16x16x32_bf16 v[140:143], a[48:51], v[180:183], v[140:143]
    ds_read_b64_tr_b16 a[70:71], v249 offset:2560
    v_mfma_f32_16x16x32_bf16 v[144:147], a[52:55], v[180:183], v[144:147]
    ds_read_b128 v[196:199], v241 offset:16384
    v_mfma_f32_16x16x32_bf16 v[148:151], v[180:183], a[56:59], v[148:151]
    ds_read_b128 v[200:203], v241 offset:20480
    v_mfma_f32_16x16x32_bf16 v[152:155], a[48:51], v[184:187], v[152:155]
    ds_read_b128 v[204:207], v241 offset:24576
    v_mfma_f32_16x16x32_bf16 v[156:159], a[52:55], v[184:187], v[156:159]
    ds_read_b128 v[208:211], v241 offset:28672
    v_mfma_f32_16x16x32_bf16 v[160:163], v[184:187], a[56:59], v[160:163]
    ds_read_b128 v[212:215], v245 offset:16384
    v_mfma_f32_16x16x32_bf16 v[164:167], a[48:51], v[188:191], v[164:167]
    s_add_u32 s72, s40, 9
    s_and_b32 s72, s72, 15
    s_mul_i32 s72, s72, 98304
    s_add_u32 m0, s59, 86016
    s_nop 0
    buffer_load_dwordx4 v254, s[20:23], s72 offen offset:0 lds
    v_mfma_f32_16x16x32_bf16 v[168:171], a[52:55], v[188:191], v[168:171]
    buffer_load_dwordx4 v254, s[20:23], s72 offen offset:1024 lds
    v_mfma_f32_16x16x32_bf16 v[172:175], v[188:191], a[56:59], v[172:175]
    buffer_load_dwordx4 v254, s[20:23], s72 offen offset:2048 lds
    v_mfma_f32_16x16x32_bf16 v[228:231], v[192:195], v[192:195], v[228:231]
    v_mfma_f32_16x16x32_bf16 v[232:235], v[236:239], v[192:195], v[232:235]
    s_waitcnt lgkmcnt(0)
    v_mfma_f32_16x16x32_bf16 v[216:219], a[60:63], v[236:239], v[216:219]
    v_mfma_f32_16x16x32_bf16 v[220:223], a[64:67], v[236:239], v[220:223]
    s_waitcnt vmcnt(13)
    s_barrier
    ds_read_b64_tr_b16 a[72:73], v248 offset:36864
    v_mfma_f32_16x16x32_bf16 v[224:227], v[236:239], a[68:71], v[224:227]
    ds_read_b64_tr_b16 a[74:75], v248 offset:37376
    v_mfma_f32_16x16x32_bf16 v[128:131], a[60:63], v[196:199], v[128:131]
    ds_read_b64_tr_b16 a[76:77], v248 offset:37888
    v_mfma_f32_16x16x32_bf16 v[132:135], a[64:67], v[196:199], v[132:135]
    ds_read_b64_tr_b16 a[78:79], v248 offset:38400
    v_mfma_f32_16x16x32_bf16 v[136:139], v[196:199], a[68:71], v[136:139]
    ds_read_b64_tr_b16 a[80:81], v248 offset:38912
    v_mfma_f32_16x16x32_bf16 v[140:143], a[60:63], v[200:203], v[140:143]
    ds_read_b64_tr_b16 a[82:83], v248 offset:39424
    v_mfma_f32_16x16x32_bf16 v[144:147], a[64:67], v[200:203], v[144:147]
    ds_read_b128 v[176:179], v242 offset:16384
    v_mfma_f32_16x16x32_bf16 v[148:151], v[200:203], a[68:71], v[148:151]
    ds_read_b128 v[180:183], v242 offset:20480
    v_mfma_f32_16x16x32_bf16 v[152:155], a[60:63], v[204:207], v[152:155]
    ds_read_b128 v[184:187], v242 offset:24576
    v_mfma_f32_16x16x32_bf16 v[156:159], a[64:67], v[204:207], v[156:159]
    ds_read_b128 v[188:191], v242 offset:28672
    v_mfma_f32_16x16x32_bf16 v[160:163], v[204:207], a[68:71], v[160:163]
    ds_read_b128 v[192:195], v246 offset:16384
    v_mfma_f32_16x16x32_bf16 v[164:167], a[60:63], v[208:211], v[164:167]
    s_mov_b32 m0, s4
    s_nop 0
    buffer_load_dwordx4 v253, s[44:47], s53 offen lds
    v_mfma_f32_16x16x32_bf16 v[168:171], a[64:67], v[208:211], v[168:171]
    s_add_u32 s72, s40, 10
    s_and_b32 s72, s72, 15
    s_mul_i32 s72, s72, 98304
    s_add_u32 m0, s59, 73728
    s_nop 0
    buffer_load_dwordx4 v254, s[20:23], s72 offen offset:0 lds
    v_mfma_f32_16x16x32_bf16 v[172:175], v[208:211], a[68:71], v[172:175]
    buffer_load_dwordx4 v254, s[20:23], s72 offen offset:1024 lds
    v_mfma_f32_16x16x32_bf16 v[228:231], v[212:215], v[212:215], v[228:231]
    buffer_load_dwordx4 v254, s[20:23], s72 offen offset:2048 lds
    v_mfma_f32_16x16x32_bf16 v[232:235], v[236:239], v[212:215], v[232:235]
    s_waitcnt lgkmcnt(0)
    v_mfma_f32_16x16x32_bf16 v[216:219], a[72:75], v[236:239], v[216:219]
    v_mfma_f32_16x16x32_bf16 v[220:223], a[76:79], v[236:239], v[220:223]
    s_waitcnt vmcnt(14)
    s_barrier
    ds_read_b64_tr_b16 a[84:85], v248 offset:24576
    v_mfma_f32_16x16x32_bf16 v[224:227], v[236:239], a[80:83], v[224:227]
    ds_read_b64_tr_b16 a[86:87], v248 offset:25088
    v_mfma_f32_16x16x32_bf16 v[128:131], a[72:75], v[176:179], v[128:131]
    ds_read_b64_tr_b16 a[88:89], v248 offset:25600
    v_mfma_f32_16x16x32_bf16 v[132:135], a[76:79], v[176:179], v[132:135]
    ds_read_b64_tr_b16 a[90:91], v248 offset:26112
    v_mfma_f32_16x16x32_bf16 v[136:139], v[176:179], a[80:83], v[136:139]
    ds_read_b64_tr_b16 a[92:93], v248 offset:26624
    v_mfma_f32_16x16x32_bf16 v[140:143], a[72:75], v[180:183], v[140:143]
    ds_read_b64_tr_b16 a[94:95], v248 offset:27136
    v_mfma_f32_16x16x32_bf16 v[144:147], a[76:79], v[180:183], v[144:147]
    ds_read_b128 v[196:199], v243 offset:16384
    v_mfma_f32_16x16x32_bf16 v[148:151], v[180:183], a[80:83], v[148:151]
    ds_read_b128 v[200:203], v243 offset:20480
    v_mfma_f32_16x16x32_bf16 v[152:155], a[72:75], v[184:187], v[152:155]
    ds_read_b128 v[204:207], v243 offset:24576
    v_mfma_f32_16x16x32_bf16 v[156:159], a[76:79], v[184:187], v[156:159]
    ds_read_b128 v[208:211], v243 offset:28672
    v_mfma_f32_16x16x32_bf16 v[160:163], v[184:187], a[80:83], v[160:163]
    ds_read_b128 v[212:215], v247 offset:16384
    v_mfma_f32_16x16x32_bf16 v[164:167], a[72:75], v[188:191], v[164:167]
    s_add_u32 s72, s40, 11
    s_and_b32 s72, s72, 15
    s_mul_i32 s72, s72, 98304
    s_add_u32 m0, s59, 61440
    s_nop 0
    buffer_load_dwordx4 v254, s[20:23], s72 offen offset:0 lds
    v_mfma_f32_16x16x32_bf16 v[168:171], a[76:79], v[188:191], v[168:171]
    buffer_load_dwordx4 v254, s[20:23], s72 offen offset:1024 lds
    v_mfma_f32_16x16x32_bf16 v[172:175], v[188:191], a[80:83], v[172:175]
    buffer_load_dwordx4 v254, s[20:23], s72 offen offset:2048 lds
    v_mfma_f32_16x16x32_bf16 v[228:231], v[192:195], v[192:195], v[228:231]
    v_mfma_f32_16x16x32_bf16 v[232:235], v[236:239], v[192:195], v[232:235]
    s_waitcnt lgkmcnt(0)
    v_mfma_f32_16x16x32_bf16 v[216:219], a[84:87], v[236:239], v[216:219]
    v_mfma_f32_16x16x32_bf16 v[220:223], a[88:91], v[236:239], v[220:223]
    s_waitcnt vmcnt(10)
    s_barrier
    ds_read_b64_tr_b16 a[96:97], v248 offset:12288
    ds_read_b64_tr_b16 a[98:99], v248 offset:12800
    v_mfma_f32_16x16x32_bf16 v[224:227], v[236:239], a[92:95], v[224:227]
    ds_read_b64_tr_b16 a[100:101], v248 offset:13312
    ds_read_b64_tr_b16 a[102:103], v248 offset:13824
    v_mfma_f32_16x16x32_bf16 v[128:131], a[84:87], v[196:199], v[128:131]
    ds_read_b64_tr_b16 a[104:105], v248 offset:14336
    v_mfma_f32_16x16x32_bf16 v[132:135], a[88:91], v[196:199], v[132:135]
    ds_read_b64_tr_b16 a[106:107], v248 offset:14848
    v_mfma_f32_16x16x32_bf16 v[136:139], v[196:199], a[92:95], v[136:139]
    ds_read_b128 v[176:179], v240 offset:32768
    v_mfma_f32_16x16x32_bf16 v[140:143], a[84:87], v[200:203], v[140:143]
    ds_read_b128 v[180:183], v240 offset:36864
    v_mfma_f32_16x16x32_bf16 v[144:147], a[88:91], v[200:203], v[144:147]
    ds_read_b128 v[184:187], v240 offset:40960
    v_mfma_f32_16x16x32_bf16 v[148:151], v[200:203], a[92:95], v[148:151]
    ds_read_b128 v[188:191], v240 offset:45056
    v_mfma_f32_16x16x32_bf16 v[152:155], a[84:87], v[204:207], v[152:155]
    ds_read_b128 v[192:195], v244 offset:32768
    v_mfma_f32_16x16x32_bf16 v[156:159], a[88:91], v[204:207], v[156:159]
    s_add_u32 s72, s40, 12
    s_and_b32 s72, s72, 15
    s_mul_i32 s72, s72, 98304
    s_add_u32 m0, s59, 49152
    s_nop 0
    buffer_load_dwordx4 v254, s[20:23], s72 offen offset:0 lds
    v_mfma_f32_16x16x32_bf16 v[160:163], v[204:207], a[92:95], v[160:163]
    buffer_load_dwordx4 v254, s[20:23], s72 offen offset:1024 lds
    v_mfma_f32_16x16x32_bf16 v[164:167], a[84:87], v[208:211], v[164:167]
    buffer_load_dwordx4 v254, s[20:23], s72 offen offset:2048 lds
    v_mfma_f32_16x16x32_bf16 v[168:171], a[88:91], v[208:211], v[168:171]
    s_lshl_b32 s73, s40, 6
    s_add_u32 s73, s73, 768
    s_and_b32 s73, s73, 1023
    s_add_u32 s73, s73, s52
    s_add_u32 m0, s4, 147456
    s_nop 0
    buffer_load_dwordx4 v250, s[16:19], s73 offen lds
    v_mfma_f32_16x16x32_bf16 v[172:175], v[208:211], a[92:95], v[172:175]
    s_add_u32 s73, s73, 32768
    s_add_u32 m0, s4, 151552
    s_nop 0
    buffer_load_dwordx4 v250, s[16:19], s73 offen lds
    v_mfma_f32_16x16x32_bf16 v[228:231], v[212:215], v[212:215], v[228:231]
    s_add_u32 s73, s73, 32768
    s_add_u32 m0, s4, 155648
    s_nop 0
    buffer_load_dwordx4 v250, s[16:19], s73 offen lds
    v_mfma_f32_16x16x32_bf16 v[232:235], v[236:239], v[212:215], v[232:235]
    s_add_u32 s73, s73, 32768
    s_add_u32 m0, s4, 159744
    s_nop 0
    buffer_load_dwordx4 v250, s[16:19], s73 offen lds
    s_mov_b64 exec, 1
    buffer_store_dwordx2 v[60:61], v6, s[8:11], s7 offen sc1
    s_mov_b64 exec, -1
    s_waitcnt lgkmcnt(0)
    v_mfma_f32_16x16x32_bf16 v[216:219], a[96:99], v[236:239], v[216:219]
    v_mfma_f32_16x16x32_bf16 v[220:223], a[100:103], v[236:239], v[220:223]
    s_waitcnt vmcnt(15)
    s_barrier
    ds_read_b64_tr_b16 a[108:109], v249 offset:36864
    v_mfma_f32_16x16x32_bf16 v[224:227], v[236:239], a[104:107], v[224:227]
    ds_read_b64_tr_b16 a[110:111], v249 offset:37376
    v_mfma_f32_16x16x32_bf16 v[128:131], a[96:99], v[176:179], v[128:131]
    ds_read_b64_tr_b16 a[112:113], v249 offset:37888
    v_mfma_f32_16x16x32_bf16 v[132:135], a[100:103], v[176:179], v[132:135]
    ds_read_b64_tr_b16 a[114:115], v249 offset:38400
    v_mfma_f32_16x16x32_bf16 v[136:139], v[176:179], a[104:107], v[136:139]
    ds_read_b64_tr_b16 a[116:117], v249 offset:38912
    v_mfma_f32_16x16x32_bf16 v[140:143], a[96:99], v[180:183], v[140:143]
    ds_read_b64_tr_b16 a[118:119], v249 offset:39424
    v_mfma_f32_16x16x32_bf16 v[144:147], a[100:103], v[180:183], v[144:147]
    ds_read_b128 v[196:199], v241 offset:32768
    v_mfma_f32_16x16x32_bf16 v[148:151], v[180:183], a[104:107], v[148:151]
    ds_read_b128 v[200:203], v241 offset:36864
    v_mfma_f32_16x16x32_bf16 v[152:155], a[96:99], v[184:187], v[152:155]
    ds_read_b128 v[204:207], v241 offset:40960
    v_mfma_f32_16x16x32_bf16 v[156:159], a[100:103], v[184:187], v[156:159]
    ds_read_b128 v[208:211], v241 offset:45056
    v_mfma_f32_16x16x32_bf16 v[160:163], v[184:187], a[104:107], v[160:163]
    ds_read_b128 v[212:215], v245 offset:32768
    v_mfma_f32_16x16x32_bf16 v[164:167], a[96:99], v[188:191], v[164:167]
    s_add_u32 s72, s40, 13
    s_and_b32 s72, s72, 15
    s_mul_i32 s72, s72, 98304
    s_add_u32 m0, s59, 36864
    s_nop 0
    buffer_load_dwordx4 v254, s[20:23], s72 offen offset:0 lds
    v_mfma_f32_16x16x32_bf16 v[168:171], a[100:103], v[188:191], v[168:171]
    buffer_load_dwordx4 v254, s[20:23], s72 offen offset:1024 lds
    v_mfma_f32_16x16x32_bf16 v[172:175], v[188:191], a[104:107], v[172:175]
    buffer_load_dwordx4 v254, s[20:23], s72 offen offset:2048 lds
    v_mfma_f32_16x16x32_bf16 v[228:231], v[192:195], v[192:195], v[228:231]
    v_mfma_f32_16x16x32_bf16 v[232:235], v[236:239], v[192:195], v[232:235]
    s_waitcnt lgkmcnt(0)
    v_mfma_f32_16x16x32_bf16 v[216:219], a[108:111], v[236:239], v[216:219]
    v_mfma_f32_16x16x32_bf16 v[220:223], a[112:115], v[236:239], v[220:223]
    s_waitcnt vmcnt(14)
    s_barrier
    ds_read_b64_tr_b16 a[120:121], v249 offset:24576
    v_mfma_f32_16x16x32_bf16 v[224:227], v[236:239], a[116:119], v[224:227]
    ds_read_b64_tr_b16 a[122:123], v249 offset:25088
    v_mfma_f32_16x16x32_bf16 v[128:131], a[108:111], v[196:199], v[128:131]
    ds_read_b64_tr_b16 a[124:125], v249 offset:25600
    v_mfma_f32_16x16x32_bf16 v[132:135], a[112:115], v[196:199], v[132:135]
    ds_read_b64_tr_b16 a[126:127], v249 offset:26112
    v_mfma_f32_16x16x32_bf16 v[136:139], v[196:199], a[116:119], v[136:139]
    ds_read_b64_tr_b16 a[128:129], v249 offset:26624
    v_mfma_f32_16x16x32_bf16 v[140:143], a[108:111], v[200:203], v[140:143]
    ds_read_b64_tr_b16 a[130:131], v249 offset:27136
    v_mfma_f32_16x16x32_bf16 v[144:147], a[112:115], v[200:203], v[144:147]
    ds_read_b128 v[176:179], v242 offset:32768
    v_mfma_f32_16x16x32_bf16 v[148:151], v[200:203], a[116:119], v[148:151]
    ds_read_b128 v[180:183], v242 offset:36864
    v_mfma_f32_16x16x32_bf16 v[152:155], a[108:111], v[204:207], v[152:155]
    ds_read_b128 v[184:187], v242 offset:40960
    v_mfma_f32_16x16x32_bf16 v[156:159], a[112:115], v[204:207], v[156:159]
    ds_read_b128 v[188:191], v242 offset:45056
    v_mfma_f32_16x16x32_bf16 v[160:163], v[204:207], a[116:119], v[160:163]
    ds_read_b128 v[192:195], v246 offset:32768
    v_mfma_f32_16x16x32_bf16 v[164:167], a[108:111], v[208:211], v[164:167]
    s_add_u32 s72, s40, 14
    s_and_b32 s72, s72, 15
    s_mul_i32 s72, s72, 98304
    s_add_u32 m0, s59, 24576
    s_nop 0
    buffer_load_dwordx4 v254, s[20:23], s72 offen offset:0 lds
    v_mfma_f32_16x16x32_bf16 v[168:171], a[112:115], v[208:211], v[168:171]
    buffer_load_dwordx4 v254, s[20:23], s72 offen offset:1024 lds
    v_mfma_f32_16x16x32_bf16 v[172:175], v[208:211], a[116:119], v[172:175]
    buffer_load_dwordx4 v254, s[20:23], s72 offen offset:2048 lds
    v_mfma_f32_16x16x32_bf16 v[228:231], v[212:215], v[212:215], v[228:231]
    ds_read_b64_tr_b16 v[64:65], v252 offset:0
    v_mfma_f32_16x16x32_bf16 v[232:235], v[236:239], v[212:215], v[232:235]
    ds_read_b64_tr_b16 v[66:67], v252 offset:512
    s_waitcnt lgkmcnt(2)
    v_mfma_f32_16x16x32_bf16 v[216:219], a[120:123], v[236:239], v[216:219]
    v_mfma_f32_16x16x32_bf16 v[220:223], a[124:127], v[236:239], v[220:223]
    s_waitcnt vmcnt(14)
    s_barrier
    ds_read_b64_tr_b16 a[132:133], v249 offset:12288
    ds_read_b64_tr_b16 a[134:135], v249 offset:12800
    v_mfma_f32_16x16x32_bf16 v[224:227], v[236:239], a[128:131], v[224:227]
    ds_read_b64_tr_b16 a[136:137], v249 offset:13312
    ds_read_b64_tr_b16 a[138:139], v249 offset:13824
    v_mfma_f32_16x16x32_bf16 v[128:131], a[120:123], v[176:179], v[128:131]
    ds_read_b64_tr_b16 a[140:141], v249 offset:14336
    v_mfma_f32_16x16x32_bf16 v[132:135], a[124:127], v[176:179], v[132:135]
    ds_read_b64_tr_b16 a[142:143], v249 offset:14848
    v_mfma_f32_16x16x32_bf16 v[136:139], v[176:179], a[128:131], v[136:139]
    ds_read_b128 v[196:199], v243 offset:32768
    v_mfma_f32_16x16x32_bf16 v[140:143], a[120:123], v[180:183], v[140:143]
    ds_read_b128 v[200:203], v243 offset:36864
    v_mfma_f32_16x16x32_bf16 v[144:147], a[124:127], v[180:183], v[144:147]
    ds_read_b128 v[204:207], v243 offset:40960
    v_mfma_f32_16x16x32_bf16 v[148:151], v[180:183], a[128:131], v[148:151]
    ds_read_b128 v[208:211], v243 offset:45056
    v_mfma_f32_16x16x32_bf16 v[152:155], a[120:123], v[184:187], v[152:155]
    ds_read_b128 v[212:215], v247 offset:32768
    v_mfma_f32_16x16x32_bf16 v[156:159], a[124:127], v[184:187], v[156:159]
    s_add_u32 s72, s40, 15
    s_and_b32 s72, s72, 15
    s_mul_i32 s72, s72, 98304
    s_add_u32 m0, s59, 12288
    s_nop 0
    buffer_load_dwordx4 v254, s[20:23], s72 offen offset:0 lds
    v_mfma_f32_16x16x32_bf16 v[160:163], v[184:187], a[128:131], v[160:163]
    buffer_load_dwordx4 v254, s[20:23], s72 offen offset:1024 lds
    v_mfma_f32_16x16x32_bf16 v[164:167], a[120:123], v[188:191], v[164:167]
    buffer_load_dwordx4 v254, s[20:23], s72 offen offset:2048 lds
    v_mfma_f32_16x16x32_bf16 v[168:171], a[124:127], v[188:191], v[168:171]
    buffer_load_dwordx4 v[100:103], v11, s[16:19], 0 offen offset:0
    v_mfma_f32_16x16x32_bf16 v[172:175], v[188:191], a[128:131], v[172:175]
    buffer_load_dwordx4 v[124:127], v11, s[16:19], 0 offen offset:64
    v_mfma_f32_16x16x32_bf16 v[228:231], v[192:195], v[192:195], v[228:231]
    s_add_u32 s79, s64, 65536
    buffer_load_dword v96, v9, s[8:11], s79 offen sc1
    v_mfma_f32_16x16x32_bf16 v[232:235], v[236:239], v[192:195], v[232:235]
    s_add_u32 s80, s60, 294912
    buffer_load_dword v96, v10, s[8:11], s80 offen sc1
    s_waitcnt lgkmcnt(0)
    v_mfma_f32_16x16x32_bf16 v[216:219], a[132:135], v[236:239], v[216:219]
    v_mfma_f32_16x16x32_bf16 v[220:223], a[136:139], v[236:239], v[220:223]
    s_waitcnt vmcnt(14)
    s_barrier
    ds_read_b64_tr_b16 a[144:145], v249 offset:0
    ds_read_b64_tr_b16 a[146:147], v249 offset:512
    v_mfma_f32_16x16x32_bf16 v[224:227], v[236:239], a[140:143], v[224:227]
    ds_read_b64_tr_b16 a[148:149], v249 offset:1024
    ds_read_b64_tr_b16 a[150:151], v249 offset:1536
    v_mfma_f32_16x16x32_bf16 v[128:131], a[132:135], v[196:199], v[128:131]
    ds_read_b64_tr_b16 a[152:153], v249 offset:2048
    ds_read_b64_tr_b16 a[154:155], v249 offset:2560
    v_mfma_f32_16x16x32_bf16 v[132:135], a[136:139], v[196:199], v[132:135]
    ds_read_b128 v[176:179], v240 offset:49152
    v_mfma_f32_16x16x32_bf16 v[136:139], v[196:199], a[140:143], v[136:139]
    ds_read_b128 v[180:183], v240 offset:53248
    v_mfma_f32_16x16x32_bf16 v[140:143], a[132:135], v[200:203], v[140:143]
    ds_read_b128 v[184:187], v240 offset:57344
    v_mfma_f32_16x16x32_bf16 v[144:147], a[136:139], v[200:203], v[144:147]
    ds_read_b128 v[188:191], v240 offset:61440
    v_mfma_f32_16x16x32_bf16 v[148:151], v[200:203], a[140:143], v[148:151]
    ds_read_b128 v[192:195], v244 offset:49152
    v_mfma_f32_16x16x32_bf16 v[152:155], a[132:135], v[204:207], v[152:155]
    s_lshl_b32 s72, s38, 7
    s_add_u32 s72, s72, 524288
    buffer_load_dwordx2 v[62:63], v71, s[8:11], s72 offen sc1
    v_mfma_f32_16x16x32_bf16 v[156:159], a[136:139], v[204:207], v[156:159]
    s_add_u32 s81, s63, 0
    buffer_store_dwordx4 v[56:59], v6, s[8:11], s81 offen offset:0 sc1
    v_mfma_f32_16x16x32_bf16 v[160:163], v[204:207], a[140:143], v[160:163]
    buffer_store_dwordx4 v[56:59], v6, s[8:11], s81 offen offset:1024 sc1
    v_mfma_f32_16x16x32_bf16 v[164:167], a[132:135], v[208:211], v[164:167]
    s_add_u32 s82, s62, 32768
    buffer_store_dwordx4 v[56:59], v6, s[8:11], s82 offen sc1
    v_mfma_f32_16x16x32_bf16 v[168:171], a[136:139], v[208:211], v[168:171]
    s_lshl_b32 s72, s36, 15
    s_add_u32 s72, s72, 393216
    s_lshl_b32 s73, s36, 12
    s_add_u32 m0, s73, 81920
    s_nop 0
    buffer_load_dwordx4 v253, s[24:27], s72 offen lds
    v_mfma_f32_16x16x32_bf16 v[172:175], v[208:211], a[140:143], v[172:175]
    s_add_u32 s72, s72, 8192
    s_add_u32 m0, s73, 82944
    s_nop 0
    buffer_load_dwordx4 v253, s[24:27], s72 offen lds
    v_mfma_f32_16x16x32_bf16 v[228:231], v[212:215], v[212:215], v[228:231]
    s_add_u32 s72, s72, 8192
    s_add_u32 m0, s73, 83968
    s_nop 0
    buffer_load_dwordx4 v253, s[24:27], s72 offen lds
    v_mfma_f32_16x16x32_bf16 v[232:235], v[236:239], v[212:215], v[232:235]
    s_add_u32 s72, s72, 8192
    s_add_u32 m0, s73, 84992
    s_nop 0
    buffer_load_dwordx4 v253, s[24:27], s72 offen lds
    s_waitcnt lgkmcnt(0)
    v_mfma_f32_16x16x32_bf16 v[216:219], a[144:147], v[236:239], v[216:219]
    v_mfma_f32_16x16x32_bf16 v[220:223], a[148:151], v[236:239], v[220:223]
    s_waitcnt vmcnt(18)
    s_barrier
    ds_read_b64_tr_b16 a[156:157], v248 offset:36864
    v_mfma_f32_16x16x32_bf16 v[224:227], v[236:239], a[152:155], v[224:227]
    ds_read_b64_tr_b16 a[158:159], v248 offset:37376
    v_mfma_f32_16x16x32_bf16 v[128:131], a[144:147], v[176:179], v[128:131]
    ds_read_b64_tr_b16 a[160:161], v248 offset:37888
    v_mfma_f32_16x16x32_bf16 v[132:135], a[148:151], v[176:179], v[132:135]
    ds_read_b64_tr_b16 a[162:163], v248 offset:38400
    v_mfma_f32_16x16x32_bf16 v[136:139], v[176:179], a[152:155], v[136:139]
    ds_read_b64_tr_b16 a[164:165], v248 offset:38912
    v_mfma_f32_16x16x32_bf16 v[140:143], a[144:147], v[180:183], v[140:143]
    ds_read_b64_tr_b16 a[166:167], v248 offset:39424
    v_mfma_f32_16x16x32_bf16 v[144:147], a[148:151], v[180:183], v[144:147]
    ds_read_b128 v[196:199], v241 offset:49152
    v_mfma_f32_16x16x32_bf16 v[148:151], v[180:183], a[152:155], v[148:151]
    ds_read_b128 v[200:203], v241 offset:53248
    v_mfma_f32_16x16x32_bf16 v[152:155], a[144:147], v[184:187], v[152:155]
    ds_read_b128 v[204:207], v241 offset:57344
    v_mfma_f32_16x16x32_bf16 v[156:159], a[148:151], v[184:187], v[156:159]
    ds_read_b128 v[208:211], v241 offset:61440
    v_mfma_f32_16x16x32_bf16 v[160:163], v[184:187], a[152:155], v[160:163]
    ds_read_b128 v[212:215], v245 offset:49152
    v_mfma_f32_16x16x32_bf16 v[164:167], a[144:147], v[188:191], v[164:167]
    s_lshl_b32 s72, s36, 15
    s_add_u32 s72, s72, 262144
    s_lshl_b32 s73, s36, 12
    s_add_u32 m0, s73, 65536
    s_nop 0
    buffer_load_dwordx4 v253, s[24:27], s72 offen lds
    v_mfma_f32_16x16x32_bf16 v[168:171], a[148:151], v[188:191], v[168:171]
    s_add_u32 s72, s72, 8192
    s_add_u32 m0, s73, 66560
    s_nop 0
    buffer_load_dwordx4 v253, s[24:27], s72 offen lds
    v_mfma_f32_16x16x32_bf16 v[172:175], v[188:191], a[152:155], v[172:175]
    s_add_u32 s72, s72, 8192
    s_add_u32 m0, s73, 67584
    s_nop 0
    buffer_load_dwordx4 v253, s[24:27], s72 offen lds
    v_mfma_f32_16x16x32_bf16 v[228:231], v[192:195], v[192:195], v[228:231]
    s_add_u32 s72, s72, 8192
    s_add_u32 m0, s73, 68608
    s_nop 0
    buffer_load_dwordx4 v253, s[24:27], s72 offen lds
    v_mfma_f32_16x16x32_bf16 v[232:235], v[236:239], v[192:195], v[232:235]
    s_waitcnt lgkmcnt(0)
    v_mfma_f32_16x16x32_bf16 v[216:219], a[156:159], v[236:239], v[216:219]
    v_mfma_f32_16x16x32_bf16 v[220:223], a[160:163], v[236:239], v[220:223]
    s_waitcnt vmcnt(19)
    s_barrier
    ds_read_b64_tr_b16 a[168:169], v248 offset:24576
    v_mfma_f32_16x16x32_bf16 v[224:227], v[236:239], a[164:167], v[224:227]
    ds_read_b64_tr_b16 a[170:171], v248 offset:25088
    v_mfma_f32_16x16x32_bf16 v[128:131], a[156:159], v[196:199], v[128:131]
    ds_read_b64_tr_b16 a[172:173], v248 offset:25600
    v_mfma_f32_16x16x32_bf16 v[132:135], a[160:163], v[196:199], v[132:135]
    ds_read_b64_tr_b16 a[174:175], v248 offset:26112
    v_mfma_f32_16x16x32_bf16 v[136:139], v[196:199], a[164:167], v[136:139]
    ds_read_b64_tr_b16 a[176:177], v248 offset:26624
    v_mfma_f32_16x16x32_bf16 v[140:143], a[156:159], v[200:203], v[140:143]
    ds_read_b64_tr_b16 a[178:179], v248 offset:27136
    v_mfma_f32_16x16x32_bf16 v[144:147], a[160:163], v[200:203], v[144:147]
    ds_read_b128 v[176:179], v242 offset:49152
    v_mfma_f32_16x16x32_bf16 v[148:151], v[200:203], a[164:167], v[148:151]
    ds_read_b128 v[180:183], v242 offset:53248
    v_mfma_f32_16x16x32_bf16 v[152:155], a[156:159], v[204:207], v[152:155]
    ds_read_b128 v[184:187], v242 offset:57344
    v_mfma_f32_16x16x32_bf16 v[156:159], a[160:163], v[204:207], v[156:159]
    ds_read_b128 v[188:191], v242 offset:61440
    v_mfma_f32_16x16x32_bf16 v[160:163], v[204:207], a[164:167], v[160:163]
    ds_read_b128 v[192:195], v246 offset:49152
    v_mfma_f32_16x16x32_bf16 v[164:167], a[156:159], v[208:211], v[164:167]
    s_lshl_b32 s72, s36, 15
    s_add_u32 s72, s72, 131072
    s_lshl_b32 s73, s36, 12
    s_add_u32 m0, s73, 49152
    s_nop 0
    buffer_load_dwordx4 v253, s[24:27], s72 offen lds
    v_mfma_f32_16x16x32_bf16 v[168:171], a[160:163], v[208:211], v[168:171]
    s_add_u32 s72, s72, 8192
    s_add_u32 m0, s73, 50176
    s_nop 0
    buffer_load_dwordx4 v253, s[24:27], s72 offen lds
    v_mfma_f32_16x16x32_bf16 v[172:175], v[208:211], a[164:167], v[172:175]
    s_add_u32 s72, s72, 8192
    s_add_u32 m0, s73, 51200
    s_nop 0
    buffer_load_dwordx4 v253, s[24:27], s72 offen lds
    v_mfma_f32_16x16x32_bf16 v[228:231], v[212:215], v[212:215], v[228:231]
    s_add_u32 s72, s72, 8192
    s_add_u32 m0, s73, 52224
    s_nop 0
    buffer_load_dwordx4 v253, s[24:27], s72 offen lds
    v_mfma_f32_16x16x32_bf16 v[232:235], v[236:239], v[212:215], v[232:235]
    s_waitcnt lgkmcnt(0)
    v_mfma_f32_16x16x32_bf16 v[216:219], a[168:171], v[236:239], v[216:219]
    v_mfma_f32_16x16x32_bf16 v[220:223], a[172:175], v[236:239], v[220:223]
    s_waitcnt vmcnt(20)
    s_barrier
    ds_read_b64_tr_b16 a[180:181], v248 offset:12288
    v_mfma_f32_16x16x32_bf16 v[224:227], v[236:239], a[176:179], v[224:227]
    ds_read_b64_tr_b16 a[182:183], v248 offset:12800
    v_mfma_f32_16x16x32_bf16 v[128:131], a[168:171], v[176:179], v[128:131]
    ds_read_b64_tr_b16 a[184:185], v248 offset:13312
    v_mfma_f32_16x16x32_bf16 v[132:135], a[172:175], v[176:179], v[132:135]
    ds_read_b64_tr_b16 a[186:187], v248 offset:13824
    v_mfma_f32_16x16x32_bf16 v[136:139], v[176:179], a[176:179], v[136:139]
    ds_read_b64_tr_b16 a[188:189], v248 offset:14336
    v_mfma_f32_16x16x32_bf16 v[140:143], a[168:171], v[180:183], v[140:143]
    ds_read_b64_tr_b16 a[190:191], v248 offset:14848
    v_mfma_f32_16x16x32_bf16 v[144:147], a[172:175], v[180:183], v[144:147]
    ds_read_b128 v[196:199], v243 offset:49152
    v_mfma_f32_16x16x32_bf16 v[148:151], v[180:183], a[176:179], v[148:151]
    ds_read_b128 v[200:203], v243 offset:53248
    v_mfma_f32_16x16x32_bf16 v[152:155], a[168:171], v[184:187], v[152:155]
    ds_read_b128 v[204:207], v243 offset:57344
    v_mfma_f32_16x16x32_bf16 v[156:159], a[172:175], v[184:187], v[156:159]
    ds_read_b128 v[208:211], v243 offset:61440
    v_mfma_f32_16x16x32_bf16 v[160:163], v[184:187], a[176:179], v[160:163]
    ds_read_b128 v[212:215], v247 offset:49152
    v_mfma_f32_16x16x32_bf16 v[164:167], a[168:171], v[188:191], v[164:167]
    s_lshl_b32 s72, s36, 15
    s_add_u32 s72, s72, 0
    s_lshl_b32 s73, s36, 12
    s_add_u32 m0, s73, 32768
    s_nop 0
    buffer_load_dwordx4 v253, s[24:27], s72 offen lds
    v_mfma_f32_16x16x32_bf16 v[168:171], a[172:175], v[188:191], v[168:171]
    s_add_u32 s72, s72, 8192
    s_add_u32 m0, s73, 33792
    s_nop 0
    buffer_load_dwordx4 v253, s[24:27], s72 offen lds
    v_mfma_f32_16x16x32_bf16 v[172:175], v[188:191], a[176:179], v[172:175]
    s_add_u32 s72, s72, 8192
    s_add_u32 m0, s73, 34816
    s_nop 0
    buffer_load_dwordx4 v253, s[24:27], s72 offen lds
    v_mfma_f32_16x16x32_bf16 v[228:231], v[192:195], v[192:195], v[228:231]
    s_add_u32 s72, s72, 8192
    s_add_u32 m0, s73, 35840
    s_nop 0
    buffer_load_dwordx4 v253, s[24:27], s72 offen lds
    v_mfma_f32_16x16x32_bf16 v[232:235], v[236:239], v[192:195], v[232:235]
    s_waitcnt lgkmcnt(0)
    v_mfma_f32_16x16x32_bf16 v[216:219], a[180:183], v[236:239], v[216:219]
    v_mfma_f32_16x16x32_bf16 v[220:223], a[184:187], v[236:239], v[220:223]
    s_waitcnt lgkmcnt(15)
    buffer_store_dwordx4 v[64:67], v6, s[8:11], s56 offen sc1
    v_mfma_f32_16x16x32_bf16 v[224:227], v[236:239], a[188:191], v[224:227]
    s_mov_b64 s[20:21], s[50:51]
    s_add_u32 s76, s40, 0
    s_and_b32 s76, s76, 15
    s_mul_i32 s76, s76, 98304
    s_add_u32 m0, s59, 98304
    s_nop 0
    buffer_load_dwordx4 v0, s[20:23], s76 offen offset:0 lds
    v_mfma_f32_16x16x32_bf16 v[128:131], a[180:183], v[196:199], v[128:131]
    buffer_load_dwordx4 v0, s[20:23], s76 offen offset:1024 lds
    v_mfma_f32_16x16x32_bf16 v[132:135], a[184:187], v[196:199], v[132:135]
    buffer_load_dwordx4 v0, s[20:23], s76 offen offset:2048 lds
    v_mfma_f32_16x16x32_bf16 v[136:139], v[196:199], a[188:191], v[136:139]
    s_add_u32 s76, s40, 1
    s_and_b32 s76, s76, 15
    s_mul_i32 s76, s76, 98304
    s_add_u32 m0, s59, 110592
    s_nop 0
    buffer_load_dwordx4 v0, s[20:23], s76 offen offset:0 lds
    v_mfma_f32_16x16x32_bf16 v[140:143], a[180:183], v[200:203], v[140:143]
    buffer_load_dwordx4 v0, s[20:23], s76 offen offset:1024 lds
    v_mfma_f32_16x16x32_bf16 v[144:147], a[184:187], v[200:203], v[144:147]
    buffer_load_dwordx4 v0, s[20:23], s76 offen offset:2048 lds
    v_mfma_f32_16x16x32_bf16 v[148:151], v[200:203], a[188:191], v[148:151]
    v_mfma_f32_16x16x32_bf16 v[152:155], a[180:183], v[204:207], v[152:155]
    v_mfma_f32_16x16x32_bf16 v[156:159], a[184:187], v[204:207], v[156:159]
    v_mfma_f32_16x16x32_bf16 v[160:163], v[204:207], a[188:191], v[160:163]
    v_mfma_f32_16x16x32_bf16 v[164:167], a[180:183], v[208:211], v[164:167]
    v_mfma_f32_16x16x32_bf16 v[168:171], a[184:187], v[208:211], v[168:171]
    v_mfma_f32_16x16x32_bf16 v[172:175], v[208:211], a[188:191], v[172:175]
    v_mfma_f32_16x16x32_bf16 v[228:231], v[212:215], v[212:215], v[228:231]
    v_mfma_f32_16x16x32_bf16 v[232:235], v[236:239], v[212:215], v[232:235]
    s_cmp_lt_u32 s36, 2
    s_cselect_b64 s[54:55], 0, -1
    s_mov_b32 s44, 0x22222222
    s_mov_b32 s45, s44
    s_lshl_b64 s[46:47], s[44:45], 1
    s_lshl_b64 s[48:49], s[44:45], 2
    s_nop 0
    v_cndmask_b32 v228, v228, v229, s[44:45]
    v_cndmask_b32 v228, v228, v230, s[46:47]
    v_cndmask_b32 v228, v228, v231, s[48:49]
    v_mul_f32 v232, 0x3b000000, v232
    v_mul_f32 v228, 0x3b000000, v228
    v_fma_f32 v228, -v232, v232, v228
    v_max_f32 v228, 0, v228
    v_cvt_pk_bf16_f32 v232, v228, -v232
    v_lshlrev_b32 v229, 16, v232
    v_add_f32 v229, 0x3727c5ac, v229
    v_cvt_pk_bf16_f32 v229, v229, v229
    v_lshlrev_b32 v229, 16, v229
    v_sqrt_f32 v229, v229
    v_and_b32 v235, 0xffff0000, v232
    v_cvt_pk_bf16_f32 v229, v229, v229
    v_lshlrev_b32 v229, 16, v229
    v_rcp_f32 v234, v229
    v_cndmask_b32 v12, v216, v217, s[44:45]
    v_cndmask_b32 v12, v12, v218, s[46:47]
    v_cndmask_b32 v12, v12, v219, s[48:49]
    v_cndmask_b32 v13, v220, v221, s[44:45]
    v_cndmask_b32 v13, v13, v222, s[46:47]
    v_cndmask_b32 v13, v13, v223, s[48:49]
    v_mov_b32 v120, v224
    s_mov_b32 exec_lo, 0x00f0000f
    s_mov_b32 exec_hi, 0xf0000f00
    ds_write_b64 v69, v[234:235] offset:24576
    s_mov_b64 exec, -1
    s_waitcnt vmcnt(26)
    v_xor_b32 v4, v62, v60
    v_xor_b32 v3, v63, v61
    v_lshrrev_b32 v5, 8, v3
    v_or_b32 v4, v4, v5
    v_cmp_ne_u32 vcc, 0, v4
    s_nop 0
    s_cbranch_vccnz L_retry_1
L_back_2:
    v_and_b32 v3, 15, v3
    v_cmp_ne_u32 vcc, 0, v3
    s_waitcnt lgkmcnt(0)
    s_barrier
    ds_read_b64 v[188:189], v68 offset:24960
    ds_read_b64 v[190:191], v70 offset:24960
    ds_read_b64 v[184:185], v68 offset:24832
    ds_read_b64 v[186:187], v70 offset:24832
    ds_read_b64 v[180:181], v68 offset:24704
    ds_read_b64 v[182:183], v70 offset:24704
    ds_read_b64 v[176:177], v68 offset:24576
    ds_read_b64 v[178:179], v70 offset:24576
    s_cbranch_vccnz L_slow
    s_add_u32 s76, s40, 2
    s_and_b32 s76, s76, 15
    s_mul_i32 s76, s76, 98304
    s_add_u32 m0, s59, 122880
    s_nop 0
    buffer_load_dwordx4 v0, s[20:23], s76 offen offset:0 lds
    s_waitcnt lgkmcnt(6)
    v_fmac_f32_dpp v168, v13, v189 row_newbcast:0 row_mask:0xf bank_mask:0xf
    v_fmac_f32_dpp v169, v13, v189 row_newbcast:1 row_mask:0xf bank_mask:0xf
    v_fmac_f32_dpp v170, v13, v189 row_newbcast:2 row_mask:0xf bank_mask:0xf
    v_fmac_f32_dpp v171, v13, v189 row_newbcast:3 row_mask:0xf bank_mask:0xf
    v_mul_f32 v168, v188, v168
    v_mul_f32 v169, v188, v169
    v_mul_f32 v170, v188, v170
    v_mul_f32 v171, v188, v171
    v_cvt_pk_bf16_f32 v72, v168, v169
    v_cvt_pk_bf16_f32 v73, v170, v171
    v_fmac_f32_dpp v164, v12, v189 row_newbcast:0 row_mask:0xf bank_mask:0xf
    v_fmac_f32_dpp v165, v12, v189 row_newbcast:1 row_mask:0xf bank_mask:0xf
    v_fmac_f32_dpp v166, v12, v189 row_newbcast:2 row_mask:0xf bank_mask:0xf
    v_fmac_f32_dpp v167, v12, v189 row_newbcast:3 row_mask:0xf bank_mask:0xf
    v_cvt_pk_bf16_f32 v222, v164, v165
    v_cvt_pk_bf16_f32 v223, v166, v167
    buffer_load_dwordx4 v0, s[20:23], s76 offen offset:1024 lds
    v_mul_f32 v247, s43, v188
    v_fmac_f32_dpp v172, v191, v120 row_newbcast:0 row_mask:0xf bank_mask:0xf
    v_fmac_f32_dpp v173, v191, v120 row_newbcast:1 row_mask:0xf bank_mask:0xf
    v_fmac_f32_dpp v174, v191, v120 row_newbcast:2 row_mask:0xf bank_mask:0xf
    v_fmac_f32_dpp v175, v191, v120 row_newbcast:3 row_mask:0xf bank_mask:0xf
    v_mul_f32_dpp v172, v190, v172 row_newbcast:0 row_mask:0xf bank_mask:0xf
    v_mul_f32_dpp v173, v190, v173 row_newbcast:1 row_mask:0xf bank_mask:0xf
    v_mul_f32_dpp v174, v190, v174 row_newbcast:2 row_mask:0xf bank_mask:0xf
    v_mul_f32_dpp v175, v190, v175 row_newbcast:3 row_mask:0xf bank_mask:0xf
    v_cvt_pk_bf16_f32 v94, v172, v173
    v_cvt_pk_bf16_f32 v95, v174, v175
    v_mov_b32 v78, v94
    v_mov_b32 v79, v95
    s_waitcnt vmcnt(25)
    s_add_u32 s73, s62, 0x20000
    s_mov_b32 exec_lo, 0xff00ff00
    s_mov_b32 exec_hi, 0xff00ff00
    buffer_store_dwordx4 v[72:75], v6, s[8:11], s62 offen sc1
    s_mov_b32 exec_lo, 0
    s_mov_b32 exec_hi, -1
    buffer_store_dwordx4 v[76:79], v6, s[8:11], s73 offen sc1
    s_mov_b32 exec_lo, -1
    buffer_load_dwordx4 v0, s[20:23], s76 offen offset:2048 lds
    s_add_u32 s76, s40, 3
    s_and_b32 s76, s76, 15
    s_mul_i32 s76, s76, 98304
    s_add_u32 m0, s59, 135168
    s_waitcnt vmcnt(24)
    ds_read_b64_tr_b16 v[24:25], v97 offset:49152
    s_add_u32 s83, s63, 0
    buffer_load_dword v96, v9, s[8:11], s83 offen sc1
    s_waitcnt lgkmcnt(5)
    ds_read_b64_tr_b16 v[26:27], v97 offset:49664
    v_fmac_f32_dpp v156, v13, v185 row_newbcast:0 row_mask:0xf bank_mask:0xf
    v_fmac_f32_dpp v157, v13, v185 row_newbcast:1 row_mask:0xf bank_mask:0xf
    v_fmac_f32_dpp v158, v13, v185 row_newbcast:2 row_mask:0xf bank_mask:0xf
    v_fmac_f32_dpp v159, v13, v185 row_newbcast:3 row_mask:0xf bank_mask:0xf
    ds_read_b64_tr_b16 v[28:29], v97 offset:49160
    v_mul_f32 v156, v184, v156
    v_mul_f32 v157, v184, v157
    v_mul_f32 v158, v184, v158
    v_mul_f32 v159, v184, v159
    ds_read_b64_tr_b16 v[30:31], v97 offset:49672
    v_cvt_pk_bf16_f32 v228, v156, v157
    v_cvt_pk_bf16_f32 v229, v158, v159
    v_fmac_f32_dpp v152, v12, v185 row_newbcast:0 row_mask:0xf bank_mask:0xf
    buffer_load_dwordx4 v0, s[20:23], s76 offen offset:0 lds
    ds_read_b64_tr_b16 v[32:33], v98 offset:49152
    v_mfma_f32_16x16x16_bf16 v[168:171], v[228:229], v[222:223], v[16:19]
    s_waitcnt lgkmcnt(7)
    v_fmac_f32_dpp v153, v12, v185 row_newbcast:1 row_mask:0xf bank_mask:0xf
    v_fmac_f32_dpp v154, v12, v185 row_newbcast:2 row_mask:0xf bank_mask:0xf
    ds_read_b64_tr_b16 v[34:35], v98 offset:49664
    v_mfma_f32_16x16x16_bf16 v[164:167], v[72:73], v[222:223], v[16:19]
    s_waitcnt lgkmcnt(6)
    v_fmac_f32_dpp v155, v12, v185 row_newbcast:3 row_mask:0xf bank_mask:0xf
    v_cvt_pk_bf16_f32 v220, v152, v153
    ds_read_b64_tr_b16 v[36:37], v98 offset:49160
    v_cvt_pk_bf16_f32 v221, v154, v155
    v_mul_f32 v246, s43, v184
    v_fmac_f32_dpp v160, v187, v120 row_newbcast:0 row_mask:0xf bank_mask:0xf
    v_fmac_f32_dpp v161, v187, v120 row_newbcast:1 row_mask:0xf bank_mask:0xf
    buffer_load_dwordx4 v0, s[20:23], s76 offen offset:1024 lds
    ds_read_b64_tr_b16 v[38:39], v98 offset:49672
    v_fmac_f32_dpp v162, v187, v120 row_newbcast:2 row_mask:0xf bank_mask:0xf
    v_fmac_f32_dpp v163, v187, v120 row_newbcast:3 row_mask:0xf bank_mask:0xf
    v_mul_f32_dpp v160, v186, v160 row_newbcast:0 row_mask:0xf bank_mask:0xf
    v_mul_f32_dpp v161, v186, v161 row_newbcast:1 row_mask:0xf bank_mask:0xf
    v_mul_f32_dpp v162, v186, v162 row_newbcast:2 row_mask:0xf bank_mask:0xf
    v_mul_f32_dpp v163, v186, v163 row_newbcast:3 row_mask:0xf bank_mask:0xf
    v_cvt_pk_bf16_f32 v92, v160, v161
    v_cvt_pk_bf16_f32 v93, v162, v163
    v_cndmask_b32 v164, v168, v164, s[28:29]
    v_cndmask_b32 v165, v169, v165, s[30:31]
    v_cndmask_b32 v166, v170, v166, s[32:33]
    v_cndmask_b32 v167, v171, v167, s[34:35]
    v_max3_f32 v168, v164, v165, v166
    v_max_f32 v169, v168, v167
    v_max_f32 v168, v168, v167
    v_fmac_f32_dpp v144, v13, v181 row_newbcast:0 row_mask:0xf bank_mask:0xf
    v_fmac_f32_dpp v145, v13, v181 row_newbcast:1 row_mask:0xf bank_mask:0xf
    buffer_load_dwordx4 v0, s[20:23], s76 offen offset:2048 lds
    s_add_u32 s76, s40, 4
    s_and_b32 s76, s76, 15
    s_mul_i32 s76, s76, 98304
    s_add_u32 m0, s59, 147456
    s_waitcnt lgkmcnt(0)
    ds_write_b128 v99, v[24:27] offset:49152
    v_permlane32_swap_b32 v168, v169
    v_max_f32 v170, v168, v169
    v_max_f32 v168, v168, v169
    v_fmac_f32_dpp v146, v13, v181 row_newbcast:2 row_mask:0xf bank_mask:0xf
    v_fmac_f32_dpp v147, v13, v181 row_newbcast:3 row_mask:0xf bank_mask:0xf
    v_permlane16_swap_b32 v168, v170
    buffer_load_dwordx4 v0, s[20:23], s76 offen offset:0 lds
    ds_write_b128 v99, v[28:31] offset:50176
    v_max_f32 v168, v168, v170
    v_mul_f32 v168, -v168, v247
    v_fma_f32 v164, v164, v247, v168
    v_fma_f32 v165, v165, v247, v168
    v_fma_f32 v166, v166, v247, v168
    v_fma_f32 v167, v167, v247, v168
    v_exp_f32 v164, v164
    ds_write_b128 v99, v[32:35] offset:51200
    buffer_load_dwordx4 v0, s[20:23], s76 offen offset:1024 lds
    v_exp_f32 v165, v165
    v_exp_f32 v166, v166
    v_exp_f32 v167, v167
    ds_write_b128 v99, v[36:39] offset:52224
    s_waitcnt vmcnt(26)
    ds_read_b64_tr_b16 v[40:41], v97 offset:32768
    v_cvt_pk_bf16_f32 v248, v164, v165
    v_cvt_pk_bf16_f32 v249, v166, v167
    v_and_b32 v170, v248, v20
    buffer_load_dwordx4 v0, s[20:23], s76 offen offset:2048 lds
    ds_read_b64_tr_b16 v[42:43], v97 offset:33280
    s_add_u32 s76, s40, 5
    s_and_b32 s76, s76, 15
    s_mul_i32 s76, s76, 98304
    s_add_u32 m0, s59, 12288
    ds_read_b64_tr_b16 v[44:45], v97 offset:32776
    v_and_b32 v171, v249, v21
    v_mfma_f32_16x16x16_bf16 v[164:167], v[22:23], v[248:249], 0
    s_add_u32 s73, s61, 0x20000
    s_mov_b32 exec_lo, 0xff00ff00
    s_mov_b32 exec_hi, 0xff00ff00
    buffer_load_dwordx4 v[80:83], v6, s[8:11], s61 offen sc1
    s_mov_b32 exec_lo, 0
    s_mov_b32 exec_hi, -1
    buffer_load_dwordx4 v[84:87], v6, s[8:11], s73 offen sc1
    s_mov_b32 exec_lo, -1
    ds_read_b64_tr_b16 v[46:47], v97 offset:33288
    buffer_load_dwordx4 v0, s[20:23], s76 offen offset:0 lds
    v_xor_b32 v168, v248, v170
    v_xor_b32 v169, v249, v171
    ds_read_b64_tr_b16 v[48:49], v98 offset:32768
    v_mul_f32 v144, v180, v144
    v_mfma_f32_16x16x32_bf16 v[172:175], v[92:95], v[168:171], 0
    v_rcp_f32 v164, v164
    ds_read_b64_tr_b16 v[50:51], v98 offset:33280
    v_mul_f32 v145, v180, v145
    v_mul_f32 v146, v180, v146
    v_mul_f32 v147, v180, v147
    v_cvt_pk_bf16_f32 v226, v144, v145
    ds_read_b64_tr_b16 v[52:53], v98 offset:32776
    buffer_load_dwordx4 v0, s[20:23], s76 offen offset:1024 lds
    v_mul_f32 v172, v164, v172
    v_mul_f32 v173, v164, v173
    ds_read_b64_tr_b16 v[54:55], v98 offset:33288
    v_mul_f32 v174, v164, v174
    v_mul_f32 v175, v164, v175
    v_cvt_pk_bf16_f32 v249, v174, v175
    v_cvt_pk_bf16_f32 v248, v172, v173
    v_cvt_pk_bf16_f32 v227, v146, v147
    v_fmac_f32_dpp v140, v12, v181 row_newbcast:0 row_mask:0xf bank_mask:0xf
    v_fmac_f32_dpp v141, v12, v181 row_newbcast:1 row_mask:0xf bank_mask:0xf
    v_mfma_f32_16x16x16_bf16 v[156:159], v[226:227], v[220:221], v[16:19]
    v_fmac_f32_dpp v142, v12, v181 row_newbcast:2 row_mask:0xf bank_mask:0xf
    v_fmac_f32_dpp v143, v12, v181 row_newbcast:3 row_mask:0xf bank_mask:0xf
    v_mfma_f32_16x16x16_bf16 v[152:155], v[228:229], v[220:221], v[16:19]
    v_cvt_pk_bf16_f32 v218, v140, v141
    v_cvt_pk_bf16_f32 v219, v142, v143
    buffer_load_dwordx4 v0, s[20:23], s76 offen offset:2048 lds
    s_add_u32 s76, s40, 6
    s_and_b32 s76, s76, 15
    s_mul_i32 s76, s76, 98304
    s_add_u32 m0, s59, 0
    v_mul_f32 v245, s43, v180
    v_fmac_f32_dpp v148, v183, v120 row_newbcast:0 row_mask:0xf bank_mask:0xf
    s_waitcnt lgkmcnt(0)
    ds_write_b128 v99, v[40:43] offset:32768
    v_fmac_f32_dpp v149, v183, v120 row_newbcast:1 row_mask:0xf bank_mask:0xf
    v_fmac_f32_dpp v150, v183, v120 row_newbcast:2 row_mask:0xf bank_mask:0xf
    v_fmac_f32_dpp v151, v183, v120 row_newbcast:3 row_mask:0xf bank_mask:0xf
    v_mul_f32_dpp v148, v182, v148 row_newbcast:0 row_mask:0xf bank_mask:0xf
    v_mul_f32_dpp v149, v182, v149 row_newbcast:1 row_mask:0xf bank_mask:0xf
    v_mul_f32_dpp v150, v182, v150 row_newbcast:2 row_mask:0xf bank_mask:0xf
    buffer_load_dwordx4 v0, s[20:23], s76 offen offset:0 lds
    ds_write_b128 v99, v[44:47] offset:33792
    v_mul_f32_dpp v151, v182, v151 row_newbcast:3 row_mask:0xf bank_mask:0xf
    v_cvt_pk_bf16_f32 v90, v148, v149
    v_cvt_pk_bf16_f32 v91, v150, v151
    v_cndmask_b32 v152, v156, v152, s[28:29]
    v_cndmask_b32 v153, v157, v153, s[30:31]
    v_cndmask_b32 v154, v158, v154, s[32:33]
    v_cndmask_b32 v155, v159, v155, s[34:35]
    v_max3_f32 v156, v152, v153, v154
    ds_write_b128 v99, v[48:51] offset:34816
    buffer_load_dwordx4 v0, s[20:23], s76 offen offset:1024 lds
    v_max_f32 v157, v156, v155
    v_max_f32 v156, v156, v155
    v_fmac_f32_dpp v132, v13, v177 row_newbcast:0 row_mask:0xf bank_mask:0xf
    v_fmac_f32_dpp v133, v13, v177 row_newbcast:1 row_mask:0xf bank_mask:0xf
    v_permlane32_swap_b32 v156, v157
    ds_write_b128 v99, v[52:55] offset:35840
    s_waitcnt vmcnt(30)
    ds_read_b64_tr_b16 v[24:25], v97 offset:16384
    v_max_f32 v158, v156, v157
    v_max_f32 v156, v156, v157
    v_fmac_f32_dpp v134, v13, v177 row_newbcast:2 row_mask:0xf bank_mask:0xf
    buffer_load_dwordx4 v0, s[20:23], s76 offen offset:2048 lds
    ds_read_b64_tr_b16 v[26:27], v97 offset:16896
    v_permlane16_swap_b32 v156, v158
    v_max_f32 v156, v156, v158
    v_mul_f32 v156, -v156, v246
    ds_read_b64_tr_b16 v[28:29], v97 offset:16392
    v_fma_f32 v152, v152, v246, v156
    v_fma_f32 v153, v153, v246, v156
    v_fma_f32 v154, v154, v246, v156
    v_fma_f32 v155, v155, v246, v156
    ds_read_b64_tr_b16 v[30:31], v97 offset:16904
    v_exp_f32 v152, v152
    v_exp_f32 v153, v153
    ds_read_b64_tr_b16 v[32:33], v98 offset:16384
    v_exp_f32 v154, v154
    v_exp_f32 v155, v155
    ds_read_b64_tr_b16 v[34:35], v98 offset:16896
    v_cvt_pk_bf16_f32 v250, v152, v153
    v_cvt_pk_bf16_f32 v251, v154, v155
    v_and_b32 v158, v250, v20
    v_and_b32 v159, v251, v21
    ds_read_b64_tr_b16 v[36:37], v98 offset:16392
    v_mfma_f32_16x16x16_bf16 v[152:155], v[22:23], v[250:251], 0
    s_waitcnt vmcnt(6)
    v_xor_b32 v156, v250, v158
    v_xor_b32 v157, v251, v159
    ds_read_b64_tr_b16 v[38:39], v98 offset:16904
    s_add_u32 s85, s65, 98304
    v_mfma_f32_16x16x32_bf16 v[160:163], v[90:93], v[156:159], 0
    v_fmac_f32_dpp v135, v13, v177 row_newbcast:3 row_mask:0xf bank_mask:0xf
    v_mul_f32 v132, v176, v132
    v_rcp_f32 v152, v152
    v_mul_f32 v133, v176, v133
    v_mul_f32 v134, v176, v134
    v_mul_f32 v135, v176, v135
    v_cvt_pk_bf16_f32 v224, v132, v133
    v_cvt_pk_bf16_f32 v225, v134, v135
    v_mul_f32 v160, v152, v160
    v_mul_f32 v161, v152, v161
    v_mfma_f32_16x16x16_bf16 v[144:147], v[224:225], v[218:219], v[16:19]
    v_mul_f32 v162, v152, v162
    v_mul_f32 v163, v152, v163
    v_mfma_f32_16x16x16_bf16 v[140:143], v[226:227], v[218:219], v[16:19]
    v_cvt_pk_bf16_f32 v251, v162, v163
    v_cvt_pk_bf16_f32 v250, v160, v161
    v_fmac_f32_dpp v128, v12, v177 row_newbcast:0 row_mask:0xf bank_mask:0xf
    s_waitcnt lgkmcnt(0)
    ds_write_b128 v99, v[24:27] offset:16384
    v_permlane16_swap_b32 v249, v251
    v_permlane16_swap_b32 v248, v250
    v_and_b32 v251, -2, v251
    buffer_store_dwordx4 v[248:251], v8, s[8:11], s85 offen
    ds_write_b128 v99, v[28:31] offset:17408
    s_waitcnt vmcnt(27)
    s_mov_b64 exec, 1
    buffer_store_dwordx2 v[60:61], v6, s[8:11], s93 offen sc1
    s_mov_b64 exec, -1
    ds_write_b128 v99, v[32:35] offset:18432
    v_fmac_f32_dpp v129, v12, v177 row_newbcast:1 row_mask:0xf bank_mask:0xf
    v_fmac_f32_dpp v130, v12, v177 row_newbcast:2 row_mask:0xf bank_mask:0xf
    v_fmac_f32_dpp v131, v12, v177 row_newbcast:3 row_mask:0xf bank_mask:0xf
    v_cvt_pk_bf16_f32 v216, v128, v129
    v_cvt_pk_bf16_f32 v217, v130, v131
    v_mul_f32 v244, s43, v176
    v_fmac_f32_dpp v136, v179, v120 row_newbcast:0 row_mask:0xf bank_mask:0xf
    v_fmac_f32_dpp v137, v179, v120 row_newbcast:1 row_mask:0xf bank_mask:0xf
    ds_write_b128 v99, v[36:39] offset:19456
    s_waitcnt vmcnt(29)
    ds_read_b64_tr_b16 v[40:41], v97 offset:0
    v_fmac_f32_dpp v138, v179, v120 row_newbcast:2 row_mask:0xf bank_mask:0xf
    v_fmac_f32_dpp v139, v179, v120 row_newbcast:3 row_mask:0xf bank_mask:0xf
    v_mul_f32_dpp v136, v178, v136 row_newbcast:0 row_mask:0xf bank_mask:0xf
    v_mul_f32_dpp v137, v178, v137 row_newbcast:1 row_mask:0xf bank_mask:0xf
    ds_read_b64_tr_b16 v[42:43], v97 offset:512
    v_mul_f32_dpp v138, v178, v138 row_newbcast:2 row_mask:0xf bank_mask:0xf
    v_mul_f32_dpp v139, v178, v139 row_newbcast:3 row_mask:0xf bank_mask:0xf
    v_cvt_pk_bf16_f32 v88, v136, v137
    v_cvt_pk_bf16_f32 v89, v138, v139
    ds_read_b64_tr_b16 v[44:45], v97 offset:8
    v_cndmask_b32 v140, v144, v140, s[28:29]
    v_cndmask_b32 v141, v145, v141, s[30:31]
    v_cndmask_b32 v142, v146, v142, s[32:33]
    v_cndmask_b32 v143, v147, v143, s[34:35]
    ds_read_b64_tr_b16 v[46:47], v97 offset:520
    v_max3_f32 v144, v140, v141, v142
    v_max_f32 v145, v144, v143
    v_max_f32 v144, v144, v143
    v_xor_b32 v4, v82, v74
    ds_read_b64_tr_b16 v[48:49], v98 offset:0
    v_permlane32_swap_b32 v144, v145
    v_max_f32 v146, v144, v145
    v_max_f32 v144, v144, v145
    ds_read_b64_tr_b16 v[50:51], v98 offset:512
    v_xor_b32 v3, v84, v74
    v_permlane16_swap_b32 v144, v146
    v_max_f32 v144, v144, v146
    ds_read_b64_tr_b16 v[52:53], v98 offset:8
    v_mul_f32 v144, -v144, v245
    v_fma_f32 v140, v140, v245, v144
    v_fma_f32 v141, v141, v245, v144
    v_fma_f32 v142, v142, v245, v144
    ds_read_b64_tr_b16 v[54:55], v98 offset:520
    v_fma_f32 v143, v143, v245, v144
    v_exp_f32 v140, v140
    v_exp_f32 v141, v141
    v_exp_f32 v142, v142
    v_exp_f32 v143, v143
    v_cvt_pk_bf16_f32 v252, v140, v141
    v_cvt_pk_bf16_f32 v253, v142, v143
    v_and_b32 v146, v252, v20
    v_and_b32 v147, v253, v21
    v_mfma_f32_16x16x16_bf16 v[140:143], v[22:23], v[252:253], 0
    v_xor_b32 v144, v252, v146
    v_xor_b32 v145, v253, v147
    v_or_b32 v4, v4, v3
    v_cmp_ne_u32 vcc, 0, v4
    v_mfma_f32_16x16x32_bf16 v[148:151], v[88:91], v[144:147], 0
    s_cbranch_vccnz L_retry_3
L_back_4:
    v_add_f32 v132, s42, v16
    s_waitcnt lgkmcnt(0)
    ds_write_b128 v99, v[40:43] offset:0
    v_rcp_f32 v140, v140
    v_add_f32 v133, s42, v17
    v_add_f32 v134, s42, v18
    v_add_f32 v135, s42, v19
    v_mfma_f32_16x16x16_bf16 v[128:131], v[224:225], v[216:217], v[16:19]
    v_mul_f32 v148, v140, v148
    ds_write_b128 v99, v[44:47] offset:1024
    v_mfma_f32_16x16x16_bf16 v[132:135], v[80:81], v[216:217], v[132:135]
    v_mul_f32 v149, v140, v149
    v_mul_f32 v150, v140, v150
    v_mul_f32 v151, v140, v151
    v_cvt_pk_bf16_f32 v253, v150, v151
    v_cvt_pk_bf16_f32 v252, v148, v149
    ds_write_b128 v99, v[48:51] offset:2048
    s_nop 1
    v_cndmask_b32 v128, v132, v128, s[28:29]
    v_cndmask_b32 v129, v133, v129, s[30:31]
    v_cndmask_b32 v130, v134, v130, s[32:33]
    v_cndmask_b32 v131, v135, v131, s[34:35]
    v_max3_f32 v132, v128, v129, v130
    v_max_f32 v133, v132, v131
    ds_write_b128 v99, v[52:55] offset:3072
    v_max_f32 v132, v132, v131
    s_nop 1
    v_permlane32_swap_b32 v132, v133
    v_max_f32 v134, v132, v133
    v_max_f32 v132, v132, v133
    s_nop 1
    v_permlane16_swap_b32 v132, v134
    v_max_f32 v132, v132, v134
    v_mul_f32 v132, -v132, v244
    v_fma_f32 v128, v128, v244, v132
    v_fma_f32 v129, v129, v244, v132
    v_fma_f32 v130, v130, v244, v132
    v_fma_f32 v131, v131, v244, v132
    v_exp_f32 v128, v128
    v_exp_f32 v129, v129
    v_exp_f32 v130, v130
    v_exp_f32 v131, v131
    v_cvt_pk_bf16_f32 v254, v128, v129
    v_cvt_pk_bf16_f32 v255, v130, v131
    v_and_b32 v134, v254, v20
    v_and_b32 v135, v255, v21
    v_mfma_f32_16x16x16_bf16 v[128:131], v[22:23], v[254:255], 0
    v_xor_b32 v132, v254, v134
    v_xor_b32 v133, v255, v135
    s_add_u32 s87, s65, 65536
    s_nop 0
    v_mfma_f32_16x16x32_bf16 v[136:139], v[86:89], v[132:135], 0
    s_nop 2
    v_rcp_f32 v128, v128
    s_nop 3
    v_mul_f32 v136, v128, v136
    v_mul_f32 v137, v128, v137
    v_mul_f32 v138, v128, v138
    v_mul_f32 v139, v128, v139
    v_cvt_pk_bf16_f32 v255, v138, v139
    v_cvt_pk_bf16_f32 v254, v136, v137
    s_nop 0
    v_permlane16_swap_b32 v253, v255
    v_permlane16_swap_b32 v252, v254
    v_and_b32 v255, -2, v255
    buffer_store_dwordx4 v[252:255], v8, s[8:11], s87 offen
    s_waitcnt lgkmcnt(0)
    s_add_u32 s88, s66, 65536
    buffer_load_dwordx4 v[24:27], v6, s[8:11], s88 offen offset:0 sc1
    buffer_load_dwordx4 v[28:31], v6, s[8:11], s88 offen offset:1024 sc1
    buffer_load_dwordx4 v[32:35], v6, s[8:11], s88 offen offset:2048 sc1
    buffer_load_dwordx4 v[36:39], v6, s[8:11], s88 offen offset:3072 sc1
    s_add_u32 s89, s66, 69632
    buffer_load_dwordx4 v[40:43], v6, s[8:11], s89 offen offset:0 sc1
    buffer_load_dwordx4 v[44:47], v6, s[8:11], s89 offen offset:1024 sc1
    buffer_load_dwordx4 v[48:51], v6, s[8:11], s89 offen offset:2048 sc1
    buffer_load_dwordx4 v[52:55], v6, s[8:11], s89 offen offset:3072 sc1
    s_add_u32 s94, s66, 73728
    buffer_load_dwordx4 v[56:59], v6, s[8:11], s94 offen offset:0 sc1
    buffer_load_dwordx4 v[60:63], v6, s[8:11], s94 offen offset:1024 sc1
    buffer_load_dwordx4 v[64:67], v6, s[8:11], s94 offen offset:2048 sc1
    buffer_load_dwordx4 v[68:71], v6, s[8:11], s94 offen offset:3072 sc1
    s_waitcnt vmcnt(15)
    s_barrier
    ds_read_b64_tr_b16 a[192:193], v1 offset:0
    ds_read_b64_tr_b16 a[194:195], v1 offset:512
    ds_read_b64_tr_b16 a[196:197], v1 offset:1024
    ds_read_b64_tr_b16 a[198:199], v1 offset:1536
    ds_read_b64_tr_b16 a[200:201], v1 offset:2048
    ds_read_b64_tr_b16 a[202:203], v1 offset:2560
    ds_read_b64_tr_b16 a[204:205], v1 offset:12288
    ds_read_b64_tr_b16 a[206:207], v1 offset:12800
    ds_read_b64_tr_b16 a[208:209], v1 offset:13312
    ds_read_b64_tr_b16 a[210:211], v1 offset:13824
    ds_read_b64_tr_b16 a[212:213], v1 offset:14336
    ds_read_b64_tr_b16 a[214:215], v1 offset:14848
    ds_read_b64_tr_b16 a[216:217], v1 offset:24576
    ds_read_b64_tr_b16 a[218:219], v1 offset:25088
    ds_read_b64_tr_b16 a[220:221], v1 offset:25600
    ds_read_b64_tr_b16 a[222:223], v1 offset:26112
    ds_read_b64_tr_b16 a[224:225], v1 offset:26624
    ds_read_b64_tr_b16 a[226:227], v1 offset:27136
    ds_read_b64_tr_b16 a[228:229], v1 offset:36864
    ds_read_b64_tr_b16 a[230:231], v1 offset:37376
    ds_read_b64_tr_b16 a[232:233], v1 offset:37888
    ds_read_b64_tr_b16 a[234:235], v1 offset:38400
    ds_read_b64_tr_b16 a[236:237], v1 offset:38912
    ds_read_b64_tr_b16 a[238:239], v1 offset:39424
    ds_read_b64_tr_b16 a[240:241], v1 offset:49152
    ds_read_b64_tr_b16 a[242:243], v1 offset:49664
    ds_read_b64_tr_b16 a[244:245], v1 offset:50176
    ds_read_b64_tr_b16 a[246:247], v1 offset:50688
    ds_read_b64_tr_b16 a[248:249], v1 offset:51200
    ds_read_b64_tr_b16 a[250:251], v1 offset:51712
    ds_read_b64_tr_b16 a[252:253], v2 offset:12288
    ds_read_b64_tr_b16 a[254:255], v2 offset:12800
    ds_read_b64_tr_b16 v[128:129], v2 offset:13312
    ds_read_b64_tr_b16 v[130:131], v2 offset:13824
    ds_read_b64_tr_b16 v[132:133], v2 offset:14336
    ds_read_b64_tr_b16 v[134:135], v2 offset:14848
    ds_read_b64_tr_b16 v[136:137], v2 offset:0
    ds_read_b64_tr_b16 v[138:139], v2 offset:512
    ds_read_b64_tr_b16 v[140:141], v2 offset:1024
    ds_read_b64_tr_b16 v[142:143], v2 offset:1536
    ds_read_b64_tr_b16 v[144:145], v2 offset:2048
    ds_read_b64_tr_b16 v[146:147], v2 offset:2560
    v_add_u32 v5, 32768, v6
    v_mfma_f32_16x16x16_bf16 v[104:107], v[14:15], v[100:101], 0
    ds_read_b128 v[80:83], v5 offset:0
    ds_read_b128 v[84:87], v5 offset:1024
    v_mfma_f32_16x16x16_bf16 v[108:111], v[14:15], v[102:103], 0
    ds_read_b128 v[96:99], v5 offset:2048
    v_mfma_f32_16x16x16_bf16 v[112:115], v[14:15], v[124:125], 0
    v_mfma_f32_16x16x16_bf16 v[116:119], v[14:15], v[126:127], 0
    s_waitcnt vmcnt(8)
    v_bitop3_b32 v4, v27, v31, v35 bitop3:0xfe
    v_bitop3_b32 v4, v4, v39, 1 bitop3:0xa8
    v_cmp_ne_u32 vcc, 0, v4
    ds_read_b128 v[72:75], v5 offset:3072
    ds_read_b128 v[76:79], v5 offset:4096
    ds_read_b128 v[88:91], v5 offset:5120
    ds_read_b128 v[92:95], v5 offset:6144
    s_cbranch_vccnz L_retry_5
L_back_6:
    s_waitcnt lgkmcnt(6)
    v_mfma_f32_16x16x32_bf16 v[104:107], v[80:83], v[24:27], v[104:107]
    ds_read_b128 v[100:103], v5 offset:7168
    s_waitcnt lgkmcnt(5)
    v_mfma_f32_16x16x32_bf16 v[108:111], v[84:87], v[24:27], v[108:111]
    ds_read_b128 v[80:83], v5 offset:8192
    s_waitcnt vmcnt(4)
    v_mfma_f32_16x16x32_bf16 v[112:115], v[96:99], v[24:27], v[112:115]
    ds_read_b128 v[84:87], v5 offset:9216
    s_waitcnt lgkmcnt(5)
    v_mfma_f32_16x16x32_bf16 v[116:119], v[72:75], v[24:27], v[116:119]
    ds_read_b128 v[96:99], v5 offset:10240
    v_bitop3_b32 v4, v43, v47, v51 bitop3:0xfe
    v_mfma_f32_16x16x32_bf16 v[104:107], v[76:79], v[28:31], v[104:107]
    ds_read_b128 v[72:75], v5 offset:11264
    s_waitcnt lgkmcnt(5)
    v_mfma_f32_16x16x32_bf16 v[108:111], v[88:91], v[28:31], v[108:111]
    ds_read_b128 v[76:79], v5 offset:12288
    v_bitop3_b32 v4, v4, v55, 1 bitop3:0xa8
    v_mfma_f32_16x16x32_bf16 v[112:115], v[92:95], v[28:31], v[112:115]
    ds_read_b128 v[88:91], v5 offset:13312
    s_waitcnt lgkmcnt(5)
    v_mfma_f32_16x16x32_bf16 v[116:119], v[100:103], v[28:31], v[116:119]
    ds_read_b128 v[92:95], v5 offset:14336
    v_cmp_ne_u32 vcc, 0, v4
    v_mfma_f32_16x16x32_bf16 v[104:107], v[80:83], v[32:35], v[104:107]
    ds_read_b128 v[100:103], v5 offset:15360
    s_waitcnt lgkmcnt(5)
    v_mfma_f32_16x16x32_bf16 v[108:111], v[84:87], v[32:35], v[108:111]
    ds_read_b128 v[80:83], v5 offset:16384
    s_cbranch_vccnz L_retry_7
L_back_8:
    v_mfma_f32_16x16x32_bf16 v[112:115], v[96:99], v[32:35], v[112:115]
    ds_read_b128 v[84:87], v5 offset:17408
    s_waitcnt lgkmcnt(5)
    v_mfma_f32_16x16x32_bf16 v[116:119], v[72:75], v[32:35], v[116:119]
    ds_read_b128 v[96:99], v5 offset:18432
    v_mfma_f32_16x16x32_bf16 v[104:107], v[76:79], v[36:39], v[104:107]
    ds_read_b128 v[72:75], v5 offset:19456
    s_waitcnt lgkmcnt(5)
    v_mfma_f32_16x16x32_bf16 v[108:111], v[88:91], v[36:39], v[108:111]
    ds_read_b128 v[76:79], v5 offset:20480
    s_barrier
    v_mfma_f32_16x16x32_bf16 v[112:115], v[92:95], v[36:39], v[112:115]
    ds_read_b128 v[88:91], v5 offset:21504
    s_waitcnt lgkmcnt(5)
    v_mfma_f32_16x16x32_bf16 v[116:119], v[100:103], v[36:39], v[116:119]
    ds_read_b128 v[92:95], v5 offset:22528
    s_add_u32 s98, s66, 77824
    v_mfma_f32_16x16x32_bf16 v[104:107], v[80:83], v[40:43], v[104:107]
    ds_read_b128 v[100:103], v5 offset:23552
    s_waitcnt lgkmcnt(5)
    buffer_load_dwordx4 v[24:27], v6, s[8:11], s98 offen offset:0 sc1
    v_mfma_f32_16x16x32_bf16 v[108:111], v[84:87], v[40:43], v[108:111]
    ds_read_b128 v[80:83], v5 offset:24576
    v_mfma_f32_16x16x32_bf16 v[112:115], v[96:99], v[40:43], v[112:115]
    ds_read_b128 v[84:87], v5 offset:25600
    s_waitcnt lgkmcnt(5)
    buffer_load_dwordx4 v[28:31], v6, s[8:11], s98 offen offset:1024 sc1
    v_mfma_f32_16x16x32_bf16 v[116:119], v[72:75], v[40:43], v[116:119]
    ds_read_b128 v[96:99], v5 offset:26624
    v_mfma_f32_16x16x32_bf16 v[104:107], v[76:79], v[44:47], v[104:107]
    ds_read_b128 v[72:75], v5 offset:27648
    s_waitcnt lgkmcnt(5)
    buffer_load_dwordx4 v[32:35], v6, s[8:11], s98 offen offset:2048 sc1
    v_mfma_f32_16x16x32_bf16 v[108:111], v[88:91], v[44:47], v[108:111]
    ds_read_b128 v[76:79], v5 offset:28672
    v_mfma_f32_16x16x32_bf16 v[112:115], v[92:95], v[44:47], v[112:115]
    ds_read_b128 v[88:91], v5 offset:29696
    s_waitcnt lgkmcnt(5)
    buffer_load_dwordx4 v[36:39], v6, s[8:11], s98 offen offset:3072 sc1
    v_mfma_f32_16x16x32_bf16 v[116:119], v[100:103], v[44:47], v[116:119]
    ds_read_b128 v[92:95], v5 offset:30720
    s_waitcnt vmcnt(4)
    v_mfma_f32_16x16x32_bf16 v[104:107], v[80:83], v[48:51], v[104:107]
    ds_read_b128 v[100:103], v5 offset:31744
    s_waitcnt lgkmcnt(5)
    v_mfma_f32_16x16x32_bf16 v[108:111], v[84:87], v[48:51], v[108:111]
    ds_read_b128 v[80:83], v5 offset:32768
    v_bitop3_b32 v4, v59, v63, v67 bitop3:0xfe
    v_mfma_f32_16x16x32_bf16 v[112:115], v[96:99], v[48:51], v[112:115]
    ds_read_b128 v[84:87], v5 offset:33792
    s_waitcnt lgkmcnt(5)
    v_mfma_f32_16x16x32_bf16 v[116:119], v[72:75], v[48:51], v[116:119]
    ds_read_b128 v[96:99], v5 offset:34816
    v_bitop3_b32 v4, v4, v71, 1 bitop3:0xa8
    v_mfma_f32_16x16x32_bf16 v[104:107], v[76:79], v[52:55], v[104:107]
    ds_read_b128 v[72:75], v5 offset:35840
    s_waitcnt lgkmcnt(5)
    v_mfma_f32_16x16x32_bf16 v[108:111], v[88:91], v[52:55], v[108:111]
    ds_read_b128 v[76:79], v5 offset:36864
    v_cmp_ne_u32 vcc, 0, v4
    v_mfma_f32_16x16x32_bf16 v[112:115], v[92:95], v[52:55], v[112:115]
    ds_read_b128 v[88:91], v5 offset:37888
    s_waitcnt lgkmcnt(5)
    v_mfma_f32_16x16x32_bf16 v[116:119], v[100:103], v[52:55], v[116:119]
    ds_read_b128 v[92:95], v5 offset:38912
    s_cbranch_vccnz L_retry_9
L_back_10:
    v_mfma_f32_16x16x32_bf16 v[104:107], v[80:83], v[56:59], v[104:107]
    ds_read_b128 v[100:103], v5 offset:39936
    s_waitcnt lgkmcnt(5)
    v_mfma_f32_16x16x32_bf16 v[108:111], v[84:87], v[56:59], v[108:111]
    ds_read_b128 v[80:83], v5 offset:40960
    s_add_u32 s76, s40, 7
    v_mfma_f32_16x16x32_bf16 v[112:115], v[96:99], v[56:59], v[112:115]
    ds_read_b128 v[84:87], v5 offset:41984
    s_waitcnt lgkmcnt(5)
    v_mfma_f32_16x16x32_bf16 v[116:119], v[72:75], v[56:59], v[116:119]
    ds_read_b128 v[96:99], v5 offset:43008
    s_and_b32 s76, s76, 15
    v_mfma_f32_16x16x32_bf16 v[104:107], v[76:79], v[60:63], v[104:107]
    ds_read_b128 v[72:75], v5 offset:44032
    s_waitcnt lgkmcnt(5)
    v_mfma_f32_16x16x32_bf16 v[108:111], v[88:91], v[60:63], v[108:111]
    ds_read_b128 v[76:79], v5 offset:45056
    s_mul_i32 s76, s76, 98304
    v_mfma_f32_16x16x32_bf16 v[112:115], v[92:95], v[60:63], v[112:115]
    ds_read_b128 v[88:91], v5 offset:46080
    s_waitcnt lgkmcnt(5)
    v_mfma_f32_16x16x32_bf16 v[116:119], v[100:103], v[60:63], v[116:119]
    ds_read_b128 v[92:95], v5 offset:47104
    s_add_u32 m0, s59, 98304
    v_mfma_f32_16x16x32_bf16 v[104:107], v[80:83], v[64:67], v[104:107]
    ds_read_b128 v[100:103], v5 offset:48128
    s_waitcnt lgkmcnt(5)
    v_mfma_f32_16x16x32_bf16 v[108:111], v[84:87], v[64:67], v[108:111]
    ds_read_b128 v[80:83], v5 offset:49152
    buffer_load_dwordx4 v0, s[20:23], s76 offen offset:0 lds
    v_mfma_f32_16x16x32_bf16 v[112:115], v[96:99], v[64:67], v[112:115]
    ds_read_b128 v[84:87], v5 offset:50176
    s_waitcnt lgkmcnt(5)
    v_mfma_f32_16x16x32_bf16 v[116:119], v[72:75], v[64:67], v[116:119]
    ds_read_b128 v[96:99], v5 offset:51200
    v_mfma_f32_16x16x32_bf16 v[104:107], v[76:79], v[68:71], v[104:107]
    ds_read_b128 v[72:75], v5 offset:52224
    s_waitcnt lgkmcnt(5)
    buffer_load_dwordx4 v0, s[20:23], s76 offen offset:1024 lds
    v_mfma_f32_16x16x32_bf16 v[108:111], v[88:91], v[68:71], v[108:111]
    ds_read_b128 v[76:79], v5 offset:53248
    s_waitcnt vmcnt(2)
    v_mfma_f32_16x16x32_bf16 v[112:115], v[92:95], v[68:71], v[112:115]
    ds_read_b128 v[88:91], v5 offset:54272
    s_waitcnt lgkmcnt(5)
    v_mfma_f32_16x16x32_bf16 v[116:119], v[100:103], v[68:71], v[116:119]
    ds_read_b128 v[92:95], v5 offset:55296
    v_bitop3_b32 v4, v27, v31, v35 bitop3:0xfe
    v_bitop3_b32 v4, v4, v39, 1 bitop3:0xa8
    v_cmp_ne_u32 vcc, 0, v4
    s_nop 0
    s_cbranch_vccnz L_retry_11
L_back_12:
    buffer_load_dwordx4 v0, s[20:23], s76 offen offset:2048 lds
    v_mfma_f32_16x16x32_bf16 v[104:107], v[80:83], v[24:27], v[104:107]
    ds_read_b128 v[100:103], v5 offset:56320
    s_waitcnt lgkmcnt(5)
    v_mfma_f32_16x16x32_bf16 v[108:111], v[84:87], v[24:27], v[108:111]
    ds_read_b128 v[80:83], v5 offset:57344
    s_add_u32 s76, s40, 8
    v_mfma_f32_16x16x32_bf16 v[112:115], v[96:99], v[24:27], v[112:115]
    ds_read_b128 v[84:87], v5 offset:58368
    s_waitcnt lgkmcnt(5)
    v_mfma_f32_16x16x32_bf16 v[116:119], v[72:75], v[24:27], v[116:119]
    ds_read_b128 v[96:99], v5 offset:61440
    s_and_b32 s76, s76, 15
    v_mfma_f32_16x16x32_bf16 v[104:107], v[76:79], v[28:31], v[104:107]
    ds_read_b128 v[72:75], v5 offset:62464
    s_waitcnt lgkmcnt(5)
    v_mfma_f32_16x16x32_bf16 v[108:111], v[88:91], v[28:31], v[108:111]
    ds_read_b128 v[76:79], v5 offset:59392
    s_mul_i32 s76, s76, 98304
    v_mfma_f32_16x16x32_bf16 v[112:115], v[92:95], v[28:31], v[112:115]
    ds_read_b128 v[88:91], v5 offset:60416
    s_waitcnt lgkmcnt(5)
    v_mfma_f32_16x16x32_bf16 v[116:119], v[100:103], v[28:31], v[116:119]
    ds_read_b128 v[92:95], v5 offset:63488
    s_add_u32 m0, s59, 110592
    v_mfma_f32_16x16x32_bf16 v[104:107], v[80:83], v[32:35], v[104:107]
    ds_read_b128 v[100:103], v5 offset:64512
    s_waitcnt lgkmcnt(5)
    v_mfma_f32_16x16x32_bf16 v[108:111], v[84:87], v[32:35], v[108:111]
    buffer_load_dwordx4 v0, s[20:23], s76 offen offset:0 lds
    v_mfma_f32_16x16x32_bf16 v[104:107], v[96:99], v[36:39], v[104:107]
    s_waitcnt lgkmcnt(3)
    v_mfma_f32_16x16x32_bf16 v[108:111], v[72:75], v[36:39], v[108:111]
    buffer_load_dwordx4 v0, s[20:23], s76 offen offset:1024 lds
    v_mfma_f32_16x16x32_bf16 v[112:115], v[76:79], v[32:35], v[112:115]
    s_waitcnt lgkmcnt(1)
    v_mfma_f32_16x16x32_bf16 v[116:119], v[88:91], v[32:35], v[116:119]
    buffer_load_dwordx4 v0, s[20:23], s76 offen offset:2048 lds
    s_add_u32 s76, s40, 9
    v_mfma_f32_16x16x32_bf16 v[112:115], v[92:95], v[36:39], v[112:115]
    s_waitcnt lgkmcnt(0)
    s_and_b32 s76, s76, 15
    s_mul_i32 s76, s76, 98304
    v_mfma_f32_16x16x32_bf16 v[116:119], v[100:103], v[36:39], v[116:119]
    s_add_u32 s78, s63, 0
    v_cvt_pk_bf16_f32 v103, v110, v111
    v_cvt_pk_bf16_f32 v100, v104, v105
    v_cvt_pk_bf16_f32 v101, v106, v107
    v_cvt_pk_bf16_f32 v102, v108, v109
    v_and_b32 v103, -2, v103
    buffer_store_dwordx4 v[100:103], v6, s[8:11], s78 offen offset:0
    s_nop 0
    v_cvt_pk_bf16_f32 v127, v118, v119
    v_cvt_pk_bf16_f32 v124, v112, v113
    v_cvt_pk_bf16_f32 v125, v114, v115
    v_cvt_pk_bf16_f32 v126, v116, v117
    v_and_b32 v127, -2, v127
    buffer_store_dwordx4 v[124:127], v6, s[8:11], s78 offen offset:1024
    v_cvt_pk_bf16_f32 v103, v110, v111
    s_nop 0
    v_cvt_pk_bf16_f32 v127, v118, v119
    s_add_u32 m0, s59, 122880
    s_nop 0
    buffer_load_dwordx4 v0, s[20:23], s76 offen offset:0 lds
    buffer_load_dwordx4 v0, s[20:23], s76 offen offset:1024 lds
    buffer_load_dwordx4 v0, s[20:23], s76 offen offset:2048 lds
    s_add_u32 s76, s40, 10
    s_and_b32 s76, s76, 15
    s_mul_i32 s76, s76, 98304
    s_add_u32 m0, s59, 135168
    s_nop 0
    buffer_load_dwordx4 v0, s[20:23], s76 offen offset:0 lds
    buffer_load_dwordx4 v0, s[20:23], s76 offen offset:1024 lds
    buffer_load_dwordx4 v0, s[20:23], s76 offen offset:2048 lds
    s_add_u32 s76, s40, 11
    s_and_b32 s76, s76, 15
    s_mul_i32 s76, s76, 98304
    s_add_u32 m0, s59, 147456
    s_nop 0
    buffer_load_dwordx4 v0, s[20:23], s76 offen offset:0 lds
    buffer_load_dwordx4 v0, s[20:23], s76 offen offset:1024 lds
    buffer_load_dwordx4 v0, s[20:23], s76 offen offset:2048 lds
    v_mov_b32 v96, 0x3f803f80
    v_mov_b32 v97, 0x3f803f80
    v_mov_b32 v98, 0x3f803f80
    v_mov_b32 v99, 0x3f803f80
    v_mfma_f32_16x16x32_bf16 v[108:111], v[100:103], v[100:103], 0
    v_mfma_f32_16x16x32_bf16 v[108:111], v[124:127], v[124:127], v[108:111]
    v_mfma_f32_16x16x32_bf16 v[104:107], v[96:99], v[100:103], 0
    v_mfma_f32_16x16x32_bf16 v[104:107], v[96:99], v[124:127], v[104:107]
    s_add_u32 s79, s60, 294912
    s_nop 4
    v_cndmask_b32 v108, v108, v109, s[44:45]
    v_cndmask_b32 v108, v108, v110, s[46:47]
    v_cndmask_b32 v108, v108, v111, s[48:49]
    v_and_b32 v105, -2, v108
    s_waitcnt vmcnt(9)
    s_add_u32 s73, s60, 49152
    buffer_load_dwordx4 v[40:43], v7, s[8:11], s73 offen offset:0 sc1
    buffer_load_dwordx4 v[44:47], v7, s[8:11], s73 offen offset:1024 sc1
    buffer_load_dwordx4 v[48:51], v7, s[8:11], s73 offen offset:2048 sc1
    buffer_load_dwordx4 v[52:55], v7, s[8:11], s73 offen offset:3072 sc1
    buffer_store_dwordx2 v[104:105], v10, s[8:11], s79 offen
    s_waitcnt vmcnt(3)
    v_bitop3_b32 v4, v43, v47, 1 bitop3:0xa8
    v_cmp_ne_u32 vcc, 0, v4
    s_nop 0
    s_cbranch_vccnz L_retry_13
L_back_14:
    ds_write_b128 v7, v[40:43] offset:16384
    ds_write_b128 v7, v[44:47] offset:17408
    s_waitcnt vmcnt(1)
    v_bitop3_b32 v4, v51, v55, 1 bitop3:0xa8
    v_cmp_ne_u32 vcc, 0, v4
    s_nop 0
    s_cbranch_vccnz L_retry_15
L_back_16:
    ds_write_b128 v7, v[48:51] offset:18432
    ds_write_b128 v7, v[52:55] offset:19456
    s_waitcnt lgkmcnt(0)
    s_waitcnt vmcnt(5)
    s_barrier
    ds_read_b128 v[40:43], v6 offset:16384
    ds_read_b128 v[44:47], v6 offset:17408
    ds_read_b128 v[48:51], v6 offset:18432
    s_add_u32 s73, s60, 32768
    buffer_load_dwordx4 v[24:27], v7, s[8:11], s73 offen offset:0 sc1
    buffer_load_dwordx4 v[28:31], v7, s[8:11], s73 offen offset:1024 sc1
    v_bfe_u32 v98, v6, 4, 4
    v_lshlrev_b32 v98, 3, v98
    v_and_b32 v99, 0x18, v98
    v_add_u32 v98, 163328, v98
    v_lshrrev_b32 v85, 8, v6
    buffer_load_dwordx4 v[32:35], v7, s[8:11], s73 offen offset:2048 sc1
    v_lshl_add_u32 v99, v85, 5, v99
    v_add_u32 v99, 163328, v99
    s_lshl_b32 s75, s36, 7
    s_add_u32 s75, s75, 163328
    v_lshrrev_b32 v85, 6, v6
    v_lshl_add_u32 v85, v85, 3, s75
    s_add_u32 s74, s60, 294912
    s_add_u32 s74, s74, s4
    buffer_load_dwordx4 v[36:39], v7, s[8:11], s73 offen offset:3072 sc1
    v_mov_b32 v88, 0x3f803f80
    v_mov_b32 v89, 0x3f803f80
    v_mov_b32 v90, 0x3f803f80
    v_mov_b32 v91, 0x3f803f80
    s_waitcnt lgkmcnt(2)
    v_mfma_f32_16x16x32_bf16 v[72:75], a[196:199], v[40:43], 0
    ds_read_b128 v[52:55], v6 offset:19456
    ds_read_b64_tr_b16 v[148:149], v1 offset:0
    v_mfma_f32_16x16x32_bf16 v[68:71], a[192:195], v[40:43], 0
    ds_read_b128 v[112:115], v6 offset:20480
    ds_read_b64_tr_b16 v[150:151], v1 offset:512
    v_mfma_f32_16x16x32_bf16 v[76:79], v[40:43], a[200:203], 0
    ds_read_b64_tr_b16 v[152:153], v1 offset:1024
    s_lshl_b32 s77, s37, 9
    ds_read_b64_tr_b16 v[154:155], v1 offset:1536
    v_mfma_f32_16x16x32_bf16 v[56:59], a[192:195], v[88:91], 0
    ds_read_b64_tr_b16 v[156:157], v1 offset:2048
    s_add_u32 s77, s77, 532480
    ds_read_b64_tr_b16 v[158:159], v1 offset:2560
    v_mfma_f32_16x16x32_bf16 v[60:63], a[196:199], v[88:91], 0
    ds_read_b64_tr_b16 v[160:161], v1 offset:12288
    buffer_load_dwordx4 v[80:83], v6, s[8:11], s74 offen sc1
    ds_read_b64_tr_b16 v[162:163], v1 offset:12800
    v_mfma_f32_16x16x32_bf16 v[64:67], v[88:91], a[200:203], 0
    s_waitcnt lgkmcnt(11)
    ds_read_b64_tr_b16 v[164:165], v1 offset:13312
    v_mfma_f32_16x16x32_bf16 v[72:75], a[208:211], v[44:47], v[72:75]
    ds_read_b128 v[116:119], v6 offset:21504
    ds_read_b64_tr_b16 v[166:167], v1 offset:13824
    v_mfma_f32_16x16x32_bf16 v[68:71], a[204:207], v[44:47], v[68:71]
    ds_read_b128 v[40:43], v6 offset:22528
    ds_read_b64_tr_b16 v[168:169], v1 offset:14336
    v_mfma_f32_16x16x32_bf16 v[76:79], v[44:47], a[212:215], v[76:79]
    ds_read_b64_tr_b16 v[170:171], v1 offset:14848
    v_lshrrev_b32 v94, 1, v6
    v_mfma_f32_16x16x32_bf16 v[56:59], a[204:207], v[88:91], v[56:59]
    buffer_load_dwordx2 v[92:93], v94, s[8:11], s77 offen sc1
    v_mfma_f32_16x16x32_bf16 v[60:63], a[208:211], v[88:91], v[60:63]
    v_mfma_f32_16x16x32_bf16 v[64:67], v[88:91], a[212:215], v[64:67]
    s_waitcnt lgkmcnt(15)
    v_mfma_f32_16x16x32_bf16 v[72:75], a[220:223], v[48:51], v[72:75]
    ds_read_b128 v[44:47], v6 offset:23552
    v_mfma_f32_16x16x32_bf16 v[68:71], a[216:219], v[48:51], v[68:71]
    v_mfma_f32_16x16x32_bf16 v[76:79], v[48:51], a[224:227], v[76:79]
    v_mfma_f32_16x16x32_bf16 v[56:59], a[216:219], v[88:91], v[56:59]
    s_waitcnt lgkmcnt(1)
    s_barrier
    s_add_u32 s76, s40, 12
    v_mfma_f32_16x16x32_bf16 v[60:63], a[220:223], v[88:91], v[60:63]
    s_and_b32 s76, s76, 15
    s_mul_i32 s76, s76, 98304
    s_add_u32 m0, s59, 98304
    v_mfma_f32_16x16x32_bf16 v[64:67], v[88:91], a[224:227], v[64:67]
    buffer_load_dwordx4 v0, s[20:23], s76 offen offset:0 lds
    v_mfma_f32_16x16x32_bf16 v[72:75], a[232:235], v[52:55], v[72:75]
    ds_read_b128 v[48:51], v6 offset:24576
    v_mfma_f32_16x16x32_bf16 v[68:71], a[228:231], v[52:55], v[68:71]
    buffer_load_dwordx4 v0, s[20:23], s76 offen offset:1024 lds
    v_mfma_f32_16x16x32_bf16 v[76:79], v[52:55], a[236:239], v[76:79]
    s_waitcnt vmcnt(4)
    v_bitop3_b32 v4, v27, v31, v35 bitop3:0xfe
    v_bitop3_b32 v4, v4, v39, 1 bitop3:0xa8
    v_mfma_f32_16x16x32_bf16 v[56:59], a[228:231], v[88:91], v[56:59]
    buffer_load_dwordx4 v0, s[20:23], s76 offen offset:2048 lds
    v_cmp_ne_u32 vcc, 0, v4
    v_mfma_f32_16x16x32_bf16 v[60:63], a[232:235], v[88:91], v[60:63]
    s_cbranch_vccnz L_retry_17
L_back_18:
    v_mfma_f32_16x16x32_bf16 v[64:67], v[88:91], a[236:239], v[64:67]
    s_waitcnt lgkmcnt(6)
    ds_write_b128 v7, v[24:27] offset:0
    v_mfma_f32_16x16x32_bf16 v[72:75], a[244:247], v[112:115], v[72:75]
    ds_read_b128 v[52:55], v6 offset:25600
    s_add_u32 s76, s40, 13
    v_mfma_f32_16x16x32_bf16 v[68:71], a[240:243], v[112:115], v[68:71]
    ds_write_b128 v7, v[28:31] offset:1024
    v_mfma_f32_16x16x32_bf16 v[76:79], v[112:115], a[248:251], v[76:79]
    s_and_b32 s76, s76, 15
    s_mul_i32 s76, s76, 98304
    s_add_u32 m0, s59, 110592
    v_mfma_f32_16x16x32_bf16 v[56:59], a[240:243], v[88:91], v[56:59]
    ds_write_b128 v7, v[32:35] offset:2048
    v_mfma_f32_16x16x32_bf16 v[60:63], a[244:247], v[88:91], v[60:63]
    buffer_load_dwordx4 v0, s[20:23], s76 offen offset:0 lds
    s_waitcnt vmcnt(5)
    v_mfma_f32_16x16x32_bf16 v[64:67], v[88:91], a[248:251], v[64:67]
    ds_write_b128 v7, v[36:39] offset:3072
    v_mfma_f32_16x16x32_bf16 v[72:75], v[128:131], v[116:119], v[72:75]
    ds_read_b128 v[112:115], v6 offset:26624
    buffer_load_dwordx4 v0, s[20:23], s76 offen offset:1024 lds
    v_mfma_f32_16x16x32_bf16 v[68:71], a[252:255], v[116:119], v[68:71]
    v_bitop3_b32 v5, v81, v83, 1 bitop3:0xa8
    v_cmp_ne_u32 vcc, 0, v5
    v_mfma_f32_16x16x32_bf16 v[76:79], v[116:119], v[132:135], v[76:79]
    buffer_load_dwordx4 v0, s[20:23], s76 offen offset:2048 lds
    s_cbranch_vccnz L_retry_19
L_back_20:
    ds_read_b64_tr_b16 v[172:173], v1 offset:24576
    v_mfma_f32_16x16x32_bf16 v[56:59], a[252:255], v[88:91], v[56:59]
    ds_read_b64_tr_b16 v[174:175], v1 offset:25088
    v_add_f32 v80, v80, v82
    v_mfma_f32_16x16x32_bf16 v[60:63], v[128:131], v[88:91], v[60:63]
    ds_read_b64_tr_b16 v[176:177], v1 offset:25600
    v_add_f32 v81, v81, v83
    v_mfma_f32_16x16x32_bf16 v[64:67], v[88:91], v[132:135], v[64:67]
    s_waitcnt lgkmcnt(10)
    ds_read_b64_tr_b16 v[178:179], v1 offset:26112
    v_mfma_f32_16x16x32_bf16 v[72:75], v[140:143], v[40:43], v[72:75]
    ds_read_b128 v[116:119], v6 offset:27648
    ds_read_b64_tr_b16 v[180:181], v1 offset:26624
    v_mfma_f32_16x16x32_bf16 v[68:71], v[136:139], v[40:43], v[68:71]
    ds_read_b64_tr_b16 v[182:183], v1 offset:27136
    v_add_f32_dpp v82, v80, v80 quad_perm:[1,0,3,2] row_mask:0xf bank_mask:0xf
    v_mfma_f32_16x16x32_bf16 v[76:79], v[40:43], v[144:147], v[76:79]
    ds_read_b64_tr_b16 v[184:185], v1 offset:36864
    v_add_f32_dpp v83, v81, v81 quad_perm:[1,0,3,2] row_mask:0xf bank_mask:0xf
    v_mfma_f32_16x16x32_bf16 v[56:59], v[136:139], v[88:91], v[56:59]
    ds_read_b64_tr_b16 v[186:187], v1 offset:37376
    v_add_f32_dpp v80, v82, v82 quad_perm:[2,3,0,1] row_mask:0xf bank_mask:0xf
    v_mfma_f32_16x16x32_bf16 v[60:63], v[140:143], v[88:91], v[60:63]
    ds_read_b64_tr_b16 v[188:189], v1 offset:37888
    v_add_f32_dpp v81, v83, v83 quad_perm:[2,3,0,1] row_mask:0xf bank_mask:0xf
    v_mfma_f32_16x16x32_bf16 v[64:67], v[88:91], v[144:147], v[64:67]
    s_waitcnt lgkmcnt(15)
    ds_read_b64_tr_b16 v[190:191], v1 offset:38400
    v_mfma_f32_16x16x32_bf16 v[72:75], v[152:155], v[44:47], v[72:75]
    ds_read_b128 v[40:43], v6 offset:28672
    ds_read_b64_tr_b16 v[192:193], v1 offset:38912
    v_mfma_f32_16x16x32_bf16 v[68:71], v[148:151], v[44:47], v[68:71]
    ds_read_b64_tr_b16 v[194:195], v1 offset:39424
    v_mul_f32 v80, 0x3b000000, v80
    v_mfma_f32_16x16x32_bf16 v[76:79], v[44:47], v[156:159], v[76:79]
    s_waitcnt vmcnt(6)
    v_mul_f32 v81, 0x3b000000, v81
    v_fma_f32 v81, -v80, v80, v81
    v_mfma_f32_16x16x32_bf16 v[56:59], v[148:151], v[88:91], v[56:59]
    v_max_f32 v81, 0, v81
    v_cvt_pk_bf16_f32 v80, v81, -v80
    v_mfma_f32_16x16x32_bf16 v[60:63], v[152:155], v[88:91], v[60:63]
    v_lshlrev_b32 v84, 16, v80
    v_add_f32 v84, 0x3727c5ac, v84
    v_mfma_f32_16x16x32_bf16 v[64:67], v[88:91], v[156:159], v[64:67]
    s_waitcnt lgkmcnt(15)
    v_cvt_pk_bf16_f32 v84, v84, v84
    v_lshlrev_b32 v84, 16, v84
    v_mfma_f32_16x16x32_bf16 v[72:75], v[164:167], v[48:51], v[72:75]
    ds_read_b128 v[44:47], v6 offset:29696
    v_xor_b32 v94, s5, v92
    v_mfma_f32_16x16x32_bf16 v[68:71], v[160:163], v[48:51], v[68:71]
    v_sqrt_f32 v84, v84
    v_mfma_f32_16x16x32_bf16 v[76:79], v[48:51], v[168:171], v[76:79]
    s_waitcnt lgkmcnt(1)
    s_barrier
    s_add_u32 s76, s40, 14
    v_mfma_f32_16x16x32_bf16 v[56:59], v[160:163], v[88:91], v[56:59]
    s_and_b32 s76, s76, 15
    s_mul_i32 s76, s76, 98304
    s_add_u32 m0, s59, 122880
    v_mfma_f32_16x16x32_bf16 v[60:63], v[164:167], v[88:91], v[60:63]
    buffer_load_dwordx4 v0, s[20:23], s76 offen offset:0 lds
    v_and_b32 v83, 0xffff0000, v80
    v_mfma_f32_16x16x32_bf16 v[64:67], v[88:91], v[168:171], v[64:67]
    s_waitcnt lgkmcnt(8)
    buffer_load_dwordx4 v0, s[20:23], s76 offen offset:1024 lds
    v_mfma_f32_16x16x32_bf16 v[72:75], v[176:179], v[52:55], v[72:75]
    ds_read_b128 v[48:51], v6 offset:30720
    v_cvt_pk_bf16_f32 v84, v84, v84
    v_mfma_f32_16x16x32_bf16 v[68:71], v[172:175], v[52:55], v[68:71]
    buffer_load_dwordx4 v0, s[20:23], s76 offen offset:2048 lds
    s_add_u32 s76, s40, 15
    v_mfma_f32_16x16x32_bf16 v[76:79], v[52:55], v[180:183], v[76:79]
    s_and_b32 s76, s76, 15
    s_mul_i32 s76, s76, 98304
    s_add_u32 m0, s59, 135168
    v_mfma_f32_16x16x32_bf16 v[56:59], v[172:175], v[88:91], v[56:59]
    buffer_load_dwordx4 v0, s[20:23], s76 offen offset:0 lds
    v_lshlrev_b32 v84, 16, v84
    v_mfma_f32_16x16x32_bf16 v[60:63], v[176:179], v[88:91], v[60:63]
    buffer_load_dwordx4 v0, s[20:23], s76 offen offset:1024 lds
    v_xor_b32 v95, s6, v93
    v_mfma_f32_16x16x32_bf16 v[64:67], v[88:91], v[180:183], v[64:67]
    s_waitcnt lgkmcnt(2)
    buffer_load_dwordx4 v0, s[20:23], s76 offen offset:2048 lds
    v_mfma_f32_16x16x32_bf16 v[72:75], v[188:191], v[112:115], v[72:75]
    ds_read_b128 v[52:55], v6 offset:31744
    ds_read_b64_tr_b16 v[196:197], v1 offset:49152
    v_mfma_f32_16x16x32_bf16 v[68:71], v[184:187], v[112:115], v[68:71]
    ds_read_b64_tr_b16 v[198:199], v1 offset:49664
    v_lshrrev_b32 v95, 8, v95
    v_mfma_f32_16x16x32_bf16 v[76:79], v[112:115], v[192:195], v[76:79]
    ds_read_b64_tr_b16 v[200:201], v1 offset:50176
    v_or_b32 v94, v94, v95
    v_mfma_f32_16x16x32_bf16 v[56:59], v[184:187], v[88:91], v[56:59]
    ds_read_b64_tr_b16 v[202:203], v1 offset:50688
    v_cmp_ne_u32 vcc, 0, v94
    v_mfma_f32_16x16x32_bf16 v[60:63], v[188:191], v[88:91], v[60:63]
    ds_read_b64_tr_b16 v[204:205], v1 offset:51200
    ds_read_b64_tr_b16 v[206:207], v1 offset:51712
    v_mfma_f32_16x16x32_bf16 v[64:67], v[88:91], v[192:195], v[64:67]
    s_waitcnt lgkmcnt(0)
    v_mfma_f32_16x16x32_bf16 v[72:75], v[200:203], v[116:119], v[72:75]
    s_cbranch_vccnz L_retry_23
L_back_24:
    v_mfma_f32_16x16x32_bf16 v[68:71], v[196:199], v[116:119], v[68:71]
    v_rcp_f32 v82, v84
    v_mfma_f32_16x16x32_bf16 v[76:79], v[116:119], v[204:207], v[76:79]
    s_waitcnt vmcnt(6)
    s_barrier
    v_mov_b32 v92, -1
    v_mfma_f32_16x16x32_bf16 v[56:59], v[196:199], v[88:91], v[56:59]
    ds_read_b64_tr_b16 v[208:209], v1 offset:0
    v_mov_b32 v93, -1
    v_mfma_f32_16x16x32_bf16 v[60:63], v[200:203], v[88:91], v[60:63]
    ds_read_b64_tr_b16 v[210:211], v1 offset:512
    ds_read_b64_tr_b16 v[212:213], v1 offset:1024
    ds_read_b64_tr_b16 v[214:215], v1 offset:1536
    ds_read_b64_tr_b16 v[216:217], v1 offset:2048
    ds_read_b64_tr_b16 v[218:219], v1 offset:2560
    v_mfma_f32_16x16x32_bf16 v[64:67], v[88:91], v[204:207], v[64:67]
    s_waitcnt lgkmcnt(0)
    ds_read_b64_tr_b16 v[220:221], v1 offset:12288
    ds_write_b64 v85, v[82:83]
    ds_read_b64_tr_b16 v[222:223], v1 offset:12800
    v_mfma_f32_16x16x32_bf16 v[72:75], v[212:215], v[40:43], v[72:75]
    ds_read_b64_tr_b16 v[224:225], v1 offset:13312
    v_mov_b32 v94, -1
    v_mfma_f32_16x16x32_bf16 v[68:71], v[208:211], v[40:43], v[68:71]
    ds_read_b64_tr_b16 v[226:227], v1 offset:13824
    v_mov_b32 v95, -1
    v_mfma_f32_16x16x32_bf16 v[76:79], v[40:43], v[216:219], v[76:79]
    ds_read_b64_tr_b16 v[228:229], v1 offset:14336
    s_add_u32 s85, s62, 65536
    ds_read_b64_tr_b16 v[230:231], v1 offset:14848
    v_mfma_f32_16x16x32_bf16 v[56:59], v[208:211], v[88:91], v[56:59]
    buffer_store_dwordx4 v[92:95], v6, s[8:11], s85 offen sc1
    v_mfma_f32_16x16x32_bf16 v[60:63], v[212:215], v[88:91], v[60:63]
    v_mfma_f32_16x16x32_bf16 v[64:67], v[88:91], v[216:219], v[64:67]
    s_waitcnt lgkmcnt(5)
    s_barrier
    s_waitcnt lgkmcnt(0)
    v_mfma_f32_16x16x32_bf16 v[72:75], v[224:227], v[44:47], v[72:75]
    ds_read_b128 v[112:115], v6 offset:0
    s_add_u32 s73, s60, 16384
    v_mfma_f32_16x16x32_bf16 v[68:71], v[220:223], v[44:47], v[68:71]
    ds_read_b128 v[116:119], v6 offset:1024
    s_lshl_b32 s72, s36, 12
    v_mfma_f32_16x16x32_bf16 v[76:79], v[44:47], v[228:231], v[76:79]
    s_add_u32 m0, s72, 16384
    s_nop 0
    buffer_load_dwordx4 v7, s[8:11], s73 offen offset:0 sc1 lds
    v_mfma_f32_16x16x32_bf16 v[56:59], v[220:223], v[88:91], v[56:59]
    ds_read_b64 v[108:109], v98 offset:384
    v_mfma_f32_16x16x32_bf16 v[60:63], v[224:227], v[88:91], v[60:63]
    s_waitcnt vmcnt(2)
    s_barrier
    ds_read_b64_tr_b16 v[232:233], v1 offset:24576
    ds_read_b64_tr_b16 v[234:235], v1 offset:25088
    ds_read_b64_tr_b16 v[236:237], v1 offset:25600
    ds_read_b64_tr_b16 v[238:239], v1 offset:26112
    ds_read_b64_tr_b16 v[240:241], v1 offset:26624
    ds_read_b64_tr_b16 v[242:243], v1 offset:27136
    ds_read_b64 v[110:111], v99 offset:384
    ds_read_b64_tr_b16 v[244:245], v1 offset:36864
    v_mfma_f32_16x16x32_bf16 v[64:67], v[88:91], v[228:231], v[64:67]
    s_waitcnt lgkmcnt(2)
    ds_read_b64_tr_b16 v[246:247], v1 offset:37376
    ds_read_b64 v[104:105], v98 offset:256
    ds_read_b64_tr_b16 v[248:249], v1 offset:37888
    v_mfma_f32_16x16x32_bf16 v[72:75], v[236:239], v[48:51], v[72:75]
    ds_read_b128 v[40:43], v6 offset:2048
    s_add_u32 m0, s72, 16384
    s_nop 0
    buffer_load_dwordx4 v7, s[8:11], s73 offen offset:1024 sc1 lds
    ds_read_b64_tr_b16 v[250:251], v1 offset:38400
    v_mfma_f32_16x16x32_bf16 v[68:71], v[232:235], v[48:51], v[68:71]
    ds_read_b128 v[44:47], v6 offset:3072
    ds_read_b64_tr_b16 v[252:253], v1 offset:38912
    v_mfma_f32_16x16x32_bf16 v[76:79], v[48:51], v[240:243], v[76:79]
    ds_read_b64_tr_b16 v[254:255], v1 offset:39424
    v_mfma_f32_16x16x32_bf16 v[56:59], v[232:235], v[88:91], v[56:59]
    s_add_u32 m0, s72, 16384
    s_nop 0
    buffer_load_dwordx4 v7, s[8:11], s73 offen offset:2048 sc1 lds
    ds_read_b64 v[106:107], v99 offset:256
    v_mfma_f32_16x16x32_bf16 v[60:63], v[236:239], v[88:91], v[60:63]
    v_mfma_f32_16x16x32_bf16 v[64:67], v[88:91], v[240:243], v[64:67]
    s_waitcnt lgkmcnt(1)
    v_mfma_f32_16x16x32_bf16 v[72:75], v[248:251], v[52:55], v[72:75]
    ds_read_b128 v[48:51], v6 offset:4096
    s_waitcnt lgkmcnt(2)
    v_mfma_f32_16x16x32_bf16 v[68:71], v[244:247], v[52:55], v[68:71]
    s_add_u32 m0, s72, 16384
    s_nop 0
    buffer_load_dwordx4 v7, s[8:11], s73 offen offset:3072 sc1 lds
    v_mfma_f32_16x16x32_bf16 v[76:79], v[52:55], v[252:255], v[76:79]
    s_barrier
    s_add_u32 s76, s70, 0
    v_mfma_f32_16x16x32_bf16 v[56:59], v[244:247], v[88:91], v[56:59]
    v_mfma_f32_16x16x32_bf16 v[60:63], v[248:251], v[88:91], v[60:63]
    s_add_u32 m0, s71, 98304
    s_nop 0
    buffer_load_dwordx4 v6, s[8:11], s76 offen offset:0 sc1 lds
    v_mfma_f32_16x16x32_bf16 v[64:67], v[88:91], v[252:255], v[64:67]
    s_waitcnt lgkmcnt(15)
    s_nop 1
    v_cndmask_b32 v121, v56, v57, s[44:45]
    v_cndmask_b32 v121, v121, v58, s[46:47]
    v_cndmask_b32 v121, v121, v59, s[48:49]
    v_cndmask_b32 v122, v60, v61, s[44:45]
    v_cndmask_b32 v122, v122, v62, s[46:47]
    v_cndmask_b32 v122, v122, v63, s[48:49]
    v_mov_b32 v123, v64
    v_mfma_f32_16x16x32_bf16 v[60:63], a[196:199], v[112:115], 0
    ds_read_b128 v[52:55], v6 offset:5120
    s_waitcnt lgkmcnt(12)
    v_mfma_f32_16x16x32_bf16 v[56:59], a[192:195], v[112:115], 0
    s_add_u32 m0, s71, 98304
    s_nop 0
    buffer_load_dwordx4 v6, s[8:11], s76 offen offset:1024 sc1 lds
    v_mfma_f32_16x16x32_bf16 v[64:67], v[112:115], a[200:203], 0
    v_fmac_f32_dpp v72, v122, v109 row_newbcast:0 row_mask:0xf bank_mask:0xf
    v_fmac_f32_dpp v73, v122, v109 row_newbcast:1 row_mask:0xf bank_mask:0xf
    v_mfma_f32_16x16x32_bf16 v[60:63], a[208:211], v[116:119], v[60:63]
    ds_read_b128 v[112:115], v6 offset:6144
    v_fmac_f32_dpp v74, v122, v109 row_newbcast:2 row_mask:0xf bank_mask:0xf
    v_mfma_f32_16x16x32_bf16 v[56:59], a[204:207], v[116:119], v[56:59]
    s_add_u32 m0, s71, 98304
    s_nop 0
    buffer_load_dwordx4 v6, s[8:11], s76 offen offset:2048 sc1 lds
    v_mfma_f32_16x16x32_bf16 v[64:67], v[116:119], a[212:215], v[64:67]
    s_waitcnt lgkmcnt(6)
    v_fmac_f32_dpp v75, v122, v109 row_newbcast:3 row_mask:0xf bank_mask:0xf
    v_mul_f32 v72, v108, v72
    v_mfma_f32_16x16x32_bf16 v[60:63], a[220:223], v[40:43], v[60:63]
    ds_read_b128 v[116:119], v6 offset:7168
    v_mul_f32 v73, v108, v73
    v_mfma_f32_16x16x32_bf16 v[56:59], a[216:219], v[40:43], v[56:59]
    s_add_u32 m0, s71, 98304
    s_nop 0
    buffer_load_dwordx4 v6, s[8:11], s76 offen offset:3072 sc1 lds
    v_mfma_f32_16x16x32_bf16 v[64:67], v[40:43], a[224:227], v[64:67]
    s_add_u32 s76, s70, 4096
    v_mul_f32 v74, v108, v74
    v_mul_f32 v75, v108, v75
    v_mfma_f32_16x16x32_bf16 v[60:63], a[232:235], v[44:47], v[60:63]
    ds_read_b128 v[40:43], v6 offset:8192
    v_cvt_pk_bf16_f32 v86, v72, v73
    v_mfma_f32_16x16x32_bf16 v[56:59], a[228:231], v[44:47], v[56:59]
    s_add_u32 m0, s71, 102400
    s_nop 0
    buffer_load_dwordx4 v6, s[8:11], s76 offen offset:0 sc1 lds
    v_mfma_f32_16x16x32_bf16 v[64:67], v[44:47], a[236:239], v[64:67]
    s_waitcnt lgkmcnt(3)
    v_cvt_pk_bf16_f32 v87, v74, v75
    v_fmac_f32_dpp v68, v121, v109 row_newbcast:0 row_mask:0xf bank_mask:0xf
    v_mfma_f32_16x16x32_bf16 v[60:63], a[244:247], v[48:51], v[60:63]
    ds_read_b128 v[44:47], v6 offset:9216
    v_fmac_f32_dpp v69, v121, v109 row_newbcast:1 row_mask:0xf bank_mask:0xf
    v_mfma_f32_16x16x32_bf16 v[56:59], a[240:243], v[48:51], v[56:59]
    s_add_u32 m0, s71, 102400
    s_nop 0
    buffer_load_dwordx4 v6, s[8:11], s76 offen offset:1024 sc1 lds
    v_mfma_f32_16x16x32_bf16 v[64:67], v[48:51], a[248:251], v[64:67]
    v_fmac_f32_dpp v70, v121, v109 row_newbcast:2 row_mask:0xf bank_mask:0xf
    v_fmac_f32_dpp v71, v121, v109 row_newbcast:3 row_mask:0xf bank_mask:0xf
    v_mfma_f32_16x16x32_bf16 v[60:63], v[128:131], v[52:55], v[60:63]
    ds_read_b128 v[48:51], v6 offset:10240
    v_cvt_pk_bf16_f32 v82, v68, v69
    v_mfma_f32_16x16x32_bf16 v[56:59], a[252:255], v[52:55], v[56:59]
    s_add_u32 m0, s71, 102400
    s_nop 0
    buffer_load_dwordx4 v6, s[8:11], s76 offen offset:2048 sc1 lds
    v_mfma_f32_16x16x32_bf16 v[64:67], v[52:55], v[132:135], v[64:67]
    s_waitcnt lgkmcnt(3)
    v_cvt_pk_bf16_f32 v83, v70, v71
    v_mul_f32 v97, s43, v108
    v_mfma_f32_16x16x32_bf16 v[60:63], v[140:143], v[112:115], v[60:63]
    ds_read_b128 v[52:55], v6 offset:11264
    v_fmac_f32_dpp v76, v111, v123 row_newbcast:0 row_mask:0xf bank_mask:0xf
    v_mfma_f32_16x16x32_bf16 v[56:59], v[136:139], v[112:115], v[56:59]
    s_add_u32 m0, s71, 102400
    s_nop 0
    buffer_load_dwordx4 v6, s[8:11], s76 offen offset:3072 sc1 lds
    v_mfma_f32_16x16x32_bf16 v[64:67], v[112:115], v[144:147], v[64:67]
    s_add_u32 s76, s70, 8192
    v_fmac_f32_dpp v77, v111, v123 row_newbcast:1 row_mask:0xf bank_mask:0xf
    v_fmac_f32_dpp v78, v111, v123 row_newbcast:2 row_mask:0xf bank_mask:0xf
    v_mfma_f32_16x16x32_bf16 v[60:63], v[152:155], v[116:119], v[60:63]
    ds_read_b128 v[112:115], v6 offset:12288
    v_fmac_f32_dpp v79, v111, v123 row_newbcast:3 row_mask:0xf bank_mask:0xf
    v_mfma_f32_16x16x32_bf16 v[56:59], v[148:151], v[116:119], v[56:59]
    s_add_u32 m0, s71, 106496
    s_nop 0
    buffer_load_dwordx4 v6, s[8:11], s76 offen offset:0 sc1 lds
    v_mfma_f32_16x16x32_bf16 v[64:67], v[116:119], v[156:159], v[64:67]
    s_waitcnt lgkmcnt(3)
    v_mul_f32_dpp v76, v110, v76 row_newbcast:0 row_mask:0xf bank_mask:0xf
    v_mul_f32_dpp v77, v110, v77 row_newbcast:1 row_mask:0xf bank_mask:0xf
    v_mfma_f32_16x16x32_bf16 v[60:63], v[164:167], v[40:43], v[60:63]
    ds_read_b128 v[116:119], v6 offset:13312
    v_mul_f32_dpp v78, v110, v78 row_newbcast:2 row_mask:0xf bank_mask:0xf
    v_mfma_f32_16x16x32_bf16 v[56:59], v[160:163], v[40:43], v[56:59]
    s_add_u32 m0, s71, 106496
    s_nop 0
    buffer_load_dwordx4 v6, s[8:11], s76 offen offset:1024 sc1 lds
    v_mfma_f32_16x16x32_bf16 v[64:67], v[40:43], v[168:171], v[64:67]
    v_mul_f32_dpp v79, v110, v79 row_newbcast:3 row_mask:0xf bank_mask:0xf
    v_cvt_pk_bf16_f32 v94, v76, v77
    v_mfma_f32_16x16x32_bf16 v[60:63], v[176:179], v[44:47], v[60:63]
    ds_read_b128 v[40:43], v6 offset:14336
    v_cvt_pk_bf16_f32 v95, v78, v79
    v_mfma_f32_16x16x32_bf16 v[56:59], v[172:175], v[44:47], v[56:59]
    ds_read_b64 v[108:109], v98 offset:128
    v_mfma_f32_16x16x32_bf16 v[64:67], v[44:47], v[180:183], v[64:67]
    s_waitcnt lgkmcnt(4)
    ds_read_b64 v[110:111], v99 offset:128
    v_mfma_f32_16x16x32_bf16 v[60:63], v[188:191], v[48:51], v[60:63]
    ds_read_b128 v[44:47], v6 offset:15360
    v_mov_b32 v68, v86
    v_mfma_f32_16x16x32_bf16 v[56:59], v[184:187], v[48:51], v[56:59]
    s_add_u32 m0, s71, 106496
    s_nop 0
    buffer_load_dwordx4 v6, s[8:11], s76 offen offset:2048 sc1 lds
    v_mfma_f32_16x16x32_bf16 v[64:67], v[48:51], v[192:195], v[64:67]
    v_mov_b32 v69, v87
    s_add_u32 s80, s62, 32768
    v_mfma_f32_16x16x32_bf16 v[60:63], v[200:203], v[52:55], v[60:63]
    v_mov_b32 v70, v94
    v_min_u32 v71, -2, v95
    v_mfma_f32_16x16x32_bf16 v[56:59], v[196:199], v[52:55], v[56:59]
    s_waitcnt vmcnt(15)
    buffer_store_dwordx4 v[68:71], v6, s[8:11], s80 offen sc1
    v_mfma_f32_16x16x32_bf16 v[64:67], v[52:55], v[204:207], v[64:67]
    s_waitcnt lgkmcnt(5)
    v_mfma_f32_16x16x32_bf16 v[60:63], v[212:215], v[112:115], v[60:63]
    s_add_u32 m0, s71, 106496
    s_nop 0
    buffer_load_dwordx4 v6, s[8:11], s76 offen offset:3072 sc1 lds
    v_mfma_f32_16x16x32_bf16 v[56:59], v[208:211], v[112:115], v[56:59]
    s_add_u32 s76, s70, 12288
    v_mfma_f32_16x16x32_bf16 v[64:67], v[112:115], v[216:219], v[64:67]
    s_waitcnt lgkmcnt(0) vmcnt(13)
    s_barrier
    v_mfma_f32_16x16x32_bf16 v[60:63], v[224:227], v[116:119], v[60:63]
    ds_read_b128 v[48:51], v6 offset:16384
    v_mfma_f32_16x16x32_bf16 v[56:59], v[220:223], v[116:119], v[56:59]
    ds_read_b128 v[52:55], v6 offset:17408
    v_mfma_f32_16x16x32_bf16 v[64:67], v[116:119], v[228:231], v[64:67]
    s_add_u32 m0, s71, 110592
    s_nop 0
    buffer_load_dwordx4 v6, s[8:11], s76 offen offset:0 sc1 lds
    v_mfma_f32_16x16x32_bf16 v[60:63], v[236:239], v[40:43], v[60:63]
    ds_read_b128 v[112:115], v6 offset:18432
    v_mfma_f32_16x16x32_bf16 v[56:59], v[232:235], v[40:43], v[56:59]
    ds_read_b128 v[116:119], v6 offset:19456
    v_mfma_f32_16x16x32_bf16 v[64:67], v[40:43], v[240:243], v[64:67]
    s_add_u32 m0, s71, 110592
    s_nop 0
    buffer_load_dwordx4 v6, s[8:11], s76 offen offset:1024 sc1 lds
    v_mfma_f32_16x16x32_bf16 v[60:63], v[248:251], v[44:47], v[60:63]
    ds_read_b128 v[40:43], v6 offset:20480
    v_mfma_f32_16x16x32_bf16 v[56:59], v[244:247], v[44:47], v[56:59]
    v_mfma_f32_16x16x32_bf16 v[64:67], v[44:47], v[252:255], v[64:67]
    s_waitcnt lgkmcnt(3)
    s_waitcnt lgkmcnt(15)
    s_nop 0
    v_mfma_f32_16x16x32_bf16 v[72:75], a[196:199], v[48:51], 0
    ds_read_b128 v[44:47], v6 offset:21504
    v_fmac_f32_dpp v60, v122, v105 row_newbcast:0 row_mask:0xf bank_mask:0xf
    v_mfma_f32_16x16x32_bf16 v[68:71], a[192:195], v[48:51], 0
    s_add_u32 m0, s71, 110592
    s_nop 0
    buffer_load_dwordx4 v6, s[8:11], s76 offen offset:2048 sc1 lds
    v_mfma_f32_16x16x32_bf16 v[76:79], v[48:51], a[200:203], 0
    v_fmac_f32_dpp v61, v122, v105 row_newbcast:1 row_mask:0xf bank_mask:0xf
    v_fmac_f32_dpp v62, v122, v105 row_newbcast:2 row_mask:0xf bank_mask:0xf
    v_mfma_f32_16x16x32_bf16 v[72:75], a[208:211], v[52:55], v[72:75]
    ds_read_b128 v[48:51], v6 offset:22528
    v_fmac_f32_dpp v63, v122, v105 row_newbcast:3 row_mask:0xf bank_mask:0xf
    v_mfma_f32_16x16x32_bf16 v[68:71], a[204:207], v[52:55], v[68:71]
    s_add_u32 m0, s69, 110592
    s_nop 0
    buffer_load_dwordx4 v6, s[8:11], s76 offen offset:3072 sc1 lds
    v_mfma_f32_16x16x32_bf16 v[76:79], v[52:55], a[212:215], v[76:79]
    s_waitcnt lgkmcnt(3)
    s_add_u32 s73, s60, 0
    s_lshl_b32 s72, s36, 12
    v_mfma_f32_16x16x32_bf16 v[72:75], a[220:223], v[112:115], v[72:75]
    ds_read_b128 v[52:55], v6 offset:23552
    v_mul_f32 v60, v104, v60
    v_mfma_f32_16x16x32_bf16 v[68:71], a[216:219], v[112:115], v[68:71]
    v_mul_f32 v61, v104, v61
    v_mul_f32 v62, v104, v62
    v_mfma_f32_16x16x32_bf16 v[76:79], v[112:115], a[224:227], v[76:79]
    s_add_u32 m0, s72, 0
    s_nop 0
    buffer_load_dwordx4 v7, s[8:11], s73 offen offset:0 sc1 lds
    v_mfma_f32_16x16x32_bf16 v[72:75], a[232:235], v[116:119], v[72:75]
    ds_read_b128 v[112:115], v6 offset:24576
    v_mul_f32 v63, v104, v63
    v_mfma_f32_16x16x32_bf16 v[68:71], a[228:231], v[116:119], v[68:71]
    v_cvt_pk_bf16_f32 v84, v60, v61
    v_cvt_pk_bf16_f32 v85, v62, v63
    v_mfma_f32_16x16x32_bf16 v[76:79], v[116:119], a[236:239], v[76:79]
    s_waitcnt lgkmcnt(3)
    v_fmac_f32_dpp v56, v121, v105 row_newbcast:0 row_mask:0xf bank_mask:0xf
    v_fmac_f32_dpp v57, v121, v105 row_newbcast:1 row_mask:0xf bank_mask:0xf
    v_mfma_f32_16x16x16_bf16 v[60:63], v[84:85], v[82:83], v[16:19]
    s_add_u32 m0, s72, 0
    s_nop 0
    buffer_load_dwordx4 v7, s[8:11], s73 offen offset:1024 sc1 lds
    v_mfma_f32_16x16x32_bf16 v[72:75], a[244:247], v[40:43], v[72:75]
    ds_read_b128 v[116:119], v6 offset:25600
    v_fmac_f32_dpp v58, v121, v105 row_newbcast:2 row_mask:0xf bank_mask:0xf
    v_mfma_f32_16x16x32_bf16 v[68:71], a[240:243], v[40:43], v[68:71]
    v_fmac_f32_dpp v59, v121, v105 row_newbcast:3 row_mask:0xf bank_mask:0xf
    v_cvt_pk_bf16_f32 v80, v56, v57
    v_mfma_f32_16x16x32_bf16 v[76:79], v[40:43], a[248:251], v[76:79]
    v_cvt_pk_bf16_f32 v81, v58, v59
    v_mul_f32 v96, s43, v104
    v_mfma_f32_16x16x16_bf16 v[56:59], v[86:87], v[82:83], v[16:19]
    s_add_u32 m0, s72, 0
    s_nop 0
    buffer_load_dwordx4 v7, s[8:11], s73 offen offset:2048 sc1 lds
    v_mfma_f32_16x16x32_bf16 v[72:75], v[128:131], v[44:47], v[72:75]
    ds_read_b128 v[40:43], v6 offset:26624
    v_fmac_f32_dpp v64, v107, v123 row_newbcast:0 row_mask:0xf bank_mask:0xf
    v_mfma_f32_16x16x32_bf16 v[68:71], a[252:255], v[44:47], v[68:71]
    v_fmac_f32_dpp v65, v107, v123 row_newbcast:1 row_mask:0xf bank_mask:0xf
    v_fmac_f32_dpp v66, v107, v123 row_newbcast:2 row_mask:0xf bank_mask:0xf
    v_mfma_f32_16x16x32_bf16 v[76:79], v[44:47], v[132:135], v[76:79]
    s_waitcnt lgkmcnt(3)
    v_fmac_f32_dpp v67, v107, v123 row_newbcast:3 row_mask:0xf bank_mask:0xf
    v_mul_f32_dpp v64, v106, v64 row_newbcast:0 row_mask:0xf bank_mask:0xf
    v_mfma_f32_16x16x32_bf16 v[72:75], v[140:143], v[48:51], v[72:75]
    ds_read_b128 v[44:47], v6 offset:27648
    v_mul_f32_dpp v65, v106, v65 row_newbcast:1 row_mask:0xf bank_mask:0xf
    v_mfma_f32_16x16x32_bf16 v[68:71], v[136:139], v[48:51], v[68:71]
    s_add_u32 m0, s72, 0
    s_nop 0
    buffer_load_dwordx4 v7, s[8:11], s73 offen offset:3072 sc1 lds
    v_mfma_f32_16x16x32_bf16 v[76:79], v[48:51], v[144:147], v[76:79]
    v_mul_f32_dpp v66, v106, v66 row_newbcast:2 row_mask:0xf bank_mask:0xf
    v_mul_f32_dpp v67, v106, v67 row_newbcast:3 row_mask:0xf bank_mask:0xf
    v_mfma_f32_16x16x32_bf16 v[72:75], v[152:155], v[52:55], v[72:75]
    ds_read_b128 v[48:51], v6 offset:28672
    v_cvt_pk_bf16_f32 v92, v64, v65
    v_mfma_f32_16x16x32_bf16 v[68:71], v[148:151], v[52:55], v[68:71]
    v_cvt_pk_bf16_f32 v93, v66, v67
    v_cndmask_b32 v56, v60, v56, s[28:29]
    v_mfma_f32_16x16x32_bf16 v[76:79], v[52:55], v[156:159], v[76:79]
    s_waitcnt lgkmcnt(3)
    ds_read_b64 v[104:105], v98 offset:0
    v_mfma_f32_16x16x32_bf16 v[72:75], v[164:167], v[112:115], v[72:75]
    ds_read_b128 v[52:55], v6 offset:29696
    v_cndmask_b32 v57, v61, v57, s[30:31]
    v_mfma_f32_16x16x32_bf16 v[68:71], v[160:163], v[112:115], v[68:71]
    ds_read_b64 v[106:107], v99 offset:0
    v_cndmask_b32 v58, v62, v58, s[32:33]
    v_mfma_f32_16x16x32_bf16 v[76:79], v[112:115], v[168:171], v[76:79]
    v_cndmask_b32 v59, v63, v59, s[34:35]
    v_max3_f32 v60, v56, v57, v58
    v_mfma_f32_16x16x32_bf16 v[72:75], v[176:179], v[116:119], v[72:75]
    ds_read_b128 v[112:115], v6 offset:30720
    v_max_f32 v61, v60, v59
    v_mfma_f32_16x16x32_bf16 v[68:71], v[172:175], v[116:119], v[68:71]
    v_max_f32 v60, v60, v59
    s_nop 0
    v_mfma_f32_16x16x32_bf16 v[76:79], v[116:119], v[180:183], v[76:79]
    s_waitcnt lgkmcnt(5)
    v_permlane32_swap_b32 v60, v61
    v_mfma_f32_16x16x32_bf16 v[72:75], v[188:191], v[40:43], v[72:75]
    ds_read_b128 v[116:119], v6 offset:31744
    v_max_f32 v62, v60, v61
    v_mfma_f32_16x16x32_bf16 v[68:71], v[184:187], v[40:43], v[68:71]
    s_add_u32 s75, s61, 32768
    v_max_f32 v60, v60, v61
    s_nop 0
    v_mfma_f32_16x16x32_bf16 v[76:79], v[40:43], v[192:195], v[76:79]
    buffer_load_dwordx4 v[88:91], v6, s[8:11], s75 offen sc1
    v_mfma_f32_16x16x32_bf16 v[72:75], v[200:203], v[44:47], v[72:75]
    v_permlane16_swap_b32 v60, v62
    v_mfma_f32_16x16x32_bf16 v[68:71], v[196:199], v[44:47], v[68:71]
    v_max_f32 v60, v60, v62
    v_mul_f32 v60, -v60, v97
    v_mfma_f32_16x16x32_bf16 v[76:79], v[44:47], v[204:207], v[76:79]
    s_waitcnt lgkmcnt(5)
    v_fma_f32 v56, v56, v97, v60
    v_fma_f32 v57, v57, v97, v60
    v_mfma_f32_16x16x32_bf16 v[72:75], v[212:215], v[48:51], v[72:75]
    v_fma_f32 v58, v58, v97, v60
    v_fma_f32 v59, v59, v97, v60
    v_mfma_f32_16x16x32_bf16 v[68:71], v[208:211], v[48:51], v[68:71]
    v_exp_f32 v56, v56
    v_mfma_f32_16x16x32_bf16 v[76:79], v[48:51], v[216:219], v[76:79]
    s_waitcnt lgkmcnt(0) vmcnt(1)
    s_barrier
    v_mfma_f32_16x16x32_bf16 v[72:75], v[224:227], v[52:55], v[72:75]
    ds_read_b128 v[40:43], v6 offset:0
    s_lshl_b32 s73, s37, 16
    v_mfma_f32_16x16x32_bf16 v[68:71], v[220:223], v[52:55], v[68:71]
    ds_read_b128 v[44:47], v6 offset:1024
    s_add_u32 s73, s73, 64512
    v_mfma_f32_16x16x32_bf16 v[76:79], v[52:55], v[228:231], v[76:79]
    s_mov_b32 m0, 162816
    v_exp_f32 v57, v57
    v_mfma_f32_16x16x32_bf16 v[72:75], v[236:239], v[112:115], v[72:75]
    ds_read_b128 v[48:51], v6 offset:2048
    v_mfma_f32_16x16x32_bf16 v[68:71], v[232:235], v[112:115], v[68:71]
    ds_read_b128 v[52:55], v6 offset:3072
    v_mfma_f32_16x16x32_bf16 v[76:79], v[112:115], v[240:243], v[76:79]
    buffer_load_dwordx4 v6, s[8:11], s73 offen sc1 lds
    v_mfma_f32_16x16x32_bf16 v[72:75], v[248:251], v[116:119], v[72:75]
    ds_read_b128 v[112:115], v6 offset:4096
    v_mfma_f32_16x16x32_bf16 v[68:71], v[244:247], v[116:119], v[68:71]
    v_exp_f32 v58, v58
    v_mfma_f32_16x16x32_bf16 v[76:79], v[116:119], v[252:255], v[76:79]
    s_waitcnt lgkmcnt(3)
    v_exp_f32 v59, v59
    v_cvt_pk_bf16_f32 v0, v56, v57
    v_cvt_pk_bf16_f32 v1, v58, v59
    v_and_b32 v62, v0, v20
    v_and_b32 v63, v1, v21
    v_mfma_f32_16x16x16_bf16 v[56:59], v[22:23], v[0:1], 0
    v_xor_b32 v60, v0, v62
    v_xor_b32 v61, v1, v63
    s_nop 1
    v_mfma_f32_16x16x32_bf16 v[64:67], v[92:95], v[60:63], 0
    s_nop 2
    v_rcp_f32 v56, v56
    s_nop 3
    v_mul_f32 v64, v56, v64
    v_mul_f32 v65, v56, v65
    v_mul_f32 v66, v56, v66
    v_mul_f32 v67, v56, v67
    v_cvt_pk_bf16_f32 v1, v66, v67
    v_cvt_pk_bf16_f32 v0, v64, v65
    v_mfma_f32_16x16x32_bf16 v[60:63], a[196:199], v[40:43], 0
    ds_read_b128 v[116:119], v6 offset:5120
    s_waitcnt lgkmcnt(15)
    v_mfma_f32_16x16x32_bf16 v[56:59], a[192:195], v[40:43], 0
    ds_read_b128 v[24:27], v6 offset:6144
    v_fmac_f32_dpp v72, v122, v109 row_newbcast:0 row_mask:0xf bank_mask:0xf
    v_mfma_f32_16x16x32_bf16 v[64:67], v[40:43], a[200:203], 0
    v_fmac_f32_dpp v73, v122, v109 row_newbcast:1 row_mask:0xf bank_mask:0xf
    v_fmac_f32_dpp v74, v122, v109 row_newbcast:2 row_mask:0xf bank_mask:0xf
    v_mfma_f32_16x16x32_bf16 v[60:63], a[208:211], v[44:47], v[60:63]
    ds_read_b128 v[28:31], v6 offset:7168
    v_fmac_f32_dpp v75, v122, v109 row_newbcast:3 row_mask:0xf bank_mask:0xf
    v_mfma_f32_16x16x32_bf16 v[56:59], a[204:207], v[44:47], v[56:59]
    ds_read_b128 v[32:35], v6 offset:8192
    v_mul_f32 v72, v108, v72
    v_mfma_f32_16x16x32_bf16 v[64:67], v[44:47], a[212:215], v[64:67]
    s_waitcnt lgkmcnt(5)
    v_mul_f32 v73, v108, v73
    v_mul_f32 v74, v108, v74
    v_mfma_f32_16x16x32_bf16 v[60:63], a[220:223], v[48:51], v[60:63]
    ds_read_b128 v[36:39], v6 offset:9216
    v_mul_f32 v75, v108, v75
    v_mfma_f32_16x16x32_bf16 v[56:59], a[216:219], v[48:51], v[56:59]
    ds_read_b128 v[40:43], v6 offset:10240
    v_cvt_pk_bf16_f32 v86, v72, v73
    v_mfma_f32_16x16x32_bf16 v[64:67], v[48:51], a[224:227], v[64:67]
    v_cvt_pk_bf16_f32 v87, v74, v75
    v_fmac_f32_dpp v68, v121, v109 row_newbcast:0 row_mask:0xf bank_mask:0xf
    v_mfma_f32_16x16x32_bf16 v[60:63], a[232:235], v[52:55], v[60:63]
    ds_read_b128 v[44:47], v6 offset:11264
    v_fmac_f32_dpp v69, v121, v109 row_newbcast:1 row_mask:0xf bank_mask:0xf
    v_mfma_f32_16x16x16_bf16 v[72:75], v[86:87], v[80:81], v[16:19]
    v_fmac_f32_dpp v70, v121, v109 row_newbcast:2 row_mask:0xf bank_mask:0xf
    v_fmac_f32_dpp v71, v121, v109 row_newbcast:3 row_mask:0xf bank_mask:0xf
    v_mfma_f32_16x16x32_bf16 v[56:59], a[228:231], v[52:55], v[56:59]
    ds_read_b128 v[48:51], v6 offset:12288
    v_cvt_pk_bf16_f32 v82, v68, v69
    v_mfma_f32_16x16x32_bf16 v[64:67], v[52:55], a[236:239], v[64:67]
    s_waitcnt lgkmcnt(7)
    v_cvt_pk_bf16_f32 v83, v70, v71
    v_mul_f32 v97, s43, v108
    v_mfma_f32_16x16x16_bf16 v[68:71], v[84:85], v[80:81], v[16:19]
    v_fmac_f32_dpp v76, v111, v123 row_newbcast:0 row_mask:0xf bank_mask:0xf
    v_fmac_f32_dpp v77, v111, v123 row_newbcast:1 row_mask:0xf bank_mask:0xf
    v_mfma_f32_16x16x32_bf16 v[60:63], a[244:247], v[112:115], v[60:63]
    ds_read_b128 v[52:55], v6 offset:13312
    v_fmac_f32_dpp v78, v111, v123 row_newbcast:2 row_mask:0xf bank_mask:0xf
    v_mfma_f32_16x16x32_bf16 v[56:59], a[240:243], v[112:115], v[56:59]
    v_fmac_f32_dpp v79, v111, v123 row_newbcast:3 row_mask:0xf bank_mask:0xf
    v_mul_f32_dpp v76, v110, v76 row_newbcast:0 row_mask:0xf bank_mask:0xf
    v_mfma_f32_16x16x32_bf16 v[64:67], v[112:115], a[248:251], v[64:67]
    v_mul_f32_dpp v77, v110, v77 row_newbcast:1 row_mask:0xf bank_mask:0xf
    v_mul_f32_dpp v78, v110, v78 row_newbcast:2 row_mask:0xf bank_mask:0xf
    v_mfma_f32_16x16x32_bf16 v[60:63], v[128:131], v[116:119], v[60:63]
    ds_read_b128 v[112:115], v6 offset:14336
    v_mul_f32_dpp v79, v110, v79 row_newbcast:3 row_mask:0xf bank_mask:0xf
    v_mfma_f32_16x16x32_bf16 v[56:59], a[252:255], v[116:119], v[56:59]
    v_cvt_pk_bf16_f32 v94, v76, v77
    v_cvt_pk_bf16_f32 v95, v78, v79
    v_mfma_f32_16x16x32_bf16 v[64:67], v[116:119], v[132:135], v[64:67]
    s_waitcnt lgkmcnt(7)
    v_cndmask_b32 v68, v72, v68, s[28:29]
    v_cndmask_b32 v69, v73, v69, s[30:31]
    v_mfma_f32_16x16x32_bf16 v[60:63], v[140:143], v[24:27], v[60:63]
    ds_read_b128 v[116:119], v6 offset:15360
    v_cndmask_b32 v70, v74, v70, s[32:33]
    v_mfma_f32_16x16x32_bf16 v[56:59], v[136:139], v[24:27], v[56:59]
    v_cndmask_b32 v71, v75, v71, s[34:35]
    v_max3_f32 v72, v68, v69, v70
    v_mfma_f32_16x16x32_bf16 v[64:67], v[24:27], v[144:147], v[64:67]
    v_max_f32 v73, v72, v71
    v_max_f32 v72, v72, v71
    v_mfma_f32_16x16x32_bf16 v[60:63], v[152:155], v[28:31], v[60:63]
    s_nop 0
    v_permlane32_swap_b32 v72, v73
    v_mfma_f32_16x16x32_bf16 v[56:59], v[148:151], v[28:31], v[56:59]
    s_waitcnt lgkmcnt(6)
    v_max_f32 v74, v72, v73
    v_max_f32 v72, v72, v73
    v_mfma_f32_16x16x32_bf16 v[60:63], v[164:167], v[32:35], v[60:63]
    s_nop 0
    v_permlane16_swap_b32 v72, v74
    v_mfma_f32_16x16x32_bf16 v[56:59], v[160:163], v[32:35], v[56:59]
    v_max_f32 v72, v72, v74
    v_mul_f32 v72, -v72, v96
    v_mfma_f32_16x16x32_bf16 v[60:63], v[176:179], v[36:39], v[60:63]
    s_waitcnt vmcnt(1)
    v_fma_f32 v68, v68, v96, v72
    v_fma_f32 v69, v69, v96, v72
    v_mfma_f32_16x16x32_bf16 v[56:59], v[172:175], v[36:39], v[56:59]
    s_waitcnt lgkmcnt(4)
    v_fma_f32 v70, v70, v96, v72
    v_fma_f32 v71, v71, v96, v72
    v_mfma_f32_16x16x32_bf16 v[60:63], v[188:191], v[40:43], v[60:63]
    v_exp_f32 v68, v68
    v_mfma_f32_16x16x32_bf16 v[56:59], v[184:187], v[40:43], v[56:59]
    v_exp_f32 v69, v69
    v_mfma_f32_16x16x32_bf16 v[60:63], v[200:203], v[44:47], v[60:63]
    v_exp_f32 v70, v70
    v_mfma_f32_16x16x32_bf16 v[56:59], v[196:199], v[44:47], v[56:59]
    s_waitcnt lgkmcnt(3)
    v_exp_f32 v71, v71
    v_mfma_f32_16x16x32_bf16 v[60:63], v[212:215], v[48:51], v[60:63]
    v_cvt_pk_bf16_f32 v2, v68, v69
    v_cvt_pk_bf16_f32 v3, v70, v71
    v_mfma_f32_16x16x32_bf16 v[56:59], v[208:211], v[48:51], v[56:59]
    s_waitcnt lgkmcnt(2)
    v_and_b32 v72, v2, v20
    v_and_b32 v73, v3, v21
    v_mfma_f32_16x16x16_bf16 v[68:71], v[22:23], v[2:3], 0
    v_xor_b32 v74, v2, v72
    v_xor_b32 v75, v3, v73
    v_mfma_f32_16x16x32_bf16 v[60:63], v[224:227], v[52:55], v[60:63]
    s_add_u32 s82, s65, 98304
    v_cmp_eq_u32 vcc, -1, v91
    v_mfma_f32_16x16x32_bf16 v[76:79], v[92:95], v[72:75], 0
    s_cbranch_vccnz L_retry_21
L_back_22:
    v_mfma_f32_16x16x32_bf16 v[56:59], v[220:223], v[52:55], v[56:59]
    s_waitcnt lgkmcnt(1)
    v_rcp_f32 v68, v68
    v_mfma_f32_16x16x32_bf16 v[60:63], v[236:239], v[112:115], v[60:63]
    s_nop 2
    v_mfma_f32_16x16x32_bf16 v[56:59], v[232:235], v[112:115], v[56:59]
    s_waitcnt lgkmcnt(0)
    v_mul_f32 v76, v68, v76
    v_mul_f32 v77, v68, v77
    v_mfma_f32_16x16x32_bf16 v[60:63], v[248:251], v[116:119], v[60:63]
    v_mul_f32 v78, v68, v78
    v_mul_f32 v79, v68, v79
    v_mfma_f32_16x16x32_bf16 v[56:59], v[244:247], v[116:119], v[56:59]
    v_cvt_pk_bf16_f32 v3, v78, v79
    v_cvt_pk_bf16_f32 v2, v76, v77
    v_mfma_f32_16x16x32_bf16 v[64:67], v[28:31], v[156:159], v[64:67]
    v_permlane16_swap_b32 v1, v3
    v_mfma_f32_16x16x32_bf16 v[64:67], v[32:35], v[168:171], v[64:67]
    v_permlane16_swap_b32 v0, v2
    v_mfma_f32_16x16x32_bf16 v[64:67], v[36:39], v[180:183], v[64:67]
    v_or_b32 v3, 1, v3
    v_fmac_f32_dpp v60, v122, v105 row_newbcast:0 row_mask:0xf bank_mask:0xf
    v_mfma_f32_16x16x32_bf16 v[64:67], v[40:43], v[192:195], v[64:67]
    buffer_store_dwordx4 v[0:3], v8, s[8:11], s82 offen
    v_mfma_f32_16x16x32_bf16 v[64:67], v[44:47], v[204:207], v[64:67]
    v_fmac_f32_dpp v61, v122, v105 row_newbcast:1 row_mask:0xf bank_mask:0xf
    v_fmac_f32_dpp v62, v122, v105 row_newbcast:2 row_mask:0xf bank_mask:0xf
    v_mfma_f32_16x16x32_bf16 v[64:67], v[48:51], v[216:219], v[64:67]
    v_fmac_f32_dpp v63, v122, v105 row_newbcast:3 row_mask:0xf bank_mask:0xf
    v_mul_f32 v60, v104, v60
    v_mfma_f32_16x16x32_bf16 v[64:67], v[52:55], v[228:231], v[64:67]
    v_mul_f32 v61, v104, v61
    v_mul_f32 v62, v104, v62
    v_mfma_f32_16x16x32_bf16 v[64:67], v[112:115], v[240:243], v[64:67]
    v_mul_f32 v63, v104, v63
    v_cvt_pk_bf16_f32 v84, v60, v61
    v_mfma_f32_16x16x32_bf16 v[64:67], v[116:119], v[252:255], v[64:67]
    v_cvt_pk_bf16_f32 v85, v62, v63
    v_fmac_f32_dpp v56, v121, v105 row_newbcast:0 row_mask:0xf bank_mask:0xf
    v_fmac_f32_dpp v57, v121, v105 row_newbcast:1 row_mask:0xf bank_mask:0xf
    v_mfma_f32_16x16x16_bf16 v[72:75], v[84:85], v[82:83], v[16:19]
    v_fmac_f32_dpp v58, v121, v105 row_newbcast:2 row_mask:0xf bank_mask:0xf
    v_fmac_f32_dpp v59, v121, v105 row_newbcast:3 row_mask:0xf bank_mask:0xf
    v_mfma_f32_16x16x16_bf16 v[68:71], v[86:87], v[82:83], v[16:19]
    v_cvt_pk_bf16_f32 v80, v56, v57
    v_cvt_pk_bf16_f32 v81, v58, v59
    v_mul_f32 v96, s43, v104
    v_add_f32 v60, s42, v16
    v_add_f32 v61, s42, v17
    v_add_f32 v62, s42, v18
    v_add_f32 v63, s42, v19
    v_mfma_f32_16x16x16_bf16 v[56:59], v[84:85], v[80:81], v[16:19]
    v_cndmask_b32 v68, v72, v68, s[28:29]
    v_cndmask_b32 v69, v73, v69, s[30:31]
    v_mfma_f32_16x16x16_bf16 v[60:63], v[88:89], v[80:81], v[60:63]
    v_cndmask_b32 v70, v74, v70, s[32:33]
    v_cndmask_b32 v71, v75, v71, s[34:35]
    v_max3_f32 v72, v68, v69, v70
    v_max_f32 v73, v72, v71
    v_max_f32 v72, v72, v71
    v_fmac_f32_dpp v64, v107, v123 row_newbcast:0 row_mask:0xf bank_mask:0xf
    v_fmac_f32_dpp v65, v107, v123 row_newbcast:1 row_mask:0xf bank_mask:0xf
    v_permlane32_swap_b32 v72, v73
    v_cndmask_b32 v56, v60, v56, s[28:29]
    v_cndmask_b32 v57, v61, v57, s[30:31]
    v_cndmask_b32 v58, v62, v58, s[32:33]
    v_cndmask_b32 v59, v63, v59, s[34:35]
    v_max3_f32 v60, v56, v57, v58
    v_max_f32 v61, v60, v59
    v_max_f32 v60, v60, v59
    v_max_f32 v74, v72, v73
    v_max_f32 v72, v72, v73
    v_permlane32_swap_b32 v60, v61
    v_max_f32 v62, v60, v61
    v_max_f32 v60, v60, v61
    v_permlane16_swap_b32 v72, v74
    v_max_f32 v72, v72, v74
    v_permlane16_swap_b32 v60, v62
    v_max_f32 v60, v60, v62
    v_mul_f32 v60, -v60, v96
    v_fma_f32 v56, v56, v96, v60
    v_fma_f32 v57, v57, v96, v60
    v_fma_f32 v58, v58, v96, v60
    v_fma_f32 v59, v59, v96, v60
    v_mul_f32 v72, -v72, v97
    v_exp_f32 v56, v56
    v_fma_f32 v68, v68, v97, v72
    v_exp_f32 v57, v57
    v_fma_f32 v69, v69, v97, v72
    v_exp_f32 v58, v58
    v_fma_f32 v70, v70, v97, v72
    v_exp_f32 v59, v59
    v_fma_f32 v71, v71, v97, v72
    v_cvt_pk_bf16_f32 v2, v56, v57
    v_exp_f32 v68, v68
    v_cvt_pk_bf16_f32 v3, v58, v59
    v_exp_f32 v69, v69
    v_and_b32 v62, v2, v20
    v_exp_f32 v70, v70
    v_and_b32 v63, v3, v21
    v_mfma_f32_16x16x16_bf16 v[56:59], v[22:23], v[2:3], 0
    s_add_u32 s86, s66, 65536
    s_mov_b64 exec, s[54:55]
    buffer_load_dwordx4 v[24:27], v6, s[8:11], s86 offen offset:0 sc1
    buffer_load_dwordx4 v[28:31], v6, s[8:11], s86 offen offset:1024 sc1
    s_mov_b64 exec, -1
    v_exp_f32 v71, v71
    v_cvt_pk_bf16_f32 v0, v68, v69
    v_xor_b32 v60, v2, v62
    v_cvt_pk_bf16_f32 v1, v70, v71
    v_xor_b32 v61, v3, v63
    v_and_b32 v74, v0, v20
    s_add_u32 s84, s65, 65536
    v_and_b32 v75, v1, v21
    v_mfma_f32_16x16x16_bf16 v[68:71], v[22:23], v[0:1], 0
    s_mov_b64 exec, s[54:55]
    buffer_load_dwordx4 v[32:35], v6, s[8:11], s86 offen offset:2048 sc1
    buffer_load_dwordx4 v[36:39], v6, s[8:11], s86 offen offset:3072 sc1
    s_mov_b64 exec, -1
    s_add_u32 s87, s66, 69632
    v_xor_b32 v72, v0, v74
    v_xor_b32 v73, v1, v75
    v_fmac_f32_dpp v66, v107, v123 row_newbcast:2 row_mask:0xf bank_mask:0xf
    v_fmac_f32_dpp v67, v107, v123 row_newbcast:3 row_mask:0xf bank_mask:0xf
    v_mul_f32_dpp v64, v106, v64 row_newbcast:0 row_mask:0xf bank_mask:0xf
    v_mul_f32_dpp v65, v106, v65 row_newbcast:1 row_mask:0xf bank_mask:0xf
    v_mul_f32_dpp v66, v106, v66 row_newbcast:2 row_mask:0xf bank_mask:0xf
    v_add_u32 v5, 98304, v6
    s_mov_b64 exec, s[54:55]
    buffer_load_dwordx4 v[40:43], v6, s[8:11], s87 offen offset:0 sc1
    buffer_load_dwordx4 v[44:47], v6, s[8:11], s87 offen offset:1024 sc1
    s_mov_b64 exec, -1
    ds_read_b128 v[80:83], v5 offset:0
    ds_read_b128 v[84:87], v5 offset:1024
    ds_read_b128 v[96:99], v5 offset:2048
    v_mul_f32_dpp v67, v106, v67 row_newbcast:3 row_mask:0xf bank_mask:0xf
    v_cvt_pk_bf16_f32 v92, v64, v65
    v_cvt_pk_bf16_f32 v93, v66, v67
    s_mov_b64 exec, s[54:55]
    buffer_load_dwordx4 v[48:51], v6, s[8:11], s87 offen offset:2048 sc1
    buffer_load_dwordx4 v[52:55], v6, s[8:11], s87 offen offset:3072 sc1
    s_mov_b64 exec, -1
    v_mfma_f32_16x16x32_bf16 v[64:67], v[90:93], v[60:63], 0
    v_rcp_f32 v56, v56
    v_mfma_f32_16x16x32_bf16 v[76:79], v[92:95], v[72:75], 0
    v_rcp_f32 v68, v68
    v_mfma_f32_16x16x16_bf16 v[104:107], v[14:15], v[100:101], 0
    v_mfma_f32_16x16x16_bf16 v[108:111], v[14:15], v[102:103], 0
    s_nop 2
    v_mul_f32 v64, v56, v64
    v_mul_f32 v65, v56, v65
    v_mul_f32 v66, v56, v66
    v_mul_f32 v67, v56, v67
    v_mul_f32 v76, v68, v76
    v_cvt_pk_bf16_f32 v3, v66, v67
    v_mul_f32 v77, v68, v77
    v_cvt_pk_bf16_f32 v2, v64, v65
    v_mul_f32 v78, v68, v78
    v_mul_f32 v79, v68, v79
    v_cvt_pk_bf16_f32 v1, v78, v79
    v_cvt_pk_bf16_f32 v0, v76, v77
    v_mfma_f32_16x16x16_bf16 v[112:115], v[14:15], v[124:125], 0
    v_permlane16_swap_b32 v1, v3
    v_permlane16_swap_b32 v0, v2
    v_or_b32 v3, 1, v3
    buffer_store_dwordx4 v[0:3], v8, s[8:11], s84 offen
    v_mfma_f32_16x16x16_bf16 v[116:119], v[14:15], v[126:127], 0
    s_cmp_lt_u32 s36, 2
    s_cbranch_scc1 L_lo_25
    s_waitcnt vmcnt(5)
    v_bitop3_b32 v4, v27, v31, v35 bitop3:0x80
    v_bitop3_b32 v4, v4, v39, 1 bitop3:0x80
    v_cmp_ne_u32 vcc, 1, v4
    ds_read_b128 v[72:75], v5 offset:3072
    ds_read_b128 v[76:79], v5 offset:4096
    ds_read_b128 v[88:91], v5 offset:5120
    ds_read_b128 v[92:95], v5 offset:6144
    s_cbranch_vccnz L_retry_39
L_back_40:
    s_waitcnt lgkmcnt(6)
    v_mfma_f32_16x16x32_bf16 v[104:107], v[80:83], v[24:27], v[104:107]
    ds_read_b128 v[100:103], v5 offset:7168
    s_waitcnt lgkmcnt(5)
    v_mfma_f32_16x16x32_bf16 v[108:111], v[84:87], v[24:27], v[108:111]
    ds_read_b128 v[80:83], v5 offset:8192
    s_add_u32 s79, s66, 73728
    v_mfma_f32_16x16x32_bf16 v[112:115], v[96:99], v[24:27], v[112:115]
    ds_read_b128 v[84:87], v5 offset:9216
    s_waitcnt lgkmcnt(5)
    buffer_load_dwordx4 v[56:59], v6, s[8:11], s79 offen offset:0 sc1
    v_mfma_f32_16x16x32_bf16 v[116:119], v[72:75], v[24:27], v[116:119]
    ds_read_b128 v[96:99], v5 offset:10240
    v_mfma_f32_16x16x32_bf16 v[104:107], v[76:79], v[28:31], v[104:107]
    ds_read_b128 v[72:75], v5 offset:11264
    s_waitcnt lgkmcnt(5)
    buffer_load_dwordx4 v[60:63], v6, s[8:11], s79 offen offset:1024 sc1
    v_mfma_f32_16x16x32_bf16 v[108:111], v[88:91], v[28:31], v[108:111]
    ds_read_b128 v[76:79], v5 offset:12288
    v_mfma_f32_16x16x32_bf16 v[112:115], v[92:95], v[28:31], v[112:115]
    ds_read_b128 v[88:91], v5 offset:13312
    s_waitcnt lgkmcnt(5)
    buffer_load_dwordx4 v[64:67], v6, s[8:11], s79 offen offset:2048 sc1
    v_mfma_f32_16x16x32_bf16 v[116:119], v[100:103], v[28:31], v[116:119]
    ds_read_b128 v[92:95], v5 offset:14336
    v_mfma_f32_16x16x32_bf16 v[104:107], v[80:83], v[32:35], v[104:107]
    ds_read_b128 v[100:103], v5 offset:15360
    s_waitcnt lgkmcnt(5)
    buffer_load_dwordx4 v[68:71], v6, s[8:11], s79 offen offset:3072 sc1
    v_mfma_f32_16x16x32_bf16 v[108:111], v[84:87], v[32:35], v[108:111]
    ds_read_b128 v[80:83], v5 offset:16384
    s_waitcnt vmcnt(5)
    v_mfma_f32_16x16x32_bf16 v[112:115], v[96:99], v[32:35], v[112:115]
    ds_read_b128 v[84:87], v5 offset:17408
    s_waitcnt lgkmcnt(5)
    v_mfma_f32_16x16x32_bf16 v[116:119], v[72:75], v[32:35], v[116:119]
    ds_read_b128 v[96:99], v5 offset:18432
    v_bitop3_b32 v4, v43, v47, v51 bitop3:0x80
    v_mfma_f32_16x16x32_bf16 v[104:107], v[76:79], v[36:39], v[104:107]
    ds_read_b128 v[72:75], v5 offset:19456
    s_waitcnt lgkmcnt(5)
    v_mfma_f32_16x16x32_bf16 v[108:111], v[88:91], v[36:39], v[108:111]
    ds_read_b128 v[76:79], v5 offset:20480
    v_bitop3_b32 v4, v4, v55, 1 bitop3:0x80
    v_mfma_f32_16x16x32_bf16 v[112:115], v[92:95], v[36:39], v[112:115]
    ds_read_b128 v[88:91], v5 offset:21504
    s_waitcnt lgkmcnt(5)
    v_mfma_f32_16x16x32_bf16 v[116:119], v[100:103], v[36:39], v[116:119]
    ds_read_b128 v[92:95], v5 offset:22528
    v_cmp_ne_u32 vcc, 1, v4
    s_nop 0
    s_cbranch_vccnz L_retry_41
L_back_42:
    v_mfma_f32_16x16x32_bf16 v[104:107], v[80:83], v[40:43], v[104:107]
    ds_read_b128 v[100:103], v5 offset:23552
    s_waitcnt lgkmcnt(5)
    v_mfma_f32_16x16x32_bf16 v[108:111], v[84:87], v[40:43], v[108:111]
    ds_read_b128 v[80:83], v5 offset:24576
    s_add_u32 s80, s66, 77824
    v_mfma_f32_16x16x32_bf16 v[112:115], v[96:99], v[40:43], v[112:115]
    ds_read_b128 v[84:87], v5 offset:25600
    s_waitcnt lgkmcnt(5)
    buffer_load_dwordx4 v[24:27], v6, s[8:11], s80 offen offset:0 sc1
    v_mfma_f32_16x16x32_bf16 v[116:119], v[72:75], v[40:43], v[116:119]
    ds_read_b128 v[96:99], v5 offset:26624
    v_mfma_f32_16x16x32_bf16 v[104:107], v[76:79], v[44:47], v[104:107]
    ds_read_b128 v[72:75], v5 offset:27648
    s_waitcnt lgkmcnt(5)
    buffer_load_dwordx4 v[28:31], v6, s[8:11], s80 offen offset:1024 sc1
    v_mfma_f32_16x16x32_bf16 v[108:111], v[88:91], v[44:47], v[108:111]
    ds_read_b128 v[76:79], v5 offset:28672
    v_mfma_f32_16x16x32_bf16 v[112:115], v[92:95], v[44:47], v[112:115]
    ds_read_b128 v[88:91], v5 offset:29696
    s_waitcnt lgkmcnt(5)
    buffer_load_dwordx4 v[32:35], v6, s[8:11], s80 offen offset:2048 sc1
    v_mfma_f32_16x16x32_bf16 v[116:119], v[100:103], v[44:47], v[116:119]
    ds_read_b128 v[92:95], v5 offset:30720
    v_mfma_f32_16x16x32_bf16 v[104:107], v[80:83], v[48:51], v[104:107]
    ds_read_b128 v[100:103], v5 offset:31744
    s_waitcnt lgkmcnt(5)
    buffer_load_dwordx4 v[36:39], v6, s[8:11], s80 offen offset:3072 sc1
    v_mfma_f32_16x16x32_bf16 v[108:111], v[84:87], v[48:51], v[108:111]
    ds_read_b128 v[80:83], v5 offset:32768
    v_mfma_f32_16x16x32_bf16 v[112:115], v[96:99], v[48:51], v[112:115]
    ds_read_b128 v[84:87], v5 offset:33792
    s_waitcnt lgkmcnt(5)
    v_mfma_f32_16x16x32_bf16 v[116:119], v[72:75], v[48:51], v[116:119]
    ds_read_b128 v[96:99], v5 offset:34816
    v_mfma_f32_16x16x32_bf16 v[104:107], v[76:79], v[52:55], v[104:107]
    ds_read_b128 v[72:75], v5 offset:35840
    s_waitcnt lgkmcnt(5)
    v_mfma_f32_16x16x32_bf16 v[108:111], v[88:91], v[52:55], v[108:111]
    ds_read_b128 v[76:79], v5 offset:36864
    s_waitcnt vmcnt(4)
    v_mfma_f32_16x16x32_bf16 v[112:115], v[92:95], v[52:55], v[112:115]
    ds_read_b128 v[88:91], v5 offset:37888
    s_waitcnt lgkmcnt(5)
    v_mfma_f32_16x16x32_bf16 v[116:119], v[100:103], v[52:55], v[116:119]
    ds_read_b128 v[92:95], v5 offset:38912
    v_bitop3_b32 v4, v59, v63, v67 bitop3:0x80
    v_bitop3_b32 v4, v4, v71, 1 bitop3:0x80
    v_cmp_ne_u32 vcc, 1, v4
    s_nop 0
    s_cbranch_vccnz L_retry_43
L_back_44:
    v_mfma_f32_16x16x32_bf16 v[104:107], v[80:83], v[56:59], v[104:107]
    ds_read_b128 v[100:103], v5 offset:39936
    s_waitcnt lgkmcnt(5)
    v_mfma_f32_16x16x32_bf16 v[108:111], v[84:87], v[56:59], v[108:111]
    ds_read_b128 v[80:83], v5 offset:40960
    v_mfma_f32_16x16x32_bf16 v[112:115], v[96:99], v[56:59], v[112:115]
    ds_read_b128 v[84:87], v5 offset:41984
    s_waitcnt lgkmcnt(5)
    v_mfma_f32_16x16x32_bf16 v[116:119], v[72:75], v[56:59], v[116:119]
    ds_read_b128 v[96:99], v5 offset:43008
    v_mfma_f32_16x16x32_bf16 v[104:107], v[76:79], v[60:63], v[104:107]
    ds_read_b128 v[72:75], v5 offset:44032
    s_waitcnt lgkmcnt(5)
    v_mfma_f32_16x16x32_bf16 v[108:111], v[88:91], v[60:63], v[108:111]
    ds_read_b128 v[76:79], v5 offset:45056
    v_mfma_f32_16x16x32_bf16 v[112:115], v[92:95], v[60:63], v[112:115]
    ds_read_b128 v[88:91], v5 offset:46080
    s_waitcnt lgkmcnt(5)
    v_mfma_f32_16x16x32_bf16 v[116:119], v[100:103], v[60:63], v[116:119]
    ds_read_b128 v[92:95], v5 offset:47104
    v_mfma_f32_16x16x32_bf16 v[104:107], v[80:83], v[64:67], v[104:107]
    ds_read_b128 v[100:103], v5 offset:48128
    s_waitcnt lgkmcnt(5)
    v_mfma_f32_16x16x32_bf16 v[108:111], v[84:87], v[64:67], v[108:111]
    ds_read_b128 v[80:83], v5 offset:49152
    v_mfma_f32_16x16x32_bf16 v[112:115], v[96:99], v[64:67], v[112:115]
    ds_read_b128 v[84:87], v5 offset:50176
    s_waitcnt lgkmcnt(5)
    v_mfma_f32_16x16x32_bf16 v[116:119], v[72:75], v[64:67], v[116:119]
    ds_read_b128 v[96:99], v5 offset:51200
    v_mfma_f32_16x16x32_bf16 v[104:107], v[76:79], v[68:71], v[104:107]
    ds_read_b128 v[72:75], v5 offset:52224
    s_waitcnt lgkmcnt(5)
    v_mfma_f32_16x16x32_bf16 v[108:111], v[88:91], v[68:71], v[108:111]
    ds_read_b128 v[76:79], v5 offset:53248
    s_waitcnt vmcnt(0)
    v_mfma_f32_16x16x32_bf16 v[112:115], v[92:95], v[68:71], v[112:115]
    ds_read_b128 v[88:91], v5 offset:54272
    s_waitcnt lgkmcnt(5)
    v_mfma_f32_16x16x32_bf16 v[116:119], v[100:103], v[68:71], v[116:119]
    ds_read_b128 v[92:95], v5 offset:55296
    v_bitop3_b32 v4, v27, v31, v35 bitop3:0x80
    v_bitop3_b32 v4, v4, v39, 1 bitop3:0x80
    v_cmp_ne_u32 vcc, 1, v4
    s_nop 0
    s_cbranch_vccnz L_retry_45
L_back_46:
    v_mfma_f32_16x16x32_bf16 v[104:107], v[80:83], v[24:27], v[104:107]
    ds_read_b128 v[100:103], v5 offset:56320
    s_waitcnt lgkmcnt(5)
    v_mfma_f32_16x16x32_bf16 v[108:111], v[84:87], v[24:27], v[108:111]
    ds_read_b128 v[80:83], v5 offset:57344
    v_mfma_f32_16x16x32_bf16 v[112:115], v[96:99], v[24:27], v[112:115]
    ds_read_b128 v[84:87], v5 offset:58368
    s_waitcnt lgkmcnt(5)
    v_mfma_f32_16x16x32_bf16 v[116:119], v[72:75], v[24:27], v[116:119]
    ds_read_b128 v[96:99], v5 offset:61440
    v_mfma_f32_16x16x32_bf16 v[104:107], v[76:79], v[28:31], v[104:107]
    ds_read_b128 v[72:75], v5 offset:62464
    s_waitcnt lgkmcnt(5)
    v_mfma_f32_16x16x32_bf16 v[108:111], v[88:91], v[28:31], v[108:111]
    ds_read_b128 v[76:79], v5 offset:59392
    v_mfma_f32_16x16x32_bf16 v[112:115], v[92:95], v[28:31], v[112:115]
    ds_read_b128 v[88:91], v5 offset:60416
    s_waitcnt lgkmcnt(5)
    v_mfma_f32_16x16x32_bf16 v[116:119], v[100:103], v[28:31], v[116:119]
    ds_read_b128 v[92:95], v5 offset:63488
    v_mfma_f32_16x16x32_bf16 v[104:107], v[80:83], v[32:35], v[104:107]
    ds_read_b128 v[100:103], v5 offset:64512
    s_waitcnt lgkmcnt(5)
    v_mfma_f32_16x16x32_bf16 v[108:111], v[84:87], v[32:35], v[108:111]
    v_mfma_f32_16x16x32_bf16 v[104:107], v[96:99], v[36:39], v[104:107]
    s_waitcnt lgkmcnt(3)
    v_mfma_f32_16x16x32_bf16 v[108:111], v[72:75], v[36:39], v[108:111]
    v_mfma_f32_16x16x32_bf16 v[112:115], v[76:79], v[32:35], v[112:115]
    s_waitcnt lgkmcnt(1)
    v_mfma_f32_16x16x32_bf16 v[116:119], v[88:91], v[32:35], v[116:119]
    v_mfma_f32_16x16x32_bf16 v[112:115], v[92:95], v[36:39], v[112:115]
    s_waitcnt lgkmcnt(0)
    v_mfma_f32_16x16x32_bf16 v[116:119], v[100:103], v[36:39], v[116:119]
    s_add_u32 s84, s63, 0
    s_nop 0
    v_cvt_pk_bf16_f32 v103, v110, v111
    v_cvt_pk_bf16_f32 v100, v104, v105
    v_cvt_pk_bf16_f32 v101, v106, v107
    v_cvt_pk_bf16_f32 v102, v108, v109
    v_or_b32 v103, 1, v103
    buffer_store_dwordx4 v[100:103], v6, s[8:11], s84 offen offset:0
    v_cvt_pk_bf16_f32 v127, v118, v119
    v_cvt_pk_bf16_f32 v124, v112, v113
    v_cvt_pk_bf16_f32 v125, v114, v115
    v_cvt_pk_bf16_f32 v126, v116, v117
    v_or_b32 v127, 1, v127
    buffer_store_dwordx4 v[124:127], v6, s[8:11], s84 offen offset:1024
    v_cvt_pk_bf16_f32 v103, v110, v111
    s_nop 0
    v_cvt_pk_bf16_f32 v127, v118, v119
    v_mov_b32 v96, 0x3f803f80
    v_mov_b32 v97, 0x3f803f80
    v_mov_b32 v98, 0x3f803f80
    v_mov_b32 v99, 0x3f803f80
    v_mfma_f32_16x16x32_bf16 v[108:111], v[100:103], v[100:103], 0
    v_mfma_f32_16x16x32_bf16 v[108:111], v[124:127], v[124:127], v[108:111]
    v_mfma_f32_16x16x32_bf16 v[104:107], v[96:99], v[100:103], 0
    v_mfma_f32_16x16x32_bf16 v[104:107], v[96:99], v[124:127], v[104:107]
    s_add_u32 s85, s60, 294912
    s_nop 4
    v_cndmask_b32 v108, v108, v109, s[44:45]
    v_cndmask_b32 v108, v108, v110, s[46:47]
    v_cndmask_b32 v108, v108, v111, s[48:49]
    v_or_b32 v105, 1, v108
    s_waitcnt vmcnt(0)
    s_add_u32 s73, s60, 49152
    buffer_load_dwordx4 v[40:43], v7, s[8:11], s73 offen offset:0 sc1
    buffer_load_dwordx4 v[44:47], v7, s[8:11], s73 offen offset:1024 sc1
    buffer_load_dwordx4 v[48:51], v7, s[8:11], s73 offen offset:2048 sc1
    buffer_load_dwordx4 v[52:55], v7, s[8:11], s73 offen offset:3072 sc1
    buffer_store_dwordx2 v[104:105], v10, s[8:11], s85 offen
    s_waitcnt vmcnt(3)
    v_bitop3_b32 v4, v43, v47, 1 bitop3:0x80
    v_cmp_ne_u32 vcc, 1, v4
    s_nop 0
    s_cbranch_vccnz L_retry_47
L_back_48:
    ds_write_b128 v7, v[40:43] offset:16384
    ds_write_b128 v7, v[44:47] offset:17408
    s_waitcnt vmcnt(1)
    v_bitop3_b32 v4, v51, v55, 1 bitop3:0x80
    v_cmp_ne_u32 vcc, 1, v4
    s_nop 0
    s_cbranch_vccnz L_retry_49
L_back_50:
    ds_write_b128 v7, v[48:51] offset:18432
    ds_write_b128 v7, v[52:55] offset:19456
    s_waitcnt lgkmcnt(0)
L_join_26:
    s_barrier
    ds_read_b128 v[40:43], v6 offset:16384
    ds_read_b128 v[44:47], v6 offset:17408
    ds_read_b128 v[48:51], v6 offset:18432
    s_add_u32 s73, s60, 32768
    buffer_load_dwordx4 v[24:27], v7, s[8:11], s73 offen offset:0 sc1
    buffer_load_dwordx4 v[28:31], v7, s[8:11], s73 offen offset:1024 sc1
    v_bfe_u32 v98, v6, 4, 4
    v_lshlrev_b32 v98, 3, v98
    v_and_b32 v99, 0x18, v98
    v_add_u32 v98, 163328, v98
    v_lshrrev_b32 v85, 8, v6
    buffer_load_dwordx4 v[32:35], v7, s[8:11], s73 offen offset:2048 sc1
    v_lshl_add_u32 v99, v85, 5, v99
    v_add_u32 v99, 163328, v99
    s_lshl_b32 s75, s36, 7
    s_add_u32 s75, s75, 163328
    v_lshrrev_b32 v85, 6, v6
    v_lshl_add_u32 v85, v85, 3, s75
    s_add_u32 s74, s60, 294912
    s_add_u32 s74, s74, s4
    buffer_load_dwordx4 v[36:39], v7, s[8:11], s73 offen offset:3072 sc1
    s_waitcnt lgkmcnt(2)
    v_mfma_f32_16x16x32_bf16 v[72:75], a[4:7], v[40:43], 0
    ds_read_b128 v[52:55], v6 offset:19456
    v_mov_b32 v0, -1
    v_mfma_f32_16x16x32_bf16 v[68:71], a[0:3], v[40:43], 0
    ds_read_b128 v[112:115], v6 offset:20480
    v_mov_b32 v1, -1
    v_mfma_f32_16x16x32_bf16 v[76:79], v[40:43], a[8:11], 0
    s_waitcnt lgkmcnt(3)
    buffer_load_dwordx4 v[80:83], v6, s[8:11], s74 offen sc1
    v_mfma_f32_16x16x32_bf16 v[72:75], a[16:19], v[44:47], v[72:75]
    ds_read_b128 v[116:119], v6 offset:21504
    v_mov_b32 v2, -1
    v_mfma_f32_16x16x32_bf16 v[68:71], a[12:15], v[44:47], v[68:71]
    ds_read_b128 v[40:43], v6 offset:22528
    v_mov_b32 v3, -1
    v_mfma_f32_16x16x32_bf16 v[76:79], v[44:47], a[20:23], v[76:79]
    s_waitcnt lgkmcnt(3)
    v_mfma_f32_16x16x32_bf16 v[72:75], a[28:31], v[48:51], v[72:75]
    ds_read_b128 v[44:47], v6 offset:23552
    s_add_u32 s95, s62, 98304
    v_mfma_f32_16x16x32_bf16 v[68:71], a[24:27], v[48:51], v[68:71]
    buffer_store_dwordx4 v[0:3], v6, s[8:11], s95 offen sc1
    v_mfma_f32_16x16x32_bf16 v[76:79], v[48:51], a[32:35], v[76:79]
    v_mfma_f32_16x16x32_bf16 v[72:75], a[40:43], v[52:55], v[72:75]
    ds_read_b128 v[48:51], v6 offset:24576
    v_mfma_f32_16x16x32_bf16 v[68:71], a[36:39], v[52:55], v[68:71]
    v_mfma_f32_16x16x32_bf16 v[76:79], v[52:55], a[44:47], v[76:79]
    s_waitcnt lgkmcnt(3)
    v_mfma_f32_16x16x32_bf16 v[72:75], a[52:55], v[112:115], v[72:75]
    ds_read_b128 v[52:55], v6 offset:25600
    v_mfma_f32_16x16x32_bf16 v[68:71], a[48:51], v[112:115], v[68:71]
    v_mfma_f32_16x16x32_bf16 v[76:79], v[112:115], a[56:59], v[76:79]
    v_mfma_f32_16x16x32_bf16 v[72:75], a[64:67], v[116:119], v[72:75]
    ds_read_b128 v[112:115], v6 offset:26624
    v_mfma_f32_16x16x32_bf16 v[68:71], a[60:63], v[116:119], v[68:71]
    v_mfma_f32_16x16x32_bf16 v[76:79], v[116:119], a[68:71], v[76:79]
    s_waitcnt lgkmcnt(3)
    v_mfma_f32_16x16x32_bf16 v[72:75], a[76:79], v[40:43], v[72:75]
    ds_read_b128 v[116:119], v6 offset:27648
    v_mfma_f32_16x16x32_bf16 v[68:71], a[72:75], v[40:43], v[68:71]
    v_mfma_f32_16x16x32_bf16 v[76:79], v[40:43], a[80:83], v[76:79]
    v_mfma_f32_16x16x32_bf16 v[72:75], a[88:91], v[44:47], v[72:75]
    ds_read_b128 v[40:43], v6 offset:28672
    s_waitcnt vmcnt(2)
    v_mfma_f32_16x16x32_bf16 v[68:71], a[84:87], v[44:47], v[68:71]
    v_bitop3_b32 v4, v27, v31, v35 bitop3:0x80
    v_bitop3_b32 v4, v4, v39, 1 bitop3:0x80
    v_mfma_f32_16x16x32_bf16 v[76:79], v[44:47], a[92:95], v[76:79]
    s_waitcnt lgkmcnt(3)
    v_cmp_ne_u32 vcc, 1, v4
    v_mfma_f32_16x16x32_bf16 v[72:75], a[100:103], v[48:51], v[72:75]
    ds_read_b128 v[44:47], v6 offset:29696
    s_cbranch_vccnz L_retry_51
L_back_52:
    v_mfma_f32_16x16x32_bf16 v[68:71], a[96:99], v[48:51], v[68:71]
    ds_write_b128 v7, v[24:27] offset:0
    v_mfma_f32_16x16x32_bf16 v[76:79], v[48:51], a[104:107], v[76:79]
    s_waitcnt vmcnt(1)
    v_bitop3_b32 v5, v81, v83, 1 bitop3:0x80
    v_cmp_ne_u32 vcc, 1, v5
    v_mfma_f32_16x16x32_bf16 v[72:75], a[112:115], v[52:55], v[72:75]
    ds_read_b128 v[48:51], v6 offset:30720
    s_cbranch_vccnz L_retry_53
L_back_54:
    v_mfma_f32_16x16x32_bf16 v[68:71], a[108:111], v[52:55], v[68:71]
    ds_write_b128 v7, v[28:31] offset:1024
    v_mfma_f32_16x16x32_bf16 v[76:79], v[52:55], a[116:119], v[76:79]
    s_waitcnt lgkmcnt(5)
    v_add_f32 v80, v80, v82
    v_add_f32 v81, v81, v83
    v_mfma_f32_16x16x32_bf16 v[72:75], a[124:127], v[112:115], v[72:75]
    ds_read_b128 v[52:55], v6 offset:31744
    v_add_f32_dpp v82, v80, v80 quad_perm:[1,0,3,2] row_mask:0xf bank_mask:0xf
    v_mfma_f32_16x16x32_bf16 v[68:71], a[120:123], v[112:115], v[68:71]
    ds_write_b128 v7, v[32:35] offset:2048
    v_mfma_f32_16x16x32_bf16 v[76:79], v[112:115], a[128:131], v[76:79]
    v_add_f32_dpp v83, v81, v81 quad_perm:[1,0,3,2] row_mask:0xf bank_mask:0xf
    v_add_f32_dpp v80, v82, v82 quad_perm:[2,3,0,1] row_mask:0xf bank_mask:0xf
    v_mfma_f32_16x16x32_bf16 v[72:75], a[136:139], v[116:119], v[72:75]
    ds_write_b128 v7, v[36:39] offset:3072
    v_mfma_f32_16x16x32_bf16 v[68:71], a[132:135], v[116:119], v[68:71]
    v_add_f32_dpp v81, v83, v83 quad_perm:[2,3,0,1] row_mask:0xf bank_mask:0xf
    v_mul_f32 v80, 0x3b000000, v80
    v_mfma_f32_16x16x32_bf16 v[76:79], v[116:119], a[140:143], v[76:79]
    s_waitcnt lgkmcnt(7)
    v_mul_f32 v81, 0x3b000000, v81
    v_fma_f32 v81, -v80, v80, v81
    v_mfma_f32_16x16x32_bf16 v[72:75], a[148:151], v[40:43], v[72:75]
    v_max_f32 v81, 0, v81
    v_cvt_pk_bf16_f32 v80, v81, -v80
    v_mfma_f32_16x16x32_bf16 v[68:71], a[144:147], v[40:43], v[68:71]
    v_lshlrev_b32 v84, 16, v80
    v_add_f32 v84, 0x3727c5ac, v84
    v_cvt_pk_bf16_f32 v84, v84, v84
    v_lshlrev_b32 v84, 16, v84
    v_sqrt_f32 v84, v84
    v_and_b32 v83, 0xffff0000, v80
    v_cvt_pk_bf16_f32 v84, v84, v84
    v_lshlrev_b32 v84, 16, v84
    v_rcp_f32 v82, v84
    s_nop 1
    ds_write_b64 v85, v[82:83]
    v_mfma_f32_16x16x32_bf16 v[76:79], v[40:43], a[152:155], v[76:79]
    s_waitcnt lgkmcnt(0)
    s_barrier
    v_mfma_f32_16x16x32_bf16 v[72:75], a[160:163], v[44:47], v[72:75]
    ds_read_b128 v[112:115], v6 offset:0
    s_add_u32 s73, s60, 16384
    v_mfma_f32_16x16x32_bf16 v[68:71], a[156:159], v[44:47], v[68:71]
    ds_read_b128 v[116:119], v6 offset:1024
    s_lshl_b32 s72, s36, 12
    v_mfma_f32_16x16x32_bf16 v[76:79], v[44:47], a[164:167], v[76:79]
    s_add_u32 m0, s72, 16384
    ds_read_b64 v[108:109], v98 offset:384
    v_mfma_f32_16x16x32_bf16 v[72:75], a[172:175], v[48:51], v[72:75]
    ds_read_b128 v[40:43], v6 offset:2048
    v_mfma_f32_16x16x32_bf16 v[68:71], a[168:171], v[48:51], v[68:71]
    ds_read_b128 v[44:47], v6 offset:3072
    v_mfma_f32_16x16x32_bf16 v[76:79], v[48:51], a[176:179], v[76:79]
    buffer_load_dwordx4 v7, s[8:11], s73 offen offset:0 sc1 lds
    v_mfma_f32_16x16x32_bf16 v[72:75], a[184:187], v[52:55], v[72:75]
    ds_read_b128 v[48:51], v6 offset:4096
    v_mfma_f32_16x16x32_bf16 v[68:71], a[180:183], v[52:55], v[68:71]
    ds_read_b64 v[110:111], v99 offset:384
    v_mfma_f32_16x16x32_bf16 v[76:79], v[52:55], a[188:191], v[76:79]
    s_waitcnt lgkmcnt(5)
    ds_read_b64 v[104:105], v98 offset:256
    v_mfma_f32_16x16x32_bf16 v[60:63], a[4:7], v[112:115], 0
    ds_read_b128 v[52:55], v6 offset:5120
    v_mfma_f32_16x16x32_bf16 v[56:59], a[0:3], v[112:115], 0
    buffer_load_dwordx4 v7, s[8:11], s73 offen offset:1024 sc1 lds
    v_mfma_f32_16x16x32_bf16 v[64:67], v[112:115], a[8:11], 0
    ds_read_b64 v[106:107], v99 offset:256
    v_mfma_f32_16x16x32_bf16 v[60:63], a[16:19], v[116:119], v[60:63]
    ds_read_b128 v[112:115], v6 offset:6144
    v_mfma_f32_16x16x32_bf16 v[56:59], a[12:15], v[116:119], v[56:59]
    v_mfma_f32_16x16x32_bf16 v[64:67], v[116:119], a[20:23], v[64:67]
    s_waitcnt lgkmcnt(6)
    buffer_load_dwordx4 v7, s[8:11], s73 offen offset:2048 sc1 lds
    v_mfma_f32_16x16x32_bf16 v[60:63], a[28:31], v[40:43], v[60:63]
    ds_read_b128 v[116:119], v6 offset:7168
    s_waitcnt lgkmcnt(5)
    v_mfma_f32_16x16x32_bf16 v[56:59], a[24:27], v[40:43], v[56:59]
    v_fmac_f32_dpp v72, v13, v109 row_newbcast:0 row_mask:0xf bank_mask:0xf
    v_fmac_f32_dpp v73, v13, v109 row_newbcast:1 row_mask:0xf bank_mask:0xf
    v_mfma_f32_16x16x32_bf16 v[64:67], v[40:43], a[32:35], v[64:67]
    v_fmac_f32_dpp v74, v13, v109 row_newbcast:2 row_mask:0xf bank_mask:0xf
    v_fmac_f32_dpp v75, v13, v109 row_newbcast:3 row_mask:0xf bank_mask:0xf
    v_mfma_f32_16x16x32_bf16 v[60:63], a[40:43], v[44:47], v[60:63]
    ds_read_b128 v[40:43], v6 offset:8192
    v_mul_f32 v72, v108, v72
    v_mfma_f32_16x16x32_bf16 v[56:59], a[36:39], v[44:47], v[56:59]
    buffer_load_dwordx4 v7, s[8:11], s73 offen offset:3072 sc1 lds
    v_mul_f32 v73, v108, v73
    v_mfma_f32_16x16x32_bf16 v[64:67], v[44:47], a[44:47], v[64:67]
    s_waitcnt lgkmcnt(4)
    v_mul_f32 v74, v108, v74
    v_mul_f32 v75, v108, v75
    v_mfma_f32_16x16x32_bf16 v[60:63], a[52:55], v[48:51], v[60:63]
    ds_read_b128 v[44:47], v6 offset:9216
    v_cvt_pk_bf16_f32 v86, v72, v73
    v_mfma_f32_16x16x32_bf16 v[56:59], a[48:51], v[48:51], v[56:59]
    v_cvt_pk_bf16_f32 v87, v74, v75
    v_fmac_f32_dpp v68, v12, v109 row_newbcast:0 row_mask:0xf bank_mask:0xf
    v_mfma_f32_16x16x32_bf16 v[64:67], v[48:51], a[56:59], v[64:67]
    v_fmac_f32_dpp v69, v12, v109 row_newbcast:1 row_mask:0xf bank_mask:0xf
    v_fmac_f32_dpp v70, v12, v109 row_newbcast:2 row_mask:0xf bank_mask:0xf
    v_mfma_f32_16x16x32_bf16 v[60:63], a[64:67], v[52:55], v[60:63]
    ds_read_b128 v[48:51], v6 offset:10240
    v_fmac_f32_dpp v71, v12, v109 row_newbcast:3 row_mask:0xf bank_mask:0xf
    v_mfma_f32_16x16x32_bf16 v[56:59], a[60:63], v[52:55], v[56:59]
    v_cvt_pk_bf16_f32 v82, v68, v69
    v_cvt_pk_bf16_f32 v83, v70, v71
    v_mfma_f32_16x16x32_bf16 v[64:67], v[52:55], a[68:71], v[64:67]
    s_waitcnt lgkmcnt(3)
    v_mul_f32 v97, s43, v108
    v_fmac_f32_dpp v76, v111, v120 row_newbcast:0 row_mask:0xf bank_mask:0xf
    v_mfma_f32_16x16x32_bf16 v[60:63], a[76:79], v[112:115], v[60:63]
    ds_read_b128 v[52:55], v6 offset:11264
    v_fmac_f32_dpp v77, v111, v120 row_newbcast:1 row_mask:0xf bank_mask:0xf
    v_mfma_f32_16x16x32_bf16 v[56:59], a[72:75], v[112:115], v[56:59]
    v_fmac_f32_dpp v78, v111, v120 row_newbcast:2 row_mask:0xf bank_mask:0xf
    v_fmac_f32_dpp v79, v111, v120 row_newbcast:3 row_mask:0xf bank_mask:0xf
    v_mfma_f32_16x16x32_bf16 v[64:67], v[112:115], a[80:83], v[64:67]
    v_mul_f32_dpp v76, v110, v76 row_newbcast:0 row_mask:0xf bank_mask:0xf
    v_mul_f32_dpp v77, v110, v77 row_newbcast:1 row_mask:0xf bank_mask:0xf
    v_mfma_f32_16x16x32_bf16 v[60:63], a[88:91], v[116:119], v[60:63]
    ds_read_b128 v[112:115], v6 offset:12288
    v_mul_f32_dpp v78, v110, v78 row_newbcast:2 row_mask:0xf bank_mask:0xf
    v_mfma_f32_16x16x32_bf16 v[56:59], a[84:87], v[116:119], v[56:59]
    v_mul_f32_dpp v79, v110, v79 row_newbcast:3 row_mask:0xf bank_mask:0xf
    v_cvt_pk_bf16_f32 v94, v76, v77
    v_mfma_f32_16x16x32_bf16 v[64:67], v[116:119], a[92:95], v[64:67]
    s_waitcnt lgkmcnt(3)
    v_cvt_pk_bf16_f32 v95, v78, v79
    v_mfma_f32_16x16x32_bf16 v[60:63], a[100:103], v[40:43], v[60:63]
    ds_read_b128 v[116:119], v6 offset:13312
    v_mfma_f32_16x16x32_bf16 v[56:59], a[96:99], v[40:43], v[56:59]
    ds_read_b64 v[108:109], v98 offset:128
    v_mfma_f32_16x16x32_bf16 v[64:67], v[40:43], a[104:107], v[64:67]
    ds_read_b64 v[110:111], v99 offset:128
    v_mov_b32 v68, v86
    v_mfma_f32_16x16x32_bf16 v[60:63], a[112:115], v[44:47], v[60:63]
    ds_read_b128 v[40:43], v6 offset:14336
    v_mov_b32 v69, v87
    v_mfma_f32_16x16x32_bf16 v[56:59], a[108:111], v[44:47], v[56:59]
    s_add_u32 s86, s62, 65536
    v_mov_b32 v70, v94
    v_min_u32 v71, -2, v95
    v_mfma_f32_16x16x32_bf16 v[64:67], v[44:47], a[116:119], v[64:67]
    s_waitcnt lgkmcnt(5)
    s_waitcnt vmcnt(4)
    v_mfma_f32_16x16x32_bf16 v[60:63], a[124:127], v[48:51], v[60:63]
    ds_read_b128 v[44:47], v6 offset:15360
    v_mfma_f32_16x16x32_bf16 v[56:59], a[120:123], v[48:51], v[56:59]
    buffer_store_dwordx4 v[68:71], v6, s[8:11], s86 offen sc1
    v_mfma_f32_16x16x32_bf16 v[64:67], v[48:51], a[128:131], v[64:67]
    v_mfma_f32_16x16x32_bf16 v[60:63], a[136:139], v[52:55], v[60:63]
    v_mfma_f32_16x16x32_bf16 v[56:59], a[132:135], v[52:55], v[56:59]
    v_mfma_f32_16x16x32_bf16 v[64:67], v[52:55], a[140:143], v[64:67]
    s_waitcnt lgkmcnt(5)
    v_mfma_f32_16x16x32_bf16 v[60:63], a[148:151], v[112:115], v[60:63]
    v_mfma_f32_16x16x32_bf16 v[56:59], a[144:147], v[112:115], v[56:59]
    v_mfma_f32_16x16x32_bf16 v[64:67], v[112:115], a[152:155], v[64:67]
    s_waitcnt lgkmcnt(0) vmcnt(1)
    s_barrier
    s_add_u32 s73, s60, 0
    v_mfma_f32_16x16x32_bf16 v[60:63], a[160:163], v[116:119], v[60:63]
    ds_read_b128 v[48:51], v6 offset:16384
    s_lshl_b32 s72, s36, 12
    v_mfma_f32_16x16x32_bf16 v[56:59], a[156:159], v[116:119], v[56:59]
    ds_read_b128 v[52:55], v6 offset:17408
    s_add_u32 m0, s72, 0
    v_mfma_f32_16x16x32_bf16 v[64:67], v[116:119], a[164:167], v[64:67]
    buffer_load_dwordx4 v7, s[8:11], s73 offen offset:0 sc1 lds
    v_mfma_f32_16x16x32_bf16 v[60:63], a[172:175], v[40:43], v[60:63]
    ds_read_b128 v[112:115], v6 offset:18432
    v_mfma_f32_16x16x32_bf16 v[56:59], a[168:171], v[40:43], v[56:59]
    ds_read_b128 v[116:119], v6 offset:19456
    v_mfma_f32_16x16x32_bf16 v[64:67], v[40:43], a[176:179], v[64:67]
    v_mfma_f32_16x16x32_bf16 v[60:63], a[184:187], v[44:47], v[60:63]
    ds_read_b128 v[40:43], v6 offset:20480
    v_mfma_f32_16x16x32_bf16 v[56:59], a[180:183], v[44:47], v[56:59]
    buffer_load_dwordx4 v7, s[8:11], s73 offen offset:1024 sc1 lds
    v_mfma_f32_16x16x32_bf16 v[64:67], v[44:47], a[188:191], v[64:67]
    s_waitcnt lgkmcnt(3)
    s_waitcnt lgkmcnt(15)
    s_nop 0
    v_mfma_f32_16x16x32_bf16 v[72:75], a[4:7], v[48:51], 0
    ds_read_b128 v[44:47], v6 offset:21504
    v_fmac_f32_dpp v60, v13, v105 row_newbcast:0 row_mask:0xf bank_mask:0xf
    v_mfma_f32_16x16x32_bf16 v[68:71], a[0:3], v[48:51], 0
    v_fmac_f32_dpp v61, v13, v105 row_newbcast:1 row_mask:0xf bank_mask:0xf
    v_fmac_f32_dpp v62, v13, v105 row_newbcast:2 row_mask:0xf bank_mask:0xf
    v_mfma_f32_16x16x32_bf16 v[76:79], v[48:51], a[8:11], 0
    buffer_load_dwordx4 v7, s[8:11], s73 offen offset:2048 sc1 lds
    v_fmac_f32_dpp v63, v13, v105 row_newbcast:3 row_mask:0xf bank_mask:0xf
    v_mfma_f32_16x16x32_bf16 v[72:75], a[16:19], v[52:55], v[72:75]
    ds_read_b128 v[48:51], v6 offset:22528
    v_mul_f32 v60, v104, v60
    v_mfma_f32_16x16x32_bf16 v[68:71], a[12:15], v[52:55], v[68:71]
    v_mul_f32 v61, v104, v61
    v_mul_f32 v62, v104, v62
    v_mfma_f32_16x16x32_bf16 v[76:79], v[52:55], a[20:23], v[76:79]
    s_waitcnt lgkmcnt(3)
    v_mul_f32 v63, v104, v63
    v_cvt_pk_bf16_f32 v84, v60, v61
    v_mfma_f32_16x16x32_bf16 v[72:75], a[28:31], v[112:115], v[72:75]
    ds_read_b128 v[52:55], v6 offset:23552
    v_cvt_pk_bf16_f32 v85, v62, v63
    v_mfma_f32_16x16x32_bf16 v[68:71], a[24:27], v[112:115], v[68:71]
    buffer_load_dwordx4 v7, s[8:11], s73 offen offset:3072 sc1 lds
    v_fmac_f32_dpp v56, v12, v105 row_newbcast:0 row_mask:0xf bank_mask:0xf
    v_mfma_f32_16x16x16_bf16 v[60:63], v[84:85], v[82:83], v[16:19]
    v_fmac_f32_dpp v57, v12, v105 row_newbcast:1 row_mask:0xf bank_mask:0xf
    v_fmac_f32_dpp v58, v12, v105 row_newbcast:2 row_mask:0xf bank_mask:0xf
    v_mfma_f32_16x16x32_bf16 v[76:79], v[112:115], a[32:35], v[76:79]
    v_fmac_f32_dpp v59, v12, v105 row_newbcast:3 row_mask:0xf bank_mask:0xf
    v_cvt_pk_bf16_f32 v80, v56, v57
    v_mfma_f32_16x16x32_bf16 v[72:75], a[40:43], v[116:119], v[72:75]
    ds_read_b128 v[112:115], v6 offset:24576
    v_cvt_pk_bf16_f32 v81, v58, v59
    v_mfma_f32_16x16x32_bf16 v[68:71], a[36:39], v[116:119], v[68:71]
    v_mul_f32 v96, s43, v104
    v_fmac_f32_dpp v64, v107, v120 row_newbcast:0 row_mask:0xf bank_mask:0xf
    v_mfma_f32_16x16x16_bf16 v[56:59], v[86:87], v[82:83], v[16:19]
    v_fmac_f32_dpp v65, v107, v120 row_newbcast:1 row_mask:0xf bank_mask:0xf
    v_fmac_f32_dpp v66, v107, v120 row_newbcast:2 row_mask:0xf bank_mask:0xf
    v_mfma_f32_16x16x32_bf16 v[76:79], v[116:119], a[44:47], v[76:79]
    s_waitcnt lgkmcnt(3)
    v_fmac_f32_dpp v67, v107, v120 row_newbcast:3 row_mask:0xf bank_mask:0xf
    v_mul_f32_dpp v64, v106, v64 row_newbcast:0 row_mask:0xf bank_mask:0xf
    v_mfma_f32_16x16x32_bf16 v[72:75], a[52:55], v[40:43], v[72:75]
    ds_read_b128 v[116:119], v6 offset:25600
    v_mul_f32_dpp v65, v106, v65 row_newbcast:1 row_mask:0xf bank_mask:0xf
    v_mfma_f32_16x16x32_bf16 v[68:71], a[48:51], v[40:43], v[68:71]
    v_mul_f32_dpp v66, v106, v66 row_newbcast:2 row_mask:0xf bank_mask:0xf
    v_mul_f32_dpp v67, v106, v67 row_newbcast:3 row_mask:0xf bank_mask:0xf
    v_mfma_f32_16x16x32_bf16 v[76:79], v[40:43], a[56:59], v[76:79]
    v_cvt_pk_bf16_f32 v92, v64, v65
    v_cvt_pk_bf16_f32 v93, v66, v67
    v_mfma_f32_16x16x32_bf16 v[72:75], a[64:67], v[44:47], v[72:75]
    ds_read_b128 v[40:43], v6 offset:26624
    v_cndmask_b32 v56, v60, v56, s[28:29]
    v_mfma_f32_16x16x32_bf16 v[68:71], a[60:63], v[44:47], v[68:71]
    ds_read_b64 v[104:105], v98 offset:0
    v_cndmask_b32 v57, v61, v57, s[30:31]
    v_mfma_f32_16x16x32_bf16 v[76:79], v[44:47], a[68:71], v[76:79]
    s_waitcnt lgkmcnt(4)
    ds_read_b64 v[106:107], v99 offset:0
    v_mfma_f32_16x16x32_bf16 v[72:75], a[76:79], v[48:51], v[72:75]
    ds_read_b128 v[44:47], v6 offset:27648
    v_cndmask_b32 v58, v62, v58, s[32:33]
    v_mfma_f32_16x16x32_bf16 v[68:71], a[72:75], v[48:51], v[68:71]
    v_cndmask_b32 v59, v63, v59, s[34:35]
    v_max3_f32 v60, v56, v57, v58
    v_mfma_f32_16x16x32_bf16 v[76:79], v[48:51], a[80:83], v[76:79]
    v_max_f32 v61, v60, v59
    v_max_f32 v60, v60, v59
    v_mfma_f32_16x16x32_bf16 v[72:75], a[88:91], v[52:55], v[72:75]
    ds_read_b128 v[48:51], v6 offset:28672
    v_mfma_f32_16x16x32_bf16 v[68:71], a[84:87], v[52:55], v[68:71]
    v_permlane32_swap_b32 v60, v61
    v_mfma_f32_16x16x32_bf16 v[76:79], v[52:55], a[92:95], v[76:79]
    s_waitcnt lgkmcnt(5)
    v_max_f32 v62, v60, v61
    v_max_f32 v60, v60, v61
    v_mfma_f32_16x16x32_bf16 v[72:75], a[100:103], v[112:115], v[72:75]
    ds_read_b128 v[52:55], v6 offset:29696
    v_mfma_f32_16x16x32_bf16 v[68:71], a[96:99], v[112:115], v[68:71]
    v_permlane16_swap_b32 v60, v62
    v_mfma_f32_16x16x32_bf16 v[76:79], v[112:115], a[104:107], v[76:79]
    v_max_f32 v60, v60, v62
    v_mul_f32 v60, -v60, v97
    v_mfma_f32_16x16x32_bf16 v[72:75], a[112:115], v[116:119], v[72:75]
    ds_read_b128 v[112:115], v6 offset:30720
    v_fma_f32 v56, v56, v97, v60
    v_mfma_f32_16x16x32_bf16 v[68:71], a[108:111], v[116:119], v[68:71]
    v_fma_f32 v57, v57, v97, v60
    v_fma_f32 v58, v58, v97, v60
    v_mfma_f32_16x16x32_bf16 v[76:79], v[116:119], a[116:119], v[76:79]
    s_waitcnt lgkmcnt(3)
    v_fma_f32 v59, v59, v97, v60
    v_mfma_f32_16x16x32_bf16 v[72:75], a[124:127], v[40:43], v[72:75]
    ds_read_b128 v[116:119], v6 offset:31744
    v_mfma_f32_16x16x32_bf16 v[68:71], a[120:123], v[40:43], v[68:71]
    v_exp_f32 v56, v56
    v_mfma_f32_16x16x32_bf16 v[76:79], v[40:43], a[128:131], v[76:79]
    s_add_u32 s75, s61, 65536
    v_exp_f32 v57, v57
    v_mfma_f32_16x16x32_bf16 v[72:75], a[136:139], v[44:47], v[72:75]
    buffer_load_dwordx4 v[88:91], v6, s[8:11], s75 offen sc1
    v_mfma_f32_16x16x32_bf16 v[68:71], a[132:135], v[44:47], v[68:71]
    v_exp_f32 v58, v58
    v_mfma_f32_16x16x32_bf16 v[76:79], v[44:47], a[140:143], v[76:79]
    s_waitcnt lgkmcnt(3)
    v_exp_f32 v59, v59
    v_mfma_f32_16x16x32_bf16 v[72:75], a[148:151], v[48:51], v[72:75]
    v_cvt_pk_bf16_f32 v0, v56, v57
    v_cvt_pk_bf16_f32 v1, v58, v59
    v_mfma_f32_16x16x32_bf16 v[68:71], a[144:147], v[48:51], v[68:71]
    v_and_b32 v62, v0, v20
    v_and_b32 v63, v1, v21
    v_mfma_f32_16x16x16_bf16 v[56:59], v[22:23], v[0:1], 0
    v_xor_b32 v60, v0, v62
    v_xor_b32 v61, v1, v63
    v_mfma_f32_16x16x32_bf16 v[76:79], v[48:51], a[152:155], v[76:79]
    s_waitcnt lgkmcnt(0) vmcnt(1)
    s_barrier
    v_mfma_f32_16x16x32_bf16 v[64:67], v[92:95], v[60:63], 0
    s_lshl_b32 s73, s37, 16
    s_add_u32 s73, s73, 64512
    s_mov_b32 m0, 162816
    v_mfma_f32_16x16x32_bf16 v[72:75], a[160:163], v[52:55], v[72:75]
    ds_read_b128 v[40:43], v6 offset:0
    v_mfma_f32_16x16x32_bf16 v[68:71], a[156:159], v[52:55], v[68:71]
    ds_read_b128 v[44:47], v6 offset:1024
    v_mfma_f32_16x16x32_bf16 v[76:79], v[52:55], a[164:167], v[76:79]
    buffer_load_dwordx4 v6, s[8:11], s73 offen sc1 lds
    v_mfma_f32_16x16x32_bf16 v[72:75], a[172:175], v[112:115], v[72:75]
    ds_read_b128 v[48:51], v6 offset:2048
    v_mfma_f32_16x16x32_bf16 v[68:71], a[168:171], v[112:115], v[68:71]
    ds_read_b128 v[52:55], v6 offset:3072
    v_mfma_f32_16x16x32_bf16 v[76:79], v[112:115], a[176:179], v[76:79]
    v_rcp_f32 v56, v56
    v_mfma_f32_16x16x32_bf16 v[72:75], a[184:187], v[116:119], v[72:75]
    ds_read_b128 v[112:115], v6 offset:4096
    v_mul_f32 v64, v56, v64
    v_mfma_f32_16x16x32_bf16 v[68:71], a[180:183], v[116:119], v[68:71]
    v_mul_f32 v65, v56, v65
    v_mul_f32 v66, v56, v66
    v_mfma_f32_16x16x32_bf16 v[76:79], v[116:119], a[188:191], v[76:79]
    s_waitcnt lgkmcnt(3)
    v_mul_f32 v67, v56, v67
    v_cvt_pk_bf16_f32 v1, v66, v67
    v_cvt_pk_bf16_f32 v0, v64, v65
    v_mfma_f32_16x16x32_bf16 v[60:63], a[4:7], v[40:43], 0
    ds_read_b128 v[116:119], v6 offset:5120
    s_waitcnt lgkmcnt(15)
    v_mfma_f32_16x16x32_bf16 v[56:59], a[0:3], v[40:43], 0
    ds_read_b128 v[24:27], v6 offset:6144
    v_fmac_f32_dpp v72, v13, v109 row_newbcast:0 row_mask:0xf bank_mask:0xf
    v_mfma_f32_16x16x32_bf16 v[64:67], v[40:43], a[8:11], 0
    v_fmac_f32_dpp v73, v13, v109 row_newbcast:1 row_mask:0xf bank_mask:0xf
    v_fmac_f32_dpp v74, v13, v109 row_newbcast:2 row_mask:0xf bank_mask:0xf
    v_mfma_f32_16x16x32_bf16 v[60:63], a[16:19], v[44:47], v[60:63]
    ds_read_b128 v[28:31], v6 offset:7168
    v_fmac_f32_dpp v75, v13, v109 row_newbcast:3 row_mask:0xf bank_mask:0xf
    v_mfma_f32_16x16x32_bf16 v[56:59], a[12:15], v[44:47], v[56:59]
    ds_read_b128 v[32:35], v6 offset:8192
    v_mul_f32 v72, v108, v72
    v_mfma_f32_16x16x32_bf16 v[64:67], v[44:47], a[20:23], v[64:67]
    s_waitcnt lgkmcnt(5)
    v_mul_f32 v73, v108, v73
    v_mul_f32 v74, v108, v74
    v_mfma_f32_16x16x32_bf16 v[60:63], a[28:31], v[48:51], v[60:63]
    ds_read_b128 v[36:39], v6 offset:9216
    v_mul_f32 v75, v108, v75
    v_mfma_f32_16x16x32_bf16 v[56:59], a[24:27], v[48:51], v[56:59]
    ds_read_b128 v[40:43], v6 offset:10240
    v_cvt_pk_bf16_f32 v86, v72, v73
    v_mfma_f32_16x16x32_bf16 v[64:67], v[48:51], a[32:35], v[64:67]
    v_cvt_pk_bf16_f32 v87, v74, v75
    v_fmac_f32_dpp v68, v12, v109 row_newbcast:0 row_mask:0xf bank_mask:0xf
    v_mfma_f32_16x16x32_bf16 v[60:63], a[40:43], v[52:55], v[60:63]
    ds_read_b128 v[44:47], v6 offset:11264
    v_fmac_f32_dpp v69, v12, v109 row_newbcast:1 row_mask:0xf bank_mask:0xf
    v_mfma_f32_16x16x16_bf16 v[72:75], v[86:87], v[80:81], v[16:19]
    v_fmac_f32_dpp v70, v12, v109 row_newbcast:2 row_mask:0xf bank_mask:0xf
    v_fmac_f32_dpp v71, v12, v109 row_newbcast:3 row_mask:0xf bank_mask:0xf
    v_mfma_f32_16x16x32_bf16 v[56:59], a[36:39], v[52:55], v[56:59]
    ds_read_b128 v[48:51], v6 offset:12288
    v_cvt_pk_bf16_f32 v82, v68, v69
    v_mfma_f32_16x16x32_bf16 v[64:67], v[52:55], a[44:47], v[64:67]
    s_waitcnt lgkmcnt(7)
    v_cvt_pk_bf16_f32 v83, v70, v71
    v_mul_f32 v97, s43, v108
    v_mfma_f32_16x16x16_bf16 v[68:71], v[84:85], v[80:81], v[16:19]
    v_fmac_f32_dpp v76, v111, v120 row_newbcast:0 row_mask:0xf bank_mask:0xf
    v_fmac_f32_dpp v77, v111, v120 row_newbcast:1 row_mask:0xf bank_mask:0xf
    v_mfma_f32_16x16x32_bf16 v[60:63], a[52:55], v[112:115], v[60:63]
    ds_read_b128 v[52:55], v6 offset:13312
    v_fmac_f32_dpp v78, v111, v120 row_newbcast:2 row_mask:0xf bank_mask:0xf
    v_mfma_f32_16x16x32_bf16 v[56:59], a[48:51], v[112:115], v[56:59]
    v_fmac_f32_dpp v79, v111, v120 row_newbcast:3 row_mask:0xf bank_mask:0xf
    v_mul_f32_dpp v76, v110, v76 row_newbcast:0 row_mask:0xf bank_mask:0xf
    v_mfma_f32_16x16x32_bf16 v[64:67], v[112:115], a[56:59], v[64:67]
    v_mul_f32_dpp v77, v110, v77 row_newbcast:1 row_mask:0xf bank_mask:0xf
    v_mul_f32_dpp v78, v110, v78 row_newbcast:2 row_mask:0xf bank_mask:0xf
    v_mfma_f32_16x16x32_bf16 v[60:63], a[64:67], v[116:119], v[60:63]
    ds_read_b128 v[112:115], v6 offset:14336
    v_mul_f32_dpp v79, v110, v79 row_newbcast:3 row_mask:0xf bank_mask:0xf
    v_mfma_f32_16x16x32_bf16 v[56:59], a[60:63], v[116:119], v[56:59]
    v_cvt_pk_bf16_f32 v94, v76, v77
    v_cvt_pk_bf16_f32 v95, v78, v79
    v_mfma_f32_16x16x32_bf16 v[64:67], v[116:119], a[68:71], v[64:67]
    s_waitcnt lgkmcnt(7)
    v_cndmask_b32 v68, v72, v68, s[28:29]
    v_cndmask_b32 v69, v73, v69, s[30:31]
    v_mfma_f32_16x16x32_bf16 v[60:63], a[76:79], v[24:27], v[60:63]
    ds_read_b128 v[116:119], v6 offset:15360
    v_cndmask_b32 v70, v74, v70, s[32:33]
    v_mfma_f32_16x16x32_bf16 v[56:59], a[72:75], v[24:27], v[56:59]
    v_cndmask_b32 v71, v75, v71, s[34:35]
    v_max3_f32 v72, v68, v69, v70
    v_mfma_f32_16x16x32_bf16 v[64:67], v[24:27], a[80:83], v[64:67]
    v_max_f32 v73, v72, v71
    v_max_f32 v72, v72, v71
    v_mfma_f32_16x16x32_bf16 v[60:63], a[88:91], v[28:31], v[60:63]
    s_nop 0
    v_permlane32_swap_b32 v72, v73
    v_mfma_f32_16x16x32_bf16 v[56:59], a[84:87], v[28:31], v[56:59]
    s_waitcnt lgkmcnt(6)
    v_max_f32 v74, v72, v73
    v_max_f32 v72, v72, v73
    v_mfma_f32_16x16x32_bf16 v[60:63], a[100:103], v[32:35], v[60:63]
    s_nop 0
    v_permlane16_swap_b32 v72, v74
    v_mfma_f32_16x16x32_bf16 v[56:59], a[96:99], v[32:35], v[56:59]
    v_max_f32 v72, v72, v74
    v_mul_f32 v72, -v72, v96
    v_mfma_f32_16x16x32_bf16 v[60:63], a[112:115], v[36:39], v[60:63]
    v_fma_f32 v68, v68, v96, v72
    v_fma_f32 v69, v69, v96, v72
    v_mfma_f32_16x16x32_bf16 v[56:59], a[108:111], v[36:39], v[56:59]
    s_waitcnt lgkmcnt(4)
    v_fma_f32 v70, v70, v96, v72
    v_fma_f32 v71, v71, v96, v72
    v_mfma_f32_16x16x32_bf16 v[60:63], a[124:127], v[40:43], v[60:63]
    v_exp_f32 v68, v68
    v_mfma_f32_16x16x32_bf16 v[56:59], a[120:123], v[40:43], v[56:59]
    v_exp_f32 v69, v69
    v_mfma_f32_16x16x32_bf16 v[60:63], a[136:139], v[44:47], v[60:63]
    v_exp_f32 v70, v70
    v_mfma_f32_16x16x32_bf16 v[56:59], a[132:135], v[44:47], v[56:59]
    s_waitcnt lgkmcnt(3)
    v_exp_f32 v71, v71
    v_mfma_f32_16x16x32_bf16 v[60:63], a[148:151], v[48:51], v[60:63]
    v_cvt_pk_bf16_f32 v2, v68, v69
    v_cvt_pk_bf16_f32 v3, v70, v71
    v_mfma_f32_16x16x32_bf16 v[56:59], a[144:147], v[48:51], v[56:59]
    s_waitcnt lgkmcnt(2)
    v_and_b32 v72, v2, v20
    v_and_b32 v73, v3, v21
    v_mfma_f32_16x16x16_bf16 v[68:71], v[22:23], v[2:3], 0
    v_xor_b32 v74, v2, v72
    v_xor_b32 v75, v3, v73
    v_mfma_f32_16x16x32_bf16 v[60:63], a[160:163], v[52:55], v[60:63]
    s_add_u32 s88, s65, 98304
    v_mfma_f32_16x16x32_bf16 v[76:79], v[92:95], v[72:75], 0
    s_waitcnt vmcnt(1)
    v_cmp_eq_u32 vcc, -1, v91
    v_mfma_f32_16x16x32_bf16 v[56:59], a[156:159], v[52:55], v[56:59]
    s_waitcnt lgkmcnt(1)
    v_rcp_f32 v68, v68
    v_mfma_f32_16x16x32_bf16 v[60:63], a[172:175], v[112:115], v[60:63]
    s_cbranch_vccnz L_retry_55
L_back_56:
    v_mfma_f32_16x16x32_bf16 v[56:59], a[168:171], v[112:115], v[56:59]
    s_waitcnt lgkmcnt(0)
    v_mul_f32 v76, v68, v76
    v_mul_f32 v77, v68, v77
    v_mfma_f32_16x16x32_bf16 v[60:63], a[184:187], v[116:119], v[60:63]
    v_mul_f32 v78, v68, v78
    v_mul_f32 v79, v68, v79
    v_mfma_f32_16x16x32_bf16 v[56:59], a[180:183], v[116:119], v[56:59]
    v_cvt_pk_bf16_f32 v3, v78, v79
    v_cvt_pk_bf16_f32 v2, v76, v77
    v_mfma_f32_16x16x32_bf16 v[64:67], v[28:31], a[92:95], v[64:67]
    v_permlane16_swap_b32 v1, v3
    v_mfma_f32_16x16x32_bf16 v[64:67], v[32:35], a[104:107], v[64:67]
    v_permlane16_swap_b32 v0, v2
    v_mfma_f32_16x16x32_bf16 v[64:67], v[36:39], a[116:119], v[64:67]
    v_and_b32 v3, -2, v3
    v_fmac_f32_dpp v60, v13, v105 row_newbcast:0 row_mask:0xf bank_mask:0xf
    v_mfma_f32_16x16x32_bf16 v[64:67], v[40:43], a[128:131], v[64:67]
    buffer_store_dwordx4 v[0:3], v8, s[8:11], s88 offen
    v_mfma_f32_16x16x32_bf16 v[64:67], v[44:47], a[140:143], v[64:67]
    v_fmac_f32_dpp v61, v13, v105 row_newbcast:1 row_mask:0xf bank_mask:0xf
    v_fmac_f32_dpp v62, v13, v105 row_newbcast:2 row_mask:0xf bank_mask:0xf
    v_mfma_f32_16x16x32_bf16 v[64:67], v[48:51], a[152:155], v[64:67]
    v_fmac_f32_dpp v63, v13, v105 row_newbcast:3 row_mask:0xf bank_mask:0xf
    v_mul_f32 v60, v104, v60
    v_mfma_f32_16x16x32_bf16 v[64:67], v[52:55], a[164:167], v[64:67]
    v_mul_f32 v61, v104, v61
    v_mul_f32 v62, v104, v62
    v_mfma_f32_16x16x32_bf16 v[64:67], v[112:115], a[176:179], v[64:67]
    v_mul_f32 v63, v104, v63
    v_cvt_pk_bf16_f32 v84, v60, v61
    v_mfma_f32_16x16x32_bf16 v[64:67], v[116:119], a[188:191], v[64:67]
    v_cvt_pk_bf16_f32 v85, v62, v63
    v_fmac_f32_dpp v56, v12, v105 row_newbcast:0 row_mask:0xf bank_mask:0xf
    v_fmac_f32_dpp v57, v12, v105 row_newbcast:1 row_mask:0xf bank_mask:0xf
    v_mfma_f32_16x16x16_bf16 v[72:75], v[84:85], v[82:83], v[16:19]
    v_fmac_f32_dpp v58, v12, v105 row_newbcast:2 row_mask:0xf bank_mask:0xf
    v_fmac_f32_dpp v59, v12, v105 row_newbcast:3 row_mask:0xf bank_mask:0xf
    v_mfma_f32_16x16x16_bf16 v[68:71], v[86:87], v[82:83], v[16:19]
    v_cvt_pk_bf16_f32 v80, v56, v57
    v_cvt_pk_bf16_f32 v81, v58, v59
    v_mul_f32 v96, s43, v104
    v_add_f32 v60, s42, v16
    v_add_f32 v61, s42, v17
    v_add_f32 v62, s42, v18
    v_add_f32 v63, s42, v19
    v_mfma_f32_16x16x16_bf16 v[56:59], v[84:85], v[80:81], v[16:19]
    v_cndmask_b32 v68, v72, v68, s[28:29]
    v_cndmask_b32 v69, v73, v69, s[30:31]
    v_mfma_f32_16x16x16_bf16 v[60:63], v[88:89], v[80:81], v[60:63]
    v_cndmask_b32 v70, v74, v70, s[32:33]
    v_cndmask_b32 v71, v75, v71, s[34:35]
    v_max3_f32 v72, v68, v69, v70
    v_max_f32 v73, v72, v71
    v_max_f32 v72, v72, v71
    v_fmac_f32_dpp v64, v107, v120 row_newbcast:0 row_mask:0xf bank_mask:0xf
    v_fmac_f32_dpp v65, v107, v120 row_newbcast:1 row_mask:0xf bank_mask:0xf
    v_permlane32_swap_b32 v72, v73
    v_cndmask_b32 v56, v60, v56, s[28:29]
    v_cndmask_b32 v57, v61, v57, s[30:31]
    v_cndmask_b32 v58, v62, v58, s[32:33]
    v_cndmask_b32 v59, v63, v59, s[34:35]
    v_max3_f32 v60, v56, v57, v58
    v_max_f32 v61, v60, v59
    v_max_f32 v60, v60, v59
    v_max_f32 v74, v72, v73
    v_max_f32 v72, v72, v73
    v_permlane32_swap_b32 v60, v61
    v_max_f32 v62, v60, v61
    v_max_f32 v60, v60, v61
    v_permlane16_swap_b32 v72, v74
    v_max_f32 v72, v72, v74
    v_permlane16_swap_b32 v60, v62
    v_max_f32 v60, v60, v62
    v_mul_f32 v60, -v60, v96
    v_fma_f32 v56, v56, v96, v60
    v_fma_f32 v57, v57, v96, v60
    v_fma_f32 v58, v58, v96, v60
    v_fma_f32 v59, v59, v96, v60
    v_mul_f32 v72, -v72, v97
    v_exp_f32 v56, v56
    v_fma_f32 v68, v68, v97, v72
    v_exp_f32 v57, v57
    v_fma_f32 v69, v69, v97, v72
    v_exp_f32 v58, v58
    v_fma_f32 v70, v70, v97, v72
    v_exp_f32 v59, v59
    v_fma_f32 v71, v71, v97, v72
    v_cvt_pk_bf16_f32 v2, v56, v57
    v_exp_f32 v68, v68
    v_cvt_pk_bf16_f32 v3, v58, v59
    v_exp_f32 v69, v69
    v_and_b32 v62, v2, v20
    v_exp_f32 v70, v70
    v_and_b32 v63, v3, v21
    v_mfma_f32_16x16x16_bf16 v[56:59], v[22:23], v[2:3], 0
    s_add_u32 s96, s66, 65536
    s_mov_b64 exec, s[54:55]
    buffer_load_dwordx4 v[24:27], v6, s[8:11], s96 offen offset:0 sc1
    buffer_load_dwordx4 v[28:31], v6, s[8:11], s96 offen offset:1024 sc1
    s_mov_b64 exec, -1
    v_exp_f32 v71, v71
    v_cvt_pk_bf16_f32 v0, v68, v69
    v_xor_b32 v60, v2, v62
    v_cvt_pk_bf16_f32 v1, v70, v71
    v_xor_b32 v61, v3, v63
    v_and_b32 v74, v0, v20
    s_add_u32 s94, s65, 65536
    v_and_b32 v75, v1, v21
    v_mfma_f32_16x16x16_bf16 v[68:71], v[22:23], v[0:1], 0
    s_mov_b64 exec, s[54:55]
    buffer_load_dwordx4 v[32:35], v6, s[8:11], s96 offen offset:2048 sc1
    buffer_load_dwordx4 v[36:39], v6, s[8:11], s96 offen offset:3072 sc1
    s_mov_b64 exec, -1
    s_add_u32 s97, s66, 69632
    v_xor_b32 v72, v0, v74
    v_xor_b32 v73, v1, v75
    v_fmac_f32_dpp v66, v107, v120 row_newbcast:2 row_mask:0xf bank_mask:0xf
    v_fmac_f32_dpp v67, v107, v120 row_newbcast:3 row_mask:0xf bank_mask:0xf
    v_mul_f32_dpp v64, v106, v64 row_newbcast:0 row_mask:0xf bank_mask:0xf
    v_mul_f32_dpp v65, v106, v65 row_newbcast:1 row_mask:0xf bank_mask:0xf
    v_mul_f32_dpp v66, v106, v66 row_newbcast:2 row_mask:0xf bank_mask:0xf
    v_add_u32 v5, 32768, v6
    s_mov_b64 exec, s[54:55]
    buffer_load_dwordx4 v[40:43], v6, s[8:11], s97 offen offset:0 sc1
    buffer_load_dwordx4 v[44:47], v6, s[8:11], s97 offen offset:1024 sc1
    s_mov_b64 exec, -1
    ds_read_b128 v[80:83], v5 offset:0
    ds_read_b128 v[84:87], v5 offset:1024
    ds_read_b128 v[96:99], v5 offset:2048
    v_mul_f32_dpp v67, v106, v67 row_newbcast:3 row_mask:0xf bank_mask:0xf
    v_cvt_pk_bf16_f32 v92, v64, v65
    v_cvt_pk_bf16_f32 v93, v66, v67
    s_mov_b64 exec, s[54:55]
    buffer_load_dwordx4 v[48:51], v6, s[8:11], s97 offen offset:2048 sc1
    buffer_load_dwordx4 v[52:55], v6, s[8:11], s97 offen offset:3072 sc1
    s_mov_b64 exec, -1
    v_mfma_f32_16x16x32_bf16 v[64:67], v[90:93], v[60:63], 0
    v_rcp_f32 v56, v56
    v_mfma_f32_16x16x32_bf16 v[76:79], v[92:95], v[72:75], 0
    v_rcp_f32 v68, v68
    v_mfma_f32_16x16x16_bf16 v[104:107], v[14:15], v[100:101], 0
    v_mfma_f32_16x16x16_bf16 v[108:111], v[14:15], v[102:103], 0
    s_nop 2
    v_mul_f32 v64, v56, v64
    v_mul_f32 v65, v56, v65
    v_mul_f32 v66, v56, v66
    v_mul_f32 v67, v56, v67
    v_mul_f32 v76, v68, v76
    v_cvt_pk_bf16_f32 v3, v66, v67
    v_mul_f32 v77, v68, v77
    v_cvt_pk_bf16_f32 v2, v64, v65
    v_mul_f32 v78, v68, v78
    v_mul_f32 v79, v68, v79
    v_cvt_pk_bf16_f32 v1, v78, v79
    v_cvt_pk_bf16_f32 v0, v76, v77
    v_mfma_f32_16x16x16_bf16 v[112:115], v[14:15], v[124:125], 0
    v_permlane16_swap_b32 v1, v3
    v_permlane16_swap_b32 v0, v2
    v_and_b32 v3, -2, v3
    buffer_store_dwordx4 v[0:3], v8, s[8:11], s94 offen
    v_mfma_f32_16x16x16_bf16 v[116:119], v[14:15], v[126:127], 0
    s_cmp_lt_u32 s36, 2
    s_cbranch_scc1 L_lo_57
    s_waitcnt vmcnt(5)
    v_bitop3_b32 v4, v27, v31, v35 bitop3:0xfe
    v_bitop3_b32 v4, v4, v39, 1 bitop3:0xa8
    v_cmp_ne_u32 vcc, 0, v4
    ds_read_b128 v[72:75], v5 offset:3072
    ds_read_b128 v[76:79], v5 offset:4096
    ds_read_b128 v[88:91], v5 offset:5120
    ds_read_b128 v[92:95], v5 offset:6144
    s_cbranch_vccnz L_retry_71
L_back_72:
    s_waitcnt lgkmcnt(6)
    v_mfma_f32_16x16x32_bf16 v[104:107], v[80:83], v[24:27], v[104:107]
    ds_read_b128 v[100:103], v5 offset:7168
    s_waitcnt lgkmcnt(5)
    v_mfma_f32_16x16x32_bf16 v[108:111], v[84:87], v[24:27], v[108:111]
    ds_read_b128 v[80:83], v5 offset:8192
    s_add_u32 s85, s66, 73728
    v_mfma_f32_16x16x32_bf16 v[112:115], v[96:99], v[24:27], v[112:115]
    ds_read_b128 v[84:87], v5 offset:9216
    s_waitcnt lgkmcnt(5)
    buffer_load_dwordx4 v[56:59], v6, s[8:11], s85 offen offset:0 sc1
    v_mfma_f32_16x16x32_bf16 v[116:119], v[72:75], v[24:27], v[116:119]
    ds_read_b128 v[96:99], v5 offset:10240
    v_mfma_f32_16x16x32_bf16 v[104:107], v[76:79], v[28:31], v[104:107]
    ds_read_b128 v[72:75], v5 offset:11264
    s_waitcnt lgkmcnt(5)
    buffer_load_dwordx4 v[60:63], v6, s[8:11], s85 offen offset:1024 sc1
    v_mfma_f32_16x16x32_bf16 v[108:111], v[88:91], v[28:31], v[108:111]
    ds_read_b128 v[76:79], v5 offset:12288
    v_mfma_f32_16x16x32_bf16 v[112:115], v[92:95], v[28:31], v[112:115]
    ds_read_b128 v[88:91], v5 offset:13312
    s_waitcnt lgkmcnt(5)
    buffer_load_dwordx4 v[64:67], v6, s[8:11], s85 offen offset:2048 sc1
    v_mfma_f32_16x16x32_bf16 v[116:119], v[100:103], v[28:31], v[116:119]
    ds_read_b128 v[92:95], v5 offset:14336
    v_mfma_f32_16x16x32_bf16 v[104:107], v[80:83], v[32:35], v[104:107]
    ds_read_b128 v[100:103], v5 offset:15360
    s_waitcnt lgkmcnt(5)
    buffer_load_dwordx4 v[68:71], v6, s[8:11], s85 offen offset:3072 sc1
    v_mfma_f32_16x16x32_bf16 v[108:111], v[84:87], v[32:35], v[108:111]
    ds_read_b128 v[80:83], v5 offset:16384
    s_waitcnt vmcnt(5)
    v_mfma_f32_16x16x32_bf16 v[112:115], v[96:99], v[32:35], v[112:115]
    ds_read_b128 v[84:87], v5 offset:17408
    s_waitcnt lgkmcnt(5)
    v_mfma_f32_16x16x32_bf16 v[116:119], v[72:75], v[32:35], v[116:119]
    ds_read_b128 v[96:99], v5 offset:18432
    v_bitop3_b32 v4, v43, v47, v51 bitop3:0xfe
    v_mfma_f32_16x16x32_bf16 v[104:107], v[76:79], v[36:39], v[104:107]
    ds_read_b128 v[72:75], v5 offset:19456
    s_waitcnt lgkmcnt(5)
    v_mfma_f32_16x16x32_bf16 v[108:111], v[88:91], v[36:39], v[108:111]
    ds_read_b128 v[76:79], v5 offset:20480
    v_bitop3_b32 v4, v4, v55, 1 bitop3:0xa8
    v_mfma_f32_16x16x32_bf16 v[112:115], v[92:95], v[36:39], v[112:115]
    ds_read_b128 v[88:91], v5 offset:21504
    s_waitcnt lgkmcnt(5)
    v_mfma_f32_16x16x32_bf16 v[116:119], v[100:103], v[36:39], v[116:119]
    ds_read_b128 v[92:95], v5 offset:22528
    v_cmp_ne_u32 vcc, 0, v4
    s_nop 0
    s_cbranch_vccnz L_retry_73
L_back_74:
    v_mfma_f32_16x16x32_bf16 v[104:107], v[80:83], v[40:43], v[104:107]
    ds_read_b128 v[100:103], v5 offset:23552
    s_waitcnt lgkmcnt(5)
    v_mfma_f32_16x16x32_bf16 v[108:111], v[84:87], v[40:43], v[108:111]
    ds_read_b128 v[80:83], v5 offset:24576
    s_add_u32 s86, s66, 77824
    v_mfma_f32_16x16x32_bf16 v[112:115], v[96:99], v[40:43], v[112:115]
    ds_read_b128 v[84:87], v5 offset:25600
    s_waitcnt lgkmcnt(5)
    buffer_load_dwordx4 v[24:27], v6, s[8:11], s86 offen offset:0 sc1
    v_mfma_f32_16x16x32_bf16 v[116:119], v[72:75], v[40:43], v[116:119]
    ds_read_b128 v[96:99], v5 offset:26624
    v_mfma_f32_16x16x32_bf16 v[104:107], v[76:79], v[44:47], v[104:107]
    ds_read_b128 v[72:75], v5 offset:27648
    s_waitcnt lgkmcnt(5)
    buffer_load_dwordx4 v[28:31], v6, s[8:11], s86 offen offset:1024 sc1
    v_mfma_f32_16x16x32_bf16 v[108:111], v[88:91], v[44:47], v[108:111]
    ds_read_b128 v[76:79], v5 offset:28672
    v_mfma_f32_16x16x32_bf16 v[112:115], v[92:95], v[44:47], v[112:115]
    ds_read_b128 v[88:91], v5 offset:29696
    s_waitcnt lgkmcnt(5)
    buffer_load_dwordx4 v[32:35], v6, s[8:11], s86 offen offset:2048 sc1
    v_mfma_f32_16x16x32_bf16 v[116:119], v[100:103], v[44:47], v[116:119]
    ds_read_b128 v[92:95], v5 offset:30720
    v_mfma_f32_16x16x32_bf16 v[104:107], v[80:83], v[48:51], v[104:107]
    ds_read_b128 v[100:103], v5 offset:31744
    s_waitcnt lgkmcnt(5)
    buffer_load_dwordx4 v[36:39], v6, s[8:11], s86 offen offset:3072 sc1
    v_mfma_f32_16x16x32_bf16 v[108:111], v[84:87], v[48:51], v[108:111]
    ds_read_b128 v[80:83], v5 offset:32768
    v_mfma_f32_16x16x32_bf16 v[112:115], v[96:99], v[48:51], v[112:115]
    ds_read_b128 v[84:87], v5 offset:33792
    s_waitcnt lgkmcnt(5)
    v_mfma_f32_16x16x32_bf16 v[116:119], v[72:75], v[48:51], v[116:119]
    ds_read_b128 v[96:99], v5 offset:34816
    v_mfma_f32_16x16x32_bf16 v[104:107], v[76:79], v[52:55], v[104:107]
    ds_read_b128 v[72:75], v5 offset:35840
    s_waitcnt lgkmcnt(5)
    v_mfma_f32_16x16x32_bf16 v[108:111], v[88:91], v[52:55], v[108:111]
    ds_read_b128 v[76:79], v5 offset:36864
    s_waitcnt vmcnt(4)
    v_mfma_f32_16x16x32_bf16 v[112:115], v[92:95], v[52:55], v[112:115]
    ds_read_b128 v[88:91], v5 offset:37888
    s_waitcnt lgkmcnt(5)
    v_mfma_f32_16x16x32_bf16 v[116:119], v[100:103], v[52:55], v[116:119]
    ds_read_b128 v[92:95], v5 offset:38912
    v_bitop3_b32 v4, v59, v63, v67 bitop3:0xfe
    v_bitop3_b32 v4, v4, v71, 1 bitop3:0xa8
    v_cmp_ne_u32 vcc, 0, v4
    s_nop 0
    s_cbranch_vccnz L_retry_75
L_back_76:
    v_mfma_f32_16x16x32_bf16 v[104:107], v[80:83], v[56:59], v[104:107]
    ds_read_b128 v[100:103], v5 offset:39936
    s_waitcnt lgkmcnt(5)
    v_mfma_f32_16x16x32_bf16 v[108:111], v[84:87], v[56:59], v[108:111]
    ds_read_b128 v[80:83], v5 offset:40960
    v_mfma_f32_16x16x32_bf16 v[112:115], v[96:99], v[56:59], v[112:115]
    ds_read_b128 v[84:87], v5 offset:41984
    s_waitcnt lgkmcnt(5)
    v_mfma_f32_16x16x32_bf16 v[116:119], v[72:75], v[56:59], v[116:119]
    ds_read_b128 v[96:99], v5 offset:43008
    v_mfma_f32_16x16x32_bf16 v[104:107], v[76:79], v[60:63], v[104:107]
    ds_read_b128 v[72:75], v5 offset:44032
    s_waitcnt lgkmcnt(5)
    v_mfma_f32_16x16x32_bf16 v[108:111], v[88:91], v[60:63], v[108:111]
    ds_read_b128 v[76:79], v5 offset:45056
    v_mfma_f32_16x16x32_bf16 v[112:115], v[92:95], v[60:63], v[112:115]
    ds_read_b128 v[88:91], v5 offset:46080
    s_waitcnt lgkmcnt(5)
    v_mfma_f32_16x16x32_bf16 v[116:119], v[100:103], v[60:63], v[116:119]
    ds_read_b128 v[92:95], v5 offset:47104
    v_mfma_f32_16x16x32_bf16 v[104:107], v[80:83], v[64:67], v[104:107]
    ds_read_b128 v[100:103], v5 offset:48128
    s_waitcnt lgkmcnt(5)
    v_mfma_f32_16x16x32_bf16 v[108:111], v[84:87], v[64:67], v[108:111]
    ds_read_b128 v[80:83], v5 offset:49152
    v_mfma_f32_16x16x32_bf16 v[112:115], v[96:99], v[64:67], v[112:115]
    ds_read_b128 v[84:87], v5 offset:50176
    s_waitcnt lgkmcnt(5)
    v_mfma_f32_16x16x32_bf16 v[116:119], v[72:75], v[64:67], v[116:119]
    ds_read_b128 v[96:99], v5 offset:51200
    v_mfma_f32_16x16x32_bf16 v[104:107], v[76:79], v[68:71], v[104:107]
    ds_read_b128 v[72:75], v5 offset:52224
    s_waitcnt lgkmcnt(5)
    v_mfma_f32_16x16x32_bf16 v[108:111], v[88:91], v[68:71], v[108:111]
    ds_read_b128 v[76:79], v5 offset:53248
    s_waitcnt vmcnt(0)
    v_mfma_f32_16x16x32_bf16 v[112:115], v[92:95], v[68:71], v[112:115]
    ds_read_b128 v[88:91], v5 offset:54272
    s_waitcnt lgkmcnt(5)
    v_mfma_f32_16x16x32_bf16 v[116:119], v[100:103], v[68:71], v[116:119]
    ds_read_b128 v[92:95], v5 offset:55296
    v_bitop3_b32 v4, v27, v31, v35 bitop3:0xfe
    v_bitop3_b32 v4, v4, v39, 1 bitop3:0xa8
    v_cmp_ne_u32 vcc, 0, v4
    s_nop 0
    s_cbranch_vccnz L_retry_77
L_back_78:
    v_mfma_f32_16x16x32_bf16 v[104:107], v[80:83], v[24:27], v[104:107]
    ds_read_b128 v[100:103], v5 offset:56320
    s_waitcnt lgkmcnt(5)
    v_mfma_f32_16x16x32_bf16 v[108:111], v[84:87], v[24:27], v[108:111]
    ds_read_b128 v[80:83], v5 offset:57344
    v_mfma_f32_16x16x32_bf16 v[112:115], v[96:99], v[24:27], v[112:115]
    ds_read_b128 v[84:87], v5 offset:58368
    s_waitcnt lgkmcnt(5)
    v_mfma_f32_16x16x32_bf16 v[116:119], v[72:75], v[24:27], v[116:119]
    ds_read_b128 v[96:99], v5 offset:61440
    v_mfma_f32_16x16x32_bf16 v[104:107], v[76:79], v[28:31], v[104:107]
    ds_read_b128 v[72:75], v5 offset:62464
    s_waitcnt lgkmcnt(5)
    v_mfma_f32_16x16x32_bf16 v[108:111], v[88:91], v[28:31], v[108:111]
    ds_read_b128 v[76:79], v5 offset:59392
    v_mfma_f32_16x16x32_bf16 v[112:115], v[92:95], v[28:31], v[112:115]
    ds_read_b128 v[88:91], v5 offset:60416
    s_waitcnt lgkmcnt(5)
    v_mfma_f32_16x16x32_bf16 v[116:119], v[100:103], v[28:31], v[116:119]
    ds_read_b128 v[92:95], v5 offset:63488
    v_mfma_f32_16x16x32_bf16 v[104:107], v[80:83], v[32:35], v[104:107]
    ds_read_b128 v[100:103], v5 offset:64512
    s_waitcnt lgkmcnt(5)
    v_mfma_f32_16x16x32_bf16 v[108:111], v[84:87], v[32:35], v[108:111]
    v_mfma_f32_16x16x32_bf16 v[104:107], v[96:99], v[36:39], v[104:107]
    s_waitcnt lgkmcnt(3)
    v_mfma_f32_16x16x32_bf16 v[108:111], v[72:75], v[36:39], v[108:111]
    v_mfma_f32_16x16x32_bf16 v[112:115], v[76:79], v[32:35], v[112:115]
    s_waitcnt lgkmcnt(1)
    v_mfma_f32_16x16x32_bf16 v[116:119], v[88:91], v[32:35], v[116:119]
    v_mfma_f32_16x16x32_bf16 v[112:115], v[92:95], v[36:39], v[112:115]
    s_waitcnt lgkmcnt(0)
    v_mfma_f32_16x16x32_bf16 v[116:119], v[100:103], v[36:39], v[116:119]
    s_add_u32 s94, s63, 0
    s_nop 0
    v_cvt_pk_bf16_f32 v103, v110, v111
    v_cvt_pk_bf16_f32 v100, v104, v105
    v_cvt_pk_bf16_f32 v101, v106, v107
    v_cvt_pk_bf16_f32 v102, v108, v109
    v_and_b32 v103, -2, v103
    buffer_store_dwordx4 v[100:103], v6, s[8:11], s94 offen offset:0
    v_cvt_pk_bf16_f32 v127, v118, v119
    v_cvt_pk_bf16_f32 v124, v112, v113
    v_cvt_pk_bf16_f32 v125, v114, v115
    v_cvt_pk_bf16_f32 v126, v116, v117
    v_and_b32 v127, -2, v127
    buffer_store_dwordx4 v[124:127], v6, s[8:11], s94 offen offset:1024
    v_cvt_pk_bf16_f32 v103, v110, v111
    s_nop 0
    v_cvt_pk_bf16_f32 v127, v118, v119
    v_mov_b32 v96, 0x3f803f80
    v_mov_b32 v97, 0x3f803f80
    v_mov_b32 v98, 0x3f803f80
    v_mov_b32 v99, 0x3f803f80
    v_mfma_f32_16x16x32_bf16 v[108:111], v[100:103], v[100:103], 0
    v_mfma_f32_16x16x32_bf16 v[108:111], v[124:127], v[124:127], v[108:111]
    v_mfma_f32_16x16x32_bf16 v[104:107], v[96:99], v[100:103], 0
    v_mfma_f32_16x16x32_bf16 v[104:107], v[96:99], v[124:127], v[104:107]
    s_add_u32 s95, s60, 294912
    s_nop 4
    v_cndmask_b32 v108, v108, v109, s[44:45]
    v_cndmask_b32 v108, v108, v110, s[46:47]
    v_cndmask_b32 v108, v108, v111, s[48:49]
    v_and_b32 v105, -2, v108
    s_waitcnt vmcnt(0)
    s_add_u32 s73, s60, 49152
    buffer_load_dwordx4 v[40:43], v7, s[8:11], s73 offen offset:0 sc1
    buffer_load_dwordx4 v[44:47], v7, s[8:11], s73 offen offset:1024 sc1
    buffer_load_dwordx4 v[48:51], v7, s[8:11], s73 offen offset:2048 sc1
    buffer_load_dwordx4 v[52:55], v7, s[8:11], s73 offen offset:3072 sc1
    buffer_store_dwordx2 v[104:105], v10, s[8:11], s95 offen
    s_waitcnt vmcnt(3)
    v_bitop3_b32 v4, v43, v47, 1 bitop3:0xa8
    v_cmp_ne_u32 vcc, 0, v4
    s_nop 0
    s_cbranch_vccnz L_retry_79
L_back_80:
    ds_write_b128 v7, v[40:43] offset:16384
    ds_write_b128 v7, v[44:47] offset:17408
    s_waitcnt vmcnt(1)
    v_bitop3_b32 v4, v51, v55, 1 bitop3:0xa8
    v_cmp_ne_u32 vcc, 0, v4
    s_nop 0
    s_cbranch_vccnz L_retry_81
L_back_82:
    ds_write_b128 v7, v[48:51] offset:18432
    ds_write_b128 v7, v[52:55] offset:19456
    s_waitcnt lgkmcnt(0)
L_join_58:
    s_barrier
    ds_read_b128 v[40:43], v6 offset:16384
    ds_read_b128 v[44:47], v6 offset:17408
    ds_read_b128 v[48:51], v6 offset:18432
    s_add_u32 s73, s60, 32768
    buffer_load_dwordx4 v[24:27], v7, s[8:11], s73 offen offset:0 sc1
    buffer_load_dwordx4 v[28:31], v7, s[8:11], s73 offen offset:1024 sc1
    v_bfe_u32 v98, v6, 4, 4
    v_lshlrev_b32 v98, 3, v98
    v_and_b32 v99, 0x18, v98
    v_add_u32 v98, 97792, v98
    v_lshrrev_b32 v85, 8, v6
    buffer_load_dwordx4 v[32:35], v7, s[8:11], s73 offen offset:2048 sc1
    v_lshl_add_u32 v99, v85, 5, v99
    v_add_u32 v99, 97792, v99
    s_lshl_b32 s75, s36, 7
    s_add_u32 s75, s75, 97792
    v_lshrrev_b32 v85, 6, v6
    v_lshl_add_u32 v85, v85, 3, s75
    s_add_u32 s74, s60, 294912
    s_add_u32 s74, s74, s4
    buffer_load_dwordx4 v[36:39], v7, s[8:11], s73 offen offset:3072 sc1
    s_waitcnt lgkmcnt(2)
    v_mfma_f32_16x16x32_bf16 v[72:75], a[196:199], v[40:43], 0
    ds_read_b128 v[52:55], v6 offset:19456
    v_mfma_f32_16x16x32_bf16 v[68:71], a[192:195], v[40:43], 0
    ds_read_b128 v[112:115], v6 offset:20480
    v_mfma_f32_16x16x32_bf16 v[76:79], v[40:43], a[200:203], 0
    s_waitcnt lgkmcnt(3)
    buffer_load_dwordx4 v[80:83], v6, s[8:11], s74 offen sc1
    v_mfma_f32_16x16x32_bf16 v[72:75], a[208:211], v[44:47], v[72:75]
    ds_read_b128 v[116:119], v6 offset:21504
    v_mfma_f32_16x16x32_bf16 v[68:71], a[204:207], v[44:47], v[68:71]
    ds_read_b128 v[40:43], v6 offset:22528
    v_mfma_f32_16x16x32_bf16 v[76:79], v[44:47], a[212:215], v[76:79]
    s_waitcnt lgkmcnt(3)
    v_mfma_f32_16x16x32_bf16 v[72:75], a[220:223], v[48:51], v[72:75]
    ds_read_b128 v[44:47], v6 offset:23552
    v_mfma_f32_16x16x32_bf16 v[68:71], a[216:219], v[48:51], v[68:71]
    v_mfma_f32_16x16x32_bf16 v[76:79], v[48:51], a[224:227], v[76:79]
    v_mfma_f32_16x16x32_bf16 v[72:75], a[232:235], v[52:55], v[72:75]
    ds_read_b128 v[48:51], v6 offset:24576
    v_mfma_f32_16x16x32_bf16 v[68:71], a[228:231], v[52:55], v[68:71]
    v_mfma_f32_16x16x32_bf16 v[76:79], v[52:55], a[236:239], v[76:79]
    s_waitcnt lgkmcnt(3)
    v_mfma_f32_16x16x32_bf16 v[72:75], a[244:247], v[112:115], v[72:75]
    ds_read_b128 v[52:55], v6 offset:25600
    v_mfma_f32_16x16x32_bf16 v[68:71], a[240:243], v[112:115], v[68:71]
    v_mfma_f32_16x16x32_bf16 v[76:79], v[112:115], a[248:251], v[76:79]
    v_mfma_f32_16x16x32_bf16 v[72:75], v[128:131], v[116:119], v[72:75]
    ds_read_b128 v[112:115], v6 offset:26624
    v_mfma_f32_16x16x32_bf16 v[68:71], a[252:255], v[116:119], v[68:71]
    v_mfma_f32_16x16x32_bf16 v[76:79], v[116:119], v[132:135], v[76:79]
    s_waitcnt lgkmcnt(3)
    v_mfma_f32_16x16x32_bf16 v[72:75], v[140:143], v[40:43], v[72:75]
    ds_read_b128 v[116:119], v6 offset:27648
    v_mfma_f32_16x16x32_bf16 v[68:71], v[136:139], v[40:43], v[68:71]
    v_mfma_f32_16x16x32_bf16 v[76:79], v[40:43], v[144:147], v[76:79]
    v_mfma_f32_16x16x32_bf16 v[72:75], v[152:155], v[44:47], v[72:75]
    ds_read_b128 v[40:43], v6 offset:28672
    v_mfma_f32_16x16x32_bf16 v[68:71], v[148:151], v[44:47], v[68:71]
    v_mfma_f32_16x16x32_bf16 v[76:79], v[44:47], v[156:159], v[76:79]
    s_waitcnt lgkmcnt(3)
    s_waitcnt vmcnt(1)
    v_bitop3_b32 v4, v27, v31, v35 bitop3:0xfe
    v_mfma_f32_16x16x32_bf16 v[72:75], v[164:167], v[48:51], v[72:75]
    ds_read_b128 v[44:47], v6 offset:29696
    v_bitop3_b32 v4, v4, v39, 1 bitop3:0xa8
    v_mfma_f32_16x16x32_bf16 v[68:71], v[160:163], v[48:51], v[68:71]
    v_cmp_ne_u32 vcc, 0, v4
    v_mfma_f32_16x16x32_bf16 v[76:79], v[48:51], v[168:171], v[76:79]
    s_cbranch_vccnz L_retry_83
L_back_84:
    v_mfma_f32_16x16x32_bf16 v[72:75], v[176:179], v[52:55], v[72:75]
    ds_read_b128 v[48:51], v6 offset:30720
    s_waitcnt vmcnt(0)
    v_mfma_f32_16x16x32_bf16 v[68:71], v[172:175], v[52:55], v[68:71]
    ds_write_b128 v7, v[24:27] offset:0
    v_mfma_f32_16x16x32_bf16 v[76:79], v[52:55], v[180:183], v[76:79]
    s_waitcnt lgkmcnt(4)
    v_bitop3_b32 v5, v81, v83, 1 bitop3:0xa8
    v_cmp_ne_u32 vcc, 0, v5
    v_mfma_f32_16x16x32_bf16 v[72:75], v[188:191], v[112:115], v[72:75]
    ds_read_b128 v[52:55], v6 offset:31744
    s_cbranch_vccnz L_retry_85
L_back_86:
    v_mfma_f32_16x16x32_bf16 v[68:71], v[184:187], v[112:115], v[68:71]
    ds_write_b128 v7, v[28:31] offset:1024
    v_mfma_f32_16x16x32_bf16 v[76:79], v[112:115], v[192:195], v[76:79]
    v_add_f32 v80, v80, v82
    v_add_f32 v81, v81, v83
    v_mfma_f32_16x16x32_bf16 v[72:75], v[200:203], v[116:119], v[72:75]
    ds_write_b128 v7, v[32:35] offset:2048
    v_mfma_f32_16x16x32_bf16 v[68:71], v[196:199], v[116:119], v[68:71]
    v_add_f32_dpp v82, v80, v80 quad_perm:[1,0,3,2] row_mask:0xf bank_mask:0xf
    v_add_f32_dpp v83, v81, v81 quad_perm:[1,0,3,2] row_mask:0xf bank_mask:0xf
    v_mfma_f32_16x16x32_bf16 v[76:79], v[116:119], v[204:207], v[76:79]
    s_waitcnt lgkmcnt(6)
    ds_write_b128 v7, v[36:39] offset:3072
    v_mfma_f32_16x16x32_bf16 v[72:75], v[212:215], v[40:43], v[72:75]
    v_add_f32_dpp v80, v82, v82 quad_perm:[2,3,0,1] row_mask:0xf bank_mask:0xf
    v_add_f32_dpp v81, v83, v83 quad_perm:[2,3,0,1] row_mask:0xf bank_mask:0xf
    v_mfma_f32_16x16x32_bf16 v[68:71], v[208:211], v[40:43], v[68:71]
    v_mul_f32 v80, 0x3b000000, v80
    v_mul_f32 v81, 0x3b000000, v81
    v_fma_f32 v81, -v80, v80, v81
    v_max_f32 v81, 0, v81
    v_cvt_pk_bf16_f32 v80, v81, -v80
    v_lshlrev_b32 v84, 16, v80
    v_add_f32 v84, 0x3727c5ac, v84
    v_cvt_pk_bf16_f32 v84, v84, v84
    v_lshlrev_b32 v84, 16, v84
    v_sqrt_f32 v84, v84
    v_and_b32 v83, 0xffff0000, v80
    v_cvt_pk_bf16_f32 v84, v84, v84
    v_lshlrev_b32 v84, 16, v84
    v_rcp_f32 v82, v84
    s_nop 1
    ds_write_b64 v85, v[82:83]
    v_mfma_f32_16x16x32_bf16 v[76:79], v[40:43], v[216:219], v[76:79]
    s_waitcnt lgkmcnt(0)
    s_barrier
    v_mfma_f32_16x16x32_bf16 v[72:75], v[224:227], v[44:47], v[72:75]
    ds_read_b128 v[112:115], v6 offset:0
    s_add_u32 s73, s60, 16384
    v_mfma_f32_16x16x32_bf16 v[68:71], v[220:223], v[44:47], v[68:71]
    ds_read_b128 v[116:119], v6 offset:1024
    s_lshl_b32 s72, s36, 12
    v_mfma_f32_16x16x32_bf16 v[76:79], v[44:47], v[228:231], v[76:79]
    s_add_u32 m0, s72, 16384
    ds_read_b64 v[108:109], v98 offset:384
    v_mfma_f32_16x16x32_bf16 v[72:75], v[236:239], v[48:51], v[72:75]
    ds_read_b128 v[40:43], v6 offset:2048
    v_mfma_f32_16x16x32_bf16 v[68:71], v[232:235], v[48:51], v[68:71]
    ds_read_b128 v[44:47], v6 offset:3072
    v_mfma_f32_16x16x32_bf16 v[76:79], v[48:51], v[240:243], v[76:79]
    buffer_load_dwordx4 v7, s[8:11], s73 offen offset:0 sc1 lds
    v_mfma_f32_16x16x32_bf16 v[72:75], v[248:251], v[52:55], v[72:75]
    ds_read_b128 v[48:51], v6 offset:4096
    v_mfma_f32_16x16x32_bf16 v[68:71], v[244:247], v[52:55], v[68:71]
    ds_read_b64 v[110:111], v99 offset:384
    v_mfma_f32_16x16x32_bf16 v[76:79], v[52:55], v[252:255], v[76:79]
    s_waitcnt lgkmcnt(5)
    ds_read_b64 v[104:105], v98 offset:256
    v_mfma_f32_16x16x32_bf16 v[60:63], a[196:199], v[112:115], 0
    ds_read_b128 v[52:55], v6 offset:5120
    v_mfma_f32_16x16x32_bf16 v[56:59], a[192:195], v[112:115], 0
    buffer_load_dwordx4 v7, s[8:11], s73 offen offset:1024 sc1 lds
    v_mfma_f32_16x16x32_bf16 v[64:67], v[112:115], a[200:203], 0
    ds_read_b64 v[106:107], v99 offset:256
    v_mfma_f32_16x16x32_bf16 v[60:63], a[208:211], v[116:119], v[60:63]
    ds_read_b128 v[112:115], v6 offset:6144
    v_mfma_f32_16x16x32_bf16 v[56:59], a[204:207], v[116:119], v[56:59]
    v_mfma_f32_16x16x32_bf16 v[64:67], v[116:119], a[212:215], v[64:67]
    s_waitcnt lgkmcnt(6)
    buffer_load_dwordx4 v7, s[8:11], s73 offen offset:2048 sc1 lds
    v_mfma_f32_16x16x32_bf16 v[60:63], a[220:223], v[40:43], v[60:63]
    ds_read_b128 v[116:119], v6 offset:7168
    s_waitcnt lgkmcnt(5)
    v_mfma_f32_16x16x32_bf16 v[56:59], a[216:219], v[40:43], v[56:59]
    v_fmac_f32_dpp v72, v122, v109 row_newbcast:0 row_mask:0xf bank_mask:0xf
    v_fmac_f32_dpp v73, v122, v109 row_newbcast:1 row_mask:0xf bank_mask:0xf
    v_mfma_f32_16x16x32_bf16 v[64:67], v[40:43], a[224:227], v[64:67]
    v_fmac_f32_dpp v74, v122, v109 row_newbcast:2 row_mask:0xf bank_mask:0xf
    v_fmac_f32_dpp v75, v122, v109 row_newbcast:3 row_mask:0xf bank_mask:0xf
    v_mfma_f32_16x16x32_bf16 v[60:63], a[232:235], v[44:47], v[60:63]
    ds_read_b128 v[40:43], v6 offset:8192
    v_mul_f32 v72, v108, v72
    v_mfma_f32_16x16x32_bf16 v[56:59], a[228:231], v[44:47], v[56:59]
    buffer_load_dwordx4 v7, s[8:11], s73 offen offset:3072 sc1 lds
    v_mul_f32 v73, v108, v73
    v_mfma_f32_16x16x32_bf16 v[64:67], v[44:47], a[236:239], v[64:67]
    s_waitcnt lgkmcnt(4)
    v_mul_f32 v74, v108, v74
    v_mul_f32 v75, v108, v75
    v_mfma_f32_16x16x32_bf16 v[60:63], a[244:247], v[48:51], v[60:63]
    ds_read_b128 v[44:47], v6 offset:9216
    v_cvt_pk_bf16_f32 v86, v72, v73
    v_mfma_f32_16x16x32_bf16 v[56:59], a[240:243], v[48:51], v[56:59]
    v_cvt_pk_bf16_f32 v87, v74, v75
    v_fmac_f32_dpp v68, v121, v109 row_newbcast:0 row_mask:0xf bank_mask:0xf
    v_mfma_f32_16x16x32_bf16 v[64:67], v[48:51], a[248:251], v[64:67]
    v_fmac_f32_dpp v69, v121, v109 row_newbcast:1 row_mask:0xf bank_mask:0xf
    v_fmac_f32_dpp v70, v121, v109 row_newbcast:2 row_mask:0xf bank_mask:0xf
    v_mfma_f32_16x16x32_bf16 v[60:63], v[128:131], v[52:55], v[60:63]
    ds_read_b128 v[48:51], v6 offset:10240
    v_fmac_f32_dpp v71, v121, v109 row_newbcast:3 row_mask:0xf bank_mask:0xf
    v_mfma_f32_16x16x32_bf16 v[56:59], a[252:255], v[52:55], v[56:59]
    v_cvt_pk_bf16_f32 v82, v68, v69
    v_cvt_pk_bf16_f32 v83, v70, v71
    v_mfma_f32_16x16x32_bf16 v[64:67], v[52:55], v[132:135], v[64:67]
    s_waitcnt lgkmcnt(3)
    v_mul_f32 v97, s43, v108
    v_fmac_f32_dpp v76, v111, v123 row_newbcast:0 row_mask:0xf bank_mask:0xf
    v_mfma_f32_16x16x32_bf16 v[60:63], v[140:143], v[112:115], v[60:63]
    ds_read_b128 v[52:55], v6 offset:11264
    v_fmac_f32_dpp v77, v111, v123 row_newbcast:1 row_mask:0xf bank_mask:0xf
    v_mfma_f32_16x16x32_bf16 v[56:59], v[136:139], v[112:115], v[56:59]
    v_fmac_f32_dpp v78, v111, v123 row_newbcast:2 row_mask:0xf bank_mask:0xf
    v_fmac_f32_dpp v79, v111, v123 row_newbcast:3 row_mask:0xf bank_mask:0xf
    v_mfma_f32_16x16x32_bf16 v[64:67], v[112:115], v[144:147], v[64:67]
    v_mul_f32_dpp v76, v110, v76 row_newbcast:0 row_mask:0xf bank_mask:0xf
    v_mul_f32_dpp v77, v110, v77 row_newbcast:1 row_mask:0xf bank_mask:0xf
    v_mfma_f32_16x16x32_bf16 v[60:63], v[152:155], v[116:119], v[60:63]
    ds_read_b128 v[112:115], v6 offset:12288
    v_mul_f32_dpp v78, v110, v78 row_newbcast:2 row_mask:0xf bank_mask:0xf
    v_mfma_f32_16x16x32_bf16 v[56:59], v[148:151], v[116:119], v[56:59]
    v_mul_f32_dpp v79, v110, v79 row_newbcast:3 row_mask:0xf bank_mask:0xf
    v_cvt_pk_bf16_f32 v94, v76, v77
    v_mfma_f32_16x16x32_bf16 v[64:67], v[116:119], v[156:159], v[64:67]
    s_waitcnt lgkmcnt(3)
    v_cvt_pk_bf16_f32 v95, v78, v79
    v_mfma_f32_16x16x32_bf16 v[60:63], v[164:167], v[40:43], v[60:63]
    ds_read_b128 v[116:119], v6 offset:13312
    v_mfma_f32_16x16x32_bf16 v[56:59], v[160:163], v[40:43], v[56:59]
    ds_read_b64 v[108:109], v98 offset:128
    v_mfma_f32_16x16x32_bf16 v[64:67], v[40:43], v[168:171], v[64:67]
    ds_read_b64 v[110:111], v99 offset:128
    v_mov_b32 v68, v86
    v_mfma_f32_16x16x32_bf16 v[60:63], v[176:179], v[44:47], v[60:63]
    ds_read_b128 v[40:43], v6 offset:14336
    v_mov_b32 v69, v87
    v_mfma_f32_16x16x32_bf16 v[56:59], v[172:175], v[44:47], v[56:59]
    s_add_u32 s96, s62, 98304
    v_mov_b32 v70, v94
    v_min_u32 v71, -2, v95
    v_mfma_f32_16x16x32_bf16 v[64:67], v[44:47], v[180:183], v[64:67]
    s_waitcnt lgkmcnt(5)
    buffer_store_dwordx4 v[68:71], v6, s[8:11], s96 offen sc1
    v_mfma_f32_16x16x32_bf16 v[60:63], v[188:191], v[48:51], v[60:63]
    ds_read_b128 v[44:47], v6 offset:15360
    v_mfma_f32_16x16x32_bf16 v[56:59], v[184:187], v[48:51], v[56:59]
    v_mfma_f32_16x16x32_bf16 v[64:67], v[48:51], v[192:195], v[64:67]
    v_mfma_f32_16x16x32_bf16 v[60:63], v[200:203], v[52:55], v[60:63]
    v_mfma_f32_16x16x32_bf16 v[56:59], v[196:199], v[52:55], v[56:59]
    v_mfma_f32_16x16x32_bf16 v[64:67], v[52:55], v[204:207], v[64:67]
    s_waitcnt lgkmcnt(5)
    v_mfma_f32_16x16x32_bf16 v[60:63], v[212:215], v[112:115], v[60:63]
    v_mfma_f32_16x16x32_bf16 v[56:59], v[208:211], v[112:115], v[56:59]
    v_mfma_f32_16x16x32_bf16 v[64:67], v[112:115], v[216:219], v[64:67]
    s_waitcnt lgkmcnt(0) vmcnt(1)
    s_barrier
    s_add_u32 s73, s60, 0
    v_mfma_f32_16x16x32_bf16 v[60:63], v[224:227], v[116:119], v[60:63]
    ds_read_b128 v[48:51], v6 offset:16384
    s_lshl_b32 s72, s36, 12
    v_mfma_f32_16x16x32_bf16 v[56:59], v[220:223], v[116:119], v[56:59]
    ds_read_b128 v[52:55], v6 offset:17408
    s_add_u32 m0, s72, 0
    v_mfma_f32_16x16x32_bf16 v[64:67], v[116:119], v[228:231], v[64:67]
    buffer_load_dwordx4 v7, s[8:11], s73 offen offset:0 sc1 lds
    v_mfma_f32_16x16x32_bf16 v[60:63], v[236:239], v[40:43], v[60:63]
    ds_read_b128 v[112:115], v6 offset:18432
    v_mfma_f32_16x16x32_bf16 v[56:59], v[232:235], v[40:43], v[56:59]
    ds_read_b128 v[116:119], v6 offset:19456
    v_mfma_f32_16x16x32_bf16 v[64:67], v[40:43], v[240:243], v[64:67]
    v_mfma_f32_16x16x32_bf16 v[60:63], v[248:251], v[44:47], v[60:63]
    ds_read_b128 v[40:43], v6 offset:20480
    v_mfma_f32_16x16x32_bf16 v[56:59], v[244:247], v[44:47], v[56:59]
    buffer_load_dwordx4 v7, s[8:11], s73 offen offset:1024 sc1 lds
    v_mfma_f32_16x16x32_bf16 v[64:67], v[44:47], v[252:255], v[64:67]
    s_waitcnt lgkmcnt(3)
    s_waitcnt lgkmcnt(15)
    s_nop 0
    v_mfma_f32_16x16x32_bf16 v[72:75], a[196:199], v[48:51], 0
    ds_read_b128 v[44:47], v6 offset:21504
    v_fmac_f32_dpp v60, v122, v105 row_newbcast:0 row_mask:0xf bank_mask:0xf
    v_mfma_f32_16x16x32_bf16 v[68:71], a[192:195], v[48:51], 0
    v_fmac_f32_dpp v61, v122, v105 row_newbcast:1 row_mask:0xf bank_mask:0xf
    v_fmac_f32_dpp v62, v122, v105 row_newbcast:2 row_mask:0xf bank_mask:0xf
    v_mfma_f32_16x16x32_bf16 v[76:79], v[48:51], a[200:203], 0
    buffer_load_dwordx4 v7, s[8:11], s73 offen offset:2048 sc1 lds
    v_fmac_f32_dpp v63, v122, v105 row_newbcast:3 row_mask:0xf bank_mask:0xf
    v_mfma_f32_16x16x32_bf16 v[72:75], a[208:211], v[52:55], v[72:75]
    ds_read_b128 v[48:51], v6 offset:22528
    v_mul_f32 v60, v104, v60
    v_mfma_f32_16x16x32_bf16 v[68:71], a[204:207], v[52:55], v[68:71]
    v_mul_f32 v61, v104, v61
    v_mul_f32 v62, v104, v62
    v_mfma_f32_16x16x32_bf16 v[76:79], v[52:55], a[212:215], v[76:79]
    s_waitcnt lgkmcnt(3)
    v_mul_f32 v63, v104, v63
    v_cvt_pk_bf16_f32 v84, v60, v61
    v_mfma_f32_16x16x32_bf16 v[72:75], a[220:223], v[112:115], v[72:75]
    ds_read_b128 v[52:55], v6 offset:23552
    v_cvt_pk_bf16_f32 v85, v62, v63
    v_mfma_f32_16x16x32_bf16 v[68:71], a[216:219], v[112:115], v[68:71]
    buffer_load_dwordx4 v7, s[8:11], s73 offen offset:3072 sc1 lds
    v_fmac_f32_dpp v56, v121, v105 row_newbcast:0 row_mask:0xf bank_mask:0xf
    v_mfma_f32_16x16x16_bf16 v[60:63], v[84:85], v[82:83], v[16:19]
    v_fmac_f32_dpp v57, v121, v105 row_newbcast:1 row_mask:0xf bank_mask:0xf
    v_fmac_f32_dpp v58, v121, v105 row_newbcast:2 row_mask:0xf bank_mask:0xf
    v_mfma_f32_16x16x32_bf16 v[76:79], v[112:115], a[224:227], v[76:79]
    v_fmac_f32_dpp v59, v121, v105 row_newbcast:3 row_mask:0xf bank_mask:0xf
    v_cvt_pk_bf16_f32 v80, v56, v57
    v_mfma_f32_16x16x32_bf16 v[72:75], a[232:235], v[116:119], v[72:75]
    ds_read_b128 v[112:115], v6 offset:24576
    v_cvt_pk_bf16_f32 v81, v58, v59
    v_mfma_f32_16x16x32_bf16 v[68:71], a[228:231], v[116:119], v[68:71]
    v_mul_f32 v96, s43, v104
    v_fmac_f32_dpp v64, v107, v123 row_newbcast:0 row_mask:0xf bank_mask:0xf
    v_mfma_f32_16x16x16_bf16 v[56:59], v[86:87], v[82:83], v[16:19]
    v_fmac_f32_dpp v65, v107, v123 row_newbcast:1 row_mask:0xf bank_mask:0xf
    v_fmac_f32_dpp v66, v107, v123 row_newbcast:2 row_mask:0xf bank_mask:0xf
    v_mfma_f32_16x16x32_bf16 v[76:79], v[116:119], a[236:239], v[76:79]
    s_waitcnt lgkmcnt(3)
    v_fmac_f32_dpp v67, v107, v123 row_newbcast:3 row_mask:0xf bank_mask:0xf
    v_mul_f32_dpp v64, v106, v64 row_newbcast:0 row_mask:0xf bank_mask:0xf
    v_mfma_f32_16x16x32_bf16 v[72:75], a[244:247], v[40:43], v[72:75]
    ds_read_b128 v[116:119], v6 offset:25600
    v_mul_f32_dpp v65, v106, v65 row_newbcast:1 row_mask:0xf bank_mask:0xf
    v_mfma_f32_16x16x32_bf16 v[68:71], a[240:243], v[40:43], v[68:71]
    v_mul_f32_dpp v66, v106, v66 row_newbcast:2 row_mask:0xf bank_mask:0xf
    v_mul_f32_dpp v67, v106, v67 row_newbcast:3 row_mask:0xf bank_mask:0xf
    v_mfma_f32_16x16x32_bf16 v[76:79], v[40:43], a[248:251], v[76:79]
    v_cvt_pk_bf16_f32 v92, v64, v65
    v_cvt_pk_bf16_f32 v93, v66, v67
    v_mfma_f32_16x16x32_bf16 v[72:75], v[128:131], v[44:47], v[72:75]
    ds_read_b128 v[40:43], v6 offset:26624
    v_cndmask_b32 v56, v60, v56, s[28:29]
    v_mfma_f32_16x16x32_bf16 v[68:71], a[252:255], v[44:47], v[68:71]
    ds_read_b64 v[104:105], v98 offset:0
    v_cndmask_b32 v57, v61, v57, s[30:31]
    v_mfma_f32_16x16x32_bf16 v[76:79], v[44:47], v[132:135], v[76:79]
    s_waitcnt lgkmcnt(4)
    ds_read_b64 v[106:107], v99 offset:0
    v_mfma_f32_16x16x32_bf16 v[72:75], v[140:143], v[48:51], v[72:75]
    ds_read_b128 v[44:47], v6 offset:27648
    v_cndmask_b32 v58, v62, v58, s[32:33]
    v_mfma_f32_16x16x32_bf16 v[68:71], v[136:139], v[48:51], v[68:71]
    v_cndmask_b32 v59, v63, v59, s[34:35]
    v_max3_f32 v60, v56, v57, v58
    v_mfma_f32_16x16x32_bf16 v[76:79], v[48:51], v[144:147], v[76:79]
    v_max_f32 v61, v60, v59
    v_max_f32 v60, v60, v59
    v_mfma_f32_16x16x32_bf16 v[72:75], v[152:155], v[52:55], v[72:75]
    ds_read_b128 v[48:51], v6 offset:28672
    v_mfma_f32_16x16x32_bf16 v[68:71], v[148:151], v[52:55], v[68:71]
    v_permlane32_swap_b32 v60, v61
    v_mfma_f32_16x16x32_bf16 v[76:79], v[52:55], v[156:159], v[76:79]
    s_waitcnt lgkmcnt(5)
    v_max_f32 v62, v60, v61
    v_max_f32 v60, v60, v61
    v_mfma_f32_16x16x32_bf16 v[72:75], v[164:167], v[112:115], v[72:75]
    ds_read_b128 v[52:55], v6 offset:29696
    v_mfma_f32_16x16x32_bf16 v[68:71], v[160:163], v[112:115], v[68:71]
    v_permlane16_swap_b32 v60, v62
    v_mfma_f32_16x16x32_bf16 v[76:79], v[112:115], v[168:171], v[76:79]
    v_max_f32 v60, v60, v62
    v_mul_f32 v60, -v60, v97
    v_mfma_f32_16x16x32_bf16 v[72:75], v[176:179], v[116:119], v[72:75]
    ds_read_b128 v[112:115], v6 offset:30720
    v_fma_f32 v56, v56, v97, v60
    v_mfma_f32_16x16x32_bf16 v[68:71], v[172:175], v[116:119], v[68:71]
    v_fma_f32 v57, v57, v97, v60
    v_fma_f32 v58, v58, v97, v60
    v_mfma_f32_16x16x32_bf16 v[76:79], v[116:119], v[180:183], v[76:79]
    s_waitcnt lgkmcnt(3)
    v_fma_f32 v59, v59, v97, v60
    v_mfma_f32_16x16x32_bf16 v[72:75], v[188:191], v[40:43], v[72:75]
    ds_read_b128 v[116:119], v6 offset:31744
    v_mfma_f32_16x16x32_bf16 v[68:71], v[184:187], v[40:43], v[68:71]
    v_exp_f32 v56, v56
    v_mfma_f32_16x16x32_bf16 v[76:79], v[40:43], v[192:195], v[76:79]
    s_add_u32 s75, s61, 98304
    v_exp_f32 v57, v57
    v_mfma_f32_16x16x32_bf16 v[72:75], v[200:203], v[44:47], v[72:75]
    buffer_load_dwordx4 v[88:91], v6, s[8:11], s75 offen sc1
    v_mfma_f32_16x16x32_bf16 v[68:71], v[196:199], v[44:47], v[68:71]
    v_exp_f32 v58, v58
    v_mfma_f32_16x16x32_bf16 v[76:79], v[44:47], v[204:207], v[76:79]
    s_waitcnt lgkmcnt(3)
    v_exp_f32 v59, v59
    v_mfma_f32_16x16x32_bf16 v[72:75], v[212:215], v[48:51], v[72:75]
    v_cvt_pk_bf16_f32 v0, v56, v57
    v_cvt_pk_bf16_f32 v1, v58, v59
    v_mfma_f32_16x16x32_bf16 v[68:71], v[208:211], v[48:51], v[68:71]
    v_and_b32 v62, v0, v20
    v_and_b32 v63, v1, v21
    v_mfma_f32_16x16x16_bf16 v[56:59], v[22:23], v[0:1], 0
    v_xor_b32 v60, v0, v62
    v_xor_b32 v61, v1, v63
    v_mfma_f32_16x16x32_bf16 v[76:79], v[48:51], v[216:219], v[76:79]
    s_waitcnt lgkmcnt(0) vmcnt(1)
    s_barrier
    v_mfma_f32_16x16x32_bf16 v[64:67], v[92:95], v[60:63], 0
    s_nop 1
    v_mfma_f32_16x16x32_bf16 v[72:75], v[224:227], v[52:55], v[72:75]
    ds_read_b128 v[40:43], v6 offset:0
    v_mfma_f32_16x16x32_bf16 v[68:71], v[220:223], v[52:55], v[68:71]
    ds_read_b128 v[44:47], v6 offset:1024
    v_mfma_f32_16x16x32_bf16 v[76:79], v[52:55], v[228:231], v[76:79]
    v_rcp_f32 v56, v56
    v_mfma_f32_16x16x32_bf16 v[72:75], v[236:239], v[112:115], v[72:75]
    ds_read_b128 v[48:51], v6 offset:2048
    v_mul_f32 v64, v56, v64
    v_mfma_f32_16x16x32_bf16 v[68:71], v[232:235], v[112:115], v[68:71]
    ds_read_b128 v[52:55], v6 offset:3072
    v_mul_f32 v65, v56, v65
    v_mfma_f32_16x16x32_bf16 v[76:79], v[112:115], v[240:243], v[76:79]
    v_mul_f32 v66, v56, v66
    v_mul_f32 v67, v56, v67
    v_mfma_f32_16x16x32_bf16 v[72:75], v[248:251], v[116:119], v[72:75]
    ds_read_b128 v[112:115], v6 offset:4096
    v_cvt_pk_bf16_f32 v1, v66, v67
    v_mfma_f32_16x16x32_bf16 v[68:71], v[244:247], v[116:119], v[68:71]
    v_cvt_pk_bf16_f32 v0, v64, v65
    v_mfma_f32_16x16x32_bf16 v[76:79], v[116:119], v[252:255], v[76:79]
    s_waitcnt lgkmcnt(3)
    s_waitcnt lgkmcnt(15)
    v_mfma_f32_16x16x32_bf16 v[60:63], a[196:199], v[40:43], 0
    ds_read_b128 v[116:119], v6 offset:5120
    v_fmac_f32_dpp v72, v122, v109 row_newbcast:0 row_mask:0xf bank_mask:0xf
    v_mfma_f32_16x16x32_bf16 v[56:59], a[192:195], v[40:43], 0
    ds_read_b128 v[24:27], v6 offset:6144
    v_fmac_f32_dpp v73, v122, v109 row_newbcast:1 row_mask:0xf bank_mask:0xf
    v_mfma_f32_16x16x32_bf16 v[64:67], v[40:43], a[200:203], 0
    v_fmac_f32_dpp v74, v122, v109 row_newbcast:2 row_mask:0xf bank_mask:0xf
    v_fmac_f32_dpp v75, v122, v109 row_newbcast:3 row_mask:0xf bank_mask:0xf
    v_mfma_f32_16x16x32_bf16 v[60:63], a[208:211], v[44:47], v[60:63]
    ds_read_b128 v[28:31], v6 offset:7168
    v_mul_f32 v72, v108, v72
    v_mfma_f32_16x16x32_bf16 v[56:59], a[204:207], v[44:47], v[56:59]
    ds_read_b128 v[32:35], v6 offset:8192
    v_mul_f32 v73, v108, v73
    v_mfma_f32_16x16x32_bf16 v[64:67], v[44:47], a[212:215], v[64:67]
    s_waitcnt lgkmcnt(5)
    v_mul_f32 v74, v108, v74
    v_mul_f32 v75, v108, v75
    v_mfma_f32_16x16x32_bf16 v[60:63], a[220:223], v[48:51], v[60:63]
    ds_read_b128 v[36:39], v6 offset:9216
    v_cvt_pk_bf16_f32 v86, v72, v73
    v_mfma_f32_16x16x32_bf16 v[56:59], a[216:219], v[48:51], v[56:59]
    ds_read_b128 v[40:43], v6 offset:10240
    v_cvt_pk_bf16_f32 v87, v74, v75
    v_mfma_f32_16x16x32_bf16 v[64:67], v[48:51], a[224:227], v[64:67]
    v_fmac_f32_dpp v68, v121, v109 row_newbcast:0 row_mask:0xf bank_mask:0xf
    v_fmac_f32_dpp v69, v121, v109 row_newbcast:1 row_mask:0xf bank_mask:0xf
    v_mfma_f32_16x16x16_bf16 v[72:75], v[86:87], v[80:81], v[16:19]
    v_fmac_f32_dpp v70, v121, v109 row_newbcast:2 row_mask:0xf bank_mask:0xf
    v_fmac_f32_dpp v71, v121, v109 row_newbcast:3 row_mask:0xf bank_mask:0xf
    v_mfma_f32_16x16x32_bf16 v[60:63], a[232:235], v[52:55], v[60:63]
    ds_read_b128 v[44:47], v6 offset:11264
    v_cvt_pk_bf16_f32 v82, v68, v69
    v_mfma_f32_16x16x32_bf16 v[56:59], a[228:231], v[52:55], v[56:59]
    ds_read_b128 v[48:51], v6 offset:12288
    v_cvt_pk_bf16_f32 v83, v70, v71
    v_mfma_f32_16x16x32_bf16 v[64:67], v[52:55], a[236:239], v[64:67]
    s_waitcnt lgkmcnt(7)
    v_mul_f32 v97, s43, v108
    v_fmac_f32_dpp v76, v111, v123 row_newbcast:0 row_mask:0xf bank_mask:0xf
    v_mfma_f32_16x16x16_bf16 v[68:71], v[84:85], v[80:81], v[16:19]
    v_fmac_f32_dpp v77, v111, v123 row_newbcast:1 row_mask:0xf bank_mask:0xf
    v_fmac_f32_dpp v78, v111, v123 row_newbcast:2 row_mask:0xf bank_mask:0xf
    v_mfma_f32_16x16x32_bf16 v[60:63], a[244:247], v[112:115], v[60:63]
    ds_read_b128 v[52:55], v6 offset:13312
    v_fmac_f32_dpp v79, v111, v123 row_newbcast:3 row_mask:0xf bank_mask:0xf
    v_mfma_f32_16x16x32_bf16 v[56:59], a[240:243], v[112:115], v[56:59]
    v_mul_f32_dpp v76, v110, v76 row_newbcast:0 row_mask:0xf bank_mask:0xf
    v_mul_f32_dpp v77, v110, v77 row_newbcast:1 row_mask:0xf bank_mask:0xf
    v_mfma_f32_16x16x32_bf16 v[64:67], v[112:115], a[248:251], v[64:67]
    v_mul_f32_dpp v78, v110, v78 row_newbcast:2 row_mask:0xf bank_mask:0xf
    v_mul_f32_dpp v79, v110, v79 row_newbcast:3 row_mask:0xf bank_mask:0xf
    v_mfma_f32_16x16x32_bf16 v[60:63], v[128:131], v[116:119], v[60:63]
    ds_read_b128 v[112:115], v6 offset:14336
    v_cvt_pk_bf16_f32 v94, v76, v77
    v_mfma_f32_16x16x32_bf16 v[56:59], a[252:255], v[116:119], v[56:59]
    v_cvt_pk_bf16_f32 v95, v78, v79
    v_cndmask_b32 v68, v72, v68, s[28:29]
    v_mfma_f32_16x16x32_bf16 v[64:67], v[116:119], v[132:135], v[64:67]
    s_waitcnt lgkmcnt(7)
    v_cndmask_b32 v69, v73, v69, s[30:31]
    v_cndmask_b32 v70, v74, v70, s[32:33]
    v_mfma_f32_16x16x32_bf16 v[60:63], v[140:143], v[24:27], v[60:63]
    ds_read_b128 v[116:119], v6 offset:15360
    v_cndmask_b32 v71, v75, v71, s[34:35]
    v_mfma_f32_16x16x32_bf16 v[56:59], v[136:139], v[24:27], v[56:59]
    v_max3_f32 v72, v68, v69, v70
    v_max_f32 v73, v72, v71
    v_mfma_f32_16x16x32_bf16 v[64:67], v[24:27], v[144:147], v[64:67]
    v_max_f32 v72, v72, v71
    s_nop 0
    v_mfma_f32_16x16x32_bf16 v[60:63], v[152:155], v[28:31], v[60:63]
    v_permlane32_swap_b32 v72, v73
    v_mfma_f32_16x16x32_bf16 v[56:59], v[148:151], v[28:31], v[56:59]
    s_waitcnt lgkmcnt(6)
    v_max_f32 v74, v72, v73
    v_max_f32 v72, v72, v73
    v_mfma_f32_16x16x32_bf16 v[60:63], v[164:167], v[32:35], v[60:63]
    s_nop 0
    v_permlane16_swap_b32 v72, v74
    v_mfma_f32_16x16x32_bf16 v[56:59], v[160:163], v[32:35], v[56:59]
    v_max_f32 v72, v72, v74
    v_mul_f32 v72, -v72, v96
    v_mfma_f32_16x16x32_bf16 v[60:63], v[176:179], v[36:39], v[60:63]
    v_fma_f32 v68, v68, v96, v72
    v_fma_f32 v69, v69, v96, v72
    v_mfma_f32_16x16x32_bf16 v[56:59], v[172:175], v[36:39], v[56:59]
    s_waitcnt lgkmcnt(4)
    v_fma_f32 v70, v70, v96, v72
    v_fma_f32 v71, v71, v96, v72
    v_mfma_f32_16x16x32_bf16 v[60:63], v[188:191], v[40:43], v[60:63]
    v_exp_f32 v68, v68
    v_mfma_f32_16x16x32_bf16 v[56:59], v[184:187], v[40:43], v[56:59]
    v_exp_f32 v69, v69
    v_mfma_f32_16x16x32_bf16 v[60:63], v[200:203], v[44:47], v[60:63]
    v_exp_f32 v70, v70
    v_mfma_f32_16x16x32_bf16 v[56:59], v[196:199], v[44:47], v[56:59]
    s_waitcnt lgkmcnt(3)
    v_exp_f32 v71, v71
    v_mfma_f32_16x16x32_bf16 v[60:63], v[212:215], v[48:51], v[60:63]
    v_cvt_pk_bf16_f32 v2, v68, v69
    v_cvt_pk_bf16_f32 v3, v70, v71
    v_mfma_f32_16x16x32_bf16 v[56:59], v[208:211], v[48:51], v[56:59]
    s_waitcnt lgkmcnt(2)
    v_and_b32 v72, v2, v20
    v_and_b32 v73, v3, v21
    v_mfma_f32_16x16x16_bf16 v[68:71], v[22:23], v[2:3], 0
    v_xor_b32 v74, v2, v72
    v_xor_b32 v75, v3, v73
    v_mfma_f32_16x16x32_bf16 v[60:63], v[224:227], v[52:55], v[60:63]
    s_add_u32 s98, s65, 98304
    v_mfma_f32_16x16x32_bf16 v[76:79], v[92:95], v[72:75], 0
    s_nop 2
    v_mfma_f32_16x16x32_bf16 v[56:59], v[220:223], v[52:55], v[56:59]
    s_waitcnt lgkmcnt(1)
    v_rcp_f32 v68, v68
    v_mfma_f32_16x16x32_bf16 v[60:63], v[236:239], v[112:115], v[60:63]
    s_waitcnt vmcnt(0)
    v_mul_f32 v76, v68, v76
    v_mul_f32 v77, v68, v77
    v_mfma_f32_16x16x32_bf16 v[56:59], v[232:235], v[112:115], v[56:59]
    s_waitcnt lgkmcnt(0)
    v_mul_f32 v78, v68, v78
    v_mul_f32 v79, v68, v79
    v_mfma_f32_16x16x32_bf16 v[60:63], v[248:251], v[116:119], v[60:63]
    v_cvt_pk_bf16_f32 v3, v78, v79
    v_cvt_pk_bf16_f32 v2, v76, v77
    v_mfma_f32_16x16x32_bf16 v[56:59], v[244:247], v[116:119], v[56:59]
    v_permlane16_swap_b32 v1, v3
    v_mfma_f32_16x16x32_bf16 v[64:67], v[28:31], v[156:159], v[64:67]
    v_permlane16_swap_b32 v0, v2
    v_mfma_f32_16x16x32_bf16 v[64:67], v[32:35], v[168:171], v[64:67]
    v_or_b32 v3, 1, v3
    v_fmac_f32_dpp v60, v122, v105 row_newbcast:0 row_mask:0xf bank_mask:0xf
    v_mfma_f32_16x16x32_bf16 v[64:67], v[36:39], v[180:183], v[64:67]
    buffer_store_dwordx4 v[0:3], v8, s[8:11], s98 offen
    v_mfma_f32_16x16x32_bf16 v[64:67], v[40:43], v[192:195], v[64:67]
    v_fmac_f32_dpp v61, v122, v105 row_newbcast:1 row_mask:0xf bank_mask:0xf
    v_fmac_f32_dpp v62, v122, v105 row_newbcast:2 row_mask:0xf bank_mask:0xf
    v_mfma_f32_16x16x32_bf16 v[64:67], v[44:47], v[204:207], v[64:67]
    v_fmac_f32_dpp v63, v122, v105 row_newbcast:3 row_mask:0xf bank_mask:0xf
    v_mul_f32 v60, v104, v60
    v_mfma_f32_16x16x32_bf16 v[64:67], v[48:51], v[216:219], v[64:67]
    v_mul_f32 v61, v104, v61
    v_mul_f32 v62, v104, v62
    v_mfma_f32_16x16x32_bf16 v[64:67], v[52:55], v[228:231], v[64:67]
    v_mul_f32 v63, v104, v63
    v_cvt_pk_bf16_f32 v84, v60, v61
    v_mfma_f32_16x16x32_bf16 v[64:67], v[112:115], v[240:243], v[64:67]
    v_cvt_pk_bf16_f32 v85, v62, v63
    v_fmac_f32_dpp v56, v121, v105 row_newbcast:0 row_mask:0xf bank_mask:0xf
    v_mfma_f32_16x16x32_bf16 v[64:67], v[116:119], v[252:255], v[64:67]
    v_fmac_f32_dpp v57, v121, v105 row_newbcast:1 row_mask:0xf bank_mask:0xf
    v_fmac_f32_dpp v58, v121, v105 row_newbcast:2 row_mask:0xf bank_mask:0xf
    v_mfma_f32_16x16x16_bf16 v[72:75], v[84:85], v[82:83], v[16:19]
    v_fmac_f32_dpp v59, v121, v105 row_newbcast:3 row_mask:0xf bank_mask:0xf
    v_cvt_pk_bf16_f32 v80, v56, v57
    v_mfma_f32_16x16x16_bf16 v[68:71], v[86:87], v[82:83], v[16:19]
    v_cvt_pk_bf16_f32 v81, v58, v59
    v_mul_f32 v96, s43, v104
    v_cmp_eq_u32 vcc, -1, v91
    v_fmac_f32_dpp v64, v107, v123 row_newbcast:0 row_mask:0xf bank_mask:0xf
    s_cbranch_vccnz L_retry_87
L_back_88:
    v_add_f32 v60, s42, v16
    v_add_f32 v61, s42, v17
    v_add_f32 v62, s42, v18
    v_add_f32 v63, s42, v19
    v_mfma_f32_16x16x16_bf16 v[56:59], v[84:85], v[80:81], v[16:19]
    v_cndmask_b32 v68, v72, v68, s[28:29]
    v_cndmask_b32 v69, v73, v69, s[30:31]
    v_mfma_f32_16x16x16_bf16 v[60:63], v[88:89], v[80:81], v[60:63]
    v_cndmask_b32 v70, v74, v70, s[32:33]
    v_cndmask_b32 v71, v75, v71, s[34:35]
    v_max3_f32 v72, v68, v69, v70
    v_max_f32 v73, v72, v71
    v_max_f32 v72, v72, v71
    v_fmac_f32_dpp v65, v107, v123 row_newbcast:1 row_mask:0xf bank_mask:0xf
    v_fmac_f32_dpp v66, v107, v123 row_newbcast:2 row_mask:0xf bank_mask:0xf
    v_permlane32_swap_b32 v72, v73
    v_cndmask_b32 v56, v60, v56, s[28:29]
    v_cndmask_b32 v57, v61, v57, s[30:31]
    v_cndmask_b32 v58, v62, v58, s[32:33]
    v_cndmask_b32 v59, v63, v59, s[34:35]
    v_max3_f32 v60, v56, v57, v58
    v_max_f32 v61, v60, v59
    v_max_f32 v60, v60, v59
    v_max_f32 v74, v72, v73
    v_max_f32 v72, v72, v73
    v_permlane32_swap_b32 v60, v61
    v_max_f32 v62, v60, v61
    v_max_f32 v60, v60, v61
    v_permlane16_swap_b32 v72, v74
    v_max_f32 v72, v72, v74
    v_permlane16_swap_b32 v60, v62
    v_max_f32 v60, v60, v62
    v_mul_f32 v60, -v60, v96
    v_fma_f32 v56, v56, v96, v60
    v_fma_f32 v57, v57, v96, v60
    v_fma_f32 v58, v58, v96, v60
    v_fma_f32 v59, v59, v96, v60
    v_mul_f32 v72, -v72, v97
    v_exp_f32 v56, v56
    v_fma_f32 v68, v68, v97, v72
    v_exp_f32 v57, v57
    v_fma_f32 v69, v69, v97, v72
    v_exp_f32 v58, v58
    v_fma_f32 v70, v70, v97, v72
    v_exp_f32 v59, v59
    v_fma_f32 v71, v71, v97, v72
    v_cvt_pk_bf16_f32 v2, v56, v57
    v_exp_f32 v68, v68
    v_cvt_pk_bf16_f32 v3, v58, v59
    v_exp_f32 v69, v69
    s_add_u32 s101, s66, 65536
    s_mov_b64 exec, s[54:55]
    buffer_load_dwordx4 v[24:27], v6, s[8:11], s101 offen offset:0 sc1
    buffer_load_dwordx4 v[28:31], v6, s[8:11], s101 offen offset:1024 sc1
    s_mov_b64 exec, -1
    v_and_b32 v62, v2, v20
    v_exp_f32 v70, v70
    v_and_b32 v63, v3, v21
    v_mfma_f32_16x16x16_bf16 v[56:59], v[22:23], v[2:3], 0
    v_exp_f32 v71, v71
    v_cvt_pk_bf16_f32 v0, v68, v69
    s_mov_b64 exec, s[54:55]
    buffer_load_dwordx4 v[32:35], v6, s[8:11], s101 offen offset:2048 sc1
    buffer_load_dwordx4 v[36:39], v6, s[8:11], s101 offen offset:3072 sc1
    s_mov_b64 exec, -1
    s_add_u32 s78, s66, 69632
    v_xor_b32 v60, v2, v62
    v_cvt_pk_bf16_f32 v1, v70, v71
    v_xor_b32 v61, v3, v63
    v_and_b32 v74, v0, v20
    s_add_u32 s100, s65, 65536
    v_and_b32 v75, v1, v21
    v_mfma_f32_16x16x16_bf16 v[68:71], v[22:23], v[0:1], 0
    s_mov_b64 exec, s[54:55]
    buffer_load_dwordx4 v[40:43], v6, s[8:11], s78 offen offset:0 sc1
    buffer_load_dwordx4 v[44:47], v6, s[8:11], s78 offen offset:1024 sc1
    s_mov_b64 exec, -1
    v_xor_b32 v72, v0, v74
    v_xor_b32 v73, v1, v75
    v_fmac_f32_dpp v67, v107, v123 row_newbcast:3 row_mask:0xf bank_mask:0xf
    v_mul_f32_dpp v64, v106, v64 row_newbcast:0 row_mask:0xf bank_mask:0xf
    v_mul_f32_dpp v65, v106, v65 row_newbcast:1 row_mask:0xf bank_mask:0xf
    v_mul_f32_dpp v66, v106, v66 row_newbcast:2 row_mask:0xf bank_mask:0xf
    v_add_u32 v5, 98304, v6
    ds_read_b128 v[80:83], v5 offset:0
    ds_read_b128 v[84:87], v5 offset:1024
    ds_read_b128 v[96:99], v5 offset:2048
    s_mov_b64 exec, s[54:55]
    buffer_load_dwordx4 v[48:51], v6, s[8:11], s78 offen offset:2048 sc1
    buffer_load_dwordx4 v[52:55], v6, s[8:11], s78 offen offset:3072 sc1
    s_mov_b64 exec, -1
    v_mul_f32_dpp v67, v106, v67 row_newbcast:3 row_mask:0xf bank_mask:0xf
    v_cvt_pk_bf16_f32 v92, v64, v65
    v_cvt_pk_bf16_f32 v93, v66, v67
    v_mfma_f32_16x16x16_bf16 v[104:107], v[14:15], v[100:101], 0
    s_nop 0
    v_mfma_f32_16x16x32_bf16 v[64:67], v[90:93], v[60:63], 0
    v_rcp_f32 v56, v56
    v_mfma_f32_16x16x32_bf16 v[76:79], v[92:95], v[72:75], 0
    v_rcp_f32 v68, v68
    v_mfma_f32_16x16x16_bf16 v[108:111], v[14:15], v[102:103], 0
    v_mfma_f32_16x16x16_bf16 v[112:115], v[14:15], v[124:125], 0
    s_nop 2
    v_mul_f32 v64, v56, v64
    v_mul_f32 v65, v56, v65
    v_mul_f32 v66, v56, v66
    v_mul_f32 v67, v56, v67
    v_mul_f32 v76, v68, v76
    v_cvt_pk_bf16_f32 v3, v66, v67
    v_mul_f32 v77, v68, v77
    v_cvt_pk_bf16_f32 v2, v64, v65
    v_mul_f32 v78, v68, v78
    v_mul_f32 v79, v68, v79
    v_cvt_pk_bf16_f32 v1, v78, v79
    v_cvt_pk_bf16_f32 v0, v76, v77
    v_mfma_f32_16x16x16_bf16 v[116:119], v[14:15], v[126:127], 0
    v_permlane16_swap_b32 v1, v3
    v_permlane16_swap_b32 v0, v2
    v_or_b32 v3, 1, v3
    buffer_store_dwordx4 v[0:3], v8, s[8:11], s100 offen
    s_cmp_lt_u32 s36, 2
    s_cbranch_scc1 L_lo_89
    s_waitcnt vmcnt(5)
    v_bitop3_b32 v4, v27, v31, v35 bitop3:0x80
    v_bitop3_b32 v4, v4, v39, 1 bitop3:0x80
    v_cmp_ne_u32 vcc, 1, v4
    ds_read_b128 v[72:75], v5 offset:3072
    ds_read_b128 v[76:79], v5 offset:4096
    ds_read_b128 v[88:91], v5 offset:5120
    ds_read_b128 v[92:95], v5 offset:6144
    s_cbranch_vccnz L_retry_99
L_back_100:
    s_waitcnt lgkmcnt(6)
    v_mfma_f32_16x16x32_bf16 v[104:107], v[80:83], v[24:27], v[104:107]
    ds_read_b128 v[100:103], v5 offset:7168
    s_waitcnt lgkmcnt(5)
    v_mfma_f32_16x16x32_bf16 v[108:111], v[84:87], v[24:27], v[108:111]
    ds_read_b128 v[80:83], v5 offset:8192
    s_add_u32 s89, s66, 73728
    v_mfma_f32_16x16x32_bf16 v[112:115], v[96:99], v[24:27], v[112:115]
    ds_read_b128 v[84:87], v5 offset:9216
    s_waitcnt lgkmcnt(5)
    buffer_load_dwordx4 v[56:59], v6, s[8:11], s89 offen offset:0 sc1
    v_mfma_f32_16x16x32_bf16 v[116:119], v[72:75], v[24:27], v[116:119]
    ds_read_b128 v[96:99], v5 offset:10240
    v_mfma_f32_16x16x32_bf16 v[104:107], v[76:79], v[28:31], v[104:107]
    ds_read_b128 v[72:75], v5 offset:11264
    s_waitcnt lgkmcnt(5)
    buffer_load_dwordx4 v[60:63], v6, s[8:11], s89 offen offset:1024 sc1
    v_mfma_f32_16x16x32_bf16 v[108:111], v[88:91], v[28:31], v[108:111]
    ds_read_b128 v[76:79], v5 offset:12288
    v_mfma_f32_16x16x32_bf16 v[112:115], v[92:95], v[28:31], v[112:115]
    ds_read_b128 v[88:91], v5 offset:13312
    s_waitcnt lgkmcnt(5)
    buffer_load_dwordx4 v[64:67], v6, s[8:11], s89 offen offset:2048 sc1
    v_mfma_f32_16x16x32_bf16 v[116:119], v[100:103], v[28:31], v[116:119]
    ds_read_b128 v[92:95], v5 offset:14336
    v_mfma_f32_16x16x32_bf16 v[104:107], v[80:83], v[32:35], v[104:107]
    ds_read_b128 v[100:103], v5 offset:15360
    s_waitcnt lgkmcnt(5)
    buffer_load_dwordx4 v[68:71], v6, s[8:11], s89 offen offset:3072 sc1
    v_mfma_f32_16x16x32_bf16 v[108:111], v[84:87], v[32:35], v[108:111]
    ds_read_b128 v[80:83], v5 offset:16384
    s_waitcnt vmcnt(5)
    v_mfma_f32_16x16x32_bf16 v[112:115], v[96:99], v[32:35], v[112:115]
    ds_read_b128 v[84:87], v5 offset:17408
    s_waitcnt lgkmcnt(5)
    v_mfma_f32_16x16x32_bf16 v[116:119], v[72:75], v[32:35], v[116:119]
    ds_read_b128 v[96:99], v5 offset:18432
    v_bitop3_b32 v4, v43, v47, v51 bitop3:0x80
    v_mfma_f32_16x16x32_bf16 v[104:107], v[76:79], v[36:39], v[104:107]
    ds_read_b128 v[72:75], v5 offset:19456
    s_waitcnt lgkmcnt(5)
    v_mfma_f32_16x16x32_bf16 v[108:111], v[88:91], v[36:39], v[108:111]
    ds_read_b128 v[76:79], v5 offset:20480
    v_bitop3_b32 v4, v4, v55, 1 bitop3:0x80
    v_mfma_f32_16x16x32_bf16 v[112:115], v[92:95], v[36:39], v[112:115]
    ds_read_b128 v[88:91], v5 offset:21504
    s_waitcnt lgkmcnt(5)
    v_mfma_f32_16x16x32_bf16 v[116:119], v[100:103], v[36:39], v[116:119]
    ds_read_b128 v[92:95], v5 offset:22528
    v_cmp_ne_u32 vcc, 1, v4
    s_nop 0
    s_cbranch_vccnz L_retry_101
L_back_102:
    v_mfma_f32_16x16x32_bf16 v[104:107], v[80:83], v[40:43], v[104:107]
    ds_read_b128 v[100:103], v5 offset:23552
    s_waitcnt lgkmcnt(5)
    v_mfma_f32_16x16x32_bf16 v[108:111], v[84:87], v[40:43], v[108:111]
    ds_read_b128 v[80:83], v5 offset:24576
    s_add_u32 s94, s66, 77824
    v_mfma_f32_16x16x32_bf16 v[112:115], v[96:99], v[40:43], v[112:115]
    ds_read_b128 v[84:87], v5 offset:25600
    s_waitcnt lgkmcnt(5)
    buffer_load_dwordx4 v[24:27], v6, s[8:11], s94 offen offset:0 sc1
    v_mfma_f32_16x16x32_bf16 v[116:119], v[72:75], v[40:43], v[116:119]
    ds_read_b128 v[96:99], v5 offset:26624
    v_mfma_f32_16x16x32_bf16 v[104:107], v[76:79], v[44:47], v[104:107]
    ds_read_b128 v[72:75], v5 offset:27648
    s_waitcnt lgkmcnt(5)
    buffer_load_dwordx4 v[28:31], v6, s[8:11], s94 offen offset:1024 sc1
    v_mfma_f32_16x16x32_bf16 v[108:111], v[88:91], v[44:47], v[108:111]
    ds_read_b128 v[76:79], v5 offset:28672
    v_mfma_f32_16x16x32_bf16 v[112:115], v[92:95], v[44:47], v[112:115]
    ds_read_b128 v[88:91], v5 offset:29696
    s_waitcnt lgkmcnt(5)
    buffer_load_dwordx4 v[32:35], v6, s[8:11], s94 offen offset:2048 sc1
    v_mfma_f32_16x16x32_bf16 v[116:119], v[100:103], v[44:47], v[116:119]
    ds_read_b128 v[92:95], v5 offset:30720
    v_mfma_f32_16x16x32_bf16 v[104:107], v[80:83], v[48:51], v[104:107]
    ds_read_b128 v[100:103], v5 offset:31744
    s_waitcnt lgkmcnt(5)
    buffer_load_dwordx4 v[36:39], v6, s[8:11], s94 offen offset:3072 sc1
    v_mfma_f32_16x16x32_bf16 v[108:111], v[84:87], v[48:51], v[108:111]
    ds_read_b128 v[80:83], v5 offset:32768
    v_mfma_f32_16x16x32_bf16 v[112:115], v[96:99], v[48:51], v[112:115]
    ds_read_b128 v[84:87], v5 offset:33792
    s_waitcnt lgkmcnt(5)
    v_mfma_f32_16x16x32_bf16 v[116:119], v[72:75], v[48:51], v[116:119]
    ds_read_b128 v[96:99], v5 offset:34816
    v_mfma_f32_16x16x32_bf16 v[104:107], v[76:79], v[52:55], v[104:107]
    ds_read_b128 v[72:75], v5 offset:35840
    s_waitcnt lgkmcnt(5)
    v_mfma_f32_16x16x32_bf16 v[108:111], v[88:91], v[52:55], v[108:111]
    ds_read_b128 v[76:79], v5 offset:36864
    s_waitcnt vmcnt(4)
    v_mfma_f32_16x16x32_bf16 v[112:115], v[92:95], v[52:55], v[112:115]
    ds_read_b128 v[88:91], v5 offset:37888
    s_waitcnt lgkmcnt(5)
    v_mfma_f32_16x16x32_bf16 v[116:119], v[100:103], v[52:55], v[116:119]
    ds_read_b128 v[92:95], v5 offset:38912
    v_bitop3_b32 v4, v59, v63, v67 bitop3:0x80
    v_bitop3_b32 v4, v4, v71, 1 bitop3:0x80
    v_cmp_ne_u32 vcc, 1, v4
    s_nop 0
    s_cbranch_vccnz L_retry_103
L_back_104:
    v_mfma_f32_16x16x32_bf16 v[104:107], v[80:83], v[56:59], v[104:107]
    ds_read_b128 v[100:103], v5 offset:39936
    s_waitcnt lgkmcnt(5)
    v_mfma_f32_16x16x32_bf16 v[108:111], v[84:87], v[56:59], v[108:111]
    ds_read_b128 v[80:83], v5 offset:40960
    v_mfma_f32_16x16x32_bf16 v[112:115], v[96:99], v[56:59], v[112:115]
    ds_read_b128 v[84:87], v5 offset:41984
    s_waitcnt lgkmcnt(5)
    v_mfma_f32_16x16x32_bf16 v[116:119], v[72:75], v[56:59], v[116:119]
    ds_read_b128 v[96:99], v5 offset:43008
    v_mfma_f32_16x16x32_bf16 v[104:107], v[76:79], v[60:63], v[104:107]
    ds_read_b128 v[72:75], v5 offset:44032
    s_waitcnt lgkmcnt(5)
    v_mfma_f32_16x16x32_bf16 v[108:111], v[88:91], v[60:63], v[108:111]
    ds_read_b128 v[76:79], v5 offset:45056
    v_mfma_f32_16x16x32_bf16 v[112:115], v[92:95], v[60:63], v[112:115]
    ds_read_b128 v[88:91], v5 offset:46080
    s_waitcnt lgkmcnt(5)
    v_mfma_f32_16x16x32_bf16 v[116:119], v[100:103], v[60:63], v[116:119]
    ds_read_b128 v[92:95], v5 offset:47104
    v_mfma_f32_16x16x32_bf16 v[104:107], v[80:83], v[64:67], v[104:107]
    ds_read_b128 v[100:103], v5 offset:48128
    s_waitcnt lgkmcnt(5)
    v_mfma_f32_16x16x32_bf16 v[108:111], v[84:87], v[64:67], v[108:111]
    ds_read_b128 v[80:83], v5 offset:49152
    v_mfma_f32_16x16x32_bf16 v[112:115], v[96:99], v[64:67], v[112:115]
    ds_read_b128 v[84:87], v5 offset:50176
    s_waitcnt lgkmcnt(5)
    v_mfma_f32_16x16x32_bf16 v[116:119], v[72:75], v[64:67], v[116:119]
    ds_read_b128 v[96:99], v5 offset:51200
    v_mfma_f32_16x16x32_bf16 v[104:107], v[76:79], v[68:71], v[104:107]
    ds_read_b128 v[72:75], v5 offset:52224
    s_waitcnt lgkmcnt(5)
    v_mfma_f32_16x16x32_bf16 v[108:111], v[88:91], v[68:71], v[108:111]
    ds_read_b128 v[76:79], v5 offset:53248
    s_waitcnt vmcnt(0)
    v_mfma_f32_16x16x32_bf16 v[112:115], v[92:95], v[68:71], v[112:115]
    ds_read_b128 v[88:91], v5 offset:54272
    s_waitcnt lgkmcnt(5)
    v_mfma_f32_16x16x32_bf16 v[116:119], v[100:103], v[68:71], v[116:119]
    ds_read_b128 v[92:95], v5 offset:55296
    v_bitop3_b32 v4, v27, v31, v35 bitop3:0x80
    v_bitop3_b32 v4, v4, v39, 1 bitop3:0x80
    v_cmp_ne_u32 vcc, 1, v4
    s_nop 0
    s_cbranch_vccnz L_retry_105
L_back_106:
    v_mfma_f32_16x16x32_bf16 v[104:107], v[80:83], v[24:27], v[104:107]
    ds_read_b128 v[100:103], v5 offset:56320
    s_waitcnt lgkmcnt(5)
    v_mfma_f32_16x16x32_bf16 v[108:111], v[84:87], v[24:27], v[108:111]
    ds_read_b128 v[80:83], v5 offset:57344
    v_mfma_f32_16x16x32_bf16 v[112:115], v[96:99], v[24:27], v[112:115]
    ds_read_b128 v[84:87], v5 offset:58368
    s_waitcnt lgkmcnt(5)
    v_mfma_f32_16x16x32_bf16 v[116:119], v[72:75], v[24:27], v[116:119]
    ds_read_b128 v[96:99], v5 offset:61440
    v_mfma_f32_16x16x32_bf16 v[104:107], v[76:79], v[28:31], v[104:107]
    ds_read_b128 v[72:75], v5 offset:62464
    s_waitcnt lgkmcnt(5)
    v_mfma_f32_16x16x32_bf16 v[108:111], v[88:91], v[28:31], v[108:111]
    ds_read_b128 v[76:79], v5 offset:59392
    v_mfma_f32_16x16x32_bf16 v[112:115], v[92:95], v[28:31], v[112:115]
    ds_read_b128 v[88:91], v5 offset:60416
    s_waitcnt lgkmcnt(5)
    v_mfma_f32_16x16x32_bf16 v[116:119], v[100:103], v[28:31], v[116:119]
    ds_read_b128 v[92:95], v5 offset:63488
    v_mfma_f32_16x16x32_bf16 v[104:107], v[80:83], v[32:35], v[104:107]
    ds_read_b128 v[100:103], v5 offset:64512
    s_waitcnt lgkmcnt(5)
    v_mfma_f32_16x16x32_bf16 v[108:111], v[84:87], v[32:35], v[108:111]
    v_mfma_f32_16x16x32_bf16 v[104:107], v[96:99], v[36:39], v[104:107]
    s_waitcnt lgkmcnt(3)
    v_mfma_f32_16x16x32_bf16 v[108:111], v[72:75], v[36:39], v[108:111]
    v_mfma_f32_16x16x32_bf16 v[112:115], v[76:79], v[32:35], v[112:115]
    s_waitcnt lgkmcnt(1)
    v_mfma_f32_16x16x32_bf16 v[116:119], v[88:91], v[32:35], v[116:119]
    v_mfma_f32_16x16x32_bf16 v[112:115], v[92:95], v[36:39], v[112:115]
    s_waitcnt lgkmcnt(0)
    v_mfma_f32_16x16x32_bf16 v[116:119], v[100:103], v[36:39], v[116:119]
    s_nop 1
    v_cvt_pk_bf16_f32 v103, v110, v111
    v_cvt_pk_bf16_f32 v100, v104, v105
    v_cvt_pk_bf16_f32 v101, v106, v107
    v_cvt_pk_bf16_f32 v102, v108, v109
    buffer_store_dwordx4 v[100:103], v11, s[12:15], 0 offen offset:0
    s_nop 0
    v_cvt_pk_bf16_f32 v127, v118, v119
    v_cvt_pk_bf16_f32 v124, v112, v113
    v_cvt_pk_bf16_f32 v125, v114, v115
    v_cvt_pk_bf16_f32 v126, v116, v117
    buffer_store_dwordx4 v[124:127], v11, s[12:15], 0 offen offset:64
    s_or_b32 s72, s2, s36
    s_cbranch_scc1 L_end
    v_mov_b32 v0, s5
    s_mov_b32 s72, 540672
    s_mov_b64 exec, 1
    buffer_store_dword v0, v6, s[8:11], s72 offen sc1
    s_endpgm
L_end:
    s_endpgm
L_retry_1:
    s_lshl_b32 s72, s38, 7
    s_add_u32 s72, s72, 524288
    buffer_load_dwordx2 v[62:63], v71, s[8:11], s72 offen sc1
    s_sub_u32 s41, s41, 1
    s_cbranch_scc1 L_end
    s_waitcnt vmcnt(0)
    v_xor_b32 v4, v62, v60
    v_xor_b32 v3, v63, v61
    v_lshrrev_b32 v5, 8, v3
    v_or_b32 v4, v4, v5
    v_cmp_ne_u32 vcc, 0, v4
    s_nop 0
    s_cbranch_vccnz L_retry_1
    s_branch L_back_2
L_retry_3:
    s_add_u32 s73, s61, 0x20000
    s_mov_b32 exec_lo, 0xff00ff00
    s_mov_b32 exec_hi, 0xff00ff00
    buffer_load_dwordx4 v[80:83], v6, s[8:11], s61 offen sc1
    s_mov_b32 exec_lo, 0
    s_mov_b32 exec_hi, -1
    buffer_load_dwordx4 v[84:87], v6, s[8:11], s73 offen sc1
    s_mov_b32 exec_lo, -1
    s_sub_u32 s41, s41, 1
    s_cbranch_scc1 L_end
    s_waitcnt vmcnt(0)
    v_xor_b32 v4, v82, v74
    v_xor_b32 v3, v84, v74
    v_or_b32 v4, v4, v3
    v_cmp_ne_u32 vcc, 0, v4
    s_nop 0
    s_cbranch_vccnz L_retry_3
    s_branch L_back_4
L_retry_5:
    s_add_u32 s95, s66, 65536
    buffer_load_dwordx4 v[24:27], v6, s[8:11], s95 offen offset:0 sc1
    buffer_load_dwordx4 v[28:31], v6, s[8:11], s95 offen offset:1024 sc1
    buffer_load_dwordx4 v[32:35], v6, s[8:11], s95 offen offset:2048 sc1
    buffer_load_dwordx4 v[36:39], v6, s[8:11], s95 offen offset:3072 sc1
    s_add_u32 s96, s66, 69632
    buffer_load_dwordx4 v[40:43], v6, s[8:11], s96 offen offset:0 sc1
    buffer_load_dwordx4 v[44:47], v6, s[8:11], s96 offen offset:1024 sc1
    buffer_load_dwordx4 v[48:51], v6, s[8:11], s96 offen offset:2048 sc1
    buffer_load_dwordx4 v[52:55], v6, s[8:11], s96 offen offset:3072 sc1
    s_add_u32 s97, s66, 73728
    buffer_load_dwordx4 v[56:59], v6, s[8:11], s97 offen offset:0 sc1
    buffer_load_dwordx4 v[60:63], v6, s[8:11], s97 offen offset:1024 sc1
    buffer_load_dwordx4 v[64:67], v6, s[8:11], s97 offen offset:2048 sc1
    buffer_load_dwordx4 v[68:71], v6, s[8:11], s97 offen offset:3072 sc1
    s_sub_u32 s41, s41, 1
    s_cbranch_scc1 L_end
    s_waitcnt vmcnt(8)
    v_bitop3_b32 v4, v27, v31, v35 bitop3:0xfe
    v_bitop3_b32 v4, v4, v39, 1 bitop3:0xa8
    v_cmp_ne_u32 vcc, 0, v4
    s_nop 0
    s_cbranch_vccnz L_retry_5
    s_branch L_back_6
L_retry_7:
    s_add_u32 s99, s66, 69632
    buffer_load_dwordx4 v[40:43], v6, s[8:11], s99 offen offset:0 sc1
    buffer_load_dwordx4 v[44:47], v6, s[8:11], s99 offen offset:1024 sc1
    buffer_load_dwordx4 v[48:51], v6, s[8:11], s99 offen offset:2048 sc1
    buffer_load_dwordx4 v[52:55], v6, s[8:11], s99 offen offset:3072 sc1
    s_sub_u32 s41, s41, 1
    s_cbranch_scc1 L_end
    s_waitcnt vmcnt(0)
    v_bitop3_b32 v4, v43, v47, v51 bitop3:0xfe
    v_bitop3_b32 v4, v4, v55, 1 bitop3:0xa8
    v_cmp_ne_u32 vcc, 0, v4
    s_nop 0
    s_cbranch_vccnz L_retry_7
    s_branch L_back_8
L_retry_9:
    s_add_u32 s100, s66, 73728
    buffer_load_dwordx4 v[56:59], v6, s[8:11], s100 offen offset:0 sc1
    buffer_load_dwordx4 v[60:63], v6, s[8:11], s100 offen offset:1024 sc1
    buffer_load_dwordx4 v[64:67], v6, s[8:11], s100 offen offset:2048 sc1
    buffer_load_dwordx4 v[68:71], v6, s[8:11], s100 offen offset:3072 sc1
    s_sub_u32 s41, s41, 1
    s_cbranch_scc1 L_end
    s_waitcnt vmcnt(0)
    v_bitop3_b32 v4, v59, v63, v67 bitop3:0xfe
    v_bitop3_b32 v4, v4, v71, 1 bitop3:0xa8
    v_cmp_ne_u32 vcc, 0, v4
    s_nop 0
    s_cbranch_vccnz L_retry_9
    s_branch L_back_10
L_retry_11:
    s_add_u32 s101, s66, 77824
    buffer_load_dwordx4 v[24:27], v6, s[8:11], s101 offen offset:0 sc1
    buffer_load_dwordx4 v[28:31], v6, s[8:11], s101 offen offset:1024 sc1
    buffer_load_dwordx4 v[32:35], v6, s[8:11], s101 offen offset:2048 sc1
    buffer_load_dwordx4 v[36:39], v6, s[8:11], s101 offen offset:3072 sc1
    s_sub_u32 s41, s41, 1
    s_cbranch_scc1 L_end
    s_waitcnt vmcnt(0)
    v_bitop3_b32 v4, v27, v31, v35 bitop3:0xfe
    v_bitop3_b32 v4, v4, v39, 1 bitop3:0xa8
    v_cmp_ne_u32 vcc, 0, v4
    s_nop 0
    s_cbranch_vccnz L_retry_11
    s_branch L_back_12
L_retry_13:
    s_add_u32 s73, s60, 49152
    buffer_load_dwordx4 v[40:43], v7, s[8:11], s73 offen offset:0 sc1
    buffer_load_dwordx4 v[44:47], v7, s[8:11], s73 offen offset:1024 sc1
    buffer_load_dwordx4 v[48:51], v7, s[8:11], s73 offen offset:2048 sc1
    buffer_load_dwordx4 v[52:55], v7, s[8:11], s73 offen offset:3072 sc1
    s_sub_u32 s41, s41, 1
    s_cbranch_scc1 L_end
    s_waitcnt vmcnt(0)
    v_bitop3_b32 v4, v43, v47, 1 bitop3:0xa8
    v_cmp_ne_u32 vcc, 0, v4
    s_nop 0
    s_cbranch_vccnz L_retry_13
    s_branch L_back_14
L_retry_15:
    buffer_load_dwordx4 v[48:51], v7, s[8:11], s73 offen offset:2048 sc1
    buffer_load_dwordx4 v[52:55], v7, s[8:11], s73 offen offset:3072 sc1
    s_sub_u32 s41, s41, 1
    s_cbranch_scc1 L_end
    s_waitcnt vmcnt(0)
    v_bitop3_b32 v4, v51, v55, 1 bitop3:0xa8
    v_cmp_ne_u32 vcc, 0, v4
    s_nop 0
    s_cbranch_vccnz L_retry_15
    s_branch L_back_16
L_retry_17:
    s_add_u32 s73, s60, 32768
    buffer_load_dwordx4 v[24:27], v7, s[8:11], s73 offen offset:0 sc1
    buffer_load_dwordx4 v[28:31], v7, s[8:11], s73 offen offset:1024 sc1
    buffer_load_dwordx4 v[32:35], v7, s[8:11], s73 offen offset:2048 sc1
    buffer_load_dwordx4 v[36:39], v7, s[8:11], s73 offen offset:3072 sc1
    s_sub_u32 s41, s41, 1
    s_cbranch_scc1 L_end
    s_waitcnt vmcnt(0)
    v_bitop3_b32 v4, v27, v31, v35 bitop3:0xfe
    v_bitop3_b32 v4, v4, v39, 1 bitop3:0xa8
    v_cmp_ne_u32 vcc, 0, v4
    s_nop 0
    s_cbranch_vccnz L_retry_17
    s_branch L_back_18
L_retry_19:
    s_add_u32 s74, s60, 294912
    s_add_u32 s74, s74, s4
    buffer_load_dwordx4 v[80:83], v6, s[8:11], s74 offen sc1
    s_sub_u32 s41, s41, 1
    s_cbranch_scc1 L_end
    s_waitcnt vmcnt(0)
    v_bitop3_b32 v5, v81, v83, 1 bitop3:0xa8
    v_cmp_ne_u32 vcc, 0, v5
    s_nop 0
    s_cbranch_vccnz L_retry_19
    s_branch L_back_20
L_retry_21:
    s_add_u32 s75, s61, 32768
    buffer_load_dwordx4 v[88:91], v6, s[8:11], s75 offen sc1
    s_sub_u32 s41, s41, 1
    s_cbranch_scc1 L_end
    s_waitcnt vmcnt(0)
    v_cmp_eq_u32 vcc, -1, v91
    s_nop 0
    s_cbranch_vccnz L_retry_21
    s_branch L_back_22
L_retry_23:
    s_lshl_b32 s77, s37, 9
    s_add_u32 s77, s77, 532480
    v_lshrrev_b32 v94, 1, v6
    buffer_load_dwordx2 v[92:93], v94, s[8:11], s77 offen sc1
    s_sub_u32 s41, s41, 1
    s_cbranch_scc1 L_end
    s_waitcnt vmcnt(0)
    v_xor_b32 v94, s5, v92
    v_xor_b32 v95, s6, v93
    v_lshrrev_b32 v95, 8, v95
    v_or_b32 v94, v94, v95
    v_cmp_ne_u32 vcc, 0, v94
    s_nop 0
    s_cbranch_vccnz L_retry_23
    s_branch L_back_24
L_retry_27:
    s_add_u32 s94, s66, 65536
    buffer_load_dwordx4 v[24:27], v6, s[8:11], s94 offen offset:0 sc1
    buffer_load_dwordx4 v[28:31], v6, s[8:11], s94 offen offset:1024 sc1
    buffer_load_dwordx4 v[32:35], v6, s[8:11], s94 offen offset:2048 sc1
    buffer_load_dwordx4 v[36:39], v6, s[8:11], s94 offen offset:3072 sc1
    s_sub_u32 s41, s41, 1
    s_cbranch_scc1 L_end
    s_waitcnt vmcnt(0)
    v_bitop3_b32 v4, v27, v31, v35 bitop3:0x80
    v_bitop3_b32 v4, v4, v39, 1 bitop3:0x80
    v_cmp_ne_u32 vcc, 1, v4
    s_nop 0
    s_cbranch_vccnz L_retry_27
    s_branch L_back_28
L_retry_29:
    s_add_u32 s97, s66, 69632
    buffer_load_dwordx4 v[40:43], v6, s[8:11], s97 offen offset:0 sc1
    buffer_load_dwordx4 v[44:47], v6, s[8:11], s97 offen offset:1024 sc1
    buffer_load_dwordx4 v[48:51], v6, s[8:11], s97 offen offset:2048 sc1
    buffer_load_dwordx4 v[52:55], v6, s[8:11], s97 offen offset:3072 sc1
    s_sub_u32 s41, s41, 1
    s_cbranch_scc1 L_end
    s_waitcnt vmcnt(0)
    v_bitop3_b32 v4, v43, v47, v51 bitop3:0x80
    v_bitop3_b32 v4, v4, v55, 1 bitop3:0x80
    v_cmp_ne_u32 vcc, 1, v4
    s_nop 0
    s_cbranch_vccnz L_retry_29
    s_branch L_back_30
L_retry_31:
    s_add_u32 s98, s66, 73728
    buffer_load_dwordx4 v[56:59], v6, s[8:11], s98 offen offset:0 sc1
    buffer_load_dwordx4 v[60:63], v6, s[8:11], s98 offen offset:1024 sc1
    buffer_load_dwordx4 v[64:67], v6, s[8:11], s98 offen offset:2048 sc1
    buffer_load_dwordx4 v[68:71], v6, s[8:11], s98 offen offset:3072 sc1
    s_sub_u32 s41, s41, 1
    s_cbranch_scc1 L_end
    s_waitcnt vmcnt(0)
    v_bitop3_b32 v4, v59, v63, v67 bitop3:0x80
    v_bitop3_b32 v4, v4, v71, 1 bitop3:0x80
    v_cmp_ne_u32 vcc, 1, v4
    s_nop 0
    s_cbranch_vccnz L_retry_31
    s_branch L_back_32
L_retry_33:
    s_add_u32 s99, s66, 77824
    buffer_load_dwordx4 v[24:27], v6, s[8:11], s99 offen offset:0 sc1
    buffer_load_dwordx4 v[28:31], v6, s[8:11], s99 offen offset:1024 sc1
    buffer_load_dwordx4 v[32:35], v6, s[8:11], s99 offen offset:2048 sc1
    buffer_load_dwordx4 v[36:39], v6, s[8:11], s99 offen offset:3072 sc1
    s_sub_u32 s41, s41, 1
    s_cbranch_scc1 L_end
    s_waitcnt vmcnt(0)
    v_bitop3_b32 v4, v27, v31, v35 bitop3:0x80
    v_bitop3_b32 v4, v4, v39, 1 bitop3:0x80
    v_cmp_ne_u32 vcc, 1, v4
    s_nop 0
    s_cbranch_vccnz L_retry_33
    s_branch L_back_34
L_retry_35:
    s_add_u32 s73, s60, 49152
    buffer_load_dwordx4 v[40:43], v7, s[8:11], s73 offen offset:0 sc1
    buffer_load_dwordx4 v[44:47], v7, s[8:11], s73 offen offset:1024 sc1
    buffer_load_dwordx4 v[48:51], v7, s[8:11], s73 offen offset:2048 sc1
    buffer_load_dwordx4 v[52:55], v7, s[8:11], s73 offen offset:3072 sc1
    s_sub_u32 s41, s41, 1
    s_cbranch_scc1 L_end
    s_waitcnt vmcnt(0)
    v_bitop3_b32 v4, v43, v47, 1 bitop3:0x80
    v_cmp_ne_u32 vcc, 1, v4
    s_nop 0
    s_cbranch_vccnz L_retry_35
    s_branch L_back_36
L_retry_37:
    buffer_load_dwordx4 v[48:51], v7, s[8:11], s73 offen offset:2048 sc1
    buffer_load_dwordx4 v[52:55], v7, s[8:11], s73 offen offset:3072 sc1
    s_sub_u32 s41, s41, 1
    s_cbranch_scc1 L_end
    s_waitcnt vmcnt(0)
    v_bitop3_b32 v4, v51, v55, 1 bitop3:0x80
    v_cmp_ne_u32 vcc, 1, v4
    s_nop 0
    s_cbranch_vccnz L_retry_37
    s_branch L_back_38
L_lo_25:
    ds_read_b128 v[72:75], v5 offset:3072
    ds_read_b128 v[76:79], v5 offset:4096
    ds_read_b128 v[88:91], v5 offset:5120
    ds_read_b128 v[92:95], v5 offset:6144
    s_waitcnt vmcnt(0)
    s_add_u32 s88, s66, 65536
    buffer_load_dwordx4 v[24:27], v6, s[8:11], s88 offen offset:0 sc1
    buffer_load_dwordx4 v[28:31], v6, s[8:11], s88 offen offset:1024 sc1
    buffer_load_dwordx4 v[32:35], v6, s[8:11], s88 offen offset:2048 sc1
    buffer_load_dwordx4 v[36:39], v6, s[8:11], s88 offen offset:3072 sc1
    s_add_u32 s89, s66, 69632
    buffer_load_dwordx4 v[40:43], v6, s[8:11], s89 offen offset:0 sc1
    buffer_load_dwordx4 v[44:47], v6, s[8:11], s89 offen offset:1024 sc1
    buffer_load_dwordx4 v[48:51], v6, s[8:11], s89 offen offset:2048 sc1
    buffer_load_dwordx4 v[52:55], v6, s[8:11], s89 offen offset:3072 sc1
    s_waitcnt vmcnt(4)
    v_bitop3_b32 v4, v27, v31, v35 bitop3:0x80
    v_bitop3_b32 v4, v4, v39, 1 bitop3:0x80
    v_cmp_ne_u32 vcc, 1, v4
    s_nop 0
    s_cbranch_vccnz L_retry_27
L_back_28:
    s_waitcnt lgkmcnt(6)
    v_mfma_f32_16x16x32_bf16 v[104:107], v[80:83], v[24:27], v[104:107]
    ds_read_b128 v[100:103], v5 offset:7168
    s_waitcnt lgkmcnt(5)
    v_mfma_f32_16x16x32_bf16 v[108:111], v[84:87], v[24:27], v[108:111]
    ds_read_b128 v[80:83], v5 offset:8192
    s_add_u32 s95, s66, 73728
    v_mfma_f32_16x16x32_bf16 v[112:115], v[96:99], v[24:27], v[112:115]
    ds_read_b128 v[84:87], v5 offset:9216
    s_waitcnt lgkmcnt(5)
    buffer_load_dwordx4 v[56:59], v6, s[8:11], s95 offen offset:0 sc1
    v_mfma_f32_16x16x32_bf16 v[116:119], v[72:75], v[24:27], v[116:119]
    ds_read_b128 v[96:99], v5 offset:10240
    v_mfma_f32_16x16x32_bf16 v[104:107], v[76:79], v[28:31], v[104:107]
    ds_read_b128 v[72:75], v5 offset:11264
    s_waitcnt lgkmcnt(5)
    buffer_load_dwordx4 v[60:63], v6, s[8:11], s95 offen offset:1024 sc1
    v_mfma_f32_16x16x32_bf16 v[108:111], v[88:91], v[28:31], v[108:111]
    ds_read_b128 v[76:79], v5 offset:12288
    v_mfma_f32_16x16x32_bf16 v[112:115], v[92:95], v[28:31], v[112:115]
    ds_read_b128 v[88:91], v5 offset:13312
    s_waitcnt lgkmcnt(5)
    buffer_load_dwordx4 v[64:67], v6, s[8:11], s95 offen offset:2048 sc1
    v_mfma_f32_16x16x32_bf16 v[116:119], v[100:103], v[28:31], v[116:119]
    ds_read_b128 v[92:95], v5 offset:14336
    v_mfma_f32_16x16x32_bf16 v[104:107], v[80:83], v[32:35], v[104:107]
    ds_read_b128 v[100:103], v5 offset:15360
    s_waitcnt lgkmcnt(5)
    buffer_load_dwordx4 v[68:71], v6, s[8:11], s95 offen offset:3072 sc1
    v_mfma_f32_16x16x32_bf16 v[108:111], v[84:87], v[32:35], v[108:111]
    ds_read_b128 v[80:83], v5 offset:16384
    s_waitcnt vmcnt(4)
    v_mfma_f32_16x16x32_bf16 v[112:115], v[96:99], v[32:35], v[112:115]
    ds_read_b128 v[84:87], v5 offset:17408
    s_waitcnt lgkmcnt(5)
    v_mfma_f32_16x16x32_bf16 v[116:119], v[72:75], v[32:35], v[116:119]
    ds_read_b128 v[96:99], v5 offset:18432
    v_bitop3_b32 v4, v43, v47, v51 bitop3:0x80
    v_mfma_f32_16x16x32_bf16 v[104:107], v[76:79], v[36:39], v[104:107]
    ds_read_b128 v[72:75], v5 offset:19456
    s_waitcnt lgkmcnt(5)
    v_mfma_f32_16x16x32_bf16 v[108:111], v[88:91], v[36:39], v[108:111]
    ds_read_b128 v[76:79], v5 offset:20480
    v_bitop3_b32 v4, v4, v55, 1 bitop3:0x80
    v_mfma_f32_16x16x32_bf16 v[112:115], v[92:95], v[36:39], v[112:115]
    ds_read_b128 v[88:91], v5 offset:21504
    s_waitcnt lgkmcnt(5)
    v_mfma_f32_16x16x32_bf16 v[116:119], v[100:103], v[36:39], v[116:119]
    ds_read_b128 v[92:95], v5 offset:22528
    v_cmp_ne_u32 vcc, 1, v4
    s_nop 0
    s_cbranch_vccnz L_retry_29
L_back_30:
    v_mfma_f32_16x16x32_bf16 v[104:107], v[80:83], v[40:43], v[104:107]
    ds_read_b128 v[100:103], v5 offset:23552
    s_waitcnt lgkmcnt(5)
    v_mfma_f32_16x16x32_bf16 v[108:111], v[84:87], v[40:43], v[108:111]
    ds_read_b128 v[80:83], v5 offset:24576
    s_add_u32 s96, s66, 77824
    v_mfma_f32_16x16x32_bf16 v[112:115], v[96:99], v[40:43], v[112:115]
    ds_read_b128 v[84:87], v5 offset:25600
    s_waitcnt lgkmcnt(5)
    buffer_load_dwordx4 v[24:27], v6, s[8:11], s96 offen offset:0 sc1
    v_mfma_f32_16x16x32_bf16 v[116:119], v[72:75], v[40:43], v[116:119]
    ds_read_b128 v[96:99], v5 offset:26624
    v_mfma_f32_16x16x32_bf16 v[104:107], v[76:79], v[44:47], v[104:107]
    ds_read_b128 v[72:75], v5 offset:27648
    s_waitcnt lgkmcnt(5)
    buffer_load_dwordx4 v[28:31], v6, s[8:11], s96 offen offset:1024 sc1
    v_mfma_f32_16x16x32_bf16 v[108:111], v[88:91], v[44:47], v[108:111]
    ds_read_b128 v[76:79], v5 offset:28672
    v_mfma_f32_16x16x32_bf16 v[112:115], v[92:95], v[44:47], v[112:115]
    ds_read_b128 v[88:91], v5 offset:29696
    s_waitcnt lgkmcnt(5)
    buffer_load_dwordx4 v[32:35], v6, s[8:11], s96 offen offset:2048 sc1
    v_mfma_f32_16x16x32_bf16 v[116:119], v[100:103], v[44:47], v[116:119]
    ds_read_b128 v[92:95], v5 offset:30720
    v_mfma_f32_16x16x32_bf16 v[104:107], v[80:83], v[48:51], v[104:107]
    ds_read_b128 v[100:103], v5 offset:31744
    s_waitcnt lgkmcnt(5)
    buffer_load_dwordx4 v[36:39], v6, s[8:11], s96 offen offset:3072 sc1
    v_mfma_f32_16x16x32_bf16 v[108:111], v[84:87], v[48:51], v[108:111]
    ds_read_b128 v[80:83], v5 offset:32768
    v_mfma_f32_16x16x32_bf16 v[112:115], v[96:99], v[48:51], v[112:115]
    ds_read_b128 v[84:87], v5 offset:33792
    s_waitcnt lgkmcnt(5)
    v_mfma_f32_16x16x32_bf16 v[116:119], v[72:75], v[48:51], v[116:119]
    ds_read_b128 v[96:99], v5 offset:34816
    v_mfma_f32_16x16x32_bf16 v[104:107], v[76:79], v[52:55], v[104:107]
    ds_read_b128 v[72:75], v5 offset:35840
    s_waitcnt lgkmcnt(5)
    v_mfma_f32_16x16x32_bf16 v[108:111], v[88:91], v[52:55], v[108:111]
    ds_read_b128 v[76:79], v5 offset:36864
    s_waitcnt vmcnt(4)
    v_mfma_f32_16x16x32_bf16 v[112:115], v[92:95], v[52:55], v[112:115]
    ds_read_b128 v[88:91], v5 offset:37888
    s_waitcnt lgkmcnt(5)
    v_mfma_f32_16x16x32_bf16 v[116:119], v[100:103], v[52:55], v[116:119]
    ds_read_b128 v[92:95], v5 offset:38912
    v_bitop3_b32 v4, v59, v63, v67 bitop3:0x80
    v_bitop3_b32 v4, v4, v71, 1 bitop3:0x80
    v_cmp_ne_u32 vcc, 1, v4
    s_nop 0
    s_cbranch_vccnz L_retry_31
L_back_32:
    v_mfma_f32_16x16x32_bf16 v[104:107], v[80:83], v[56:59], v[104:107]
    ds_read_b128 v[100:103], v5 offset:39936
    s_waitcnt lgkmcnt(5)
    v_mfma_f32_16x16x32_bf16 v[108:111], v[84:87], v[56:59], v[108:111]
    ds_read_b128 v[80:83], v5 offset:40960
    v_mfma_f32_16x16x32_bf16 v[112:115], v[96:99], v[56:59], v[112:115]
    ds_read_b128 v[84:87], v5 offset:41984
    s_waitcnt lgkmcnt(5)
    v_mfma_f32_16x16x32_bf16 v[116:119], v[72:75], v[56:59], v[116:119]
    ds_read_b128 v[96:99], v5 offset:43008
    v_mfma_f32_16x16x32_bf16 v[104:107], v[76:79], v[60:63], v[104:107]
    ds_read_b128 v[72:75], v5 offset:44032
    s_waitcnt lgkmcnt(5)
    v_mfma_f32_16x16x32_bf16 v[108:111], v[88:91], v[60:63], v[108:111]
    ds_read_b128 v[76:79], v5 offset:45056
    v_mfma_f32_16x16x32_bf16 v[112:115], v[92:95], v[60:63], v[112:115]
    ds_read_b128 v[88:91], v5 offset:46080
    s_waitcnt lgkmcnt(5)
    v_mfma_f32_16x16x32_bf16 v[116:119], v[100:103], v[60:63], v[116:119]
    ds_read_b128 v[92:95], v5 offset:47104
    v_mfma_f32_16x16x32_bf16 v[104:107], v[80:83], v[64:67], v[104:107]
    ds_read_b128 v[100:103], v5 offset:48128
    s_waitcnt lgkmcnt(5)
    v_mfma_f32_16x16x32_bf16 v[108:111], v[84:87], v[64:67], v[108:111]
    ds_read_b128 v[80:83], v5 offset:49152
    v_mfma_f32_16x16x32_bf16 v[112:115], v[96:99], v[64:67], v[112:115]
    ds_read_b128 v[84:87], v5 offset:50176
    s_waitcnt lgkmcnt(5)
    v_mfma_f32_16x16x32_bf16 v[116:119], v[72:75], v[64:67], v[116:119]
    ds_read_b128 v[96:99], v5 offset:51200
    v_mfma_f32_16x16x32_bf16 v[104:107], v[76:79], v[68:71], v[104:107]
    ds_read_b128 v[72:75], v5 offset:52224
    s_waitcnt lgkmcnt(5)
    v_mfma_f32_16x16x32_bf16 v[108:111], v[88:91], v[68:71], v[108:111]
    ds_read_b128 v[76:79], v5 offset:53248
    s_waitcnt vmcnt(0)
    v_mfma_f32_16x16x32_bf16 v[112:115], v[92:95], v[68:71], v[112:115]
    ds_read_b128 v[88:91], v5 offset:54272
    s_waitcnt lgkmcnt(5)
    v_mfma_f32_16x16x32_bf16 v[116:119], v[100:103], v[68:71], v[116:119]
    ds_read_b128 v[92:95], v5 offset:55296
    v_bitop3_b32 v4, v27, v31, v35 bitop3:0x80
    v_bitop3_b32 v4, v4, v39, 1 bitop3:0x80
    v_cmp_ne_u32 vcc, 1, v4
    s_nop 0
    s_cbranch_vccnz L_retry_33
L_back_34:
    v_mfma_f32_16x16x32_bf16 v[104:107], v[80:83], v[24:27], v[104:107]
    ds_read_b128 v[100:103], v5 offset:56320
    s_waitcnt lgkmcnt(5)
    v_mfma_f32_16x16x32_bf16 v[108:111], v[84:87], v[24:27], v[108:111]
    ds_read_b128 v[80:83], v5 offset:57344
    v_mfma_f32_16x16x32_bf16 v[112:115], v[96:99], v[24:27], v[112:115]
    ds_read_b128 v[84:87], v5 offset:58368
    s_waitcnt lgkmcnt(5)
    v_mfma_f32_16x16x32_bf16 v[116:119], v[72:75], v[24:27], v[116:119]
    ds_read_b128 v[96:99], v5 offset:61440
    s_add_u32 s73, s60, 49152
    v_mfma_f32_16x16x32_bf16 v[104:107], v[76:79], v[28:31], v[104:107]
    ds_read_b128 v[72:75], v5 offset:62464
    s_waitcnt lgkmcnt(5)
    buffer_load_dwordx4 v[40:43], v7, s[8:11], s73 offen offset:0 sc1
    v_mfma_f32_16x16x32_bf16 v[108:111], v[88:91], v[28:31], v[108:111]
    ds_read_b128 v[76:79], v5 offset:59392
    v_mfma_f32_16x16x32_bf16 v[112:115], v[92:95], v[28:31], v[112:115]
    ds_read_b128 v[88:91], v5 offset:60416
    s_waitcnt lgkmcnt(5)
    buffer_load_dwordx4 v[44:47], v7, s[8:11], s73 offen offset:1024 sc1
    v_mfma_f32_16x16x32_bf16 v[116:119], v[100:103], v[28:31], v[116:119]
    ds_read_b128 v[92:95], v5 offset:63488
    v_mfma_f32_16x16x32_bf16 v[104:107], v[80:83], v[32:35], v[104:107]
    ds_read_b128 v[100:103], v5 offset:64512
    s_waitcnt lgkmcnt(5)
    buffer_load_dwordx4 v[48:51], v7, s[8:11], s73 offen offset:2048 sc1
    v_mfma_f32_16x16x32_bf16 v[108:111], v[84:87], v[32:35], v[108:111]
    v_mfma_f32_16x16x32_bf16 v[104:107], v[96:99], v[36:39], v[104:107]
    s_waitcnt lgkmcnt(3)
    buffer_load_dwordx4 v[52:55], v7, s[8:11], s73 offen offset:3072 sc1
    v_mfma_f32_16x16x32_bf16 v[108:111], v[72:75], v[36:39], v[108:111]
    v_mfma_f32_16x16x32_bf16 v[112:115], v[76:79], v[32:35], v[112:115]
    s_waitcnt lgkmcnt(1)
    v_mfma_f32_16x16x32_bf16 v[116:119], v[88:91], v[32:35], v[116:119]
    v_mfma_f32_16x16x32_bf16 v[112:115], v[92:95], v[36:39], v[112:115]
    s_waitcnt lgkmcnt(0)
    v_mfma_f32_16x16x32_bf16 v[116:119], v[100:103], v[36:39], v[116:119]
    s_add_u32 s100, s63, 0
    s_nop 0
    v_cvt_pk_bf16_f32 v103, v110, v111
    v_cvt_pk_bf16_f32 v100, v104, v105
    v_cvt_pk_bf16_f32 v101, v106, v107
    v_cvt_pk_bf16_f32 v102, v108, v109
    buffer_store_dwordx4 v[100:103], v6, s[8:11], s100 offen offset:0
    s_nop 0
    v_cvt_pk_bf16_f32 v127, v118, v119
    v_cvt_pk_bf16_f32 v124, v112, v113
    v_cvt_pk_bf16_f32 v125, v114, v115
    v_cvt_pk_bf16_f32 v126, v116, v117
    buffer_store_dwordx4 v[124:127], v6, s[8:11], s100 offen offset:1024
    v_mov_b32 v96, 0x3f803f80
    v_mov_b32 v97, 0x3f803f80
    v_mov_b32 v98, 0x3f803f80
    v_mov_b32 v99, 0x3f803f80
    v_mfma_f32_16x16x32_bf16 v[108:111], v[100:103], v[100:103], 0
    v_mfma_f32_16x16x32_bf16 v[108:111], v[124:127], v[124:127], v[108:111]
    v_mfma_f32_16x16x32_bf16 v[104:107], v[96:99], v[100:103], 0
    v_mfma_f32_16x16x32_bf16 v[104:107], v[96:99], v[124:127], v[104:107]
    s_waitcnt vmcnt(4)
    v_bitop3_b32 v4, v43, v47, 1 bitop3:0x80
    v_cmp_ne_u32 vcc, 1, v4
    s_nop 0
    s_cbranch_vccnz L_retry_35
L_back_36:
    ds_write_b128 v7, v[40:43] offset:16384
    ds_write_b128 v7, v[44:47] offset:17408
    s_waitcnt vmcnt(2)
    v_bitop3_b32 v4, v51, v55, 1 bitop3:0x80
    v_cmp_ne_u32 vcc, 1, v4
    s_nop 0
    s_cbranch_vccnz L_retry_37
L_back_38:
    ds_write_b128 v7, v[48:51] offset:18432
    ds_write_b128 v7, v[52:55] offset:19456
    s_add_u32 s101, s60, 294912
    v_cndmask_b32 v108, v108, v109, s[44:45]
    v_cndmask_b32 v108, v108, v110, s[46:47]
    v_cndmask_b32 v108, v108, v111, s[48:49]
    v_or_b32 v105, 1, v108
    s_waitcnt vmcnt(0)
    buffer_store_dwordx2 v[104:105], v10, s[8:11], s101 offen
    s_waitcnt lgkmcnt(0)
    s_branch L_join_26
L_retry_39:
    s_add_u32 s78, s66, 65536
    buffer_load_dwordx4 v[24:27], v6, s[8:11], s78 offen offset:0 sc1
    buffer_load_dwordx4 v[28:31], v6, s[8:11], s78 offen offset:1024 sc1
    buffer_load_dwordx4 v[32:35], v6, s[8:11], s78 offen offset:2048 sc1
    buffer_load_dwordx4 v[36:39], v6, s[8:11], s78 offen offset:3072 sc1
    s_sub_u32 s41, s41, 1
    s_cbranch_scc1 L_end
    s_waitcnt vmcnt(0)
    v_bitop3_b32 v4, v27, v31, v35 bitop3:0x80
    v_bitop3_b32 v4, v4, v39, 1 bitop3:0x80
    v_cmp_ne_u32 vcc, 1, v4
    s_nop 0
    s_cbranch_vccnz L_retry_39
    s_branch L_back_40
L_retry_41:
    s_add_u32 s81, s66, 69632
    buffer_load_dwordx4 v[40:43], v6, s[8:11], s81 offen offset:0 sc1
    buffer_load_dwordx4 v[44:47], v6, s[8:11], s81 offen offset:1024 sc1
    buffer_load_dwordx4 v[48:51], v6, s[8:11], s81 offen offset:2048 sc1
    buffer_load_dwordx4 v[52:55], v6, s[8:11], s81 offen offset:3072 sc1
    s_sub_u32 s41, s41, 1
    s_cbranch_scc1 L_end
    s_waitcnt vmcnt(0)
    v_bitop3_b32 v4, v43, v47, v51 bitop3:0x80
    v_bitop3_b32 v4, v4, v55, 1 bitop3:0x80
    v_cmp_ne_u32 vcc, 1, v4
    s_nop 0
    s_cbranch_vccnz L_retry_41
    s_branch L_back_42
L_retry_43:
    s_add_u32 s82, s66, 73728
    buffer_load_dwordx4 v[56:59], v6, s[8:11], s82 offen offset:0 sc1
    buffer_load_dwordx4 v[60:63], v6, s[8:11], s82 offen offset:1024 sc1
    buffer_load_dwordx4 v[64:67], v6, s[8:11], s82 offen offset:2048 sc1
    buffer_load_dwordx4 v[68:71], v6, s[8:11], s82 offen offset:3072 sc1
    s_sub_u32 s41, s41, 1
    s_cbranch_scc1 L_end
    s_waitcnt vmcnt(0)
    v_bitop3_b32 v4, v59, v63, v67 bitop3:0x80
    v_bitop3_b32 v4, v4, v71, 1 bitop3:0x80
    v_cmp_ne_u32 vcc, 1, v4
    s_nop 0
    s_cbranch_vccnz L_retry_43
    s_branch L_back_44
L_retry_45:
    s_add_u32 s83, s66, 77824
    buffer_load_dwordx4 v[24:27], v6, s[8:11], s83 offen offset:0 sc1
    buffer_load_dwordx4 v[28:31], v6, s[8:11], s83 offen offset:1024 sc1
    buffer_load_dwordx4 v[32:35], v6, s[8:11], s83 offen offset:2048 sc1
    buffer_load_dwordx4 v[36:39], v6, s[8:11], s83 offen offset:3072 sc1
    s_sub_u32 s41, s41, 1
    s_cbranch_scc1 L_end
    s_waitcnt vmcnt(0)
    v_bitop3_b32 v4, v27, v31, v35 bitop3:0x80
    v_bitop3_b32 v4, v4, v39, 1 bitop3:0x80
    v_cmp_ne_u32 vcc, 1, v4
    s_nop 0
    s_cbranch_vccnz L_retry_45
    s_branch L_back_46
L_retry_47:
    s_add_u32 s73, s60, 49152
    buffer_load_dwordx4 v[40:43], v7, s[8:11], s73 offen offset:0 sc1
    buffer_load_dwordx4 v[44:47], v7, s[8:11], s73 offen offset:1024 sc1
    buffer_load_dwordx4 v[48:51], v7, s[8:11], s73 offen offset:2048 sc1
    buffer_load_dwordx4 v[52:55], v7, s[8:11], s73 offen offset:3072 sc1
    s_sub_u32 s41, s41, 1
    s_cbranch_scc1 L_end
    s_waitcnt vmcnt(0)
    v_bitop3_b32 v4, v43, v47, 1 bitop3:0x80
    v_cmp_ne_u32 vcc, 1, v4
    s_nop 0
    s_cbranch_vccnz L_retry_47
    s_branch L_back_48
L_retry_49:
    buffer_load_dwordx4 v[48:51], v7, s[8:11], s73 offen offset:2048 sc1
    buffer_load_dwordx4 v[52:55], v7, s[8:11], s73 offen offset:3072 sc1
    s_sub_u32 s41, s41, 1
    s_cbranch_scc1 L_end
    s_waitcnt vmcnt(0)
    v_bitop3_b32 v4, v51, v55, 1 bitop3:0x80
    v_cmp_ne_u32 vcc, 1, v4
    s_nop 0
    s_cbranch_vccnz L_retry_49
    s_branch L_back_50
L_retry_51:
    s_add_u32 s73, s60, 32768
    buffer_load_dwordx4 v[24:27], v7, s[8:11], s73 offen offset:0 sc1
    buffer_load_dwordx4 v[28:31], v7, s[8:11], s73 offen offset:1024 sc1
    buffer_load_dwordx4 v[32:35], v7, s[8:11], s73 offen offset:2048 sc1
    buffer_load_dwordx4 v[36:39], v7, s[8:11], s73 offen offset:3072 sc1
    s_sub_u32 s41, s41, 1
    s_cbranch_scc1 L_end
    s_waitcnt vmcnt(0)
    v_bitop3_b32 v4, v27, v31, v35 bitop3:0x80
    v_bitop3_b32 v4, v4, v39, 1 bitop3:0x80
    v_cmp_ne_u32 vcc, 1, v4
    s_nop 0
    s_cbranch_vccnz L_retry_51
    s_branch L_back_52
L_retry_53:
    s_add_u32 s74, s60, 294912
    s_add_u32 s74, s74, s4
    buffer_load_dwordx4 v[80:83], v6, s[8:11], s74 offen sc1
    s_sub_u32 s41, s41, 1
    s_cbranch_scc1 L_end
    s_waitcnt vmcnt(0)
    v_bitop3_b32 v5, v81, v83, 1 bitop3:0x80
    v_cmp_ne_u32 vcc, 1, v5
    s_nop 0
    s_cbranch_vccnz L_retry_53
    s_branch L_back_54
L_retry_55:
    s_add_u32 s75, s61, 65536
    buffer_load_dwordx4 v[88:91], v6, s[8:11], s75 offen sc1
    s_sub_u32 s41, s41, 1
    s_cbranch_scc1 L_end
    s_waitcnt vmcnt(0)
    v_cmp_eq_u32 vcc, -1, v91
    s_nop 0
    s_cbranch_vccnz L_retry_55
    s_branch L_back_56
L_retry_59:
    s_add_u32 s100, s66, 65536
    buffer_load_dwordx4 v[24:27], v6, s[8:11], s100 offen offset:0 sc1
    buffer_load_dwordx4 v[28:31], v6, s[8:11], s100 offen offset:1024 sc1
    buffer_load_dwordx4 v[32:35], v6, s[8:11], s100 offen offset:2048 sc1
    buffer_load_dwordx4 v[36:39], v6, s[8:11], s100 offen offset:3072 sc1
    s_sub_u32 s41, s41, 1
    s_cbranch_scc1 L_end
    s_waitcnt vmcnt(0)
    v_bitop3_b32 v4, v27, v31, v35 bitop3:0xfe
    v_bitop3_b32 v4, v4, v39, 1 bitop3:0xa8
    v_cmp_ne_u32 vcc, 0, v4
    s_nop 0
    s_cbranch_vccnz L_retry_59
    s_branch L_back_60
L_retry_61:
    s_add_u32 s79, s66, 69632
    buffer_load_dwordx4 v[40:43], v6, s[8:11], s79 offen offset:0 sc1
    buffer_load_dwordx4 v[44:47], v6, s[8:11], s79 offen offset:1024 sc1
    buffer_load_dwordx4 v[48:51], v6, s[8:11], s79 offen offset:2048 sc1
    buffer_load_dwordx4 v[52:55], v6, s[8:11], s79 offen offset:3072 sc1
    s_sub_u32 s41, s41, 1
    s_cbranch_scc1 L_end
    s_waitcnt vmcnt(0)
    v_bitop3_b32 v4, v43, v47, v51 bitop3:0xfe
    v_bitop3_b32 v4, v4, v55, 1 bitop3:0xa8
    v_cmp_ne_u32 vcc, 0, v4
    s_nop 0
    s_cbranch_vccnz L_retry_61
    s_branch L_back_62
L_retry_63:
    s_add_u32 s80, s66, 73728
    buffer_load_dwordx4 v[56:59], v6, s[8:11], s80 offen offset:0 sc1
    buffer_load_dwordx4 v[60:63], v6, s[8:11], s80 offen offset:1024 sc1
    buffer_load_dwordx4 v[64:67], v6, s[8:11], s80 offen offset:2048 sc1
    buffer_load_dwordx4 v[68:71], v6, s[8:11], s80 offen offset:3072 sc1
    s_sub_u32 s41, s41, 1
    s_cbranch_scc1 L_end
    s_waitcnt vmcnt(0)
    v_bitop3_b32 v4, v59, v63, v67 bitop3:0xfe
    v_bitop3_b32 v4, v4, v71, 1 bitop3:0xa8
    v_cmp_ne_u32 vcc, 0, v4
    s_nop 0
    s_cbranch_vccnz L_retry_63
    s_branch L_back_64
L_retry_65:
    s_add_u32 s81, s66, 77824
    buffer_load_dwordx4 v[24:27], v6, s[8:11], s81 offen offset:0 sc1
    buffer_load_dwordx4 v[28:31], v6, s[8:11], s81 offen offset:1024 sc1
    buffer_load_dwordx4 v[32:35], v6, s[8:11], s81 offen offset:2048 sc1
    buffer_load_dwordx4 v[36:39], v6, s[8:11], s81 offen offset:3072 sc1
    s_sub_u32 s41, s41, 1
    s_cbranch_scc1 L_end
    s_waitcnt vmcnt(0)
    v_bitop3_b32 v4, v27, v31, v35 bitop3:0xfe
    v_bitop3_b32 v4, v4, v39, 1 bitop3:0xa8
    v_cmp_ne_u32 vcc, 0, v4
    s_nop 0
    s_cbranch_vccnz L_retry_65
    s_branch L_back_66
L_retry_67:
    s_add_u32 s73, s60, 49152
    buffer_load_dwordx4 v[40:43], v7, s[8:11], s73 offen offset:0 sc1
    buffer_load_dwordx4 v[44:47], v7, s[8:11], s73 offen offset:1024 sc1
    buffer_load_dwordx4 v[48:51], v7, s[8:11], s73 offen offset:2048 sc1
    buffer_load_dwordx4 v[52:55], v7, s[8:11], s73 offen offset:3072 sc1
    s_sub_u32 s41, s41, 1
    s_cbranch_scc1 L_end
    s_waitcnt vmcnt(0)
    v_bitop3_b32 v4, v43, v47, 1 bitop3:0xa8
    v_cmp_ne_u32 vcc, 0, v4
    s_nop 0
    s_cbranch_vccnz L_retry_67
    s_branch L_back_68
L_retry_69:
    buffer_load_dwordx4 v[48:51], v7, s[8:11], s73 offen offset:2048 sc1
    buffer_load_dwordx4 v[52:55], v7, s[8:11], s73 offen offset:3072 sc1
    s_sub_u32 s41, s41, 1
    s_cbranch_scc1 L_end
    s_waitcnt vmcnt(0)
    v_bitop3_b32 v4, v51, v55, 1 bitop3:0xa8
    v_cmp_ne_u32 vcc, 0, v4
    s_nop 0
    s_cbranch_vccnz L_retry_69
    s_branch L_back_70
L_lo_57:
    ds_read_b128 v[72:75], v5 offset:3072
    ds_read_b128 v[76:79], v5 offset:4096
    ds_read_b128 v[88:91], v5 offset:5120
    ds_read_b128 v[92:95], v5 offset:6144
    s_waitcnt vmcnt(0)
    s_add_u32 s98, s66, 65536
    buffer_load_dwordx4 v[24:27], v6, s[8:11], s98 offen offset:0 sc1
    buffer_load_dwordx4 v[28:31], v6, s[8:11], s98 offen offset:1024 sc1
    buffer_load_dwordx4 v[32:35], v6, s[8:11], s98 offen offset:2048 sc1
    buffer_load_dwordx4 v[36:39], v6, s[8:11], s98 offen offset:3072 sc1
    s_add_u32 s99, s66, 69632
    buffer_load_dwordx4 v[40:43], v6, s[8:11], s99 offen offset:0 sc1
    buffer_load_dwordx4 v[44:47], v6, s[8:11], s99 offen offset:1024 sc1
    buffer_load_dwordx4 v[48:51], v6, s[8:11], s99 offen offset:2048 sc1
    buffer_load_dwordx4 v[52:55], v6, s[8:11], s99 offen offset:3072 sc1
    s_waitcnt vmcnt(4)
    v_bitop3_b32 v4, v27, v31, v35 bitop3:0xfe
    v_bitop3_b32 v4, v4, v39, 1 bitop3:0xa8
    v_cmp_ne_u32 vcc, 0, v4
    s_nop 0
    s_cbranch_vccnz L_retry_59
L_back_60:
    s_waitcnt lgkmcnt(6)
    v_mfma_f32_16x16x32_bf16 v[104:107], v[80:83], v[24:27], v[104:107]
    ds_read_b128 v[100:103], v5 offset:7168
    s_waitcnt lgkmcnt(5)
    v_mfma_f32_16x16x32_bf16 v[108:111], v[84:87], v[24:27], v[108:111]
    ds_read_b128 v[80:83], v5 offset:8192
    s_add_u32 s101, s66, 73728
    v_mfma_f32_16x16x32_bf16 v[112:115], v[96:99], v[24:27], v[112:115]
    ds_read_b128 v[84:87], v5 offset:9216
    s_waitcnt lgkmcnt(5)
    buffer_load_dwordx4 v[56:59], v6, s[8:11], s101 offen offset:0 sc1
    v_mfma_f32_16x16x32_bf16 v[116:119], v[72:75], v[24:27], v[116:119]
    ds_read_b128 v[96:99], v5 offset:10240
    v_mfma_f32_16x16x32_bf16 v[104:107], v[76:79], v[28:31], v[104:107]
    ds_read_b128 v[72:75], v5 offset:11264
    s_waitcnt lgkmcnt(5)
    buffer_load_dwordx4 v[60:63], v6, s[8:11], s101 offen offset:1024 sc1
    v_mfma_f32_16x16x32_bf16 v[108:111], v[88:91], v[28:31], v[108:111]
    ds_read_b128 v[76:79], v5 offset:12288
    v_mfma_f32_16x16x32_bf16 v[112:115], v[92:95], v[28:31], v[112:115]
    ds_read_b128 v[88:91], v5 offset:13312
    s_waitcnt lgkmcnt(5)
    buffer_load_dwordx4 v[64:67], v6, s[8:11], s101 offen offset:2048 sc1
    v_mfma_f32_16x16x32_bf16 v[116:119], v[100:103], v[28:31], v[116:119]
    ds_read_b128 v[92:95], v5 offset:14336
    v_mfma_f32_16x16x32_bf16 v[104:107], v[80:83], v[32:35], v[104:107]
    ds_read_b128 v[100:103], v5 offset:15360
    s_waitcnt lgkmcnt(5)
    buffer_load_dwordx4 v[68:71], v6, s[8:11], s101 offen offset:3072 sc1
    v_mfma_f32_16x16x32_bf16 v[108:111], v[84:87], v[32:35], v[108:111]
    ds_read_b128 v[80:83], v5 offset:16384
    s_waitcnt vmcnt(4)
    v_mfma_f32_16x16x32_bf16 v[112:115], v[96:99], v[32:35], v[112:115]
    ds_read_b128 v[84:87], v5 offset:17408
    s_waitcnt lgkmcnt(5)
    v_mfma_f32_16x16x32_bf16 v[116:119], v[72:75], v[32:35], v[116:119]
    ds_read_b128 v[96:99], v5 offset:18432
    v_bitop3_b32 v4, v43, v47, v51 bitop3:0xfe
    v_mfma_f32_16x16x32_bf16 v[104:107], v[76:79], v[36:39], v[104:107]
    ds_read_b128 v[72:75], v5 offset:19456
    s_waitcnt lgkmcnt(5)
    v_mfma_f32_16x16x32_bf16 v[108:111], v[88:91], v[36:39], v[108:111]
    ds_read_b128 v[76:79], v5 offset:20480
    v_bitop3_b32 v4, v4, v55, 1 bitop3:0xa8
    v_mfma_f32_16x16x32_bf16 v[112:115], v[92:95], v[36:39], v[112:115]
    ds_read_b128 v[88:91], v5 offset:21504
    s_waitcnt lgkmcnt(5)
    v_mfma_f32_16x16x32_bf16 v[116:119], v[100:103], v[36:39], v[116:119]
    ds_read_b128 v[92:95], v5 offset:22528
    v_cmp_ne_u32 vcc, 0, v4
    s_nop 0
    s_cbranch_vccnz L_retry_61
L_back_62:
    v_mfma_f32_16x16x32_bf16 v[104:107], v[80:83], v[40:43], v[104:107]
    ds_read_b128 v[100:103], v5 offset:23552
    s_waitcnt lgkmcnt(5)
    v_mfma_f32_16x16x32_bf16 v[108:111], v[84:87], v[40:43], v[108:111]
    ds_read_b128 v[80:83], v5 offset:24576
    s_add_u32 s78, s66, 77824
    v_mfma_f32_16x16x32_bf16 v[112:115], v[96:99], v[40:43], v[112:115]
    ds_read_b128 v[84:87], v5 offset:25600
    s_waitcnt lgkmcnt(5)
    buffer_load_dwordx4 v[24:27], v6, s[8:11], s78 offen offset:0 sc1
    v_mfma_f32_16x16x32_bf16 v[116:119], v[72:75], v[40:43], v[116:119]
    ds_read_b128 v[96:99], v5 offset:26624
    v_mfma_f32_16x16x32_bf16 v[104:107], v[76:79], v[44:47], v[104:107]
    ds_read_b128 v[72:75], v5 offset:27648
    s_waitcnt lgkmcnt(5)
    buffer_load_dwordx4 v[28:31], v6, s[8:11], s78 offen offset:1024 sc1
    v_mfma_f32_16x16x32_bf16 v[108:111], v[88:91], v[44:47], v[108:111]
    ds_read_b128 v[76:79], v5 offset:28672
    v_mfma_f32_16x16x32_bf16 v[112:115], v[92:95], v[44:47], v[112:115]
    ds_read_b128 v[88:91], v5 offset:29696
    s_waitcnt lgkmcnt(5)
    buffer_load_dwordx4 v[32:35], v6, s[8:11], s78 offen offset:2048 sc1
    v_mfma_f32_16x16x32_bf16 v[116:119], v[100:103], v[44:47], v[116:119]
    ds_read_b128 v[92:95], v5 offset:30720
    v_mfma_f32_16x16x32_bf16 v[104:107], v[80:83], v[48:51], v[104:107]
    ds_read_b128 v[100:103], v5 offset:31744
    s_waitcnt lgkmcnt(5)
    buffer_load_dwordx4 v[36:39], v6, s[8:11], s78 offen offset:3072 sc1
    v_mfma_f32_16x16x32_bf16 v[108:111], v[84:87], v[48:51], v[108:111]
    ds_read_b128 v[80:83], v5 offset:32768
    v_mfma_f32_16x16x32_bf16 v[112:115], v[96:99], v[48:51], v[112:115]
    ds_read_b128 v[84:87], v5 offset:33792
    s_waitcnt lgkmcnt(5)
    v_mfma_f32_16x16x32_bf16 v[116:119], v[72:75], v[48:51], v[116:119]
    ds_read_b128 v[96:99], v5 offset:34816
    v_mfma_f32_16x16x32_bf16 v[104:107], v[76:79], v[52:55], v[104:107]
    ds_read_b128 v[72:75], v5 offset:35840
    s_waitcnt lgkmcnt(5)
    v_mfma_f32_16x16x32_bf16 v[108:111], v[88:91], v[52:55], v[108:111]
    ds_read_b128 v[76:79], v5 offset:36864
    s_waitcnt vmcnt(4)
    v_mfma_f32_16x16x32_bf16 v[112:115], v[92:95], v[52:55], v[112:115]
    ds_read_b128 v[88:91], v5 offset:37888
    s_waitcnt lgkmcnt(5)
    v_mfma_f32_16x16x32_bf16 v[116:119], v[100:103], v[52:55], v[116:119]
    ds_read_b128 v[92:95], v5 offset:38912
    v_bitop3_b32 v4, v59, v63, v67 bitop3:0xfe
    v_bitop3_b32 v4, v4, v71, 1 bitop3:0xa8
    v_cmp_ne_u32 vcc, 0, v4
    s_nop 0
    s_cbranch_vccnz L_retry_63
L_back_64:
    v_mfma_f32_16x16x32_bf16 v[104:107], v[80:83], v[56:59], v[104:107]
    ds_read_b128 v[100:103], v5 offset:39936
    s_waitcnt lgkmcnt(5)
    v_mfma_f32_16x16x32_bf16 v[108:111], v[84:87], v[56:59], v[108:111]
    ds_read_b128 v[80:83], v5 offset:40960
    v_mfma_f32_16x16x32_bf16 v[112:115], v[96:99], v[56:59], v[112:115]
    ds_read_b128 v[84:87], v5 offset:41984
    s_waitcnt lgkmcnt(5)
    v_mfma_f32_16x16x32_bf16 v[116:119], v[72:75], v[56:59], v[116:119]
    ds_read_b128 v[96:99], v5 offset:43008
    v_mfma_f32_16x16x32_bf16 v[104:107], v[76:79], v[60:63], v[104:107]
    ds_read_b128 v[72:75], v5 offset:44032
    s_waitcnt lgkmcnt(5)
    v_mfma_f32_16x16x32_bf16 v[108:111], v[88:91], v[60:63], v[108:111]
    ds_read_b128 v[76:79], v5 offset:45056
    v_mfma_f32_16x16x32_bf16 v[112:115], v[92:95], v[60:63], v[112:115]
    ds_read_b128 v[88:91], v5 offset:46080
    s_waitcnt lgkmcnt(5)
    v_mfma_f32_16x16x32_bf16 v[116:119], v[100:103], v[60:63], v[116:119]
    ds_read_b128 v[92:95], v5 offset:47104
    v_mfma_f32_16x16x32_bf16 v[104:107], v[80:83], v[64:67], v[104:107]
    ds_read_b128 v[100:103], v5 offset:48128
    s_waitcnt lgkmcnt(5)
    v_mfma_f32_16x16x32_bf16 v[108:111], v[84:87], v[64:67], v[108:111]
    ds_read_b128 v[80:83], v5 offset:49152
    v_mfma_f32_16x16x32_bf16 v[112:115], v[96:99], v[64:67], v[112:115]
    ds_read_b128 v[84:87], v5 offset:50176
    s_waitcnt lgkmcnt(5)
    v_mfma_f32_16x16x32_bf16 v[116:119], v[72:75], v[64:67], v[116:119]
    ds_read_b128 v[96:99], v5 offset:51200
    v_mfma_f32_16x16x32_bf16 v[104:107], v[76:79], v[68:71], v[104:107]
    ds_read_b128 v[72:75], v5 offset:52224
    s_waitcnt lgkmcnt(5)
    v_mfma_f32_16x16x32_bf16 v[108:111], v[88:91], v[68:71], v[108:111]
    ds_read_b128 v[76:79], v5 offset:53248
    s_waitcnt vmcnt(0)
    v_mfma_f32_16x16x32_bf16 v[112:115], v[92:95], v[68:71], v[112:115]
    ds_read_b128 v[88:91], v5 offset:54272
    s_waitcnt lgkmcnt(5)
    v_mfma_f32_16x16x32_bf16 v[116:119], v[100:103], v[68:71], v[116:119]
    ds_read_b128 v[92:95], v5 offset:55296
    v_bitop3_b32 v4, v27, v31, v35 bitop3:0xfe
    v_bitop3_b32 v4, v4, v39, 1 bitop3:0xa8
    v_cmp_ne_u32 vcc, 0, v4
    s_nop 0
    s_cbranch_vccnz L_retry_65
L_back_66:
    v_mfma_f32_16x16x32_bf16 v[104:107], v[80:83], v[24:27], v[104:107]
    ds_read_b128 v[100:103], v5 offset:56320
    s_waitcnt lgkmcnt(5)
    v_mfma_f32_16x16x32_bf16 v[108:111], v[84:87], v[24:27], v[108:111]
    ds_read_b128 v[80:83], v5 offset:57344
    v_mfma_f32_16x16x32_bf16 v[112:115], v[96:99], v[24:27], v[112:115]
    ds_read_b128 v[84:87], v5 offset:58368
    s_waitcnt lgkmcnt(5)
    v_mfma_f32_16x16x32_bf16 v[116:119], v[72:75], v[24:27], v[116:119]
    ds_read_b128 v[96:99], v5 offset:61440
    s_add_u32 s73, s60, 49152
    v_mfma_f32_16x16x32_bf16 v[104:107], v[76:79], v[28:31], v[104:107]
    ds_read_b128 v[72:75], v5 offset:62464
    s_waitcnt lgkmcnt(5)
    buffer_load_dwordx4 v[40:43], v7, s[8:11], s73 offen offset:0 sc1
    v_mfma_f32_16x16x32_bf16 v[108:111], v[88:91], v[28:31], v[108:111]
    ds_read_b128 v[76:79], v5 offset:59392
    v_mfma_f32_16x16x32_bf16 v[112:115], v[92:95], v[28:31], v[112:115]
    ds_read_b128 v[88:91], v5 offset:60416
    s_waitcnt lgkmcnt(5)
    buffer_load_dwordx4 v[44:47], v7, s[8:11], s73 offen offset:1024 sc1
    v_mfma_f32_16x16x32_bf16 v[116:119], v[100:103], v[28:31], v[116:119]
    ds_read_b128 v[92:95], v5 offset:63488
    v_mfma_f32_16x16x32_bf16 v[104:107], v[80:83], v[32:35], v[104:107]
    ds_read_b128 v[100:103], v5 offset:64512
    s_waitcnt lgkmcnt(5)
    buffer_load_dwordx4 v[48:51], v7, s[8:11], s73 offen offset:2048 sc1
    v_mfma_f32_16x16x32_bf16 v[108:111], v[84:87], v[32:35], v[108:111]
    v_mfma_f32_16x16x32_bf16 v[104:107], v[96:99], v[36:39], v[104:107]
    s_waitcnt lgkmcnt(3)
    buffer_load_dwordx4 v[52:55], v7, s[8:11], s73 offen offset:3072 sc1
    v_mfma_f32_16x16x32_bf16 v[108:111], v[72:75], v[36:39], v[108:111]
    v_mfma_f32_16x16x32_bf16 v[112:115], v[76:79], v[32:35], v[112:115]
    s_waitcnt lgkmcnt(1)
    v_mfma_f32_16x16x32_bf16 v[116:119], v[88:91], v[32:35], v[116:119]
    v_mfma_f32_16x16x32_bf16 v[112:115], v[92:95], v[36:39], v[112:115]
    s_waitcnt lgkmcnt(0)
    v_mfma_f32_16x16x32_bf16 v[116:119], v[100:103], v[36:39], v[116:119]
    s_add_u32 s82, s63, 0
    s_nop 0
    v_cvt_pk_bf16_f32 v103, v110, v111
    v_cvt_pk_bf16_f32 v100, v104, v105
    v_cvt_pk_bf16_f32 v101, v106, v107
    v_cvt_pk_bf16_f32 v102, v108, v109
    buffer_store_dwordx4 v[100:103], v6, s[8:11], s82 offen offset:0
    s_nop 0
    v_cvt_pk_bf16_f32 v127, v118, v119
    v_cvt_pk_bf16_f32 v124, v112, v113
    v_cvt_pk_bf16_f32 v125, v114, v115
    v_cvt_pk_bf16_f32 v126, v116, v117
    buffer_store_dwordx4 v[124:127], v6, s[8:11], s82 offen offset:1024
    v_mov_b32 v96, 0x3f803f80
    v_mov_b32 v97, 0x3f803f80
    v_mov_b32 v98, 0x3f803f80
    v_mov_b32 v99, 0x3f803f80
    v_mfma_f32_16x16x32_bf16 v[108:111], v[100:103], v[100:103], 0
    v_mfma_f32_16x16x32_bf16 v[108:111], v[124:127], v[124:127], v[108:111]
    v_mfma_f32_16x16x32_bf16 v[104:107], v[96:99], v[100:103], 0
    v_mfma_f32_16x16x32_bf16 v[104:107], v[96:99], v[124:127], v[104:107]
    s_waitcnt vmcnt(4)
    v_bitop3_b32 v4, v43, v47, 1 bitop3:0xa8
    v_cmp_ne_u32 vcc, 0, v4
    s_nop 0
    s_cbranch_vccnz L_retry_67
L_back_68:
    ds_write_b128 v7, v[40:43] offset:16384
    ds_write_b128 v7, v[44:47] offset:17408
    s_waitcnt vmcnt(2)
    v_bitop3_b32 v4, v51, v55, 1 bitop3:0xa8
    v_cmp_ne_u32 vcc, 0, v4
    s_nop 0
    s_cbranch_vccnz L_retry_69
L_back_70:
    ds_write_b128 v7, v[48:51] offset:18432
    ds_write_b128 v7, v[52:55] offset:19456
    s_add_u32 s83, s60, 294912
    v_cndmask_b32 v108, v108, v109, s[44:45]
    v_cndmask_b32 v108, v108, v110, s[46:47]
    v_cndmask_b32 v108, v108, v111, s[48:49]
    v_and_b32 v105, -2, v108
    s_waitcnt vmcnt(0)
    buffer_store_dwordx2 v[104:105], v10, s[8:11], s83 offen
    s_waitcnt lgkmcnt(0)
    s_branch L_join_58
L_retry_71:
    s_add_u32 s84, s66, 65536
    buffer_load_dwordx4 v[24:27], v6, s[8:11], s84 offen offset:0 sc1
    buffer_load_dwordx4 v[28:31], v6, s[8:11], s84 offen offset:1024 sc1
    buffer_load_dwordx4 v[32:35], v6, s[8:11], s84 offen offset:2048 sc1
    buffer_load_dwordx4 v[36:39], v6, s[8:11], s84 offen offset:3072 sc1
    s_sub_u32 s41, s41, 1
    s_cbranch_scc1 L_end
    s_waitcnt vmcnt(0)
    v_bitop3_b32 v4, v27, v31, v35 bitop3:0xfe
    v_bitop3_b32 v4, v4, v39, 1 bitop3:0xa8
    v_cmp_ne_u32 vcc, 0, v4
    s_nop 0
    s_cbranch_vccnz L_retry_71
    s_branch L_back_72
L_retry_73:
    s_add_u32 s87, s66, 69632
    buffer_load_dwordx4 v[40:43], v6, s[8:11], s87 offen offset:0 sc1
    buffer_load_dwordx4 v[44:47], v6, s[8:11], s87 offen offset:1024 sc1
    buffer_load_dwordx4 v[48:51], v6, s[8:11], s87 offen offset:2048 sc1
    buffer_load_dwordx4 v[52:55], v6, s[8:11], s87 offen offset:3072 sc1
    s_sub_u32 s41, s41, 1
    s_cbranch_scc1 L_end
    s_waitcnt vmcnt(0)
    v_bitop3_b32 v4, v43, v47, v51 bitop3:0xfe
    v_bitop3_b32 v4, v4, v55, 1 bitop3:0xa8
    v_cmp_ne_u32 vcc, 0, v4
    s_nop 0
    s_cbranch_vccnz L_retry_73
    s_branch L_back_74
L_retry_75:
    s_add_u32 s88, s66, 73728
    buffer_load_dwordx4 v[56:59], v6, s[8:11], s88 offen offset:0 sc1
    buffer_load_dwordx4 v[60:63], v6, s[8:11], s88 offen offset:1024 sc1
    buffer_load_dwordx4 v[64:67], v6, s[8:11], s88 offen offset:2048 sc1
    buffer_load_dwordx4 v[68:71], v6, s[8:11], s88 offen offset:3072 sc1
    s_sub_u32 s41, s41, 1
    s_cbranch_scc1 L_end
    s_waitcnt vmcnt(0)
    v_bitop3_b32 v4, v59, v63, v67 bitop3:0xfe
    v_bitop3_b32 v4, v4, v71, 1 bitop3:0xa8
    v_cmp_ne_u32 vcc, 0, v4
    s_nop 0
    s_cbranch_vccnz L_retry_75
    s_branch L_back_76
L_retry_77:
    s_add_u32 s89, s66, 77824
    buffer_load_dwordx4 v[24:27], v6, s[8:11], s89 offen offset:0 sc1
    buffer_load_dwordx4 v[28:31], v6, s[8:11], s89 offen offset:1024 sc1
    buffer_load_dwordx4 v[32:35], v6, s[8:11], s89 offen offset:2048 sc1
    buffer_load_dwordx4 v[36:39], v6, s[8:11], s89 offen offset:3072 sc1
    s_sub_u32 s41, s41, 1
    s_cbranch_scc1 L_end
    s_waitcnt vmcnt(0)
    v_bitop3_b32 v4, v27, v31, v35 bitop3:0xfe
    v_bitop3_b32 v4, v4, v39, 1 bitop3:0xa8
    v_cmp_ne_u32 vcc, 0, v4
    s_nop 0
    s_cbranch_vccnz L_retry_77
    s_branch L_back_78
L_retry_79:
    s_add_u32 s73, s60, 49152
    buffer_load_dwordx4 v[40:43], v7, s[8:11], s73 offen offset:0 sc1
    buffer_load_dwordx4 v[44:47], v7, s[8:11], s73 offen offset:1024 sc1
    buffer_load_dwordx4 v[48:51], v7, s[8:11], s73 offen offset:2048 sc1
    buffer_load_dwordx4 v[52:55], v7, s[8:11], s73 offen offset:3072 sc1
    s_sub_u32 s41, s41, 1
    s_cbranch_scc1 L_end
    s_waitcnt vmcnt(0)
    v_bitop3_b32 v4, v43, v47, 1 bitop3:0xa8
    v_cmp_ne_u32 vcc, 0, v4
    s_nop 0
    s_cbranch_vccnz L_retry_79
    s_branch L_back_80
L_retry_81:
    buffer_load_dwordx4 v[48:51], v7, s[8:11], s73 offen offset:2048 sc1
    buffer_load_dwordx4 v[52:55], v7, s[8:11], s73 offen offset:3072 sc1
    s_sub_u32 s41, s41, 1
    s_cbranch_scc1 L_end
    s_waitcnt vmcnt(0)
    v_bitop3_b32 v4, v51, v55, 1 bitop3:0xa8
    v_cmp_ne_u32 vcc, 0, v4
    s_nop 0
    s_cbranch_vccnz L_retry_81
    s_branch L_back_82
L_retry_83:
    s_add_u32 s73, s60, 32768
    buffer_load_dwordx4 v[24:27], v7, s[8:11], s73 offen offset:0 sc1
    buffer_load_dwordx4 v[28:31], v7, s[8:11], s73 offen offset:1024 sc1
    buffer_load_dwordx4 v[32:35], v7, s[8:11], s73 offen offset:2048 sc1
    buffer_load_dwordx4 v[36:39], v7, s[8:11], s73 offen offset:3072 sc1
    s_sub_u32 s41, s41, 1
    s_cbranch_scc1 L_end
    s_waitcnt vmcnt(0)
    v_bitop3_b32 v4, v27, v31, v35 bitop3:0xfe
    v_bitop3_b32 v4, v4, v39, 1 bitop3:0xa8
    v_cmp_ne_u32 vcc, 0, v4
    s_nop 0
    s_cbranch_vccnz L_retry_83
    s_branch L_back_84
L_retry_85:
    s_add_u32 s74, s60, 294912
    s_add_u32 s74, s74, s4
    buffer_load_dwordx4 v[80:83], v6, s[8:11], s74 offen sc1
    s_sub_u32 s41, s41, 1
    s_cbranch_scc1 L_end
    s_waitcnt vmcnt(0)
    v_bitop3_b32 v5, v81, v83, 1 bitop3:0xa8
    v_cmp_ne_u32 vcc, 0, v5
    s_nop 0
    s_cbranch_vccnz L_retry_85
    s_branch L_back_86
L_retry_87:
    s_add_u32 s75, s61, 98304
    buffer_load_dwordx4 v[88:91], v6, s[8:11], s75 offen sc1
    s_sub_u32 s41, s41, 1
    s_cbranch_scc1 L_end
    s_waitcnt vmcnt(0)
    v_cmp_eq_u32 vcc, -1, v91
    s_nop 0
    s_cbranch_vccnz L_retry_87
    s_branch L_back_88
L_retry_91:
    s_add_u32 s81, s66, 65536
    buffer_load_dwordx4 v[24:27], v6, s[8:11], s81 offen offset:0 sc1
    buffer_load_dwordx4 v[28:31], v6, s[8:11], s81 offen offset:1024 sc1
    buffer_load_dwordx4 v[32:35], v6, s[8:11], s81 offen offset:2048 sc1
    buffer_load_dwordx4 v[36:39], v6, s[8:11], s81 offen offset:3072 sc1
    s_sub_u32 s41, s41, 1
    s_cbranch_scc1 L_end
    s_waitcnt vmcnt(0)
    v_bitop3_b32 v4, v27, v31, v35 bitop3:0x80
    v_bitop3_b32 v4, v4, v39, 1 bitop3:0x80
    v_cmp_ne_u32 vcc, 1, v4
    s_nop 0
    s_cbranch_vccnz L_retry_91
    s_branch L_back_92
L_retry_93:
    s_add_u32 s84, s66, 69632
    buffer_load_dwordx4 v[40:43], v6, s[8:11], s84 offen offset:0 sc1
    buffer_load_dwordx4 v[44:47], v6, s[8:11], s84 offen offset:1024 sc1
    buffer_load_dwordx4 v[48:51], v6, s[8:11], s84 offen offset:2048 sc1
    buffer_load_dwordx4 v[52:55], v6, s[8:11], s84 offen offset:3072 sc1
    s_sub_u32 s41, s41, 1
    s_cbranch_scc1 L_end
    s_waitcnt vmcnt(0)
    v_bitop3_b32 v4, v43, v47, v51 bitop3:0x80
    v_bitop3_b32 v4, v4, v55, 1 bitop3:0x80
    v_cmp_ne_u32 vcc, 1, v4
    s_nop 0
    s_cbranch_vccnz L_retry_93
    s_branch L_back_94
L_retry_95:
    s_add_u32 s85, s66, 73728
    buffer_load_dwordx4 v[56:59], v6, s[8:11], s85 offen offset:0 sc1
    buffer_load_dwordx4 v[60:63], v6, s[8:11], s85 offen offset:1024 sc1
    buffer_load_dwordx4 v[64:67], v6, s[8:11], s85 offen offset:2048 sc1
    buffer_load_dwordx4 v[68:71], v6, s[8:11], s85 offen offset:3072 sc1
    s_sub_u32 s41, s41, 1
    s_cbranch_scc1 L_end
    s_waitcnt vmcnt(0)
    v_bitop3_b32 v4, v59, v63, v67 bitop3:0x80
    v_bitop3_b32 v4, v4, v71, 1 bitop3:0x80
    v_cmp_ne_u32 vcc, 1, v4
    s_nop 0
    s_cbranch_vccnz L_retry_95
    s_branch L_back_96
L_retry_97:
    s_add_u32 s86, s66, 77824
    buffer_load_dwordx4 v[24:27], v6, s[8:11], s86 offen offset:0 sc1
    buffer_load_dwordx4 v[28:31], v6, s[8:11], s86 offen offset:1024 sc1
    buffer_load_dwordx4 v[32:35], v6, s[8:11], s86 offen offset:2048 sc1
    buffer_load_dwordx4 v[36:39], v6, s[8:11], s86 offen offset:3072 sc1
    s_sub_u32 s41, s41, 1
    s_cbranch_scc1 L_end
    s_waitcnt vmcnt(0)
    v_bitop3_b32 v4, v27, v31, v35 bitop3:0x80
    v_bitop3_b32 v4, v4, v39, 1 bitop3:0x80
    v_cmp_ne_u32 vcc, 1, v4
    s_nop 0
    s_cbranch_vccnz L_retry_97
    s_branch L_back_98
L_lo_89:
    ds_read_b128 v[72:75], v5 offset:3072
    ds_read_b128 v[76:79], v5 offset:4096
    ds_read_b128 v[88:91], v5 offset:5120
    ds_read_b128 v[92:95], v5 offset:6144
    s_waitcnt vmcnt(0)
    s_add_u32 s79, s66, 65536
    buffer_load_dwordx4 v[24:27], v6, s[8:11], s79 offen offset:0 sc1
    buffer_load_dwordx4 v[28:31], v6, s[8:11], s79 offen offset:1024 sc1
    buffer_load_dwordx4 v[32:35], v6, s[8:11], s79 offen offset:2048 sc1
    buffer_load_dwordx4 v[36:39], v6, s[8:11], s79 offen offset:3072 sc1
    s_add_u32 s80, s66, 69632
    buffer_load_dwordx4 v[40:43], v6, s[8:11], s80 offen offset:0 sc1
    buffer_load_dwordx4 v[44:47], v6, s[8:11], s80 offen offset:1024 sc1
    buffer_load_dwordx4 v[48:51], v6, s[8:11], s80 offen offset:2048 sc1
    buffer_load_dwordx4 v[52:55], v6, s[8:11], s80 offen offset:3072 sc1
    s_waitcnt vmcnt(4)
    v_bitop3_b32 v4, v27, v31, v35 bitop3:0x80
    v_bitop3_b32 v4, v4, v39, 1 bitop3:0x80
    v_cmp_ne_u32 vcc, 1, v4
    s_nop 0
    s_cbranch_vccnz L_retry_91
L_back_92:
    s_waitcnt lgkmcnt(6)
    v_mfma_f32_16x16x32_bf16 v[104:107], v[80:83], v[24:27], v[104:107]
    ds_read_b128 v[100:103], v5 offset:7168
    s_waitcnt lgkmcnt(5)
    v_mfma_f32_16x16x32_bf16 v[108:111], v[84:87], v[24:27], v[108:111]
    ds_read_b128 v[80:83], v5 offset:8192
    s_add_u32 s82, s66, 73728
    v_mfma_f32_16x16x32_bf16 v[112:115], v[96:99], v[24:27], v[112:115]
    ds_read_b128 v[84:87], v5 offset:9216
    s_waitcnt lgkmcnt(5)
    buffer_load_dwordx4 v[56:59], v6, s[8:11], s82 offen offset:0 sc1
    v_mfma_f32_16x16x32_bf16 v[116:119], v[72:75], v[24:27], v[116:119]
    ds_read_b128 v[96:99], v5 offset:10240
    v_mfma_f32_16x16x32_bf16 v[104:107], v[76:79], v[28:31], v[104:107]
    ds_read_b128 v[72:75], v5 offset:11264
    s_waitcnt lgkmcnt(5)
    buffer_load_dwordx4 v[60:63], v6, s[8:11], s82 offen offset:1024 sc1
    v_mfma_f32_16x16x32_bf16 v[108:111], v[88:91], v[28:31], v[108:111]
    ds_read_b128 v[76:79], v5 offset:12288
    v_mfma_f32_16x16x32_bf16 v[112:115], v[92:95], v[28:31], v[112:115]
    ds_read_b128 v[88:91], v5 offset:13312
    s_waitcnt lgkmcnt(5)
    buffer_load_dwordx4 v[64:67], v6, s[8:11], s82 offen offset:2048 sc1
    v_mfma_f32_16x16x32_bf16 v[116:119], v[100:103], v[28:31], v[116:119]
    ds_read_b128 v[92:95], v5 offset:14336
    v_mfma_f32_16x16x32_bf16 v[104:107], v[80:83], v[32:35], v[104:107]
    ds_read_b128 v[100:103], v5 offset:15360
    s_waitcnt lgkmcnt(5)
    buffer_load_dwordx4 v[68:71], v6, s[8:11], s82 offen offset:3072 sc1
    v_mfma_f32_16x16x32_bf16 v[108:111], v[84:87], v[32:35], v[108:111]
    ds_read_b128 v[80:83], v5 offset:16384
    s_waitcnt vmcnt(4)
    v_mfma_f32_16x16x32_bf16 v[112:115], v[96:99], v[32:35], v[112:115]
    ds_read_b128 v[84:87], v5 offset:17408
    s_waitcnt lgkmcnt(5)
    v_mfma_f32_16x16x32_bf16 v[116:119], v[72:75], v[32:35], v[116:119]
    ds_read_b128 v[96:99], v5 offset:18432
    v_bitop3_b32 v4, v43, v47, v51 bitop3:0x80
    v_mfma_f32_16x16x32_bf16 v[104:107], v[76:79], v[36:39], v[104:107]
    ds_read_b128 v[72:75], v5 offset:19456
    s_waitcnt lgkmcnt(5)
    v_mfma_f32_16x16x32_bf16 v[108:111], v[88:91], v[36:39], v[108:111]
    ds_read_b128 v[76:79], v5 offset:20480
    v_bitop3_b32 v4, v4, v55, 1 bitop3:0x80
    v_mfma_f32_16x16x32_bf16 v[112:115], v[92:95], v[36:39], v[112:115]
    ds_read_b128 v[88:91], v5 offset:21504
    s_waitcnt lgkmcnt(5)
    v_mfma_f32_16x16x32_bf16 v[116:119], v[100:103], v[36:39], v[116:119]
    ds_read_b128 v[92:95], v5 offset:22528
    v_cmp_ne_u32 vcc, 1, v4
    s_nop 0
    s_cbranch_vccnz L_retry_93
L_back_94:
    v_mfma_f32_16x16x32_bf16 v[104:107], v[80:83], v[40:43], v[104:107]
    ds_read_b128 v[100:103], v5 offset:23552
    s_waitcnt lgkmcnt(5)
    v_mfma_f32_16x16x32_bf16 v[108:111], v[84:87], v[40:43], v[108:111]
    ds_read_b128 v[80:83], v5 offset:24576
    s_add_u32 s83, s66, 77824
    v_mfma_f32_16x16x32_bf16 v[112:115], v[96:99], v[40:43], v[112:115]
    ds_read_b128 v[84:87], v5 offset:25600
    s_waitcnt lgkmcnt(5)
    buffer_load_dwordx4 v[24:27], v6, s[8:11], s83 offen offset:0 sc1
    v_mfma_f32_16x16x32_bf16 v[116:119], v[72:75], v[40:43], v[116:119]
    ds_read_b128 v[96:99], v5 offset:26624
    v_mfma_f32_16x16x32_bf16 v[104:107], v[76:79], v[44:47], v[104:107]
    ds_read_b128 v[72:75], v5 offset:27648
    s_waitcnt lgkmcnt(5)
    buffer_load_dwordx4 v[28:31], v6, s[8:11], s83 offen offset:1024 sc1
    v_mfma_f32_16x16x32_bf16 v[108:111], v[88:91], v[44:47], v[108:111]
    ds_read_b128 v[76:79], v5 offset:28672
    v_mfma_f32_16x16x32_bf16 v[112:115], v[92:95], v[44:47], v[112:115]
    ds_read_b128 v[88:91], v5 offset:29696
    s_waitcnt lgkmcnt(5)
    buffer_load_dwordx4 v[32:35], v6, s[8:11], s83 offen offset:2048 sc1
    v_mfma_f32_16x16x32_bf16 v[116:119], v[100:103], v[44:47], v[116:119]
    ds_read_b128 v[92:95], v5 offset:30720
    v_mfma_f32_16x16x32_bf16 v[104:107], v[80:83], v[48:51], v[104:107]
    ds_read_b128 v[100:103], v5 offset:31744
    s_waitcnt lgkmcnt(5)
    buffer_load_dwordx4 v[36:39], v6, s[8:11], s83 offen offset:3072 sc1
    v_mfma_f32_16x16x32_bf16 v[108:111], v[84:87], v[48:51], v[108:111]
    ds_read_b128 v[80:83], v5 offset:32768
    v_mfma_f32_16x16x32_bf16 v[112:115], v[96:99], v[48:51], v[112:115]
    ds_read_b128 v[84:87], v5 offset:33792
    s_waitcnt lgkmcnt(5)
    v_mfma_f32_16x16x32_bf16 v[116:119], v[72:75], v[48:51], v[116:119]
    ds_read_b128 v[96:99], v5 offset:34816
    v_mfma_f32_16x16x32_bf16 v[104:107], v[76:79], v[52:55], v[104:107]
    ds_read_b128 v[72:75], v5 offset:35840
    s_waitcnt lgkmcnt(5)
    v_mfma_f32_16x16x32_bf16 v[108:111], v[88:91], v[52:55], v[108:111]
    ds_read_b128 v[76:79], v5 offset:36864
    s_waitcnt vmcnt(4)
    v_mfma_f32_16x16x32_bf16 v[112:115], v[92:95], v[52:55], v[112:115]
    ds_read_b128 v[88:91], v5 offset:37888
    s_waitcnt lgkmcnt(5)
    v_mfma_f32_16x16x32_bf16 v[116:119], v[100:103], v[52:55], v[116:119]
    ds_read_b128 v[92:95], v5 offset:38912
    v_bitop3_b32 v4, v59, v63, v67 bitop3:0x80
    v_bitop3_b32 v4, v4, v71, 1 bitop3:0x80
    v_cmp_ne_u32 vcc, 1, v4
    s_nop 0
    s_cbranch_vccnz L_retry_95
L_back_96:
    v_mfma_f32_16x16x32_bf16 v[104:107], v[80:83], v[56:59], v[104:107]
    ds_read_b128 v[100:103], v5 offset:39936
    s_waitcnt lgkmcnt(5)
    v_mfma_f32_16x16x32_bf16 v[108:111], v[84:87], v[56:59], v[108:111]
    ds_read_b128 v[80:83], v5 offset:40960
    v_mfma_f32_16x16x32_bf16 v[112:115], v[96:99], v[56:59], v[112:115]
    ds_read_b128 v[84:87], v5 offset:41984
    s_waitcnt lgkmcnt(5)
    v_mfma_f32_16x16x32_bf16 v[116:119], v[72:75], v[56:59], v[116:119]
    ds_read_b128 v[96:99], v5 offset:43008
    v_mfma_f32_16x16x32_bf16 v[104:107], v[76:79], v[60:63], v[104:107]
    ds_read_b128 v[72:75], v5 offset:44032
    s_waitcnt lgkmcnt(5)
    v_mfma_f32_16x16x32_bf16 v[108:111], v[88:91], v[60:63], v[108:111]
    ds_read_b128 v[76:79], v5 offset:45056
    v_mfma_f32_16x16x32_bf16 v[112:115], v[92:95], v[60:63], v[112:115]
    ds_read_b128 v[88:91], v5 offset:46080
    s_waitcnt lgkmcnt(5)
    v_mfma_f32_16x16x32_bf16 v[116:119], v[100:103], v[60:63], v[116:119]
    ds_read_b128 v[92:95], v5 offset:47104
    v_mfma_f32_16x16x32_bf16 v[104:107], v[80:83], v[64:67], v[104:107]
    ds_read_b128 v[100:103], v5 offset:48128
    s_waitcnt lgkmcnt(5)
    v_mfma_f32_16x16x32_bf16 v[108:111], v[84:87], v[64:67], v[108:111]
    ds_read_b128 v[80:83], v5 offset:49152
    v_mfma_f32_16x16x32_bf16 v[112:115], v[96:99], v[64:67], v[112:115]
    ds_read_b128 v[84:87], v5 offset:50176
    s_waitcnt lgkmcnt(5)
    v_mfma_f32_16x16x32_bf16 v[116:119], v[72:75], v[64:67], v[116:119]
    ds_read_b128 v[96:99], v5 offset:51200
    v_mfma_f32_16x16x32_bf16 v[104:107], v[76:79], v[68:71], v[104:107]
    ds_read_b128 v[72:75], v5 offset:52224
    s_waitcnt lgkmcnt(5)
    v_mfma_f32_16x16x32_bf16 v[108:111], v[88:91], v[68:71], v[108:111]
    ds_read_b128 v[76:79], v5 offset:53248
    s_waitcnt vmcnt(0)
    v_mfma_f32_16x16x32_bf16 v[112:115], v[92:95], v[68:71], v[112:115]
    ds_read_b128 v[88:91], v5 offset:54272
    s_waitcnt lgkmcnt(5)
    v_mfma_f32_16x16x32_bf16 v[116:119], v[100:103], v[68:71], v[116:119]
    ds_read_b128 v[92:95], v5 offset:55296
    v_bitop3_b32 v4, v27, v31, v35 bitop3:0x80
    v_bitop3_b32 v4, v4, v39, 1 bitop3:0x80
    v_cmp_ne_u32 vcc, 1, v4
    s_nop 0
    s_cbranch_vccnz L_retry_97
L_back_98:
    v_mfma_f32_16x16x32_bf16 v[104:107], v[80:83], v[24:27], v[104:107]
    ds_read_b128 v[100:103], v5 offset:56320
    s_waitcnt lgkmcnt(5)
    v_mfma_f32_16x16x32_bf16 v[108:111], v[84:87], v[24:27], v[108:111]
    ds_read_b128 v[80:83], v5 offset:57344
    v_mfma_f32_16x16x32_bf16 v[112:115], v[96:99], v[24:27], v[112:115]
    ds_read_b128 v[84:87], v5 offset:58368
    s_waitcnt lgkmcnt(5)
    v_mfma_f32_16x16x32_bf16 v[116:119], v[72:75], v[24:27], v[116:119]
    ds_read_b128 v[96:99], v5 offset:61440
    v_mfma_f32_16x16x32_bf16 v[104:107], v[76:79], v[28:31], v[104:107]
    ds_read_b128 v[72:75], v5 offset:62464
    s_waitcnt lgkmcnt(5)
    v_mfma_f32_16x16x32_bf16 v[108:111], v[88:91], v[28:31], v[108:111]
    ds_read_b128 v[76:79], v5 offset:59392
    v_mfma_f32_16x16x32_bf16 v[112:115], v[92:95], v[28:31], v[112:115]
    ds_read_b128 v[88:91], v5 offset:60416
    s_waitcnt lgkmcnt(5)
    v_mfma_f32_16x16x32_bf16 v[116:119], v[100:103], v[28:31], v[116:119]
    ds_read_b128 v[92:95], v5 offset:63488
    v_mfma_f32_16x16x32_bf16 v[104:107], v[80:83], v[32:35], v[104:107]
    ds_read_b128 v[100:103], v5 offset:64512
    s_waitcnt lgkmcnt(5)
    v_mfma_f32_16x16x32_bf16 v[108:111], v[84:87], v[32:35], v[108:111]
    v_mfma_f32_16x16x32_bf16 v[104:107], v[96:99], v[36:39], v[104:107]
    s_waitcnt lgkmcnt(3)
    v_mfma_f32_16x16x32_bf16 v[108:111], v[72:75], v[36:39], v[108:111]
    v_mfma_f32_16x16x32_bf16 v[112:115], v[76:79], v[32:35], v[112:115]
    s_waitcnt lgkmcnt(1)
    v_mfma_f32_16x16x32_bf16 v[116:119], v[88:91], v[32:35], v[116:119]
    v_mfma_f32_16x16x32_bf16 v[112:115], v[92:95], v[36:39], v[112:115]
    s_waitcnt lgkmcnt(0)
    v_mfma_f32_16x16x32_bf16 v[116:119], v[100:103], v[36:39], v[116:119]
    s_nop 1
    v_cvt_pk_bf16_f32 v103, v110, v111
    v_cvt_pk_bf16_f32 v100, v104, v105
    v_cvt_pk_bf16_f32 v101, v106, v107
    v_cvt_pk_bf16_f32 v102, v108, v109
    buffer_store_dwordx4 v[100:103], v11, s[12:15], 0 offen offset:0
    s_nop 0
    v_cvt_pk_bf16_f32 v127, v118, v119
    v_cvt_pk_bf16_f32 v124, v112, v113
    v_cvt_pk_bf16_f32 v125, v114, v115
    v_cvt_pk_bf16_f32 v126, v116, v117
    buffer_store_dwordx4 v[124:127], v11, s[12:15], 0 offen offset:64
    s_or_b32 s72, s2, s36
    s_cbranch_scc1 L_end
    v_mov_b32 v0, s5
    s_mov_b32 s72, 540672
    s_mov_b64 exec, 1
    buffer_store_dword v0, v6, s[8:11], s72 offen sc1
    s_endpgm
L_retry_99:
    s_add_u32 s88, s66, 65536
    buffer_load_dwordx4 v[24:27], v6, s[8:11], s88 offen offset:0 sc1
    buffer_load_dwordx4 v[28:31], v6, s[8:11], s88 offen offset:1024 sc1
    buffer_load_dwordx4 v[32:35], v6, s[8:11], s88 offen offset:2048 sc1
    buffer_load_dwordx4 v[36:39], v6, s[8:11], s88 offen offset:3072 sc1
    s_sub_u32 s41, s41, 1
    s_cbranch_scc1 L_end
    s_waitcnt vmcnt(0)
    v_bitop3_b32 v4, v27, v31, v35 bitop3:0x80
    v_bitop3_b32 v4, v4, v39, 1 bitop3:0x80
    v_cmp_ne_u32 vcc, 1, v4
    s_nop 0
    s_cbranch_vccnz L_retry_99
    s_branch L_back_100
L_retry_101:
    s_add_u32 s95, s66, 69632
    buffer_load_dwordx4 v[40:43], v6, s[8:11], s95 offen offset:0 sc1
    buffer_load_dwordx4 v[44:47], v6, s[8:11], s95 offen offset:1024 sc1
    buffer_load_dwordx4 v[48:51], v6, s[8:11], s95 offen offset:2048 sc1
    buffer_load_dwordx4 v[52:55], v6, s[8:11], s95 offen offset:3072 sc1
    s_sub_u32 s41, s41, 1
    s_cbranch_scc1 L_end
    s_waitcnt vmcnt(0)
    v_bitop3_b32 v4, v43, v47, v51 bitop3:0x80
    v_bitop3_b32 v4, v4, v55, 1 bitop3:0x80
    v_cmp_ne_u32 vcc, 1, v4
    s_nop 0
    s_cbranch_vccnz L_retry_101
    s_branch L_back_102
L_retry_103:
    s_add_u32 s96, s66, 73728
    buffer_load_dwordx4 v[56:59], v6, s[8:11], s96 offen offset:0 sc1
    buffer_load_dwordx4 v[60:63], v6, s[8:11], s96 offen offset:1024 sc1
    buffer_load_dwordx4 v[64:67], v6, s[8:11], s96 offen offset:2048 sc1
    buffer_load_dwordx4 v[68:71], v6, s[8:11], s96 offen offset:3072 sc1
    s_sub_u32 s41, s41, 1
    s_cbranch_scc1 L_end
    s_waitcnt vmcnt(0)
    v_bitop3_b32 v4, v59, v63, v67 bitop3:0x80
    v_bitop3_b32 v4, v4, v71, 1 bitop3:0x80
    v_cmp_ne_u32 vcc, 1, v4
    s_nop 0
    s_cbranch_vccnz L_retry_103
    s_branch L_back_104
L_retry_105:
    s_add_u32 s97, s66, 77824
    buffer_load_dwordx4 v[24:27], v6, s[8:11], s97 offen offset:0 sc1
    buffer_load_dwordx4 v[28:31], v6, s[8:11], s97 offen offset:1024 sc1
    buffer_load_dwordx4 v[32:35], v6, s[8:11], s97 offen offset:2048 sc1
    buffer_load_dwordx4 v[36:39], v6, s[8:11], s97 offen offset:3072 sc1
    s_sub_u32 s41, s41, 1
    s_cbranch_scc1 L_end
    s_waitcnt vmcnt(0)
    v_bitop3_b32 v4, v27, v31, v35 bitop3:0x80
    v_bitop3_b32 v4, v4, v39, 1 bitop3:0x80
    v_cmp_ne_u32 vcc, 1, v4
    s_nop 0
    s_cbranch_vccnz L_retry_105
    s_branch L_back_106
L_slow:
    s_add_u32 s76, s40, 2
    s_and_b32 s76, s76, 15
    s_mul_i32 s76, s76, 98304
    s_add_u32 m0, s59, 122880
    s_nop 0
    buffer_load_dwordx4 v0, s[20:23], s76 offen offset:0 lds
    s_waitcnt lgkmcnt(6)
    v_fmac_f32_dpp v168, v13, v189 row_newbcast:0 row_mask:0xf bank_mask:0xf
    v_fmac_f32_dpp v169, v13, v189 row_newbcast:1 row_mask:0xf bank_mask:0xf
    v_fmac_f32_dpp v170, v13, v189 row_newbcast:2 row_mask:0xf bank_mask:0xf
    v_fmac_f32_dpp v171, v13, v189 row_newbcast:3 row_mask:0xf bank_mask:0xf
    v_mul_f32 v168, v188, v168
    v_mul_f32 v169, v188, v169
    v_mul_f32 v170, v188, v170
    v_mul_f32 v171, v188, v171
    v_cvt_pk_bf16_f32 v72, v168, v169
    v_cvt_pk_bf16_f32 v73, v170, v171
    v_fmac_f32_dpp v164, v12, v189 row_newbcast:0 row_mask:0xf bank_mask:0xf
    v_fmac_f32_dpp v165, v12, v189 row_newbcast:1 row_mask:0xf bank_mask:0xf
    v_fmac_f32_dpp v166, v12, v189 row_newbcast:2 row_mask:0xf bank_mask:0xf
    v_fmac_f32_dpp v167, v12, v189 row_newbcast:3 row_mask:0xf bank_mask:0xf
    v_cvt_pk_bf16_f32 v222, v164, v165
    v_cvt_pk_bf16_f32 v223, v166, v167
    buffer_load_dwordx4 v0, s[20:23], s76 offen offset:1024 lds
    v_mul_f32 v247, s43, v188
    v_fmac_f32_dpp v172, v191, v120 row_newbcast:0 row_mask:0xf bank_mask:0xf
    v_fmac_f32_dpp v173, v191, v120 row_newbcast:1 row_mask:0xf bank_mask:0xf
    v_fmac_f32_dpp v174, v191, v120 row_newbcast:2 row_mask:0xf bank_mask:0xf
    v_fmac_f32_dpp v175, v191, v120 row_newbcast:3 row_mask:0xf bank_mask:0xf
    v_mul_f32_dpp v172, v190, v172 row_newbcast:0 row_mask:0xf bank_mask:0xf
    v_mul_f32_dpp v173, v190, v173 row_newbcast:1 row_mask:0xf bank_mask:0xf
    v_mul_f32_dpp v174, v190, v174 row_newbcast:2 row_mask:0xf bank_mask:0xf
    v_mul_f32_dpp v175, v190, v175 row_newbcast:3 row_mask:0xf bank_mask:0xf
    v_cvt_pk_bf16_f32 v94, v172, v173
    v_cvt_pk_bf16_f32 v95, v174, v175
    v_mov_b32 v78, v94
    v_mov_b32 v79, v95
    s_waitcnt vmcnt(25)
    s_add_u32 s73, s62, 0x20000
    s_mov_b32 exec_lo, 0xff00ff00
    s_mov_b32 exec_hi, 0xff00ff00
    buffer_store_dwordx4 v[72:75], v6, s[8:11], s62 offen sc1
    s_mov_b32 exec_lo, 0
    s_mov_b32 exec_hi, -1
    buffer_store_dwordx4 v[76:79], v6, s[8:11], s73 offen sc1
    s_mov_b32 exec_lo, -1
    buffer_load_dwordx4 v0, s[20:23], s76 offen offset:2048 lds
    s_add_u32 s76, s40, 3
    s_and_b32 s76, s76, 15
    s_mul_i32 s76, s76, 98304
    s_add_u32 m0, s59, 135168
    s_waitcnt vmcnt(24)
    ds_read_b64_tr_b16 v[24:25], v97 offset:49152
    s_add_u32 s99, s63, 0
    buffer_load_dword v96, v9, s[8:11], s99 offen sc1
    s_waitcnt lgkmcnt(5)
    ds_read_b64_tr_b16 v[26:27], v97 offset:49664
    v_fmac_f32_dpp v156, v13, v185 row_newbcast:0 row_mask:0xf bank_mask:0xf
    v_fmac_f32_dpp v157, v13, v185 row_newbcast:1 row_mask:0xf bank_mask:0xf
    v_fmac_f32_dpp v158, v13, v185 row_newbcast:2 row_mask:0xf bank_mask:0xf
    v_fmac_f32_dpp v159, v13, v185 row_newbcast:3 row_mask:0xf bank_mask:0xf
    ds_read_b64_tr_b16 v[28:29], v97 offset:49160
    v_mul_f32 v156, v184, v156
    v_mul_f32 v157, v184, v157
    v_mul_f32 v158, v184, v158
    v_mul_f32 v159, v184, v159
    ds_read_b64_tr_b16 v[30:31], v97 offset:49672
    v_cvt_pk_bf16_f32 v228, v156, v157
    v_cvt_pk_bf16_f32 v229, v158, v159
    v_fmac_f32_dpp v152, v12, v185 row_newbcast:0 row_mask:0xf bank_mask:0xf
    buffer_load_dwordx4 v0, s[20:23], s76 offen offset:0 lds
    ds_read_b64_tr_b16 v[32:33], v98 offset:49152
    v_mfma_f32_16x16x16_bf16 v[168:171], v[228:229], v[222:223], v[16:19]
    s_waitcnt lgkmcnt(7)
    v_fmac_f32_dpp v153, v12, v185 row_newbcast:1 row_mask:0xf bank_mask:0xf
    v_fmac_f32_dpp v154, v12, v185 row_newbcast:2 row_mask:0xf bank_mask:0xf
    ds_read_b64_tr_b16 v[34:35], v98 offset:49664
    v_mfma_f32_16x16x16_bf16 v[164:167], v[72:73], v[222:223], v[16:19]
    s_waitcnt lgkmcnt(6)
    v_fmac_f32_dpp v155, v12, v185 row_newbcast:3 row_mask:0xf bank_mask:0xf
    v_cvt_pk_bf16_f32 v220, v152, v153
    ds_read_b64_tr_b16 v[36:37], v98 offset:49160
    v_cvt_pk_bf16_f32 v221, v154, v155
    v_mul_f32 v246, s43, v184
    v_fmac_f32_dpp v160, v187, v120 row_newbcast:0 row_mask:0xf bank_mask:0xf
    v_fmac_f32_dpp v161, v187, v120 row_newbcast:1 row_mask:0xf bank_mask:0xf
    buffer_load_dwordx4 v0, s[20:23], s76 offen offset:1024 lds
    ds_read_b64_tr_b16 v[38:39], v98 offset:49672
    v_fmac_f32_dpp v162, v187, v120 row_newbcast:2 row_mask:0xf bank_mask:0xf
    v_fmac_f32_dpp v163, v187, v120 row_newbcast:3 row_mask:0xf bank_mask:0xf
    v_mul_f32_dpp v160, v186, v160 row_newbcast:0 row_mask:0xf bank_mask:0xf
    v_mul_f32_dpp v161, v186, v161 row_newbcast:1 row_mask:0xf bank_mask:0xf
    v_mul_f32_dpp v162, v186, v162 row_newbcast:2 row_mask:0xf bank_mask:0xf
    v_mul_f32_dpp v163, v186, v163 row_newbcast:3 row_mask:0xf bank_mask:0xf
    v_cvt_pk_bf16_f32 v92, v160, v161
    v_cvt_pk_bf16_f32 v93, v162, v163
    v_cndmask_b32 v164, v168, v164, s[28:29]
    v_cndmask_b32 v165, v169, v165, s[30:31]
    v_cndmask_b32 v166, v170, v166, s[32:33]
    v_cndmask_b32 v167, v171, v167, s[34:35]
    v_max3_f32 v168, v164, v165, v166
    v_max_f32 v169, v168, v167
    v_max_f32 v168, v168, v167
    v_fmac_f32_dpp v144, v13, v181 row_newbcast:0 row_mask:0xf bank_mask:0xf
    v_fmac_f32_dpp v145, v13, v181 row_newbcast:1 row_mask:0xf bank_mask:0xf
    buffer_load_dwordx4 v0, s[20:23], s76 offen offset:2048 lds
    s_add_u32 s76, s40, 4
    s_and_b32 s76, s76, 15
    s_mul_i32 s76, s76, 98304
    s_add_u32 m0, s59, 147456
    s_waitcnt lgkmcnt(0)
    ds_write_b128 v99, v[24:27] offset:49152
    v_permlane32_swap_b32 v168, v169
    v_max_f32 v170, v168, v169
    v_max_f32 v168, v168, v169
    v_fmac_f32_dpp v146, v13, v181 row_newbcast:2 row_mask:0xf bank_mask:0xf
    v_fmac_f32_dpp v147, v13, v181 row_newbcast:3 row_mask:0xf bank_mask:0xf
    v_permlane16_swap_b32 v168, v170
    buffer_load_dwordx4 v0, s[20:23], s76 offen offset:0 lds
    ds_write_b128 v99, v[28:31] offset:50176
    v_max_f32 v168, v168, v170
    v_mul_f32 v168, -v168, v247
    v_fma_f32 v164, v164, v247, v168
    v_fma_f32 v165, v165, v247, v168
    v_fma_f32 v166, v166, v247, v168
    v_fma_f32 v167, v167, v247, v168
    v_exp_f32 v164, v164
    ds_write_b128 v99, v[32:35] offset:51200
    buffer_load_dwordx4 v0, s[20:23], s76 offen offset:1024 lds
    v_exp_f32 v165, v165
    v_exp_f32 v166, v166
    v_exp_f32 v167, v167
    ds_write_b128 v99, v[36:39] offset:52224
    s_waitcnt vmcnt(26)
    ds_read_b64_tr_b16 v[40:41], v97 offset:32768
    v_cvt_pk_bf16_f32 v248, v164, v165
    v_cvt_pk_bf16_f32 v249, v166, v167
    v_and_b32 v170, v248, v20
    buffer_load_dwordx4 v0, s[20:23], s76 offen offset:2048 lds
    ds_read_b64_tr_b16 v[42:43], v97 offset:33280
    s_add_u32 s76, s40, 5
    s_and_b32 s76, s76, 15
    s_mul_i32 s76, s76, 98304
    s_add_u32 m0, s59, 12288
    ds_read_b64_tr_b16 v[44:45], v97 offset:32776
    v_and_b32 v171, v249, v21
    v_mfma_f32_16x16x16_bf16 v[164:167], v[22:23], v[248:249], 0
    s_add_u32 s73, s61, 0x20000
    s_mov_b32 exec_lo, 0xff00ff00
    s_mov_b32 exec_hi, 0xff00ff00
    buffer_load_dwordx4 v[80:83], v6, s[8:11], s61 offen sc1
    s_mov_b32 exec_lo, 0
    s_mov_b32 exec_hi, -1
    buffer_load_dwordx4 v[84:87], v6, s[8:11], s73 offen sc1
    s_mov_b32 exec_lo, -1
    ds_read_b64_tr_b16 v[46:47], v97 offset:33288
    buffer_load_dwordx4 v0, s[20:23], s76 offen offset:0 lds
    v_xor_b32 v168, v248, v170
    v_xor_b32 v169, v249, v171
    ds_read_b64_tr_b16 v[48:49], v98 offset:32768
    v_mul_f32 v144, v180, v144
    v_mfma_f32_16x16x32_bf16 v[172:175], v[92:95], v[168:171], 0
    v_rcp_f32 v164, v164
    ds_read_b64_tr_b16 v[50:51], v98 offset:33280
    v_mul_f32 v145, v180, v145
    v_mul_f32 v146, v180, v146
    v_mul_f32 v147, v180, v147
    v_cvt_pk_bf16_f32 v226, v144, v145
    ds_read_b64_tr_b16 v[52:53], v98 offset:32776
    buffer_load_dwordx4 v0, s[20:23], s76 offen offset:1024 lds
    v_mul_f32 v172, v164, v172
    v_mul_f32 v173, v164, v173
    ds_read_b64_tr_b16 v[54:55], v98 offset:33288
    v_mul_f32 v174, v164, v174
    v_mul_f32 v175, v164, v175
    v_cvt_pk_bf16_f32 v249, v174, v175
    v_cvt_pk_bf16_f32 v248, v172, v173
    v_cvt_pk_bf16_f32 v227, v146, v147
    v_fmac_f32_dpp v140, v12, v181 row_newbcast:0 row_mask:0xf bank_mask:0xf
    v_fmac_f32_dpp v141, v12, v181 row_newbcast:1 row_mask:0xf bank_mask:0xf
    v_mfma_f32_16x16x16_bf16 v[156:159], v[226:227], v[220:221], v[16:19]
    v_fmac_f32_dpp v142, v12, v181 row_newbcast:2 row_mask:0xf bank_mask:0xf
    v_fmac_f32_dpp v143, v12, v181 row_newbcast:3 row_mask:0xf bank_mask:0xf
    v_mfma_f32_16x16x16_bf16 v[152:155], v[228:229], v[220:221], v[16:19]
    v_cvt_pk_bf16_f32 v218, v140, v141
    v_cvt_pk_bf16_f32 v219, v142, v143
    buffer_load_dwordx4 v0, s[20:23], s76 offen offset:2048 lds
    s_add_u32 s76, s40, 6
    s_and_b32 s76, s76, 15
    s_mul_i32 s76, s76, 98304
    s_add_u32 m0, s59, 0
    v_mul_f32 v245, s43, v180
    v_fmac_f32_dpp v148, v183, v120 row_newbcast:0 row_mask:0xf bank_mask:0xf
    s_waitcnt lgkmcnt(0)
    ds_write_b128 v99, v[40:43] offset:32768
    v_fmac_f32_dpp v149, v183, v120 row_newbcast:1 row_mask:0xf bank_mask:0xf
    v_fmac_f32_dpp v150, v183, v120 row_newbcast:2 row_mask:0xf bank_mask:0xf
    v_fmac_f32_dpp v151, v183, v120 row_newbcast:3 row_mask:0xf bank_mask:0xf
    v_mul_f32_dpp v148, v182, v148 row_newbcast:0 row_mask:0xf bank_mask:0xf
    v_mul_f32_dpp v149, v182, v149 row_newbcast:1 row_mask:0xf bank_mask:0xf
    v_mul_f32_dpp v150, v182, v150 row_newbcast:2 row_mask:0xf bank_mask:0xf
    buffer_load_dwordx4 v0, s[20:23], s76 offen offset:0 lds
    ds_write_b128 v99, v[44:47] offset:33792
    v_mul_f32_dpp v151, v182, v151 row_newbcast:3 row_mask:0xf bank_mask:0xf
    v_cvt_pk_bf16_f32 v90, v148, v149
    v_cvt_pk_bf16_f32 v91, v150, v151
    v_cndmask_b32 v152, v156, v152, s[28:29]
    v_cndmask_b32 v153, v157, v153, s[30:31]
    v_cndmask_b32 v154, v158, v154, s[32:33]
    v_cndmask_b32 v155, v159, v155, s[34:35]
    v_max3_f32 v156, v152, v153, v154
    ds_write_b128 v99, v[48:51] offset:34816
    buffer_load_dwordx4 v0, s[20:23], s76 offen offset:1024 lds
    v_max_f32 v157, v156, v155
    v_max_f32 v156, v156, v155
    v_fmac_f32_dpp v132, v13, v177 row_newbcast:0 row_mask:0xf bank_mask:0xf
    v_fmac_f32_dpp v133, v13, v177 row_newbcast:1 row_mask:0xf bank_mask:0xf
    v_permlane32_swap_b32 v156, v157
    ds_write_b128 v99, v[52:55] offset:35840
    s_waitcnt vmcnt(30)
    ds_read_b64_tr_b16 v[24:25], v97 offset:16384
    v_max_f32 v158, v156, v157
    v_max_f32 v156, v156, v157
    v_fmac_f32_dpp v134, v13, v177 row_newbcast:2 row_mask:0xf bank_mask:0xf
    buffer_load_dwordx4 v0, s[20:23], s76 offen offset:2048 lds
    ds_read_b64_tr_b16 v[26:27], v97 offset:16896
    v_permlane16_swap_b32 v156, v158
    v_max_f32 v156, v156, v158
    v_mul_f32 v156, -v156, v246
    ds_read_b64_tr_b16 v[28:29], v97 offset:16392
    v_fma_f32 v152, v152, v246, v156
    v_fma_f32 v153, v153, v246, v156
    v_fma_f32 v154, v154, v246, v156
    v_fma_f32 v155, v155, v246, v156
    ds_read_b64_tr_b16 v[30:31], v97 offset:16904
    v_exp_f32 v152, v152
    v_exp_f32 v153, v153
    ds_read_b64_tr_b16 v[32:33], v98 offset:16384
    v_exp_f32 v154, v154
    v_exp_f32 v155, v155
    ds_read_b64_tr_b16 v[34:35], v98 offset:16896
    v_cvt_pk_bf16_f32 v250, v152, v153
    v_cvt_pk_bf16_f32 v251, v154, v155
    v_and_b32 v158, v250, v20
    v_and_b32 v159, v251, v21
    ds_read_b64_tr_b16 v[36:37], v98 offset:16392
    v_mfma_f32_16x16x16_bf16 v[152:155], v[22:23], v[250:251], 0
    s_waitcnt vmcnt(6)
    v_xor_b32 v156, v250, v158
    v_xor_b32 v157, v251, v159
    ds_read_b64_tr_b16 v[38:39], v98 offset:16904
    s_add_u32 s101, s65, 98304
    v_mfma_f32_16x16x32_bf16 v[160:163], v[90:93], v[156:159], 0
    v_fmac_f32_dpp v135, v13, v177 row_newbcast:3 row_mask:0xf bank_mask:0xf
    v_mul_f32 v132, v176, v132
    v_rcp_f32 v152, v152
    v_mul_f32 v133, v176, v133
    v_mul_f32 v134, v176, v134
    v_mul_f32 v135, v176, v135
    v_cvt_pk_bf16_f32 v224, v132, v133
    v_cvt_pk_bf16_f32 v225, v134, v135
    v_mul_f32 v160, v152, v160
    v_mul_f32 v161, v152, v161
    v_mfma_f32_16x16x16_bf16 v[144:147], v[224:225], v[218:219], v[16:19]
    v_mul_f32 v162, v152, v162
    v_mul_f32 v163, v152, v163
    v_mfma_f32_16x16x16_bf16 v[140:143], v[226:227], v[218:219], v[16:19]
    v_cvt_pk_bf16_f32 v251, v162, v163
    v_cvt_pk_bf16_f32 v250, v160, v161
    v_fmac_f32_dpp v128, v12, v177 row_newbcast:0 row_mask:0xf bank_mask:0xf
    s_waitcnt lgkmcnt(0)
    ds_write_b128 v99, v[24:27] offset:16384
    v_permlane16_swap_b32 v249, v251
    v_permlane16_swap_b32 v248, v250
    v_and_b32 v251, -2, v251
    buffer_store_dwordx4 v[248:251], v8, s[8:11], s101 offen sc1
    ds_write_b128 v99, v[28:31] offset:17408
    s_waitcnt vmcnt(27)
    s_mov_b64 exec, 1
    buffer_store_dwordx2 v[60:61], v6, s[8:11], s93 offen sc1
    s_mov_b64 exec, -1
    ds_write_b128 v99, v[32:35] offset:18432
    v_fmac_f32_dpp v129, v12, v177 row_newbcast:1 row_mask:0xf bank_mask:0xf
    v_fmac_f32_dpp v130, v12, v177 row_newbcast:2 row_mask:0xf bank_mask:0xf
    v_fmac_f32_dpp v131, v12, v177 row_newbcast:3 row_mask:0xf bank_mask:0xf
    v_cvt_pk_bf16_f32 v216, v128, v129
    v_cvt_pk_bf16_f32 v217, v130, v131
    v_mul_f32 v244, s43, v176
    v_fmac_f32_dpp v136, v179, v120 row_newbcast:0 row_mask:0xf bank_mask:0xf
    v_fmac_f32_dpp v137, v179, v120 row_newbcast:1 row_mask:0xf bank_mask:0xf
    ds_write_b128 v99, v[36:39] offset:19456
    s_waitcnt vmcnt(29)
    ds_read_b64_tr_b16 v[40:41], v97 offset:0
    v_fmac_f32_dpp v138, v179, v120 row_newbcast:2 row_mask:0xf bank_mask:0xf
    v_fmac_f32_dpp v139, v179, v120 row_newbcast:3 row_mask:0xf bank_mask:0xf
    v_mul_f32_dpp v136, v178, v136 row_newbcast:0 row_mask:0xf bank_mask:0xf
    v_mul_f32_dpp v137, v178, v137 row_newbcast:1 row_mask:0xf bank_mask:0xf
    ds_read_b64_tr_b16 v[42:43], v97 offset:512
    v_mul_f32_dpp v138, v178, v138 row_newbcast:2 row_mask:0xf bank_mask:0xf
    v_mul_f32_dpp v139, v178, v139 row_newbcast:3 row_mask:0xf bank_mask:0xf
    v_cvt_pk_bf16_f32 v88, v136, v137
    v_cvt_pk_bf16_f32 v89, v138, v139
    ds_read_b64_tr_b16 v[44:45], v97 offset:8
    v_cndmask_b32 v140, v144, v140, s[28:29]
    v_cndmask_b32 v141, v145, v141, s[30:31]
    v_cndmask_b32 v142, v146, v142, s[32:33]
    v_cndmask_b32 v143, v147, v143, s[34:35]
    ds_read_b64_tr_b16 v[46:47], v97 offset:520
    v_max3_f32 v144, v140, v141, v142
    v_max_f32 v145, v144, v143
    v_max_f32 v144, v144, v143
    v_xor_b32 v4, v82, v74
    ds_read_b64_tr_b16 v[48:49], v98 offset:0
    v_permlane32_swap_b32 v144, v145
    v_max_f32 v146, v144, v145
    v_max_f32 v144, v144, v145
    ds_read_b64_tr_b16 v[50:51], v98 offset:512
    v_xor_b32 v3, v84, v74
    v_permlane16_swap_b32 v144, v146
    v_max_f32 v144, v144, v146
    ds_read_b64_tr_b16 v[52:53], v98 offset:8
    v_mul_f32 v144, -v144, v245
    v_fma_f32 v140, v140, v245, v144
    v_fma_f32 v141, v141, v245, v144
    v_fma_f32 v142, v142, v245, v144
    ds_read_b64_tr_b16 v[54:55], v98 offset:520
    v_fma_f32 v143, v143, v245, v144
    v_exp_f32 v140, v140
    v_exp_f32 v141, v141
    v_exp_f32 v142, v142
    v_exp_f32 v143, v143
    v_cvt_pk_bf16_f32 v252, v140, v141
    v_cvt_pk_bf16_f32 v253, v142, v143
    v_and_b32 v146, v252, v20
    v_and_b32 v147, v253, v21
    v_mfma_f32_16x16x16_bf16 v[140:143], v[22:23], v[252:253], 0
    v_xor_b32 v144, v252, v146
    v_xor_b32 v145, v253, v147
    v_or_b32 v4, v4, v3
    v_cmp_ne_u32 vcc, 0, v4
    v_mfma_f32_16x16x32_bf16 v[148:151], v[88:91], v[144:147], 0
    s_cbranch_vccnz L_retry_107
L_back_108:
    v_add_f32 v132, s42, v16
    s_waitcnt lgkmcnt(0)
    ds_write_b128 v99, v[40:43] offset:0
    v_rcp_f32 v140, v140
    v_add_f32 v133, s42, v17
    v_add_f32 v134, s42, v18
    v_add_f32 v135, s42, v19
    v_mfma_f32_16x16x16_bf16 v[128:131], v[224:225], v[216:217], v[16:19]
    v_mul_f32 v148, v140, v148
    ds_write_b128 v99, v[44:47] offset:1024
    v_mfma_f32_16x16x16_bf16 v[132:135], v[80:81], v[216:217], v[132:135]
    v_mul_f32 v149, v140, v149
    v_mul_f32 v150, v140, v150
    v_mul_f32 v151, v140, v151
    v_cvt_pk_bf16_f32 v253, v150, v151
    v_cvt_pk_bf16_f32 v252, v148, v149
    ds_write_b128 v99, v[48:51] offset:2048
    s_nop 1
    v_cndmask_b32 v128, v132, v128, s[28:29]
    v_cndmask_b32 v129, v133, v129, s[30:31]
    v_cndmask_b32 v130, v134, v130, s[32:33]
    v_cndmask_b32 v131, v135, v131, s[34:35]
    v_max3_f32 v132, v128, v129, v130
    v_max_f32 v133, v132, v131
    ds_write_b128 v99, v[52:55] offset:3072
    v_max_f32 v132, v132, v131
    s_nop 1
    v_permlane32_swap_b32 v132, v133
    v_max_f32 v134, v132, v133
    v_max_f32 v132, v132, v133
    s_nop 1
    v_permlane16_swap_b32 v132, v134
    v_max_f32 v132, v132, v134
    v_mul_f32 v132, -v132, v244
    v_fma_f32 v128, v128, v244, v132
    v_fma_f32 v129, v129, v244, v132
    v_fma_f32 v130, v130, v244, v132
    v_fma_f32 v131, v131, v244, v132
    v_exp_f32 v128, v128
    v_exp_f32 v129, v129
    v_exp_f32 v130, v130
    v_exp_f32 v131, v131
    v_cvt_pk_bf16_f32 v254, v128, v129
    v_cvt_pk_bf16_f32 v255, v130, v131
    v_and_b32 v134, v254, v20
    v_and_b32 v135, v255, v21
    v_mfma_f32_16x16x16_bf16 v[128:131], v[22:23], v[254:255], 0
    v_xor_b32 v132, v254, v134
    v_xor_b32 v133, v255, v135
    s_add_u32 s79, s65, 65536
    s_nop 0
    v_mfma_f32_16x16x32_bf16 v[136:139], v[86:89], v[132:135], 0
    s_nop 2
    v_rcp_f32 v128, v128
    s_nop 3
    v_mul_f32 v136, v128, v136
    v_mul_f32 v137, v128, v137
    v_mul_f32 v138, v128, v138
    v_mul_f32 v139, v128, v139
    v_cvt_pk_bf16_f32 v255, v138, v139
    v_cvt_pk_bf16_f32 v254, v136, v137
    s_nop 0
    v_permlane16_swap_b32 v253, v255
    v_permlane16_swap_b32 v252, v254
    v_and_b32 v255, -2, v255
    buffer_store_dwordx4 v[252:255], v8, s[8:11], s79 offen sc1
    s_waitcnt lgkmcnt(0)
    s_add_u32 s80, s66, 65536
    buffer_load_dwordx4 v[24:27], v6, s[8:11], s80 offen offset:0 sc1
    buffer_load_dwordx4 v[28:31], v6, s[8:11], s80 offen offset:1024 sc1
    buffer_load_dwordx4 v[32:35], v6, s[8:11], s80 offen offset:2048 sc1
    buffer_load_dwordx4 v[36:39], v6, s[8:11], s80 offen offset:3072 sc1
    s_add_u32 s81, s66, 69632
    buffer_load_dwordx4 v[40:43], v6, s[8:11], s81 offen offset:0 sc1
    buffer_load_dwordx4 v[44:47], v6, s[8:11], s81 offen offset:1024 sc1
    buffer_load_dwordx4 v[48:51], v6, s[8:11], s81 offen offset:2048 sc1
    buffer_load_dwordx4 v[52:55], v6, s[8:11], s81 offen offset:3072 sc1
    s_add_u32 s82, s66, 73728
    buffer_load_dwordx4 v[56:59], v6, s[8:11], s82 offen offset:0 sc1
    buffer_load_dwordx4 v[60:63], v6, s[8:11], s82 offen offset:1024 sc1
    buffer_load_dwordx4 v[64:67], v6, s[8:11], s82 offen offset:2048 sc1
    buffer_load_dwordx4 v[68:71], v6, s[8:11], s82 offen offset:3072 sc1
    s_waitcnt vmcnt(15)
    s_barrier
    ds_read_b64_tr_b16 a[192:193], v1 offset:0
    ds_read_b64_tr_b16 a[194:195], v1 offset:512
    ds_read_b64_tr_b16 a[196:197], v1 offset:1024
    ds_read_b64_tr_b16 a[198:199], v1 offset:1536
    ds_read_b64_tr_b16 a[200:201], v1 offset:2048
    ds_read_b64_tr_b16 a[202:203], v1 offset:2560
    ds_read_b64_tr_b16 a[204:205], v1 offset:12288
    ds_read_b64_tr_b16 a[206:207], v1 offset:12800
    ds_read_b64_tr_b16 a[208:209], v1 offset:13312
    ds_read_b64_tr_b16 a[210:211], v1 offset:13824
    ds_read_b64_tr_b16 a[212:213], v1 offset:14336
    ds_read_b64_tr_b16 a[214:215], v1 offset:14848
    ds_read_b64_tr_b16 a[216:217], v1 offset:24576
    ds_read_b64_tr_b16 a[218:219], v1 offset:25088
    ds_read_b64_tr_b16 a[220:221], v1 offset:25600
    ds_read_b64_tr_b16 a[222:223], v1 offset:26112
    ds_read_b64_tr_b16 a[224:225], v1 offset:26624
    ds_read_b64_tr_b16 a[226:227], v1 offset:27136
    ds_read_b64_tr_b16 a[228:229], v1 offset:36864
    ds_read_b64_tr_b16 a[230:231], v1 offset:37376
    ds_read_b64_tr_b16 a[232:233], v1 offset:37888
    ds_read_b64_tr_b16 a[234:235], v1 offset:38400
    ds_read_b64_tr_b16 a[236:237], v1 offset:38912
    ds_read_b64_tr_b16 a[238:239], v1 offset:39424
    ds_read_b64_tr_b16 a[240:241], v1 offset:49152
    ds_read_b64_tr_b16 a[242:243], v1 offset:49664
    ds_read_b64_tr_b16 a[244:245], v1 offset:50176
    ds_read_b64_tr_b16 a[246:247], v1 offset:50688
    ds_read_b64_tr_b16 a[248:249], v1 offset:51200
    ds_read_b64_tr_b16 a[250:251], v1 offset:51712
    ds_read_b64_tr_b16 a[252:253], v2 offset:12288
    ds_read_b64_tr_b16 a[254:255], v2 offset:12800
    ds_read_b64_tr_b16 v[128:129], v2 offset:13312
    ds_read_b64_tr_b16 v[130:131], v2 offset:13824
    ds_read_b64_tr_b16 v[132:133], v2 offset:14336
    ds_read_b64_tr_b16 v[134:135], v2 offset:14848
    ds_read_b64_tr_b16 v[136:137], v2 offset:0
    ds_read_b64_tr_b16 v[138:139], v2 offset:512
    ds_read_b64_tr_b16 v[140:141], v2 offset:1024
    ds_read_b64_tr_b16 v[142:143], v2 offset:1536
    ds_read_b64_tr_b16 v[144:145], v2 offset:2048
    ds_read_b64_tr_b16 v[146:147], v2 offset:2560
    v_add_u32 v5, 32768, v6
    v_mfma_f32_16x16x16_bf16 v[104:107], v[14:15], v[100:101], 0
    ds_read_b128 v[80:83], v5 offset:0
    ds_read_b128 v[84:87], v5 offset:1024
    v_mfma_f32_16x16x16_bf16 v[108:111], v[14:15], v[102:103], 0
    ds_read_b128 v[96:99], v5 offset:2048
    v_mfma_f32_16x16x16_bf16 v[112:115], v[14:15], v[124:125], 0
    v_mfma_f32_16x16x16_bf16 v[116:119], v[14:15], v[126:127], 0
    s_waitcnt vmcnt(8)
    v_bitop3_b32 v4, v27, v31, v35 bitop3:0xfe
    v_bitop3_b32 v4, v4, v39, 1 bitop3:0xa8
    v_cmp_ne_u32 vcc, 0, v4
    ds_read_b128 v[72:75], v5 offset:3072
    ds_read_b128 v[76:79], v5 offset:4096
    ds_read_b128 v[88:91], v5 offset:5120
    ds_read_b128 v[92:95], v5 offset:6144
    s_cbranch_vccnz L_retry_109
L_back_110:
    s_waitcnt lgkmcnt(6)
    v_mfma_f32_16x16x32_bf16 v[104:107], v[80:83], v[24:27], v[104:107]
    ds_read_b128 v[100:103], v5 offset:7168
    s_waitcnt lgkmcnt(5)
    v_mfma_f32_16x16x32_bf16 v[108:111], v[84:87], v[24:27], v[108:111]
    ds_read_b128 v[80:83], v5 offset:8192
    s_waitcnt vmcnt(4)
    v_mfma_f32_16x16x32_bf16 v[112:115], v[96:99], v[24:27], v[112:115]
    ds_read_b128 v[84:87], v5 offset:9216
    s_waitcnt lgkmcnt(5)
    v_mfma_f32_16x16x32_bf16 v[116:119], v[72:75], v[24:27], v[116:119]
    ds_read_b128 v[96:99], v5 offset:10240
    v_bitop3_b32 v4, v43, v47, v51 bitop3:0xfe
    v_mfma_f32_16x16x32_bf16 v[104:107], v[76:79], v[28:31], v[104:107]
    ds_read_b128 v[72:75], v5 offset:11264
    s_waitcnt lgkmcnt(5)
    v_mfma_f32_16x16x32_bf16 v[108:111], v[88:91], v[28:31], v[108:111]
    ds_read_b128 v[76:79], v5 offset:12288
    v_bitop3_b32 v4, v4, v55, 1 bitop3:0xa8
    v_mfma_f32_16x16x32_bf16 v[112:115], v[92:95], v[28:31], v[112:115]
    ds_read_b128 v[88:91], v5 offset:13312
    s_waitcnt lgkmcnt(5)
    v_mfma_f32_16x16x32_bf16 v[116:119], v[100:103], v[28:31], v[116:119]
    ds_read_b128 v[92:95], v5 offset:14336
    v_cmp_ne_u32 vcc, 0, v4
    v_mfma_f32_16x16x32_bf16 v[104:107], v[80:83], v[32:35], v[104:107]
    ds_read_b128 v[100:103], v5 offset:15360
    s_waitcnt lgkmcnt(5)
    v_mfma_f32_16x16x32_bf16 v[108:111], v[84:87], v[32:35], v[108:111]
    ds_read_b128 v[80:83], v5 offset:16384
    s_cbranch_vccnz L_retry_111
L_back_112:
    v_mfma_f32_16x16x32_bf16 v[112:115], v[96:99], v[32:35], v[112:115]
    ds_read_b128 v[84:87], v5 offset:17408
    s_waitcnt lgkmcnt(5)
    v_mfma_f32_16x16x32_bf16 v[116:119], v[72:75], v[32:35], v[116:119]
    ds_read_b128 v[96:99], v5 offset:18432
    v_mfma_f32_16x16x32_bf16 v[104:107], v[76:79], v[36:39], v[104:107]
    ds_read_b128 v[72:75], v5 offset:19456
    s_waitcnt lgkmcnt(5)
    v_mfma_f32_16x16x32_bf16 v[108:111], v[88:91], v[36:39], v[108:111]
    ds_read_b128 v[76:79], v5 offset:20480
    s_barrier
    v_mfma_f32_16x16x32_bf16 v[112:115], v[92:95], v[36:39], v[112:115]
    ds_read_b128 v[88:91], v5 offset:21504
    s_waitcnt lgkmcnt(5)
    v_mfma_f32_16x16x32_bf16 v[116:119], v[100:103], v[36:39], v[116:119]
    ds_read_b128 v[92:95], v5 offset:22528
    s_add_u32 s86, s66, 77824
    v_mfma_f32_16x16x32_bf16 v[104:107], v[80:83], v[40:43], v[104:107]
    ds_read_b128 v[100:103], v5 offset:23552
    s_waitcnt lgkmcnt(5)
    buffer_load_dwordx4 v[24:27], v6, s[8:11], s86 offen offset:0 sc1
    v_mfma_f32_16x16x32_bf16 v[108:111], v[84:87], v[40:43], v[108:111]
    ds_read_b128 v[80:83], v5 offset:24576
    v_mfma_f32_16x16x32_bf16 v[112:115], v[96:99], v[40:43], v[112:115]
    ds_read_b128 v[84:87], v5 offset:25600
    s_waitcnt lgkmcnt(5)
    buffer_load_dwordx4 v[28:31], v6, s[8:11], s86 offen offset:1024 sc1
    v_mfma_f32_16x16x32_bf16 v[116:119], v[72:75], v[40:43], v[116:119]
    ds_read_b128 v[96:99], v5 offset:26624
    v_mfma_f32_16x16x32_bf16 v[104:107], v[76:79], v[44:47], v[104:107]
    ds_read_b128 v[72:75], v5 offset:27648
    s_waitcnt lgkmcnt(5)
    buffer_load_dwordx4 v[32:35], v6, s[8:11], s86 offen offset:2048 sc1
    v_mfma_f32_16x16x32_bf16 v[108:111], v[88:91], v[44:47], v[108:111]
    ds_read_b128 v[76:79], v5 offset:28672
    v_mfma_f32_16x16x32_bf16 v[112:115], v[92:95], v[44:47], v[112:115]
    ds_read_b128 v[88:91], v5 offset:29696
    s_waitcnt lgkmcnt(5)
    buffer_load_dwordx4 v[36:39], v6, s[8:11], s86 offen offset:3072 sc1
    v_mfma_f32_16x16x32_bf16 v[116:119], v[100:103], v[44:47], v[116:119]
    ds_read_b128 v[92:95], v5 offset:30720
    s_waitcnt vmcnt(4)
    v_mfma_f32_16x16x32_bf16 v[104:107], v[80:83], v[48:51], v[104:107]
    ds_read_b128 v[100:103], v5 offset:31744
    s_waitcnt lgkmcnt(5)
    v_mfma_f32_16x16x32_bf16 v[108:111], v[84:87], v[48:51], v[108:111]
    ds_read_b128 v[80:83], v5 offset:32768
    v_bitop3_b32 v4, v59, v63, v67 bitop3:0xfe
    v_mfma_f32_16x16x32_bf16 v[112:115], v[96:99], v[48:51], v[112:115]
    ds_read_b128 v[84:87], v5 offset:33792
    s_waitcnt lgkmcnt(5)
    v_mfma_f32_16x16x32_bf16 v[116:119], v[72:75], v[48:51], v[116:119]
    ds_read_b128 v[96:99], v5 offset:34816
    v_bitop3_b32 v4, v4, v71, 1 bitop3:0xa8
    v_mfma_f32_16x16x32_bf16 v[104:107], v[76:79], v[52:55], v[104:107]
    ds_read_b128 v[72:75], v5 offset:35840
    s_waitcnt lgkmcnt(5)
    v_mfma_f32_16x16x32_bf16 v[108:111], v[88:91], v[52:55], v[108:111]
    ds_read_b128 v[76:79], v5 offset:36864
    v_cmp_ne_u32 vcc, 0, v4
    v_mfma_f32_16x16x32_bf16 v[112:115], v[92:95], v[52:55], v[112:115]
    ds_read_b128 v[88:91], v5 offset:37888
    s_waitcnt lgkmcnt(5)
    v_mfma_f32_16x16x32_bf16 v[116:119], v[100:103], v[52:55], v[116:119]
    ds_read_b128 v[92:95], v5 offset:38912
    s_cbranch_vccnz L_retry_113
L_back_114:
    v_mfma_f32_16x16x32_bf16 v[104:107], v[80:83], v[56:59], v[104:107]
    ds_read_b128 v[100:103], v5 offset:39936
    s_waitcnt lgkmcnt(5)
    v_mfma_f32_16x16x32_bf16 v[108:111], v[84:87], v[56:59], v[108:111]
    ds_read_b128 v[80:83], v5 offset:40960
    s_add_u32 s76, s40, 7
    v_mfma_f32_16x16x32_bf16 v[112:115], v[96:99], v[56:59], v[112:115]
    ds_read_b128 v[84:87], v5 offset:41984
    s_waitcnt lgkmcnt(5)
    v_mfma_f32_16x16x32_bf16 v[116:119], v[72:75], v[56:59], v[116:119]
    ds_read_b128 v[96:99], v5 offset:43008
    s_and_b32 s76, s76, 15
    v_mfma_f32_16x16x32_bf16 v[104:107], v[76:79], v[60:63], v[104:107]
    ds_read_b128 v[72:75], v5 offset:44032
    s_waitcnt lgkmcnt(5)
    v_mfma_f32_16x16x32_bf16 v[108:111], v[88:91], v[60:63], v[108:111]
    ds_read_b128 v[76:79], v5 offset:45056
    s_mul_i32 s76, s76, 98304
    v_mfma_f32_16x16x32_bf16 v[112:115], v[92:95], v[60:63], v[112:115]
    ds_read_b128 v[88:91], v5 offset:46080
    s_waitcnt lgkmcnt(5)
    v_mfma_f32_16x16x32_bf16 v[116:119], v[100:103], v[60:63], v[116:119]
    ds_read_b128 v[92:95], v5 offset:47104
    s_add_u32 m0, s59, 98304
    v_mfma_f32_16x16x32_bf16 v[104:107], v[80:83], v[64:67], v[104:107]
    ds_read_b128 v[100:103], v5 offset:48128
    s_waitcnt lgkmcnt(5)
    v_mfma_f32_16x16x32_bf16 v[108:111], v[84:87], v[64:67], v[108:111]
    ds_read_b128 v[80:83], v5 offset:49152
    buffer_load_dwordx4 v0, s[20:23], s76 offen offset:0 lds
    v_mfma_f32_16x16x32_bf16 v[112:115], v[96:99], v[64:67], v[112:115]
    ds_read_b128 v[84:87], v5 offset:50176
    s_waitcnt lgkmcnt(5)
    v_mfma_f32_16x16x32_bf16 v[116:119], v[72:75], v[64:67], v[116:119]
    ds_read_b128 v[96:99], v5 offset:51200
    v_mfma_f32_16x16x32_bf16 v[104:107], v[76:79], v[68:71], v[104:107]
    ds_read_b128 v[72:75], v5 offset:52224
    s_waitcnt lgkmcnt(5)
    buffer_load_dwordx4 v0, s[20:23], s76 offen offset:1024 lds
    v_mfma_f32_16x16x32_bf16 v[108:111], v[88:91], v[68:71], v[108:111]
    ds_read_b128 v[76:79], v5 offset:53248
    s_waitcnt vmcnt(2)
    v_mfma_f32_16x16x32_bf16 v[112:115], v[92:95], v[68:71], v[112:115]
    ds_read_b128 v[88:91], v5 offset:54272
    s_waitcnt lgkmcnt(5)
    v_mfma_f32_16x16x32_bf16 v[116:119], v[100:103], v[68:71], v[116:119]
    ds_read_b128 v[92:95], v5 offset:55296
    v_bitop3_b32 v4, v27, v31, v35 bitop3:0xfe
    v_bitop3_b32 v4, v4, v39, 1 bitop3:0xa8
    v_cmp_ne_u32 vcc, 0, v4
    s_nop 0
    s_cbranch_vccnz L_retry_115
L_back_116:
    buffer_load_dwordx4 v0, s[20:23], s76 offen offset:2048 lds
    v_mfma_f32_16x16x32_bf16 v[104:107], v[80:83], v[24:27], v[104:107]
    ds_read_b128 v[100:103], v5 offset:56320
    s_waitcnt lgkmcnt(5)
    v_mfma_f32_16x16x32_bf16 v[108:111], v[84:87], v[24:27], v[108:111]
    ds_read_b128 v[80:83], v5 offset:57344
    s_add_u32 s76, s40, 8
    v_mfma_f32_16x16x32_bf16 v[112:115], v[96:99], v[24:27], v[112:115]
    ds_read_b128 v[84:87], v5 offset:58368
    s_waitcnt lgkmcnt(5)
    v_mfma_f32_16x16x32_bf16 v[116:119], v[72:75], v[24:27], v[116:119]
    ds_read_b128 v[96:99], v5 offset:61440
    s_and_b32 s76, s76, 15
    v_mfma_f32_16x16x32_bf16 v[104:107], v[76:79], v[28:31], v[104:107]
    ds_read_b128 v[72:75], v5 offset:62464
    s_waitcnt lgkmcnt(5)
    v_mfma_f32_16x16x32_bf16 v[108:111], v[88:91], v[28:31], v[108:111]
    ds_read_b128 v[76:79], v5 offset:59392
    s_mul_i32 s76, s76, 98304
    v_mfma_f32_16x16x32_bf16 v[112:115], v[92:95], v[28:31], v[112:115]
    ds_read_b128 v[88:91], v5 offset:60416
    s_waitcnt lgkmcnt(5)
    v_mfma_f32_16x16x32_bf16 v[116:119], v[100:103], v[28:31], v[116:119]
    ds_read_b128 v[92:95], v5 offset:63488
    s_add_u32 m0, s59, 110592
    v_mfma_f32_16x16x32_bf16 v[104:107], v[80:83], v[32:35], v[104:107]
    ds_read_b128 v[100:103], v5 offset:64512
    s_waitcnt lgkmcnt(5)
    v_mfma_f32_16x16x32_bf16 v[108:111], v[84:87], v[32:35], v[108:111]
    buffer_load_dwordx4 v0, s[20:23], s76 offen offset:0 lds
    v_mfma_f32_16x16x32_bf16 v[104:107], v[96:99], v[36:39], v[104:107]
    s_waitcnt lgkmcnt(3)
    v_mfma_f32_16x16x32_bf16 v[108:111], v[72:75], v[36:39], v[108:111]
    buffer_load_dwordx4 v0, s[20:23], s76 offen offset:1024 lds
    v_mfma_f32_16x16x32_bf16 v[112:115], v[76:79], v[32:35], v[112:115]
    s_waitcnt lgkmcnt(1)
    v_mfma_f32_16x16x32_bf16 v[116:119], v[88:91], v[32:35], v[116:119]
    buffer_load_dwordx4 v0, s[20:23], s76 offen offset:2048 lds
    s_add_u32 s76, s40, 9
    v_mfma_f32_16x16x32_bf16 v[112:115], v[92:95], v[36:39], v[112:115]
    s_waitcnt lgkmcnt(0)
    s_and_b32 s76, s76, 15
    s_mul_i32 s76, s76, 98304
    v_mfma_f32_16x16x32_bf16 v[116:119], v[100:103], v[36:39], v[116:119]
    s_add_u32 s94, s63, 0
    v_cvt_pk_bf16_f32 v103, v110, v111
    v_cvt_pk_bf16_f32 v100, v104, v105
    v_cvt_pk_bf16_f32 v101, v106, v107
    v_cvt_pk_bf16_f32 v102, v108, v109
    v_and_b32 v103, -2, v103
    buffer_store_dwordx4 v[100:103], v6, s[8:11], s94 offen offset:0 sc1
    s_nop 0
    v_cvt_pk_bf16_f32 v127, v118, v119
    v_cvt_pk_bf16_f32 v124, v112, v113
    v_cvt_pk_bf16_f32 v125, v114, v115
    v_cvt_pk_bf16_f32 v126, v116, v117
    v_and_b32 v127, -2, v127
    buffer_store_dwordx4 v[124:127], v6, s[8:11], s94 offen offset:1024 sc1
    v_cvt_pk_bf16_f32 v103, v110, v111
    s_nop 0
    v_cvt_pk_bf16_f32 v127, v118, v119
    s_add_u32 m0, s59, 122880
    s_nop 0
    buffer_load_dwordx4 v0, s[20:23], s76 offen offset:0 lds
    buffer_load_dwordx4 v0, s[20:23], s76 offen offset:1024 lds
    buffer_load_dwordx4 v0, s[20:23], s76 offen offset:2048 lds
    s_add_u32 s76, s40, 10
    s_and_b32 s76, s76, 15
    s_mul_i32 s76, s76, 98304
    s_add_u32 m0, s59, 135168
    s_nop 0
    buffer_load_dwordx4 v0, s[20:23], s76 offen offset:0 lds
    buffer_load_dwordx4 v0, s[20:23], s76 offen offset:1024 lds
    buffer_load_dwordx4 v0, s[20:23], s76 offen offset:2048 lds
    s_add_u32 s76, s40, 11
    s_and_b32 s76, s76, 15
    s_mul_i32 s76, s76, 98304
    s_add_u32 m0, s59, 147456
    s_nop 0
    buffer_load_dwordx4 v0, s[20:23], s76 offen offset:0 lds
    buffer_load_dwordx4 v0, s[20:23], s76 offen offset:1024 lds
    buffer_load_dwordx4 v0, s[20:23], s76 offen offset:2048 lds
    v_mov_b32 v96, 0x3f803f80
    v_mov_b32 v97, 0x3f803f80
    v_mov_b32 v98, 0x3f803f80
    v_mov_b32 v99, 0x3f803f80
    v_mfma_f32_16x16x32_bf16 v[108:111], v[100:103], v[100:103], 0
    v_mfma_f32_16x16x32_bf16 v[108:111], v[124:127], v[124:127], v[108:111]
    v_mfma_f32_16x16x32_bf16 v[104:107], v[96:99], v[100:103], 0
    v_mfma_f32_16x16x32_bf16 v[104:107], v[96:99], v[124:127], v[104:107]
    s_add_u32 s95, s60, 294912
    s_nop 4
    v_cndmask_b32 v108, v108, v109, s[44:45]
    v_cndmask_b32 v108, v108, v110, s[46:47]
    v_cndmask_b32 v108, v108, v111, s[48:49]
    v_and_b32 v105, -2, v108
    s_waitcnt vmcnt(9)
    s_add_u32 s73, s60, 49152
    buffer_load_dwordx4 v[40:43], v7, s[8:11], s73 offen offset:0 sc1
    buffer_load_dwordx4 v[44:47], v7, s[8:11], s73 offen offset:1024 sc1
    buffer_load_dwordx4 v[48:51], v7, s[8:11], s73 offen offset:2048 sc1
    buffer_load_dwordx4 v[52:55], v7, s[8:11], s73 offen offset:3072 sc1
    buffer_store_dwordx2 v[104:105], v10, s[8:11], s95 offen sc1
    s_waitcnt vmcnt(3)
    v_bitop3_b32 v4, v43, v47, 1 bitop3:0xa8
    v_cmp_ne_u32 vcc, 0, v4
    s_nop 0
    s_cbranch_vccnz L_retry_117
L_back_118:
    ds_write_b128 v7, v[40:43] offset:16384
    ds_write_b128 v7, v[44:47] offset:17408
    s_waitcnt vmcnt(1)
    v_bitop3_b32 v4, v51, v55, 1 bitop3:0xa8
    v_cmp_ne_u32 vcc, 0, v4
    s_nop 0
    s_cbranch_vccnz L_retry_119
L_back_120:
    ds_write_b128 v7, v[48:51] offset:18432
    ds_write_b128 v7, v[52:55] offset:19456
    s_waitcnt lgkmcnt(0)
    s_waitcnt vmcnt(5)
    s_barrier
    ds_read_b128 v[40:43], v6 offset:16384
    ds_read_b128 v[44:47], v6 offset:17408
    ds_read_b128 v[48:51], v6 offset:18432
    s_add_u32 s73, s60, 32768
    buffer_load_dwordx4 v[24:27], v7, s[8:11], s73 offen offset:0 sc1
    buffer_load_dwordx4 v[28:31], v7, s[8:11], s73 offen offset:1024 sc1
    v_bfe_u32 v98, v6, 4, 4
    v_lshlrev_b32 v98, 3, v98
    v_and_b32 v99, 0x18, v98
    v_add_u32 v98, 163328, v98
    v_lshrrev_b32 v85, 8, v6
    buffer_load_dwordx4 v[32:35], v7, s[8:11], s73 offen offset:2048 sc1
    v_lshl_add_u32 v99, v85, 5, v99
    v_add_u32 v99, 163328, v99
    s_lshl_b32 s75, s36, 7
    s_add_u32 s75, s75, 163328
    v_lshrrev_b32 v85, 6, v6
    v_lshl_add_u32 v85, v85, 3, s75
    s_add_u32 s74, s60, 294912
    s_add_u32 s74, s74, s4
    buffer_load_dwordx4 v[36:39], v7, s[8:11], s73 offen offset:3072 sc1
    v_mov_b32 v88, 0x3f803f80
    v_mov_b32 v89, 0x3f803f80
    v_mov_b32 v90, 0x3f803f80
    v_mov_b32 v91, 0x3f803f80
    s_waitcnt lgkmcnt(2)
    v_mfma_f32_16x16x32_bf16 v[72:75], a[196:199], v[40:43], 0
    ds_read_b128 v[52:55], v6 offset:19456
    ds_read_b64_tr_b16 v[148:149], v1 offset:0
    v_mfma_f32_16x16x32_bf16 v[68:71], a[192:195], v[40:43], 0
    ds_read_b128 v[112:115], v6 offset:20480
    ds_read_b64_tr_b16 v[150:151], v1 offset:512
    v_mfma_f32_16x16x32_bf16 v[76:79], v[40:43], a[200:203], 0
    ds_read_b64_tr_b16 v[152:153], v1 offset:1024
    s_lshl_b32 s77, s37, 9
    ds_read_b64_tr_b16 v[154:155], v1 offset:1536
    v_mfma_f32_16x16x32_bf16 v[56:59], a[192:195], v[88:91], 0
    ds_read_b64_tr_b16 v[156:157], v1 offset:2048
    s_add_u32 s77, s77, 532480
    ds_read_b64_tr_b16 v[158:159], v1 offset:2560
    v_mfma_f32_16x16x32_bf16 v[60:63], a[196:199], v[88:91], 0
    ds_read_b64_tr_b16 v[160:161], v1 offset:12288
    buffer_load_dwordx4 v[80:83], v6, s[8:11], s74 offen sc1
    ds_read_b64_tr_b16 v[162:163], v1 offset:12800
    v_mfma_f32_16x16x32_bf16 v[64:67], v[88:91], a[200:203], 0
    s_waitcnt lgkmcnt(11)
    ds_read_b64_tr_b16 v[164:165], v1 offset:13312
    v_mfma_f32_16x16x32_bf16 v[72:75], a[208:211], v[44:47], v[72:75]
    ds_read_b128 v[116:119], v6 offset:21504
    ds_read_b64_tr_b16 v[166:167], v1 offset:13824
    v_mfma_f32_16x16x32_bf16 v[68:71], a[204:207], v[44:47], v[68:71]
    ds_read_b128 v[40:43], v6 offset:22528
    ds_read_b64_tr_b16 v[168:169], v1 offset:14336
    v_mfma_f32_16x16x32_bf16 v[76:79], v[44:47], a[212:215], v[76:79]
    ds_read_b64_tr_b16 v[170:171], v1 offset:14848
    v_lshrrev_b32 v94, 1, v6
    v_mfma_f32_16x16x32_bf16 v[56:59], a[204:207], v[88:91], v[56:59]
    buffer_load_dwordx2 v[92:93], v94, s[8:11], s77 offen sc1
    v_mfma_f32_16x16x32_bf16 v[60:63], a[208:211], v[88:91], v[60:63]
    v_mfma_f32_16x16x32_bf16 v[64:67], v[88:91], a[212:215], v[64:67]
    s_waitcnt lgkmcnt(15)
    v_mfma_f32_16x16x32_bf16 v[72:75], a[220:223], v[48:51], v[72:75]
    ds_read_b128 v[44:47], v6 offset:23552
    v_mfma_f32_16x16x32_bf16 v[68:71], a[216:219], v[48:51], v[68:71]
    v_mfma_f32_16x16x32_bf16 v[76:79], v[48:51], a[224:227], v[76:79]
    v_mfma_f32_16x16x32_bf16 v[56:59], a[216:219], v[88:91], v[56:59]
    s_waitcnt lgkmcnt(1)
    s_barrier
    s_add_u32 s76, s40, 12
    v_mfma_f32_16x16x32_bf16 v[60:63], a[220:223], v[88:91], v[60:63]
    s_and_b32 s76, s76, 15
    s_mul_i32 s76, s76, 98304
    s_add_u32 m0, s59, 98304
    v_mfma_f32_16x16x32_bf16 v[64:67], v[88:91], a[224:227], v[64:67]
    buffer_load_dwordx4 v0, s[20:23], s76 offen offset:0 lds
    v_mfma_f32_16x16x32_bf16 v[72:75], a[232:235], v[52:55], v[72:75]
    ds_read_b128 v[48:51], v6 offset:24576
    v_mfma_f32_16x16x32_bf16 v[68:71], a[228:231], v[52:55], v[68:71]
    buffer_load_dwordx4 v0, s[20:23], s76 offen offset:1024 lds
    v_mfma_f32_16x16x32_bf16 v[76:79], v[52:55], a[236:239], v[76:79]
    s_waitcnt vmcnt(4)
    v_bitop3_b32 v4, v27, v31, v35 bitop3:0xfe
    v_bitop3_b32 v4, v4, v39, 1 bitop3:0xa8
    v_mfma_f32_16x16x32_bf16 v[56:59], a[228:231], v[88:91], v[56:59]
    buffer_load_dwordx4 v0, s[20:23], s76 offen offset:2048 lds
    v_cmp_ne_u32 vcc, 0, v4
    v_mfma_f32_16x16x32_bf16 v[60:63], a[232:235], v[88:91], v[60:63]
    s_cbranch_vccnz L_retry_121
L_back_122:
    v_mfma_f32_16x16x32_bf16 v[64:67], v[88:91], a[236:239], v[64:67]
    s_waitcnt lgkmcnt(6)
    ds_write_b128 v7, v[24:27] offset:0
    v_mfma_f32_16x16x32_bf16 v[72:75], a[244:247], v[112:115], v[72:75]
    ds_read_b128 v[52:55], v6 offset:25600
    s_add_u32 s76, s40, 13
    v_mfma_f32_16x16x32_bf16 v[68:71], a[240:243], v[112:115], v[68:71]
    ds_write_b128 v7, v[28:31] offset:1024
    v_mfma_f32_16x16x32_bf16 v[76:79], v[112:115], a[248:251], v[76:79]
    s_and_b32 s76, s76, 15
    s_mul_i32 s76, s76, 98304
    s_add_u32 m0, s59, 110592
    v_mfma_f32_16x16x32_bf16 v[56:59], a[240:243], v[88:91], v[56:59]
    ds_write_b128 v7, v[32:35] offset:2048
    v_mfma_f32_16x16x32_bf16 v[60:63], a[244:247], v[88:91], v[60:63]
    buffer_load_dwordx4 v0, s[20:23], s76 offen offset:0 lds
    s_waitcnt vmcnt(5)
    v_mfma_f32_16x16x32_bf16 v[64:67], v[88:91], a[248:251], v[64:67]
    ds_write_b128 v7, v[36:39] offset:3072
    v_mfma_f32_16x16x32_bf16 v[72:75], v[128:131], v[116:119], v[72:75]
    ds_read_b128 v[112:115], v6 offset:26624
    buffer_load_dwordx4 v0, s[20:23], s76 offen offset:1024 lds
    v_mfma_f32_16x16x32_bf16 v[68:71], a[252:255], v[116:119], v[68:71]
    v_bitop3_b32 v5, v81, v83, 1 bitop3:0xa8
    v_cmp_ne_u32 vcc, 0, v5
    v_mfma_f32_16x16x32_bf16 v[76:79], v[116:119], v[132:135], v[76:79]
    buffer_load_dwordx4 v0, s[20:23], s76 offen offset:2048 lds
    s_cbranch_vccnz L_retry_123
L_back_124:
    ds_read_b64_tr_b16 v[172:173], v1 offset:24576
    v_mfma_f32_16x16x32_bf16 v[56:59], a[252:255], v[88:91], v[56:59]
    ds_read_b64_tr_b16 v[174:175], v1 offset:25088
    v_add_f32 v80, v80, v82
    v_mfma_f32_16x16x32_bf16 v[60:63], v[128:131], v[88:91], v[60:63]
    ds_read_b64_tr_b16 v[176:177], v1 offset:25600
    v_add_f32 v81, v81, v83
    v_mfma_f32_16x16x32_bf16 v[64:67], v[88:91], v[132:135], v[64:67]
    s_waitcnt lgkmcnt(10)
    ds_read_b64_tr_b16 v[178:179], v1 offset:26112
    v_mfma_f32_16x16x32_bf16 v[72:75], v[140:143], v[40:43], v[72:75]
    ds_read_b128 v[116:119], v6 offset:27648
    ds_read_b64_tr_b16 v[180:181], v1 offset:26624
    v_mfma_f32_16x16x32_bf16 v[68:71], v[136:139], v[40:43], v[68:71]
    ds_read_b64_tr_b16 v[182:183], v1 offset:27136
    v_add_f32_dpp v82, v80, v80 quad_perm:[1,0,3,2] row_mask:0xf bank_mask:0xf
    v_mfma_f32_16x16x32_bf16 v[76:79], v[40:43], v[144:147], v[76:79]
    ds_read_b64_tr_b16 v[184:185], v1 offset:36864
    v_add_f32_dpp v83, v81, v81 quad_perm:[1,0,3,2] row_mask:0xf bank_mask:0xf
    v_mfma_f32_16x16x32_bf16 v[56:59], v[136:139], v[88:91], v[56:59]
    ds_read_b64_tr_b16 v[186:187], v1 offset:37376
    v_add_f32_dpp v80, v82, v82 quad_perm:[2,3,0,1] row_mask:0xf bank_mask:0xf
    v_mfma_f32_16x16x32_bf16 v[60:63], v[140:143], v[88:91], v[60:63]
    ds_read_b64_tr_b16 v[188:189], v1 offset:37888
    v_add_f32_dpp v81, v83, v83 quad_perm:[2,3,0,1] row_mask:0xf bank_mask:0xf
    v_mfma_f32_16x16x32_bf16 v[64:67], v[88:91], v[144:147], v[64:67]
    s_waitcnt lgkmcnt(15)
    ds_read_b64_tr_b16 v[190:191], v1 offset:38400
    v_mfma_f32_16x16x32_bf16 v[72:75], v[152:155], v[44:47], v[72:75]
    ds_read_b128 v[40:43], v6 offset:28672
    ds_read_b64_tr_b16 v[192:193], v1 offset:38912
    v_mfma_f32_16x16x32_bf16 v[68:71], v[148:151], v[44:47], v[68:71]
    ds_read_b64_tr_b16 v[194:195], v1 offset:39424
    v_mul_f32 v80, 0x3b000000, v80
    v_mfma_f32_16x16x32_bf16 v[76:79], v[44:47], v[156:159], v[76:79]
    s_waitcnt vmcnt(6)
    v_mul_f32 v81, 0x3b000000, v81
    v_fma_f32 v81, -v80, v80, v81
    v_mfma_f32_16x16x32_bf16 v[56:59], v[148:151], v[88:91], v[56:59]
    v_max_f32 v81, 0, v81
    v_cvt_pk_bf16_f32 v80, v81, -v80
    v_mfma_f32_16x16x32_bf16 v[60:63], v[152:155], v[88:91], v[60:63]
    v_lshlrev_b32 v84, 16, v80
    v_add_f32 v84, 0x3727c5ac, v84
    v_mfma_f32_16x16x32_bf16 v[64:67], v[88:91], v[156:159], v[64:67]
    s_waitcnt lgkmcnt(15)
    v_cvt_pk_bf16_f32 v84, v84, v84
    v_lshlrev_b32 v84, 16, v84
    v_mfma_f32_16x16x32_bf16 v[72:75], v[164:167], v[48:51], v[72:75]
    ds_read_b128 v[44:47], v6 offset:29696
    v_xor_b32 v94, s5, v92
    v_mfma_f32_16x16x32_bf16 v[68:71], v[160:163], v[48:51], v[68:71]
    v_sqrt_f32 v84, v84
    v_mfma_f32_16x16x32_bf16 v[76:79], v[48:51], v[168:171], v[76:79]
    s_waitcnt lgkmcnt(1)
    s_barrier
    s_add_u32 s76, s40, 14
    v_mfma_f32_16x16x32_bf16 v[56:59], v[160:163], v[88:91], v[56:59]
    s_and_b32 s76, s76, 15
    s_mul_i32 s76, s76, 98304
    s_add_u32 m0, s59, 122880
    v_mfma_f32_16x16x32_bf16 v[60:63], v[164:167], v[88:91], v[60:63]
    buffer_load_dwordx4 v0, s[20:23], s76 offen offset:0 lds
    v_and_b32 v83, 0xffff0000, v80
    v_mfma_f32_16x16x32_bf16 v[64:67], v[88:91], v[168:171], v[64:67]
    s_waitcnt lgkmcnt(8)
    buffer_load_dwordx4 v0, s[20:23], s76 offen offset:1024 lds
    v_mfma_f32_16x16x32_bf16 v[72:75], v[176:179], v[52:55], v[72:75]
    ds_read_b128 v[48:51], v6 offset:30720
    v_cvt_pk_bf16_f32 v84, v84, v84
    v_mfma_f32_16x16x32_bf16 v[68:71], v[172:175], v[52:55], v[68:71]
    buffer_load_dwordx4 v0, s[20:23], s76 offen offset:2048 lds
    s_add_u32 s76, s40, 15
    v_mfma_f32_16x16x32_bf16 v[76:79], v[52:55], v[180:183], v[76:79]
    s_and_b32 s76, s76, 15
    s_mul_i32 s76, s76, 98304
    s_add_u32 m0, s59, 135168
    v_mfma_f32_16x16x32_bf16 v[56:59], v[172:175], v[88:91], v[56:59]
    buffer_load_dwordx4 v0, s[20:23], s76 offen offset:0 lds
    v_lshlrev_b32 v84, 16, v84
    v_mfma_f32_16x16x32_bf16 v[60:63], v[176:179], v[88:91], v[60:63]
    buffer_load_dwordx4 v0, s[20:23], s76 offen offset:1024 lds
    v_xor_b32 v95, s6, v93
    v_mfma_f32_16x16x32_bf16 v[64:67], v[88:91], v[180:183], v[64:67]
    s_waitcnt lgkmcnt(2)
    buffer_load_dwordx4 v0, s[20:23], s76 offen offset:2048 lds
    v_mfma_f32_16x16x32_bf16 v[72:75], v[188:191], v[112:115], v[72:75]
    ds_read_b128 v[52:55], v6 offset:31744
    ds_read_b64_tr_b16 v[196:197], v1 offset:49152
    v_mfma_f32_16x16x32_bf16 v[68:71], v[184:187], v[112:115], v[68:71]
    ds_read_b64_tr_b16 v[198:199], v1 offset:49664
    v_lshrrev_b32 v95, 8, v95
    v_mfma_f32_16x16x32_bf16 v[76:79], v[112:115], v[192:195], v[76:79]
    ds_read_b64_tr_b16 v[200:201], v1 offset:50176
    v_or_b32 v94, v94, v95
    v_mfma_f32_16x16x32_bf16 v[56:59], v[184:187], v[88:91], v[56:59]
    ds_read_b64_tr_b16 v[202:203], v1 offset:50688
    v_cmp_ne_u32 vcc, 0, v94
    v_mfma_f32_16x16x32_bf16 v[60:63], v[188:191], v[88:91], v[60:63]
    ds_read_b64_tr_b16 v[204:205], v1 offset:51200
    ds_read_b64_tr_b16 v[206:207], v1 offset:51712
    v_mfma_f32_16x16x32_bf16 v[64:67], v[88:91], v[192:195], v[64:67]
    s_waitcnt lgkmcnt(0)
    v_mfma_f32_16x16x32_bf16 v[72:75], v[200:203], v[116:119], v[72:75]
    s_cbranch_vccnz L_retry_127
L_back_128:
    v_mfma_f32_16x16x32_bf16 v[68:71], v[196:199], v[116:119], v[68:71]
    v_rcp_f32 v82, v84
    v_mfma_f32_16x16x32_bf16 v[76:79], v[116:119], v[204:207], v[76:79]
    s_waitcnt vmcnt(6)
    s_barrier
    v_mov_b32 v92, -1
    v_mfma_f32_16x16x32_bf16 v[56:59], v[196:199], v[88:91], v[56:59]
    ds_read_b64_tr_b16 v[208:209], v1 offset:0
    v_mov_b32 v93, -1
    v_mfma_f32_16x16x32_bf16 v[60:63], v[200:203], v[88:91], v[60:63]
    ds_read_b64_tr_b16 v[210:211], v1 offset:512
    ds_read_b64_tr_b16 v[212:213], v1 offset:1024
    ds_read_b64_tr_b16 v[214:215], v1 offset:1536
    ds_read_b64_tr_b16 v[216:217], v1 offset:2048
    ds_read_b64_tr_b16 v[218:219], v1 offset:2560
    v_mfma_f32_16x16x32_bf16 v[64:67], v[88:91], v[204:207], v[64:67]
    s_waitcnt lgkmcnt(0)
    ds_read_b64_tr_b16 v[220:221], v1 offset:12288
    ds_write_b64 v85, v[82:83]
    ds_read_b64_tr_b16 v[222:223], v1 offset:12800
    v_mfma_f32_16x16x32_bf16 v[72:75], v[212:215], v[40:43], v[72:75]
    ds_read_b64_tr_b16 v[224:225], v1 offset:13312
    v_mov_b32 v94, -1
    v_mfma_f32_16x16x32_bf16 v[68:71], v[208:211], v[40:43], v[68:71]
    ds_read_b64_tr_b16 v[226:227], v1 offset:13824
    v_mov_b32 v95, -1
    v_mfma_f32_16x16x32_bf16 v[76:79], v[40:43], v[216:219], v[76:79]
    ds_read_b64_tr_b16 v[228:229], v1 offset:14336
    s_add_u32 s101, s62, 65536
    ds_read_b64_tr_b16 v[230:231], v1 offset:14848
    v_mfma_f32_16x16x32_bf16 v[56:59], v[208:211], v[88:91], v[56:59]
    buffer_store_dwordx4 v[92:95], v6, s[8:11], s101 offen sc1
    v_mfma_f32_16x16x32_bf16 v[60:63], v[212:215], v[88:91], v[60:63]
    v_mfma_f32_16x16x32_bf16 v[64:67], v[88:91], v[216:219], v[64:67]
    s_waitcnt lgkmcnt(5)
    s_barrier
    s_waitcnt lgkmcnt(0)
    v_mfma_f32_16x16x32_bf16 v[72:75], v[224:227], v[44:47], v[72:75]
    ds_read_b128 v[112:115], v6 offset:0
    s_add_u32 s73, s60, 16384
    v_mfma_f32_16x16x32_bf16 v[68:71], v[220:223], v[44:47], v[68:71]
    ds_read_b128 v[116:119], v6 offset:1024
    s_lshl_b32 s72, s36, 12
    v_mfma_f32_16x16x32_bf16 v[76:79], v[44:47], v[228:231], v[76:79]
    s_add_u32 m0, s72, 16384
    s_nop 0
    buffer_load_dwordx4 v7, s[8:11], s73 offen offset:0 sc1 lds
    v_mfma_f32_16x16x32_bf16 v[56:59], v[220:223], v[88:91], v[56:59]
    ds_read_b64 v[108:109], v98 offset:384
    v_mfma_f32_16x16x32_bf16 v[60:63], v[224:227], v[88:91], v[60:63]
    s_waitcnt vmcnt(2)
    s_barrier
    ds_read_b64_tr_b16 v[232:233], v1 offset:24576
    ds_read_b64_tr_b16 v[234:235], v1 offset:25088
    ds_read_b64_tr_b16 v[236:237], v1 offset:25600
    ds_read_b64_tr_b16 v[238:239], v1 offset:26112
    ds_read_b64_tr_b16 v[240:241], v1 offset:26624
    ds_read_b64_tr_b16 v[242:243], v1 offset:27136
    ds_read_b64 v[110:111], v99 offset:384
    ds_read_b64_tr_b16 v[244:245], v1 offset:36864
    v_mfma_f32_16x16x32_bf16 v[64:67], v[88:91], v[228:231], v[64:67]
    s_waitcnt lgkmcnt(2)
    ds_read_b64_tr_b16 v[246:247], v1 offset:37376
    ds_read_b64 v[104:105], v98 offset:256
    ds_read_b64_tr_b16 v[248:249], v1 offset:37888
    v_mfma_f32_16x16x32_bf16 v[72:75], v[236:239], v[48:51], v[72:75]
    ds_read_b128 v[40:43], v6 offset:2048
    s_add_u32 m0, s72, 16384
    s_nop 0
    buffer_load_dwordx4 v7, s[8:11], s73 offen offset:1024 sc1 lds
    ds_read_b64_tr_b16 v[250:251], v1 offset:38400
    v_mfma_f32_16x16x32_bf16 v[68:71], v[232:235], v[48:51], v[68:71]
    ds_read_b128 v[44:47], v6 offset:3072
    ds_read_b64_tr_b16 v[252:253], v1 offset:38912
    v_mfma_f32_16x16x32_bf16 v[76:79], v[48:51], v[240:243], v[76:79]
    ds_read_b64_tr_b16 v[254:255], v1 offset:39424
    v_mfma_f32_16x16x32_bf16 v[56:59], v[232:235], v[88:91], v[56:59]
    s_add_u32 m0, s72, 16384
    s_nop 0
    buffer_load_dwordx4 v7, s[8:11], s73 offen offset:2048 sc1 lds
    ds_read_b64 v[106:107], v99 offset:256
    v_mfma_f32_16x16x32_bf16 v[60:63], v[236:239], v[88:91], v[60:63]
    v_mfma_f32_16x16x32_bf16 v[64:67], v[88:91], v[240:243], v[64:67]
    s_waitcnt lgkmcnt(1)
    v_mfma_f32_16x16x32_bf16 v[72:75], v[248:251], v[52:55], v[72:75]
    ds_read_b128 v[48:51], v6 offset:4096
    s_waitcnt lgkmcnt(2)
    v_mfma_f32_16x16x32_bf16 v[68:71], v[244:247], v[52:55], v[68:71]
    s_add_u32 m0, s72, 16384
    s_nop 0
    buffer_load_dwordx4 v7, s[8:11], s73 offen offset:3072 sc1 lds
    v_mfma_f32_16x16x32_bf16 v[76:79], v[52:55], v[252:255], v[76:79]
    s_barrier
    s_add_u32 s76, s70, 0
    v_mfma_f32_16x16x32_bf16 v[56:59], v[244:247], v[88:91], v[56:59]
    v_mfma_f32_16x16x32_bf16 v[60:63], v[248:251], v[88:91], v[60:63]
    s_add_u32 m0, s71, 98304
    s_nop 0
    buffer_load_dwordx4 v6, s[8:11], s76 offen offset:0 sc1 lds
    v_mfma_f32_16x16x32_bf16 v[64:67], v[88:91], v[252:255], v[64:67]
    s_waitcnt lgkmcnt(15)
    s_nop 1
    v_cndmask_b32 v121, v56, v57, s[44:45]
    v_cndmask_b32 v121, v121, v58, s[46:47]
    v_cndmask_b32 v121, v121, v59, s[48:49]
    v_cndmask_b32 v122, v60, v61, s[44:45]
    v_cndmask_b32 v122, v122, v62, s[46:47]
    v_cndmask_b32 v122, v122, v63, s[48:49]
    v_mov_b32 v123, v64
    v_mfma_f32_16x16x32_bf16 v[60:63], a[196:199], v[112:115], 0
    ds_read_b128 v[52:55], v6 offset:5120
    s_waitcnt lgkmcnt(12)
    v_mfma_f32_16x16x32_bf16 v[56:59], a[192:195], v[112:115], 0
    s_add_u32 m0, s71, 98304
    s_nop 0
    buffer_load_dwordx4 v6, s[8:11], s76 offen offset:1024 sc1 lds
    v_mfma_f32_16x16x32_bf16 v[64:67], v[112:115], a[200:203], 0
    v_fmac_f32_dpp v72, v122, v109 row_newbcast:0 row_mask:0xf bank_mask:0xf
    v_fmac_f32_dpp v73, v122, v109 row_newbcast:1 row_mask:0xf bank_mask:0xf
    v_mfma_f32_16x16x32_bf16 v[60:63], a[208:211], v[116:119], v[60:63]
    ds_read_b128 v[112:115], v6 offset:6144
    v_fmac_f32_dpp v74, v122, v109 row_newbcast:2 row_mask:0xf bank_mask:0xf
    v_mfma_f32_16x16x32_bf16 v[56:59], a[204:207], v[116:119], v[56:59]
    s_add_u32 m0, s71, 98304
    s_nop 0
    buffer_load_dwordx4 v6, s[8:11], s76 offen offset:2048 sc1 lds
    v_mfma_f32_16x16x32_bf16 v[64:67], v[116:119], a[212:215], v[64:67]
    s_waitcnt lgkmcnt(6)
    v_fmac_f32_dpp v75, v122, v109 row_newbcast:3 row_mask:0xf bank_mask:0xf
    v_mul_f32 v72, v108, v72
    v_mfma_f32_16x16x32_bf16 v[60:63], a[220:223], v[40:43], v[60:63]
    ds_read_b128 v[116:119], v6 offset:7168
    v_mul_f32 v73, v108, v73
    v_mfma_f32_16x16x32_bf16 v[56:59], a[216:219], v[40:43], v[56:59]
    s_add_u32 m0, s71, 98304
    s_nop 0
    buffer_load_dwordx4 v6, s[8:11], s76 offen offset:3072 sc1 lds
    v_mfma_f32_16x16x32_bf16 v[64:67], v[40:43], a[224:227], v[64:67]
    s_add_u32 s76, s70, 4096
    v_mul_f32 v74, v108, v74
    v_mul_f32 v75, v108, v75
    v_mfma_f32_16x16x32_bf16 v[60:63], a[232:235], v[44:47], v[60:63]
    ds_read_b128 v[40:43], v6 offset:8192
    v_cvt_pk_bf16_f32 v86, v72, v73
    v_mfma_f32_16x16x32_bf16 v[56:59], a[228:231], v[44:47], v[56:59]
    s_add_u32 m0, s71, 102400
    s_nop 0
    buffer_load_dwordx4 v6, s[8:11], s76 offen offset:0 sc1 lds
    v_mfma_f32_16x16x32_bf16 v[64:67], v[44:47], a[236:239], v[64:67]
    s_waitcnt lgkmcnt(3)
    v_cvt_pk_bf16_f32 v87, v74, v75
    v_fmac_f32_dpp v68, v121, v109 row_newbcast:0 row_mask:0xf bank_mask:0xf
    v_mfma_f32_16x16x32_bf16 v[60:63], a[244:247], v[48:51], v[60:63]
    ds_read_b128 v[44:47], v6 offset:9216
    v_fmac_f32_dpp v69, v121, v109 row_newbcast:1 row_mask:0xf bank_mask:0xf
    v_mfma_f32_16x16x32_bf16 v[56:59], a[240:243], v[48:51], v[56:59]
    s_add_u32 m0, s71, 102400
    s_nop 0
    buffer_load_dwordx4 v6, s[8:11], s76 offen offset:1024 sc1 lds
    v_mfma_f32_16x16x32_bf16 v[64:67], v[48:51], a[248:251], v[64:67]
    v_fmac_f32_dpp v70, v121, v109 row_newbcast:2 row_mask:0xf bank_mask:0xf
    v_fmac_f32_dpp v71, v121, v109 row_newbcast:3 row_mask:0xf bank_mask:0xf
    v_mfma_f32_16x16x32_bf16 v[60:63], v[128:131], v[52:55], v[60:63]
    ds_read_b128 v[48:51], v6 offset:10240
    v_cvt_pk_bf16_f32 v82, v68, v69
    v_mfma_f32_16x16x32_bf16 v[56:59], a[252:255], v[52:55], v[56:59]
    s_add_u32 m0, s71, 102400
    s_nop 0
    buffer_load_dwordx4 v6, s[8:11], s76 offen offset:2048 sc1 lds
    v_mfma_f32_16x16x32_bf16 v[64:67], v[52:55], v[132:135], v[64:67]
    s_waitcnt lgkmcnt(3)
    v_cvt_pk_bf16_f32 v83, v70, v71
    v_mul_f32 v97, s43, v108
    v_mfma_f32_16x16x32_bf16 v[60:63], v[140:143], v[112:115], v[60:63]
    ds_read_b128 v[52:55], v6 offset:11264
    v_fmac_f32_dpp v76, v111, v123 row_newbcast:0 row_mask:0xf bank_mask:0xf
    v_mfma_f32_16x16x32_bf16 v[56:59], v[136:139], v[112:115], v[56:59]
    s_add_u32 m0, s71, 102400
    s_nop 0
    buffer_load_dwordx4 v6, s[8:11], s76 offen offset:3072 sc1 lds
    v_mfma_f32_16x16x32_bf16 v[64:67], v[112:115], v[144:147], v[64:67]
    s_add_u32 s76, s70, 8192
    v_fmac_f32_dpp v77, v111, v123 row_newbcast:1 row_mask:0xf bank_mask:0xf
    v_fmac_f32_dpp v78, v111, v123 row_newbcast:2 row_mask:0xf bank_mask:0xf
    v_mfma_f32_16x16x32_bf16 v[60:63], v[152:155], v[116:119], v[60:63]
    ds_read_b128 v[112:115], v6 offset:12288
    v_fmac_f32_dpp v79, v111, v123 row_newbcast:3 row_mask:0xf bank_mask:0xf
    v_mfma_f32_16x16x32_bf16 v[56:59], v[148:151], v[116:119], v[56:59]
    s_add_u32 m0, s71, 106496
    s_nop 0
    buffer_load_dwordx4 v6, s[8:11], s76 offen offset:0 sc1 lds
    v_mfma_f32_16x16x32_bf16 v[64:67], v[116:119], v[156:159], v[64:67]
    s_waitcnt lgkmcnt(3)
    v_mul_f32_dpp v76, v110, v76 row_newbcast:0 row_mask:0xf bank_mask:0xf
    v_mul_f32_dpp v77, v110, v77 row_newbcast:1 row_mask:0xf bank_mask:0xf
    v_mfma_f32_16x16x32_bf16 v[60:63], v[164:167], v[40:43], v[60:63]
    ds_read_b128 v[116:119], v6 offset:13312
    v_mul_f32_dpp v78, v110, v78 row_newbcast:2 row_mask:0xf bank_mask:0xf
    v_mfma_f32_16x16x32_bf16 v[56:59], v[160:163], v[40:43], v[56:59]
    s_add_u32 m0, s71, 106496
    s_nop 0
    buffer_load_dwordx4 v6, s[8:11], s76 offen offset:1024 sc1 lds
    v_mfma_f32_16x16x32_bf16 v[64:67], v[40:43], v[168:171], v[64:67]
    v_mul_f32_dpp v79, v110, v79 row_newbcast:3 row_mask:0xf bank_mask:0xf
    v_cvt_pk_bf16_f32 v94, v76, v77
    v_mfma_f32_16x16x32_bf16 v[60:63], v[176:179], v[44:47], v[60:63]
    ds_read_b128 v[40:43], v6 offset:14336
    v_cvt_pk_bf16_f32 v95, v78, v79
    v_mfma_f32_16x16x32_bf16 v[56:59], v[172:175], v[44:47], v[56:59]
    ds_read_b64 v[108:109], v98 offset:128
    v_mfma_f32_16x16x32_bf16 v[64:67], v[44:47], v[180:183], v[64:67]
    s_waitcnt lgkmcnt(4)
    ds_read_b64 v[110:111], v99 offset:128
    v_mfma_f32_16x16x32_bf16 v[60:63], v[188:191], v[48:51], v[60:63]
    ds_read_b128 v[44:47], v6 offset:15360
    v_mov_b32 v68, v86
    v_mfma_f32_16x16x32_bf16 v[56:59], v[184:187], v[48:51], v[56:59]
    s_add_u32 m0, s71, 106496
    s_nop 0
    buffer_load_dwordx4 v6, s[8:11], s76 offen offset:2048 sc1 lds
    v_mfma_f32_16x16x32_bf16 v[64:67], v[48:51], v[192:195], v[64:67]
    v_mov_b32 v69, v87
    s_add_u32 s96, s62, 32768
    v_mfma_f32_16x16x32_bf16 v[60:63], v[200:203], v[52:55], v[60:63]
    v_mov_b32 v70, v94
    v_min_u32 v71, -2, v95
    v_mfma_f32_16x16x32_bf16 v[56:59], v[196:199], v[52:55], v[56:59]
    s_waitcnt vmcnt(15)
    buffer_store_dwordx4 v[68:71], v6, s[8:11], s96 offen sc1
    v_mfma_f32_16x16x32_bf16 v[64:67], v[52:55], v[204:207], v[64:67]
    s_waitcnt lgkmcnt(5)
    v_mfma_f32_16x16x32_bf16 v[60:63], v[212:215], v[112:115], v[60:63]
    s_add_u32 m0, s71, 106496
    s_nop 0
    buffer_load_dwordx4 v6, s[8:11], s76 offen offset:3072 sc1 lds
    v_mfma_f32_16x16x32_bf16 v[56:59], v[208:211], v[112:115], v[56:59]
    s_add_u32 s76, s70, 12288
    v_mfma_f32_16x16x32_bf16 v[64:67], v[112:115], v[216:219], v[64:67]
    s_waitcnt lgkmcnt(0) vmcnt(13)
    s_barrier
    v_mfma_f32_16x16x32_bf16 v[60:63], v[224:227], v[116:119], v[60:63]
    ds_read_b128 v[48:51], v6 offset:16384
    v_mfma_f32_16x16x32_bf16 v[56:59], v[220:223], v[116:119], v[56:59]
    ds_read_b128 v[52:55], v6 offset:17408
    v_mfma_f32_16x16x32_bf16 v[64:67], v[116:119], v[228:231], v[64:67]
    s_add_u32 m0, s71, 110592
    s_nop 0
    buffer_load_dwordx4 v6, s[8:11], s76 offen offset:0 sc1 lds
    v_mfma_f32_16x16x32_bf16 v[60:63], v[236:239], v[40:43], v[60:63]
    ds_read_b128 v[112:115], v6 offset:18432
    v_mfma_f32_16x16x32_bf16 v[56:59], v[232:235], v[40:43], v[56:59]
    ds_read_b128 v[116:119], v6 offset:19456
    v_mfma_f32_16x16x32_bf16 v[64:67], v[40:43], v[240:243], v[64:67]
    s_add_u32 m0, s71, 110592
    s_nop 0
    buffer_load_dwordx4 v6, s[8:11], s76 offen offset:1024 sc1 lds
    v_mfma_f32_16x16x32_bf16 v[60:63], v[248:251], v[44:47], v[60:63]
    ds_read_b128 v[40:43], v6 offset:20480
    v_mfma_f32_16x16x32_bf16 v[56:59], v[244:247], v[44:47], v[56:59]
    v_mfma_f32_16x16x32_bf16 v[64:67], v[44:47], v[252:255], v[64:67]
    s_waitcnt lgkmcnt(3)
    s_waitcnt lgkmcnt(15)
    s_nop 0
    v_mfma_f32_16x16x32_bf16 v[72:75], a[196:199], v[48:51], 0
    ds_read_b128 v[44:47], v6 offset:21504
    v_fmac_f32_dpp v60, v122, v105 row_newbcast:0 row_mask:0xf bank_mask:0xf
    v_mfma_f32_16x16x32_bf16 v[68:71], a[192:195], v[48:51], 0
    s_add_u32 m0, s71, 110592
    s_nop 0
    buffer_load_dwordx4 v6, s[8:11], s76 offen offset:2048 sc1 lds
    v_mfma_f32_16x16x32_bf16 v[76:79], v[48:51], a[200:203], 0
    v_fmac_f32_dpp v61, v122, v105 row_newbcast:1 row_mask:0xf bank_mask:0xf
    v_fmac_f32_dpp v62, v122, v105 row_newbcast:2 row_mask:0xf bank_mask:0xf
    v_mfma_f32_16x16x32_bf16 v[72:75], a[208:211], v[52:55], v[72:75]
    ds_read_b128 v[48:51], v6 offset:22528
    v_fmac_f32_dpp v63, v122, v105 row_newbcast:3 row_mask:0xf bank_mask:0xf
    v_mfma_f32_16x16x32_bf16 v[68:71], a[204:207], v[52:55], v[68:71]
    s_add_u32 m0, s69, 110592
    s_nop 0
    buffer_load_dwordx4 v6, s[8:11], s76 offen offset:3072 sc1 lds
    v_mfma_f32_16x16x32_bf16 v[76:79], v[52:55], a[212:215], v[76:79]
    s_waitcnt lgkmcnt(3)
    s_add_u32 s73, s60, 0
    s_lshl_b32 s72, s36, 12
    v_mfma_f32_16x16x32_bf16 v[72:75], a[220:223], v[112:115], v[72:75]
    ds_read_b128 v[52:55], v6 offset:23552
    v_mul_f32 v60, v104, v60
    v_mfma_f32_16x16x32_bf16 v[68:71], a[216:219], v[112:115], v[68:71]
    v_mul_f32 v61, v104, v61
    v_mul_f32 v62, v104, v62
    v_mfma_f32_16x16x32_bf16 v[76:79], v[112:115], a[224:227], v[76:79]
    s_add_u32 m0, s72, 0
    s_nop 0
    buffer_load_dwordx4 v7, s[8:11], s73 offen offset:0 sc1 lds
    v_mfma_f32_16x16x32_bf16 v[72:75], a[232:235], v[116:119], v[72:75]
    ds_read_b128 v[112:115], v6 offset:24576
    v_mul_f32 v63, v104, v63
    v_mfma_f32_16x16x32_bf16 v[68:71], a[228:231], v[116:119], v[68:71]
    v_cvt_pk_bf16_f32 v84, v60, v61
    v_cvt_pk_bf16_f32 v85, v62, v63
    v_mfma_f32_16x16x32_bf16 v[76:79], v[116:119], a[236:239], v[76:79]
    s_waitcnt lgkmcnt(3)
    v_fmac_f32_dpp v56, v121, v105 row_newbcast:0 row_mask:0xf bank_mask:0xf
    v_fmac_f32_dpp v57, v121, v105 row_newbcast:1 row_mask:0xf bank_mask:0xf
    v_mfma_f32_16x16x16_bf16 v[60:63], v[84:85], v[82:83], v[16:19]
    s_add_u32 m0, s72, 0
    s_nop 0
    buffer_load_dwordx4 v7, s[8:11], s73 offen offset:1024 sc1 lds
    v_mfma_f32_16x16x32_bf16 v[72:75], a[244:247], v[40:43], v[72:75]
    ds_read_b128 v[116:119], v6 offset:25600
    v_fmac_f32_dpp v58, v121, v105 row_newbcast:2 row_mask:0xf bank_mask:0xf
    v_mfma_f32_16x16x32_bf16 v[68:71], a[240:243], v[40:43], v[68:71]
    v_fmac_f32_dpp v59, v121, v105 row_newbcast:3 row_mask:0xf bank_mask:0xf
    v_cvt_pk_bf16_f32 v80, v56, v57
    v_mfma_f32_16x16x32_bf16 v[76:79], v[40:43], a[248:251], v[76:79]
    v_cvt_pk_bf16_f32 v81, v58, v59
    v_mul_f32 v96, s43, v104
    v_mfma_f32_16x16x16_bf16 v[56:59], v[86:87], v[82:83], v[16:19]
    s_add_u32 m0, s72, 0
    s_nop 0
    buffer_load_dwordx4 v7, s[8:11], s73 offen offset:2048 sc1 lds
    v_mfma_f32_16x16x32_bf16 v[72:75], v[128:131], v[44:47], v[72:75]
    ds_read_b128 v[40:43], v6 offset:26624
    v_fmac_f32_dpp v64, v107, v123 row_newbcast:0 row_mask:0xf bank_mask:0xf
    v_mfma_f32_16x16x32_bf16 v[68:71], a[252:255], v[44:47], v[68:71]
    v_fmac_f32_dpp v65, v107, v123 row_newbcast:1 row_mask:0xf bank_mask:0xf
    v_fmac_f32_dpp v66, v107, v123 row_newbcast:2 row_mask:0xf bank_mask:0xf
    v_mfma_f32_16x16x32_bf16 v[76:79], v[44:47], v[132:135], v[76:79]
    s_waitcnt lgkmcnt(3)
    v_fmac_f32_dpp v67, v107, v123 row_newbcast:3 row_mask:0xf bank_mask:0xf
    v_mul_f32_dpp v64, v106, v64 row_newbcast:0 row_mask:0xf bank_mask:0xf
    v_mfma_f32_16x16x32_bf16 v[72:75], v[140:143], v[48:51], v[72:75]
    ds_read_b128 v[44:47], v6 offset:27648
    v_mul_f32_dpp v65, v106, v65 row_newbcast:1 row_mask:0xf bank_mask:0xf
    v_mfma_f32_16x16x32_bf16 v[68:71], v[136:139], v[48:51], v[68:71]
    s_add_u32 m0, s72, 0
    s_nop 0
    buffer_load_dwordx4 v7, s[8:11], s73 offen offset:3072 sc1 lds
    v_mfma_f32_16x16x32_bf16 v[76:79], v[48:51], v[144:147], v[76:79]
    v_mul_f32_dpp v66, v106, v66 row_newbcast:2 row_mask:0xf bank_mask:0xf
    v_mul_f32_dpp v67, v106, v67 row_newbcast:3 row_mask:0xf bank_mask:0xf
    v_mfma_f32_16x16x32_bf16 v[72:75], v[152:155], v[52:55], v[72:75]
    ds_read_b128 v[48:51], v6 offset:28672
    v_cvt_pk_bf16_f32 v92, v64, v65
    v_mfma_f32_16x16x32_bf16 v[68:71], v[148:151], v[52:55], v[68:71]
    v_cvt_pk_bf16_f32 v93, v66, v67
    v_cndmask_b32 v56, v60, v56, s[28:29]
    v_mfma_f32_16x16x32_bf16 v[76:79], v[52:55], v[156:159], v[76:79]
    s_waitcnt lgkmcnt(3)
    ds_read_b64 v[104:105], v98 offset:0
    v_mfma_f32_16x16x32_bf16 v[72:75], v[164:167], v[112:115], v[72:75]
    ds_read_b128 v[52:55], v6 offset:29696
    v_cndmask_b32 v57, v61, v57, s[30:31]
    v_mfma_f32_16x16x32_bf16 v[68:71], v[160:163], v[112:115], v[68:71]
    ds_read_b64 v[106:107], v99 offset:0
    v_cndmask_b32 v58, v62, v58, s[32:33]
    v_mfma_f32_16x16x32_bf16 v[76:79], v[112:115], v[168:171], v[76:79]
    v_cndmask_b32 v59, v63, v59, s[34:35]
    v_max3_f32 v60, v56, v57, v58
    v_mfma_f32_16x16x32_bf16 v[72:75], v[176:179], v[116:119], v[72:75]
    ds_read_b128 v[112:115], v6 offset:30720
    v_max_f32 v61, v60, v59
    v_mfma_f32_16x16x32_bf16 v[68:71], v[172:175], v[116:119], v[68:71]
    v_max_f32 v60, v60, v59
    s_nop 0
    v_mfma_f32_16x16x32_bf16 v[76:79], v[116:119], v[180:183], v[76:79]
    s_waitcnt lgkmcnt(5)
    v_permlane32_swap_b32 v60, v61
    v_mfma_f32_16x16x32_bf16 v[72:75], v[188:191], v[40:43], v[72:75]
    ds_read_b128 v[116:119], v6 offset:31744
    v_max_f32 v62, v60, v61
    v_mfma_f32_16x16x32_bf16 v[68:71], v[184:187], v[40:43], v[68:71]
    s_add_u32 s75, s61, 32768
    v_max_f32 v60, v60, v61
    s_nop 0
    v_mfma_f32_16x16x32_bf16 v[76:79], v[40:43], v[192:195], v[76:79]
    buffer_load_dwordx4 v[88:91], v6, s[8:11], s75 offen sc1
    v_mfma_f32_16x16x32_bf16 v[72:75], v[200:203], v[44:47], v[72:75]
    v_permlane16_swap_b32 v60, v62
    v_mfma_f32_16x16x32_bf16 v[68:71], v[196:199], v[44:47], v[68:71]
    v_max_f32 v60, v60, v62
    v_mul_f32 v60, -v60, v97
    v_mfma_f32_16x16x32_bf16 v[76:79], v[44:47], v[204:207], v[76:79]
    s_waitcnt lgkmcnt(5)
    v_fma_f32 v56, v56, v97, v60
    v_fma_f32 v57, v57, v97, v60
    v_mfma_f32_16x16x32_bf16 v[72:75], v[212:215], v[48:51], v[72:75]
    v_fma_f32 v58, v58, v97, v60
    v_fma_f32 v59, v59, v97, v60
    v_mfma_f32_16x16x32_bf16 v[68:71], v[208:211], v[48:51], v[68:71]
    v_exp_f32 v56, v56
    v_mfma_f32_16x16x32_bf16 v[76:79], v[48:51], v[216:219], v[76:79]
    s_waitcnt lgkmcnt(0) vmcnt(1)
    s_barrier
    v_mfma_f32_16x16x32_bf16 v[72:75], v[224:227], v[52:55], v[72:75]
    ds_read_b128 v[40:43], v6 offset:0
    s_lshl_b32 s73, s37, 16
    v_mfma_f32_16x16x32_bf16 v[68:71], v[220:223], v[52:55], v[68:71]
    ds_read_b128 v[44:47], v6 offset:1024
    s_add_u32 s73, s73, 64512
    v_mfma_f32_16x16x32_bf16 v[76:79], v[52:55], v[228:231], v[76:79]
    s_mov_b32 m0, 162816
    v_exp_f32 v57, v57
    v_mfma_f32_16x16x32_bf16 v[72:75], v[236:239], v[112:115], v[72:75]
    ds_read_b128 v[48:51], v6 offset:2048
    v_mfma_f32_16x16x32_bf16 v[68:71], v[232:235], v[112:115], v[68:71]
    ds_read_b128 v[52:55], v6 offset:3072
    v_mfma_f32_16x16x32_bf16 v[76:79], v[112:115], v[240:243], v[76:79]
    buffer_load_dwordx4 v6, s[8:11], s73 offen sc1 lds
    v_mfma_f32_16x16x32_bf16 v[72:75], v[248:251], v[116:119], v[72:75]
    ds_read_b128 v[112:115], v6 offset:4096
    v_mfma_f32_16x16x32_bf16 v[68:71], v[244:247], v[116:119], v[68:71]
    v_exp_f32 v58, v58
    v_mfma_f32_16x16x32_bf16 v[76:79], v[116:119], v[252:255], v[76:79]
    s_waitcnt lgkmcnt(3)
    v_exp_f32 v59, v59
    v_cvt_pk_bf16_f32 v0, v56, v57
    v_cvt_pk_bf16_f32 v1, v58, v59
    v_and_b32 v62, v0, v20
    v_and_b32 v63, v1, v21
    v_mfma_f32_16x16x16_bf16 v[56:59], v[22:23], v[0:1], 0
    v_xor_b32 v60, v0, v62
    v_xor_b32 v61, v1, v63
    s_nop 1
    v_mfma_f32_16x16x32_bf16 v[64:67], v[92:95], v[60:63], 0
    s_nop 2
    v_rcp_f32 v56, v56
    s_nop 3
    v_mul_f32 v64, v56, v64
    v_mul_f32 v65, v56, v65
    v_mul_f32 v66, v56, v66
    v_mul_f32 v67, v56, v67
    v_cvt_pk_bf16_f32 v1, v66, v67
    v_cvt_pk_bf16_f32 v0, v64, v65
    v_mfma_f32_16x16x32_bf16 v[60:63], a[196:199], v[40:43], 0
    ds_read_b128 v[116:119], v6 offset:5120
    s_waitcnt lgkmcnt(15)
    v_mfma_f32_16x16x32_bf16 v[56:59], a[192:195], v[40:43], 0
    ds_read_b128 v[24:27], v6 offset:6144
    v_fmac_f32_dpp v72, v122, v109 row_newbcast:0 row_mask:0xf bank_mask:0xf
    v_mfma_f32_16x16x32_bf16 v[64:67], v[40:43], a[200:203], 0
    v_fmac_f32_dpp v73, v122, v109 row_newbcast:1 row_mask:0xf bank_mask:0xf
    v_fmac_f32_dpp v74, v122, v109 row_newbcast:2 row_mask:0xf bank_mask:0xf
    v_mfma_f32_16x16x32_bf16 v[60:63], a[208:211], v[44:47], v[60:63]
    ds_read_b128 v[28:31], v6 offset:7168
    v_fmac_f32_dpp v75, v122, v109 row_newbcast:3 row_mask:0xf bank_mask:0xf
    v_mfma_f32_16x16x32_bf16 v[56:59], a[204:207], v[44:47], v[56:59]
    ds_read_b128 v[32:35], v6 offset:8192
    v_mul_f32 v72, v108, v72
    v_mfma_f32_16x16x32_bf16 v[64:67], v[44:47], a[212:215], v[64:67]
    s_waitcnt lgkmcnt(5)
    v_mul_f32 v73, v108, v73
    v_mul_f32 v74, v108, v74
    v_mfma_f32_16x16x32_bf16 v[60:63], a[220:223], v[48:51], v[60:63]
    ds_read_b128 v[36:39], v6 offset:9216
    v_mul_f32 v75, v108, v75
    v_mfma_f32_16x16x32_bf16 v[56:59], a[216:219], v[48:51], v[56:59]
    ds_read_b128 v[40:43], v6 offset:10240
    v_cvt_pk_bf16_f32 v86, v72, v73
    v_mfma_f32_16x16x32_bf16 v[64:67], v[48:51], a[224:227], v[64:67]
    v_cvt_pk_bf16_f32 v87, v74, v75
    v_fmac_f32_dpp v68, v121, v109 row_newbcast:0 row_mask:0xf bank_mask:0xf
    v_mfma_f32_16x16x32_bf16 v[60:63], a[232:235], v[52:55], v[60:63]
    ds_read_b128 v[44:47], v6 offset:11264
    v_fmac_f32_dpp v69, v121, v109 row_newbcast:1 row_mask:0xf bank_mask:0xf
    v_mfma_f32_16x16x16_bf16 v[72:75], v[86:87], v[80:81], v[16:19]
    v_fmac_f32_dpp v70, v121, v109 row_newbcast:2 row_mask:0xf bank_mask:0xf
    v_fmac_f32_dpp v71, v121, v109 row_newbcast:3 row_mask:0xf bank_mask:0xf
    v_mfma_f32_16x16x32_bf16 v[56:59], a[228:231], v[52:55], v[56:59]
    ds_read_b128 v[48:51], v6 offset:12288
    v_cvt_pk_bf16_f32 v82, v68, v69
    v_mfma_f32_16x16x32_bf16 v[64:67], v[52:55], a[236:239], v[64:67]
    s_waitcnt lgkmcnt(7)
    v_cvt_pk_bf16_f32 v83, v70, v71
    v_mul_f32 v97, s43, v108
    v_mfma_f32_16x16x16_bf16 v[68:71], v[84:85], v[80:81], v[16:19]
    v_fmac_f32_dpp v76, v111, v123 row_newbcast:0 row_mask:0xf bank_mask:0xf
    v_fmac_f32_dpp v77, v111, v123 row_newbcast:1 row_mask:0xf bank_mask:0xf
    v_mfma_f32_16x16x32_bf16 v[60:63], a[244:247], v[112:115], v[60:63]
    ds_read_b128 v[52:55], v6 offset:13312
    v_fmac_f32_dpp v78, v111, v123 row_newbcast:2 row_mask:0xf bank_mask:0xf
    v_mfma_f32_16x16x32_bf16 v[56:59], a[240:243], v[112:115], v[56:59]
    v_fmac_f32_dpp v79, v111, v123 row_newbcast:3 row_mask:0xf bank_mask:0xf
    v_mul_f32_dpp v76, v110, v76 row_newbcast:0 row_mask:0xf bank_mask:0xf
    v_mfma_f32_16x16x32_bf16 v[64:67], v[112:115], a[248:251], v[64:67]
    v_mul_f32_dpp v77, v110, v77 row_newbcast:1 row_mask:0xf bank_mask:0xf
    v_mul_f32_dpp v78, v110, v78 row_newbcast:2 row_mask:0xf bank_mask:0xf
    v_mfma_f32_16x16x32_bf16 v[60:63], v[128:131], v[116:119], v[60:63]
    ds_read_b128 v[112:115], v6 offset:14336
    v_mul_f32_dpp v79, v110, v79 row_newbcast:3 row_mask:0xf bank_mask:0xf
    v_mfma_f32_16x16x32_bf16 v[56:59], a[252:255], v[116:119], v[56:59]
    v_cvt_pk_bf16_f32 v94, v76, v77
    v_cvt_pk_bf16_f32 v95, v78, v79
    v_mfma_f32_16x16x32_bf16 v[64:67], v[116:119], v[132:135], v[64:67]
    s_waitcnt lgkmcnt(7)
    v_cndmask_b32 v68, v72, v68, s[28:29]
    v_cndmask_b32 v69, v73, v69, s[30:31]
    v_mfma_f32_16x16x32_bf16 v[60:63], v[140:143], v[24:27], v[60:63]
    ds_read_b128 v[116:119], v6 offset:15360
    v_cndmask_b32 v70, v74, v70, s[32:33]
    v_mfma_f32_16x16x32_bf16 v[56:59], v[136:139], v[24:27], v[56:59]
    v_cndmask_b32 v71, v75, v71, s[34:35]
    v_max3_f32 v72, v68, v69, v70
    v_mfma_f32_16x16x32_bf16 v[64:67], v[24:27], v[144:147], v[64:67]
    v_max_f32 v73, v72, v71
    v_max_f32 v72, v72, v71
    v_mfma_f32_16x16x32_bf16 v[60:63], v[152:155], v[28:31], v[60:63]
    s_nop 0
    v_permlane32_swap_b32 v72, v73
    v_mfma_f32_16x16x32_bf16 v[56:59], v[148:151], v[28:31], v[56:59]
    s_waitcnt lgkmcnt(6)
    v_max_f32 v74, v72, v73
    v_max_f32 v72, v72, v73
    v_mfma_f32_16x16x32_bf16 v[60:63], v[164:167], v[32:35], v[60:63]
    s_nop 0
    v_permlane16_swap_b32 v72, v74
    v_mfma_f32_16x16x32_bf16 v[56:59], v[160:163], v[32:35], v[56:59]
    v_max_f32 v72, v72, v74
    v_mul_f32 v72, -v72, v96
    v_mfma_f32_16x16x32_bf16 v[60:63], v[176:179], v[36:39], v[60:63]
    s_waitcnt vmcnt(1)
    v_fma_f32 v68, v68, v96, v72
    v_fma_f32 v69, v69, v96, v72
    v_mfma_f32_16x16x32_bf16 v[56:59], v[172:175], v[36:39], v[56:59]
    s_waitcnt lgkmcnt(4)
    v_fma_f32 v70, v70, v96, v72
    v_fma_f32 v71, v71, v96, v72
    v_mfma_f32_16x16x32_bf16 v[60:63], v[188:191], v[40:43], v[60:63]
    v_exp_f32 v68, v68
    v_mfma_f32_16x16x32_bf16 v[56:59], v[184:187], v[40:43], v[56:59]
    v_exp_f32 v69, v69
    v_mfma_f32_16x16x32_bf16 v[60:63], v[200:203], v[44:47], v[60:63]
    v_exp_f32 v70, v70
    v_mfma_f32_16x16x32_bf16 v[56:59], v[196:199], v[44:47], v[56:59]
    s_waitcnt lgkmcnt(3)
    v_exp_f32 v71, v71
    v_mfma_f32_16x16x32_bf16 v[60:63], v[212:215], v[48:51], v[60:63]
    v_cvt_pk_bf16_f32 v2, v68, v69
    v_cvt_pk_bf16_f32 v3, v70, v71
    v_mfma_f32_16x16x32_bf16 v[56:59], v[208:211], v[48:51], v[56:59]
    s_waitcnt lgkmcnt(2)
    v_and_b32 v72, v2, v20
    v_and_b32 v73, v3, v21
    v_mfma_f32_16x16x16_bf16 v[68:71], v[22:23], v[2:3], 0
    v_xor_b32 v74, v2, v72
    v_xor_b32 v75, v3, v73
    v_mfma_f32_16x16x32_bf16 v[60:63], v[224:227], v[52:55], v[60:63]
    s_add_u32 s98, s65, 98304
    v_cmp_eq_u32 vcc, -1, v91
    v_mfma_f32_16x16x32_bf16 v[76:79], v[92:95], v[72:75], 0
    s_cbranch_vccnz L_retry_125
L_back_126:
    v_mfma_f32_16x16x32_bf16 v[56:59], v[220:223], v[52:55], v[56:59]
    s_waitcnt lgkmcnt(1)
    v_rcp_f32 v68, v68
    v_mfma_f32_16x16x32_bf16 v[60:63], v[236:239], v[112:115], v[60:63]
    s_nop 2
    v_mfma_f32_16x16x32_bf16 v[56:59], v[232:235], v[112:115], v[56:59]
    s_waitcnt lgkmcnt(0)
    v_mul_f32 v76, v68, v76
    v_mul_f32 v77, v68, v77
    v_mfma_f32_16x16x32_bf16 v[60:63], v[248:251], v[116:119], v[60:63]
    v_mul_f32 v78, v68, v78
    v_mul_f32 v79, v68, v79
    v_mfma_f32_16x16x32_bf16 v[56:59], v[244:247], v[116:119], v[56:59]
    v_cvt_pk_bf16_f32 v3, v78, v79
    v_cvt_pk_bf16_f32 v2, v76, v77
    v_mfma_f32_16x16x32_bf16 v[64:67], v[28:31], v[156:159], v[64:67]
    v_permlane16_swap_b32 v1, v3
    v_mfma_f32_16x16x32_bf16 v[64:67], v[32:35], v[168:171], v[64:67]
    v_permlane16_swap_b32 v0, v2
    v_mfma_f32_16x16x32_bf16 v[64:67], v[36:39], v[180:183], v[64:67]
    v_or_b32 v3, 1, v3
    v_fmac_f32_dpp v60, v122, v105 row_newbcast:0 row_mask:0xf bank_mask:0xf
    v_mfma_f32_16x16x32_bf16 v[64:67], v[40:43], v[192:195], v[64:67]
    buffer_store_dwordx4 v[0:3], v8, s[8:11], s98 offen sc1
    v_mfma_f32_16x16x32_bf16 v[64:67], v[44:47], v[204:207], v[64:67]
    v_fmac_f32_dpp v61, v122, v105 row_newbcast:1 row_mask:0xf bank_mask:0xf
    v_fmac_f32_dpp v62, v122, v105 row_newbcast:2 row_mask:0xf bank_mask:0xf
    v_mfma_f32_16x16x32_bf16 v[64:67], v[48:51], v[216:219], v[64:67]
    v_fmac_f32_dpp v63, v122, v105 row_newbcast:3 row_mask:0xf bank_mask:0xf
    v_mul_f32 v60, v104, v60
    v_mfma_f32_16x16x32_bf16 v[64:67], v[52:55], v[228:231], v[64:67]
    v_mul_f32 v61, v104, v61
    v_mul_f32 v62, v104, v62
    v_mfma_f32_16x16x32_bf16 v[64:67], v[112:115], v[240:243], v[64:67]
    v_mul_f32 v63, v104, v63
    v_cvt_pk_bf16_f32 v84, v60, v61
    v_mfma_f32_16x16x32_bf16 v[64:67], v[116:119], v[252:255], v[64:67]
    v_cvt_pk_bf16_f32 v85, v62, v63
    v_fmac_f32_dpp v56, v121, v105 row_newbcast:0 row_mask:0xf bank_mask:0xf
    v_fmac_f32_dpp v57, v121, v105 row_newbcast:1 row_mask:0xf bank_mask:0xf
    v_mfma_f32_16x16x16_bf16 v[72:75], v[84:85], v[82:83], v[16:19]
    v_fmac_f32_dpp v58, v121, v105 row_newbcast:2 row_mask:0xf bank_mask:0xf
    v_fmac_f32_dpp v59, v121, v105 row_newbcast:3 row_mask:0xf bank_mask:0xf
    v_mfma_f32_16x16x16_bf16 v[68:71], v[86:87], v[82:83], v[16:19]
    v_cvt_pk_bf16_f32 v80, v56, v57
    v_cvt_pk_bf16_f32 v81, v58, v59
    v_mul_f32 v96, s43, v104
    v_add_f32 v60, s42, v16
    v_add_f32 v61, s42, v17
    v_add_f32 v62, s42, v18
    v_add_f32 v63, s42, v19
    v_mfma_f32_16x16x16_bf16 v[56:59], v[84:85], v[80:81], v[16:19]
    v_cndmask_b32 v68, v72, v68, s[28:29]
    v_cndmask_b32 v69, v73, v69, s[30:31]
    v_mfma_f32_16x16x16_bf16 v[60:63], v[88:89], v[80:81], v[60:63]
    v_cndmask_b32 v70, v74, v70, s[32:33]
    v_cndmask_b32 v71, v75, v71, s[34:35]
    v_max3_f32 v72, v68, v69, v70
    v_max_f32 v73, v72, v71
    v_max_f32 v72, v72, v71
    v_fmac_f32_dpp v64, v107, v123 row_newbcast:0 row_mask:0xf bank_mask:0xf
    v_fmac_f32_dpp v65, v107, v123 row_newbcast:1 row_mask:0xf bank_mask:0xf
    v_permlane32_swap_b32 v72, v73
    v_cndmask_b32 v56, v60, v56, s[28:29]
    v_cndmask_b32 v57, v61, v57, s[30:31]
    v_cndmask_b32 v58, v62, v58, s[32:33]
    v_cndmask_b32 v59, v63, v59, s[34:35]
    v_max3_f32 v60, v56, v57, v58
    v_max_f32 v61, v60, v59
    v_max_f32 v60, v60, v59
    v_max_f32 v74, v72, v73
    v_max_f32 v72, v72, v73
    v_permlane32_swap_b32 v60, v61
    v_max_f32 v62, v60, v61
    v_max_f32 v60, v60, v61
    v_permlane16_swap_b32 v72, v74
    v_max_f32 v72, v72, v74
    v_permlane16_swap_b32 v60, v62
    v_max_f32 v60, v60, v62
    v_mul_f32 v60, -v60, v96
    v_fma_f32 v56, v56, v96, v60
    v_fma_f32 v57, v57, v96, v60
    v_fma_f32 v58, v58, v96, v60
    v_fma_f32 v59, v59, v96, v60
    v_mul_f32 v72, -v72, v97
    v_exp_f32 v56, v56
    v_fma_f32 v68, v68, v97, v72
    v_exp_f32 v57, v57
    v_fma_f32 v69, v69, v97, v72
    v_exp_f32 v58, v58
    v_fma_f32 v70, v70, v97, v72
    v_exp_f32 v59, v59
    v_fma_f32 v71, v71, v97, v72
    v_cvt_pk_bf16_f32 v2, v56, v57
    v_exp_f32 v68, v68
    v_cvt_pk_bf16_f32 v3, v58, v59
    v_exp_f32 v69, v69
    v_and_b32 v62, v2, v20
    v_exp_f32 v70, v70
    v_and_b32 v63, v3, v21
    v_mfma_f32_16x16x16_bf16 v[56:59], v[22:23], v[2:3], 0
    s_add_u32 s78, s66, 65536
    s_mov_b64 exec, s[54:55]
    buffer_load_dwordx4 v[24:27], v6, s[8:11], s78 offen offset:0 sc1
    buffer_load_dwordx4 v[28:31], v6, s[8:11], s78 offen offset:1024 sc1
    s_mov_b64 exec, -1
    v_exp_f32 v71, v71
    v_cvt_pk_bf16_f32 v0, v68, v69
    v_xor_b32 v60, v2, v62
    v_cvt_pk_bf16_f32 v1, v70, v71
    v_xor_b32 v61, v3, v63
    v_and_b32 v74, v0, v20
    s_add_u32 s100, s65, 65536
    v_and_b32 v75, v1, v21
    v_mfma_f32_16x16x16_bf16 v[68:71], v[22:23], v[0:1], 0
    s_mov_b64 exec, s[54:55]
    buffer_load_dwordx4 v[32:35], v6, s[8:11], s78 offen offset:2048 sc1
    buffer_load_dwordx4 v[36:39], v6, s[8:11], s78 offen offset:3072 sc1
    s_mov_b64 exec, -1
    s_add_u32 s79, s66, 69632
    v_xor_b32 v72, v0, v74
    v_xor_b32 v73, v1, v75
    v_fmac_f32_dpp v66, v107, v123 row_newbcast:2 row_mask:0xf bank_mask:0xf
    v_fmac_f32_dpp v67, v107, v123 row_newbcast:3 row_mask:0xf bank_mask:0xf
    v_mul_f32_dpp v64, v106, v64 row_newbcast:0 row_mask:0xf bank_mask:0xf
    v_mul_f32_dpp v65, v106, v65 row_newbcast:1 row_mask:0xf bank_mask:0xf
    v_mul_f32_dpp v66, v106, v66 row_newbcast:2 row_mask:0xf bank_mask:0xf
    v_add_u32 v5, 98304, v6
    s_mov_b64 exec, s[54:55]
    buffer_load_dwordx4 v[40:43], v6, s[8:11], s79 offen offset:0 sc1
    buffer_load_dwordx4 v[44:47], v6, s[8:11], s79 offen offset:1024 sc1
    s_mov_b64 exec, -1
    ds_read_b128 v[80:83], v5 offset:0
    ds_read_b128 v[84:87], v5 offset:1024
    ds_read_b128 v[96:99], v5 offset:2048
    v_mul_f32_dpp v67, v106, v67 row_newbcast:3 row_mask:0xf bank_mask:0xf
    v_cvt_pk_bf16_f32 v92, v64, v65
    v_cvt_pk_bf16_f32 v93, v66, v67
    s_mov_b64 exec, s[54:55]
    buffer_load_dwordx4 v[48:51], v6, s[8:11], s79 offen offset:2048 sc1
    buffer_load_dwordx4 v[52:55], v6, s[8:11], s79 offen offset:3072 sc1
    s_mov_b64 exec, -1
    v_mfma_f32_16x16x32_bf16 v[64:67], v[90:93], v[60:63], 0
    v_rcp_f32 v56, v56
    v_mfma_f32_16x16x32_bf16 v[76:79], v[92:95], v[72:75], 0
    v_rcp_f32 v68, v68
    v_mfma_f32_16x16x16_bf16 v[104:107], v[14:15], v[100:101], 0
    v_mfma_f32_16x16x16_bf16 v[108:111], v[14:15], v[102:103], 0
    s_nop 2
    v_mul_f32 v64, v56, v64
    v_mul_f32 v65, v56, v65
    v_mul_f32 v66, v56, v66
    v_mul_f32 v67, v56, v67
    v_mul_f32 v76, v68, v76
    v_cvt_pk_bf16_f32 v3, v66, v67
    v_mul_f32 v77, v68, v77
    v_cvt_pk_bf16_f32 v2, v64, v65
    v_mul_f32 v78, v68, v78
    v_mul_f32 v79, v68, v79
    v_cvt_pk_bf16_f32 v1, v78, v79
    v_cvt_pk_bf16_f32 v0, v76, v77
    v_mfma_f32_16x16x16_bf16 v[112:115], v[14:15], v[124:125], 0
    v_permlane16_swap_b32 v1, v3
    v_permlane16_swap_b32 v0, v2
    v_or_b32 v3, 1, v3
    buffer_store_dwordx4 v[0:3], v8, s[8:11], s100 offen sc1
    v_mfma_f32_16x16x16_bf16 v[116:119], v[14:15], v[126:127], 0
    s_cmp_lt_u32 s36, 2
    s_cbranch_scc1 L_lo_129
    s_waitcnt vmcnt(5)
    v_bitop3_b32 v4, v27, v31, v35 bitop3:0x80
    v_bitop3_b32 v4, v4, v39, 1 bitop3:0x80
    v_cmp_ne_u32 vcc, 1, v4
    ds_read_b128 v[72:75], v5 offset:3072
    ds_read_b128 v[76:79], v5 offset:4096
    ds_read_b128 v[88:91], v5 offset:5120
    ds_read_b128 v[92:95], v5 offset:6144
    s_cbranch_vccnz L_retry_143
L_back_144:
    s_waitcnt lgkmcnt(6)
    v_mfma_f32_16x16x32_bf16 v[104:107], v[80:83], v[24:27], v[104:107]
    ds_read_b128 v[100:103], v5 offset:7168
    s_waitcnt lgkmcnt(5)
    v_mfma_f32_16x16x32_bf16 v[108:111], v[84:87], v[24:27], v[108:111]
    ds_read_b128 v[80:83], v5 offset:8192
    s_add_u32 s95, s66, 73728
    v_mfma_f32_16x16x32_bf16 v[112:115], v[96:99], v[24:27], v[112:115]
    ds_read_b128 v[84:87], v5 offset:9216
    s_waitcnt lgkmcnt(5)
    buffer_load_dwordx4 v[56:59], v6, s[8:11], s95 offen offset:0 sc1
    v_mfma_f32_16x16x32_bf16 v[116:119], v[72:75], v[24:27], v[116:119]
    ds_read_b128 v[96:99], v5 offset:10240
    v_mfma_f32_16x16x32_bf16 v[104:107], v[76:79], v[28:31], v[104:107]
    ds_read_b128 v[72:75], v5 offset:11264
    s_waitcnt lgkmcnt(5)
    buffer_load_dwordx4 v[60:63], v6, s[8:11], s95 offen offset:1024 sc1
    v_mfma_f32_16x16x32_bf16 v[108:111], v[88:91], v[28:31], v[108:111]
    ds_read_b128 v[76:79], v5 offset:12288
    v_mfma_f32_16x16x32_bf16 v[112:115], v[92:95], v[28:31], v[112:115]
    ds_read_b128 v[88:91], v5 offset:13312
    s_waitcnt lgkmcnt(5)
    buffer_load_dwordx4 v[64:67], v6, s[8:11], s95 offen offset:2048 sc1
    v_mfma_f32_16x16x32_bf16 v[116:119], v[100:103], v[28:31], v[116:119]
    ds_read_b128 v[92:95], v5 offset:14336
    v_mfma_f32_16x16x32_bf16 v[104:107], v[80:83], v[32:35], v[104:107]
    ds_read_b128 v[100:103], v5 offset:15360
    s_waitcnt lgkmcnt(5)
    buffer_load_dwordx4 v[68:71], v6, s[8:11], s95 offen offset:3072 sc1
    v_mfma_f32_16x16x32_bf16 v[108:111], v[84:87], v[32:35], v[108:111]
    ds_read_b128 v[80:83], v5 offset:16384
    s_waitcnt vmcnt(5)
    v_mfma_f32_16x16x32_bf16 v[112:115], v[96:99], v[32:35], v[112:115]
    ds_read_b128 v[84:87], v5 offset:17408
    s_waitcnt lgkmcnt(5)
    v_mfma_f32_16x16x32_bf16 v[116:119], v[72:75], v[32:35], v[116:119]
    ds_read_b128 v[96:99], v5 offset:18432
    v_bitop3_b32 v4, v43, v47, v51 bitop3:0x80
    v_mfma_f32_16x16x32_bf16 v[104:107], v[76:79], v[36:39], v[104:107]
    ds_read_b128 v[72:75], v5 offset:19456
    s_waitcnt lgkmcnt(5)
    v_mfma_f32_16x16x32_bf16 v[108:111], v[88:91], v[36:39], v[108:111]
    ds_read_b128 v[76:79], v5 offset:20480
    v_bitop3_b32 v4, v4, v55, 1 bitop3:0x80
    v_mfma_f32_16x16x32_bf16 v[112:115], v[92:95], v[36:39], v[112:115]
    ds_read_b128 v[88:91], v5 offset:21504
    s_waitcnt lgkmcnt(5)
    v_mfma_f32_16x16x32_bf16 v[116:119], v[100:103], v[36:39], v[116:119]
    ds_read_b128 v[92:95], v5 offset:22528
    v_cmp_ne_u32 vcc, 1, v4
    s_nop 0
    s_cbranch_vccnz L_retry_145
L_back_146:
    v_mfma_f32_16x16x32_bf16 v[104:107], v[80:83], v[40:43], v[104:107]
    ds_read_b128 v[100:103], v5 offset:23552
    s_waitcnt lgkmcnt(5)
    v_mfma_f32_16x16x32_bf16 v[108:111], v[84:87], v[40:43], v[108:111]
    ds_read_b128 v[80:83], v5 offset:24576
    s_add_u32 s96, s66, 77824
    v_mfma_f32_16x16x32_bf16 v[112:115], v[96:99], v[40:43], v[112:115]
    ds_read_b128 v[84:87], v5 offset:25600
    s_waitcnt lgkmcnt(5)
    buffer_load_dwordx4 v[24:27], v6, s[8:11], s96 offen offset:0 sc1
    v_mfma_f32_16x16x32_bf16 v[116:119], v[72:75], v[40:43], v[116:119]
    ds_read_b128 v[96:99], v5 offset:26624
    v_mfma_f32_16x16x32_bf16 v[104:107], v[76:79], v[44:47], v[104:107]
    ds_read_b128 v[72:75], v5 offset:27648
    s_waitcnt lgkmcnt(5)
    buffer_load_dwordx4 v[28:31], v6, s[8:11], s96 offen offset:1024 sc1
    v_mfma_f32_16x16x32_bf16 v[108:111], v[88:91], v[44:47], v[108:111]
    ds_read_b128 v[76:79], v5 offset:28672
    v_mfma_f32_16x16x32_bf16 v[112:115], v[92:95], v[44:47], v[112:115]
    ds_read_b128 v[88:91], v5 offset:29696
    s_waitcnt lgkmcnt(5)
    buffer_load_dwordx4 v[32:35], v6, s[8:11], s96 offen offset:2048 sc1
    v_mfma_f32_16x16x32_bf16 v[116:119], v[100:103], v[44:47], v[116:119]
    ds_read_b128 v[92:95], v5 offset:30720
    v_mfma_f32_16x16x32_bf16 v[104:107], v[80:83], v[48:51], v[104:107]
    ds_read_b128 v[100:103], v5 offset:31744
    s_waitcnt lgkmcnt(5)
    buffer_load_dwordx4 v[36:39], v6, s[8:11], s96 offen offset:3072 sc1
    v_mfma_f32_16x16x32_bf16 v[108:111], v[84:87], v[48:51], v[108:111]
    ds_read_b128 v[80:83], v5 offset:32768
    v_mfma_f32_16x16x32_bf16 v[112:115], v[96:99], v[48:51], v[112:115]
    ds_read_b128 v[84:87], v5 offset:33792
    s_waitcnt lgkmcnt(5)
    v_mfma_f32_16x16x32_bf16 v[116:119], v[72:75], v[48:51], v[116:119]
    ds_read_b128 v[96:99], v5 offset:34816
    v_mfma_f32_16x16x32_bf16 v[104:107], v[76:79], v[52:55], v[104:107]
    ds_read_b128 v[72:75], v5 offset:35840
    s_waitcnt lgkmcnt(5)
    v_mfma_f32_16x16x32_bf16 v[108:111], v[88:91], v[52:55], v[108:111]
    ds_read_b128 v[76:79], v5 offset:36864
    s_waitcnt vmcnt(4)
    v_mfma_f32_16x16x32_bf16 v[112:115], v[92:95], v[52:55], v[112:115]
    ds_read_b128 v[88:91], v5 offset:37888
    s_waitcnt lgkmcnt(5)
    v_mfma_f32_16x16x32_bf16 v[116:119], v[100:103], v[52:55], v[116:119]
    ds_read_b128 v[92:95], v5 offset:38912
    v_bitop3_b32 v4, v59, v63, v67 bitop3:0x80
    v_bitop3_b32 v4, v4, v71, 1 bitop3:0x80
    v_cmp_ne_u32 vcc, 1, v4
    s_nop 0
    s_cbranch_vccnz L_retry_147
L_back_148:
    v_mfma_f32_16x16x32_bf16 v[104:107], v[80:83], v[56:59], v[104:107]
    ds_read_b128 v[100:103], v5 offset:39936
    s_waitcnt lgkmcnt(5)
    v_mfma_f32_16x16x32_bf16 v[108:111], v[84:87], v[56:59], v[108:111]
    ds_read_b128 v[80:83], v5 offset:40960
    v_mfma_f32_16x16x32_bf16 v[112:115], v[96:99], v[56:59], v[112:115]
    ds_read_b128 v[84:87], v5 offset:41984
    s_waitcnt lgkmcnt(5)
    v_mfma_f32_16x16x32_bf16 v[116:119], v[72:75], v[56:59], v[116:119]
    ds_read_b128 v[96:99], v5 offset:43008
    v_mfma_f32_16x16x32_bf16 v[104:107], v[76:79], v[60:63], v[104:107]
    ds_read_b128 v[72:75], v5 offset:44032
    s_waitcnt lgkmcnt(5)
    v_mfma_f32_16x16x32_bf16 v[108:111], v[88:91], v[60:63], v[108:111]
    ds_read_b128 v[76:79], v5 offset:45056
    v_mfma_f32_16x16x32_bf16 v[112:115], v[92:95], v[60:63], v[112:115]
    ds_read_b128 v[88:91], v5 offset:46080
    s_waitcnt lgkmcnt(5)
    v_mfma_f32_16x16x32_bf16 v[116:119], v[100:103], v[60:63], v[116:119]
    ds_read_b128 v[92:95], v5 offset:47104
    v_mfma_f32_16x16x32_bf16 v[104:107], v[80:83], v[64:67], v[104:107]
    ds_read_b128 v[100:103], v5 offset:48128
    s_waitcnt lgkmcnt(5)
    v_mfma_f32_16x16x32_bf16 v[108:111], v[84:87], v[64:67], v[108:111]
    ds_read_b128 v[80:83], v5 offset:49152
    v_mfma_f32_16x16x32_bf16 v[112:115], v[96:99], v[64:67], v[112:115]
    ds_read_b128 v[84:87], v5 offset:50176
    s_waitcnt lgkmcnt(5)
    v_mfma_f32_16x16x32_bf16 v[116:119], v[72:75], v[64:67], v[116:119]
    ds_read_b128 v[96:99], v5 offset:51200
    v_mfma_f32_16x16x32_bf16 v[104:107], v[76:79], v[68:71], v[104:107]
    ds_read_b128 v[72:75], v5 offset:52224
    s_waitcnt lgkmcnt(5)
    v_mfma_f32_16x16x32_bf16 v[108:111], v[88:91], v[68:71], v[108:111]
    ds_read_b128 v[76:79], v5 offset:53248
    s_waitcnt vmcnt(0)
    v_mfma_f32_16x16x32_bf16 v[112:115], v[92:95], v[68:71], v[112:115]
    ds_read_b128 v[88:91], v5 offset:54272
    s_waitcnt lgkmcnt(5)
    v_mfma_f32_16x16x32_bf16 v[116:119], v[100:103], v[68:71], v[116:119]
    ds_read_b128 v[92:95], v5 offset:55296
    v_bitop3_b32 v4, v27, v31, v35 bitop3:0x80
    v_bitop3_b32 v4, v4, v39, 1 bitop3:0x80
    v_cmp_ne_u32 vcc, 1, v4
    s_nop 0
    s_cbranch_vccnz L_retry_149
L_back_150:
    v_mfma_f32_16x16x32_bf16 v[104:107], v[80:83], v[24:27], v[104:107]
    ds_read_b128 v[100:103], v5 offset:56320
    s_waitcnt lgkmcnt(5)
    v_mfma_f32_16x16x32_bf16 v[108:111], v[84:87], v[24:27], v[108:111]
    ds_read_b128 v[80:83], v5 offset:57344
    v_mfma_f32_16x16x32_bf16 v[112:115], v[96:99], v[24:27], v[112:115]
    ds_read_b128 v[84:87], v5 offset:58368
    s_waitcnt lgkmcnt(5)
    v_mfma_f32_16x16x32_bf16 v[116:119], v[72:75], v[24:27], v[116:119]
    ds_read_b128 v[96:99], v5 offset:61440
    v_mfma_f32_16x16x32_bf16 v[104:107], v[76:79], v[28:31], v[104:107]
    ds_read_b128 v[72:75], v5 offset:62464
    s_waitcnt lgkmcnt(5)
    v_mfma_f32_16x16x32_bf16 v[108:111], v[88:91], v[28:31], v[108:111]
    ds_read_b128 v[76:79], v5 offset:59392
    v_mfma_f32_16x16x32_bf16 v[112:115], v[92:95], v[28:31], v[112:115]
    ds_read_b128 v[88:91], v5 offset:60416
    s_waitcnt lgkmcnt(5)
    v_mfma_f32_16x16x32_bf16 v[116:119], v[100:103], v[28:31], v[116:119]
    ds_read_b128 v[92:95], v5 offset:63488
    v_mfma_f32_16x16x32_bf16 v[104:107], v[80:83], v[32:35], v[104:107]
    ds_read_b128 v[100:103], v5 offset:64512
    s_waitcnt lgkmcnt(5)
    v_mfma_f32_16x16x32_bf16 v[108:111], v[84:87], v[32:35], v[108:111]
    v_mfma_f32_16x16x32_bf16 v[104:107], v[96:99], v[36:39], v[104:107]
    s_waitcnt lgkmcnt(3)
    v_mfma_f32_16x16x32_bf16 v[108:111], v[72:75], v[36:39], v[108:111]
    v_mfma_f32_16x16x32_bf16 v[112:115], v[76:79], v[32:35], v[112:115]
    s_waitcnt lgkmcnt(1)
    v_mfma_f32_16x16x32_bf16 v[116:119], v[88:91], v[32:35], v[116:119]
    v_mfma_f32_16x16x32_bf16 v[112:115], v[92:95], v[36:39], v[112:115]
    s_waitcnt lgkmcnt(0)
    v_mfma_f32_16x16x32_bf16 v[116:119], v[100:103], v[36:39], v[116:119]
    s_add_u32 s100, s63, 0
    s_nop 0
    v_cvt_pk_bf16_f32 v103, v110, v111
    v_cvt_pk_bf16_f32 v100, v104, v105
    v_cvt_pk_bf16_f32 v101, v106, v107
    v_cvt_pk_bf16_f32 v102, v108, v109
    v_or_b32 v103, 1, v103
    buffer_store_dwordx4 v[100:103], v6, s[8:11], s100 offen offset:0 sc1
    v_cvt_pk_bf16_f32 v127, v118, v119
    v_cvt_pk_bf16_f32 v124, v112, v113
    v_cvt_pk_bf16_f32 v125, v114, v115
    v_cvt_pk_bf16_f32 v126, v116, v117
    v_or_b32 v127, 1, v127
    buffer_store_dwordx4 v[124:127], v6, s[8:11], s100 offen offset:1024 sc1
    v_cvt_pk_bf16_f32 v103, v110, v111
    s_nop 0
    v_cvt_pk_bf16_f32 v127, v118, v119
    v_mov_b32 v96, 0x3f803f80
    v_mov_b32 v97, 0x3f803f80
    v_mov_b32 v98, 0x3f803f80
    v_mov_b32 v99, 0x3f803f80
    v_mfma_f32_16x16x32_bf16 v[108:111], v[100:103], v[100:103], 0
    v_mfma_f32_16x16x32_bf16 v[108:111], v[124:127], v[124:127], v[108:111]
    v_mfma_f32_16x16x32_bf16 v[104:107], v[96:99], v[100:103], 0
    v_mfma_f32_16x16x32_bf16 v[104:107], v[96:99], v[124:127], v[104:107]
    s_add_u32 s101, s60, 294912
    s_nop 4
    v_cndmask_b32 v108, v108, v109, s[44:45]
    v_cndmask_b32 v108, v108, v110, s[46:47]
    v_cndmask_b32 v108, v108, v111, s[48:49]
    v_or_b32 v105, 1, v108
    s_waitcnt vmcnt(0)
    s_add_u32 s73, s60, 49152
    buffer_load_dwordx4 v[40:43], v7, s[8:11], s73 offen offset:0 sc1
    buffer_load_dwordx4 v[44:47], v7, s[8:11], s73 offen offset:1024 sc1
    buffer_load_dwordx4 v[48:51], v7, s[8:11], s73 offen offset:2048 sc1
    buffer_load_dwordx4 v[52:55], v7, s[8:11], s73 offen offset:3072 sc1
    buffer_store_dwordx2 v[104:105], v10, s[8:11], s101 offen sc1
    s_waitcnt vmcnt(3)
    v_bitop3_b32 v4, v43, v47, 1 bitop3:0x80
    v_cmp_ne_u32 vcc, 1, v4
    s_nop 0
    s_cbranch_vccnz L_retry_151
L_back_152:
    ds_write_b128 v7, v[40:43] offset:16384
    ds_write_b128 v7, v[44:47] offset:17408
    s_waitcnt vmcnt(1)
    v_bitop3_b32 v4, v51, v55, 1 bitop3:0x80
    v_cmp_ne_u32 vcc, 1, v4
    s_nop 0
    s_cbranch_vccnz L_retry_153
L_back_154:
    ds_write_b128 v7, v[48:51] offset:18432
    ds_write_b128 v7, v[52:55] offset:19456
    s_waitcnt lgkmcnt(0)
L_join_130:
    s_barrier
    ds_read_b128 v[40:43], v6 offset:16384
    ds_read_b128 v[44:47], v6 offset:17408
    ds_read_b128 v[48:51], v6 offset:18432
    s_add_u32 s73, s60, 32768
    buffer_load_dwordx4 v[24:27], v7, s[8:11], s73 offen offset:0 sc1
    buffer_load_dwordx4 v[28:31], v7, s[8:11], s73 offen offset:1024 sc1
    v_bfe_u32 v98, v6, 4, 4
    v_lshlrev_b32 v98, 3, v98
    v_and_b32 v99, 0x18, v98
    v_add_u32 v98, 163328, v98
    v_lshrrev_b32 v85, 8, v6
    buffer_load_dwordx4 v[32:35], v7, s[8:11], s73 offen offset:2048 sc1
    v_lshl_add_u32 v99, v85, 5, v99
    v_add_u32 v99, 163328, v99
    s_lshl_b32 s75, s36, 7
    s_add_u32 s75, s75, 163328
    v_lshrrev_b32 v85, 6, v6
    v_lshl_add_u32 v85, v85, 3, s75
    s_add_u32 s74, s60, 294912
    s_add_u32 s74, s74, s4
    buffer_load_dwordx4 v[36:39], v7, s[8:11], s73 offen offset:3072 sc1
    s_waitcnt lgkmcnt(2)
    v_mfma_f32_16x16x32_bf16 v[72:75], a[4:7], v[40:43], 0
    ds_read_b128 v[52:55], v6 offset:19456
    v_mov_b32 v0, -1
    v_mfma_f32_16x16x32_bf16 v[68:71], a[0:3], v[40:43], 0
    ds_read_b128 v[112:115], v6 offset:20480
    v_mov_b32 v1, -1
    v_mfma_f32_16x16x32_bf16 v[76:79], v[40:43], a[8:11], 0
    s_waitcnt lgkmcnt(3)
    buffer_load_dwordx4 v[80:83], v6, s[8:11], s74 offen sc1
    v_mfma_f32_16x16x32_bf16 v[72:75], a[16:19], v[44:47], v[72:75]
    ds_read_b128 v[116:119], v6 offset:21504
    v_mov_b32 v2, -1
    v_mfma_f32_16x16x32_bf16 v[68:71], a[12:15], v[44:47], v[68:71]
    ds_read_b128 v[40:43], v6 offset:22528
    v_mov_b32 v3, -1
    v_mfma_f32_16x16x32_bf16 v[76:79], v[44:47], a[20:23], v[76:79]
    s_waitcnt lgkmcnt(3)
    v_mfma_f32_16x16x32_bf16 v[72:75], a[28:31], v[48:51], v[72:75]
    ds_read_b128 v[44:47], v6 offset:23552
    s_add_u32 s83, s62, 98304
    v_mfma_f32_16x16x32_bf16 v[68:71], a[24:27], v[48:51], v[68:71]
    buffer_store_dwordx4 v[0:3], v6, s[8:11], s83 offen sc1
    v_mfma_f32_16x16x32_bf16 v[76:79], v[48:51], a[32:35], v[76:79]
    v_mfma_f32_16x16x32_bf16 v[72:75], a[40:43], v[52:55], v[72:75]
    ds_read_b128 v[48:51], v6 offset:24576
    v_mfma_f32_16x16x32_bf16 v[68:71], a[36:39], v[52:55], v[68:71]
    v_mfma_f32_16x16x32_bf16 v[76:79], v[52:55], a[44:47], v[76:79]
    s_waitcnt lgkmcnt(3)
    v_mfma_f32_16x16x32_bf16 v[72:75], a[52:55], v[112:115], v[72:75]
    ds_read_b128 v[52:55], v6 offset:25600
    v_mfma_f32_16x16x32_bf16 v[68:71], a[48:51], v[112:115], v[68:71]
    v_mfma_f32_16x16x32_bf16 v[76:79], v[112:115], a[56:59], v[76:79]
    v_mfma_f32_16x16x32_bf16 v[72:75], a[64:67], v[116:119], v[72:75]
    ds_read_b128 v[112:115], v6 offset:26624
    v_mfma_f32_16x16x32_bf16 v[68:71], a[60:63], v[116:119], v[68:71]
    v_mfma_f32_16x16x32_bf16 v[76:79], v[116:119], a[68:71], v[76:79]
    s_waitcnt lgkmcnt(3)
    v_mfma_f32_16x16x32_bf16 v[72:75], a[76:79], v[40:43], v[72:75]
    ds_read_b128 v[116:119], v6 offset:27648
    v_mfma_f32_16x16x32_bf16 v[68:71], a[72:75], v[40:43], v[68:71]
    v_mfma_f32_16x16x32_bf16 v[76:79], v[40:43], a[80:83], v[76:79]
    v_mfma_f32_16x16x32_bf16 v[72:75], a[88:91], v[44:47], v[72:75]
    ds_read_b128 v[40:43], v6 offset:28672
    s_waitcnt vmcnt(2)
    v_mfma_f32_16x16x32_bf16 v[68:71], a[84:87], v[44:47], v[68:71]
    v_bitop3_b32 v4, v27, v31, v35 bitop3:0x80
    v_bitop3_b32 v4, v4, v39, 1 bitop3:0x80
    v_mfma_f32_16x16x32_bf16 v[76:79], v[44:47], a[92:95], v[76:79]
    s_waitcnt lgkmcnt(3)
    v_cmp_ne_u32 vcc, 1, v4
    v_mfma_f32_16x16x32_bf16 v[72:75], a[100:103], v[48:51], v[72:75]
    ds_read_b128 v[44:47], v6 offset:29696
    s_cbranch_vccnz L_retry_155
L_back_156:
    v_mfma_f32_16x16x32_bf16 v[68:71], a[96:99], v[48:51], v[68:71]
    ds_write_b128 v7, v[24:27] offset:0
    v_mfma_f32_16x16x32_bf16 v[76:79], v[48:51], a[104:107], v[76:79]
    s_waitcnt vmcnt(1)
    v_bitop3_b32 v5, v81, v83, 1 bitop3:0x80
    v_cmp_ne_u32 vcc, 1, v5
    v_mfma_f32_16x16x32_bf16 v[72:75], a[112:115], v[52:55], v[72:75]
    ds_read_b128 v[48:51], v6 offset:30720
    s_cbranch_vccnz L_retry_157
L_back_158:
    v_mfma_f32_16x16x32_bf16 v[68:71], a[108:111], v[52:55], v[68:71]
    ds_write_b128 v7, v[28:31] offset:1024
    v_mfma_f32_16x16x32_bf16 v[76:79], v[52:55], a[116:119], v[76:79]
    s_waitcnt lgkmcnt(5)
    v_add_f32 v80, v80, v82
    v_add_f32 v81, v81, v83
    v_mfma_f32_16x16x32_bf16 v[72:75], a[124:127], v[112:115], v[72:75]
    ds_read_b128 v[52:55], v6 offset:31744
    v_add_f32_dpp v82, v80, v80 quad_perm:[1,0,3,2] row_mask:0xf bank_mask:0xf
    v_mfma_f32_16x16x32_bf16 v[68:71], a[120:123], v[112:115], v[68:71]
    ds_write_b128 v7, v[32:35] offset:2048
    v_mfma_f32_16x16x32_bf16 v[76:79], v[112:115], a[128:131], v[76:79]
    v_add_f32_dpp v83, v81, v81 quad_perm:[1,0,3,2] row_mask:0xf bank_mask:0xf
    v_add_f32_dpp v80, v82, v82 quad_perm:[2,3,0,1] row_mask:0xf bank_mask:0xf
    v_mfma_f32_16x16x32_bf16 v[72:75], a[136:139], v[116:119], v[72:75]
    ds_write_b128 v7, v[36:39] offset:3072
    v_mfma_f32_16x16x32_bf16 v[68:71], a[132:135], v[116:119], v[68:71]
    v_add_f32_dpp v81, v83, v83 quad_perm:[2,3,0,1] row_mask:0xf bank_mask:0xf
    v_mul_f32 v80, 0x3b000000, v80
    v_mfma_f32_16x16x32_bf16 v[76:79], v[116:119], a[140:143], v[76:79]
    s_waitcnt lgkmcnt(7)
    v_mul_f32 v81, 0x3b000000, v81
    v_fma_f32 v81, -v80, v80, v81
    v_mfma_f32_16x16x32_bf16 v[72:75], a[148:151], v[40:43], v[72:75]
    v_max_f32 v81, 0, v81
    v_cvt_pk_bf16_f32 v80, v81, -v80
    v_mfma_f32_16x16x32_bf16 v[68:71], a[144:147], v[40:43], v[68:71]
    v_lshlrev_b32 v84, 16, v80
    v_add_f32 v84, 0x3727c5ac, v84
    v_cvt_pk_bf16_f32 v84, v84, v84
    v_lshlrev_b32 v84, 16, v84
    v_sqrt_f32 v84, v84
    v_and_b32 v83, 0xffff0000, v80
    v_cvt_pk_bf16_f32 v84, v84, v84
    v_lshlrev_b32 v84, 16, v84
    v_rcp_f32 v82, v84
    s_nop 1
    ds_write_b64 v85, v[82:83]
    v_mfma_f32_16x16x32_bf16 v[76:79], v[40:43], a[152:155], v[76:79]
    s_waitcnt lgkmcnt(0)
    s_barrier
    v_mfma_f32_16x16x32_bf16 v[72:75], a[160:163], v[44:47], v[72:75]
    ds_read_b128 v[112:115], v6 offset:0
    s_add_u32 s73, s60, 16384
    v_mfma_f32_16x16x32_bf16 v[68:71], a[156:159], v[44:47], v[68:71]
    ds_read_b128 v[116:119], v6 offset:1024
    s_lshl_b32 s72, s36, 12
    v_mfma_f32_16x16x32_bf16 v[76:79], v[44:47], a[164:167], v[76:79]
    s_add_u32 m0, s72, 16384
    ds_read_b64 v[108:109], v98 offset:384
    v_mfma_f32_16x16x32_bf16 v[72:75], a[172:175], v[48:51], v[72:75]
    ds_read_b128 v[40:43], v6 offset:2048
    v_mfma_f32_16x16x32_bf16 v[68:71], a[168:171], v[48:51], v[68:71]
    ds_read_b128 v[44:47], v6 offset:3072
    v_mfma_f32_16x16x32_bf16 v[76:79], v[48:51], a[176:179], v[76:79]
    buffer_load_dwordx4 v7, s[8:11], s73 offen offset:0 sc1 lds
    v_mfma_f32_16x16x32_bf16 v[72:75], a[184:187], v[52:55], v[72:75]
    ds_read_b128 v[48:51], v6 offset:4096
    v_mfma_f32_16x16x32_bf16 v[68:71], a[180:183], v[52:55], v[68:71]
    ds_read_b64 v[110:111], v99 offset:384
    v_mfma_f32_16x16x32_bf16 v[76:79], v[52:55], a[188:191], v[76:79]
    s_waitcnt lgkmcnt(5)
    ds_read_b64 v[104:105], v98 offset:256
    v_mfma_f32_16x16x32_bf16 v[60:63], a[4:7], v[112:115], 0
    ds_read_b128 v[52:55], v6 offset:5120
    v_mfma_f32_16x16x32_bf16 v[56:59], a[0:3], v[112:115], 0
    buffer_load_dwordx4 v7, s[8:11], s73 offen offset:1024 sc1 lds
    v_mfma_f32_16x16x32_bf16 v[64:67], v[112:115], a[8:11], 0
    ds_read_b64 v[106:107], v99 offset:256
    v_mfma_f32_16x16x32_bf16 v[60:63], a[16:19], v[116:119], v[60:63]
    ds_read_b128 v[112:115], v6 offset:6144
    v_mfma_f32_16x16x32_bf16 v[56:59], a[12:15], v[116:119], v[56:59]
    v_mfma_f32_16x16x32_bf16 v[64:67], v[116:119], a[20:23], v[64:67]
    s_waitcnt lgkmcnt(6)
    buffer_load_dwordx4 v7, s[8:11], s73 offen offset:2048 sc1 lds
    v_mfma_f32_16x16x32_bf16 v[60:63], a[28:31], v[40:43], v[60:63]
    ds_read_b128 v[116:119], v6 offset:7168
    s_waitcnt lgkmcnt(5)
    v_mfma_f32_16x16x32_bf16 v[56:59], a[24:27], v[40:43], v[56:59]
    v_fmac_f32_dpp v72, v13, v109 row_newbcast:0 row_mask:0xf bank_mask:0xf
    v_fmac_f32_dpp v73, v13, v109 row_newbcast:1 row_mask:0xf bank_mask:0xf
    v_mfma_f32_16x16x32_bf16 v[64:67], v[40:43], a[32:35], v[64:67]
    v_fmac_f32_dpp v74, v13, v109 row_newbcast:2 row_mask:0xf bank_mask:0xf
    v_fmac_f32_dpp v75, v13, v109 row_newbcast:3 row_mask:0xf bank_mask:0xf
    v_mfma_f32_16x16x32_bf16 v[60:63], a[40:43], v[44:47], v[60:63]
    ds_read_b128 v[40:43], v6 offset:8192
    v_mul_f32 v72, v108, v72
    v_mfma_f32_16x16x32_bf16 v[56:59], a[36:39], v[44:47], v[56:59]
    buffer_load_dwordx4 v7, s[8:11], s73 offen offset:3072 sc1 lds
    v_mul_f32 v73, v108, v73
    v_mfma_f32_16x16x32_bf16 v[64:67], v[44:47], a[44:47], v[64:67]
    s_waitcnt lgkmcnt(4)
    v_mul_f32 v74, v108, v74
    v_mul_f32 v75, v108, v75
    v_mfma_f32_16x16x32_bf16 v[60:63], a[52:55], v[48:51], v[60:63]
    ds_read_b128 v[44:47], v6 offset:9216
    v_cvt_pk_bf16_f32 v86, v72, v73
    v_mfma_f32_16x16x32_bf16 v[56:59], a[48:51], v[48:51], v[56:59]
    v_cvt_pk_bf16_f32 v87, v74, v75
    v_fmac_f32_dpp v68, v12, v109 row_newbcast:0 row_mask:0xf bank_mask:0xf
    v_mfma_f32_16x16x32_bf16 v[64:67], v[48:51], a[56:59], v[64:67]
    v_fmac_f32_dpp v69, v12, v109 row_newbcast:1 row_mask:0xf bank_mask:0xf
    v_fmac_f32_dpp v70, v12, v109 row_newbcast:2 row_mask:0xf bank_mask:0xf
    v_mfma_f32_16x16x32_bf16 v[60:63], a[64:67], v[52:55], v[60:63]
    ds_read_b128 v[48:51], v6 offset:10240
    v_fmac_f32_dpp v71, v12, v109 row_newbcast:3 row_mask:0xf bank_mask:0xf
    v_mfma_f32_16x16x32_bf16 v[56:59], a[60:63], v[52:55], v[56:59]
    v_cvt_pk_bf16_f32 v82, v68, v69
    v_cvt_pk_bf16_f32 v83, v70, v71
    v_mfma_f32_16x16x32_bf16 v[64:67], v[52:55], a[68:71], v[64:67]
    s_waitcnt lgkmcnt(3)
    v_mul_f32 v97, s43, v108
    v_fmac_f32_dpp v76, v111, v120 row_newbcast:0 row_mask:0xf bank_mask:0xf
    v_mfma_f32_16x16x32_bf16 v[60:63], a[76:79], v[112:115], v[60:63]
    ds_read_b128 v[52:55], v6 offset:11264
    v_fmac_f32_dpp v77, v111, v120 row_newbcast:1 row_mask:0xf bank_mask:0xf
    v_mfma_f32_16x16x32_bf16 v[56:59], a[72:75], v[112:115], v[56:59]
    v_fmac_f32_dpp v78, v111, v120 row_newbcast:2 row_mask:0xf bank_mask:0xf
    v_fmac_f32_dpp v79, v111, v120 row_newbcast:3 row_mask:0xf bank_mask:0xf
    v_mfma_f32_16x16x32_bf16 v[64:67], v[112:115], a[80:83], v[64:67]
    v_mul_f32_dpp v76, v110, v76 row_newbcast:0 row_mask:0xf bank_mask:0xf
    v_mul_f32_dpp v77, v110, v77 row_newbcast:1 row_mask:0xf bank_mask:0xf
    v_mfma_f32_16x16x32_bf16 v[60:63], a[88:91], v[116:119], v[60:63]
    ds_read_b128 v[112:115], v6 offset:12288
    v_mul_f32_dpp v78, v110, v78 row_newbcast:2 row_mask:0xf bank_mask:0xf
    v_mfma_f32_16x16x32_bf16 v[56:59], a[84:87], v[116:119], v[56:59]
    v_mul_f32_dpp v79, v110, v79 row_newbcast:3 row_mask:0xf bank_mask:0xf
    v_cvt_pk_bf16_f32 v94, v76, v77
    v_mfma_f32_16x16x32_bf16 v[64:67], v[116:119], a[92:95], v[64:67]
    s_waitcnt lgkmcnt(3)
    v_cvt_pk_bf16_f32 v95, v78, v79
    v_mfma_f32_16x16x32_bf16 v[60:63], a[100:103], v[40:43], v[60:63]
    ds_read_b128 v[116:119], v6 offset:13312
    v_mfma_f32_16x16x32_bf16 v[56:59], a[96:99], v[40:43], v[56:59]
    ds_read_b64 v[108:109], v98 offset:128
    v_mfma_f32_16x16x32_bf16 v[64:67], v[40:43], a[104:107], v[64:67]
    ds_read_b64 v[110:111], v99 offset:128
    v_mov_b32 v68, v86
    v_mfma_f32_16x16x32_bf16 v[60:63], a[112:115], v[44:47], v[60:63]
    ds_read_b128 v[40:43], v6 offset:14336
    v_mov_b32 v69, v87
    v_mfma_f32_16x16x32_bf16 v[56:59], a[108:111], v[44:47], v[56:59]
    s_add_u32 s78, s62, 65536
    v_mov_b32 v70, v94
    v_min_u32 v71, -2, v95
    v_mfma_f32_16x16x32_bf16 v[64:67], v[44:47], a[116:119], v[64:67]
    s_waitcnt lgkmcnt(5)
    s_waitcnt vmcnt(4)
    v_mfma_f32_16x16x32_bf16 v[60:63], a[124:127], v[48:51], v[60:63]
    ds_read_b128 v[44:47], v6 offset:15360
    v_mfma_f32_16x16x32_bf16 v[56:59], a[120:123], v[48:51], v[56:59]
    buffer_store_dwordx4 v[68:71], v6, s[8:11], s78 offen sc1
    v_mfma_f32_16x16x32_bf16 v[64:67], v[48:51], a[128:131], v[64:67]
    v_mfma_f32_16x16x32_bf16 v[60:63], a[136:139], v[52:55], v[60:63]
    v_mfma_f32_16x16x32_bf16 v[56:59], a[132:135], v[52:55], v[56:59]
    v_mfma_f32_16x16x32_bf16 v[64:67], v[52:55], a[140:143], v[64:67]
    s_waitcnt lgkmcnt(5)
    v_mfma_f32_16x16x32_bf16 v[60:63], a[148:151], v[112:115], v[60:63]
    v_mfma_f32_16x16x32_bf16 v[56:59], a[144:147], v[112:115], v[56:59]
    v_mfma_f32_16x16x32_bf16 v[64:67], v[112:115], a[152:155], v[64:67]
    s_waitcnt lgkmcnt(0) vmcnt(1)
    s_barrier
    s_add_u32 s73, s60, 0
    v_mfma_f32_16x16x32_bf16 v[60:63], a[160:163], v[116:119], v[60:63]
    ds_read_b128 v[48:51], v6 offset:16384
    s_lshl_b32 s72, s36, 12
    v_mfma_f32_16x16x32_bf16 v[56:59], a[156:159], v[116:119], v[56:59]
    ds_read_b128 v[52:55], v6 offset:17408
    s_add_u32 m0, s72, 0
    v_mfma_f32_16x16x32_bf16 v[64:67], v[116:119], a[164:167], v[64:67]
    buffer_load_dwordx4 v7, s[8:11], s73 offen offset:0 sc1 lds
    v_mfma_f32_16x16x32_bf16 v[60:63], a[172:175], v[40:43], v[60:63]
    ds_read_b128 v[112:115], v6 offset:18432
    v_mfma_f32_16x16x32_bf16 v[56:59], a[168:171], v[40:43], v[56:59]
    ds_read_b128 v[116:119], v6 offset:19456
    v_mfma_f32_16x16x32_bf16 v[64:67], v[40:43], a[176:179], v[64:67]
    v_mfma_f32_16x16x32_bf16 v[60:63], a[184:187], v[44:47], v[60:63]
    ds_read_b128 v[40:43], v6 offset:20480
    v_mfma_f32_16x16x32_bf16 v[56:59], a[180:183], v[44:47], v[56:59]
    buffer_load_dwordx4 v7, s[8:11], s73 offen offset:1024 sc1 lds
    v_mfma_f32_16x16x32_bf16 v[64:67], v[44:47], a[188:191], v[64:67]
    s_waitcnt lgkmcnt(3)
    s_waitcnt lgkmcnt(15)
    s_nop 0
    v_mfma_f32_16x16x32_bf16 v[72:75], a[4:7], v[48:51], 0
    ds_read_b128 v[44:47], v6 offset:21504
    v_fmac_f32_dpp v60, v13, v105 row_newbcast:0 row_mask:0xf bank_mask:0xf
    v_mfma_f32_16x16x32_bf16 v[68:71], a[0:3], v[48:51], 0
    v_fmac_f32_dpp v61, v13, v105 row_newbcast:1 row_mask:0xf bank_mask:0xf
    v_fmac_f32_dpp v62, v13, v105 row_newbcast:2 row_mask:0xf bank_mask:0xf
    v_mfma_f32_16x16x32_bf16 v[76:79], v[48:51], a[8:11], 0
    buffer_load_dwordx4 v7, s[8:11], s73 offen offset:2048 sc1 lds
    v_fmac_f32_dpp v63, v13, v105 row_newbcast:3 row_mask:0xf bank_mask:0xf
    v_mfma_f32_16x16x32_bf16 v[72:75], a[16:19], v[52:55], v[72:75]
    ds_read_b128 v[48:51], v6 offset:22528
    v_mul_f32 v60, v104, v60
    v_mfma_f32_16x16x32_bf16 v[68:71], a[12:15], v[52:55], v[68:71]
    v_mul_f32 v61, v104, v61
    v_mul_f32 v62, v104, v62
    v_mfma_f32_16x16x32_bf16 v[76:79], v[52:55], a[20:23], v[76:79]
    s_waitcnt lgkmcnt(3)
    v_mul_f32 v63, v104, v63
    v_cvt_pk_bf16_f32 v84, v60, v61
    v_mfma_f32_16x16x32_bf16 v[72:75], a[28:31], v[112:115], v[72:75]
    ds_read_b128 v[52:55], v6 offset:23552
    v_cvt_pk_bf16_f32 v85, v62, v63
    v_mfma_f32_16x16x32_bf16 v[68:71], a[24:27], v[112:115], v[68:71]
    buffer_load_dwordx4 v7, s[8:11], s73 offen offset:3072 sc1 lds
    v_fmac_f32_dpp v56, v12, v105 row_newbcast:0 row_mask:0xf bank_mask:0xf
    v_mfma_f32_16x16x16_bf16 v[60:63], v[84:85], v[82:83], v[16:19]
    v_fmac_f32_dpp v57, v12, v105 row_newbcast:1 row_mask:0xf bank_mask:0xf
    v_fmac_f32_dpp v58, v12, v105 row_newbcast:2 row_mask:0xf bank_mask:0xf
    v_mfma_f32_16x16x32_bf16 v[76:79], v[112:115], a[32:35], v[76:79]
    v_fmac_f32_dpp v59, v12, v105 row_newbcast:3 row_mask:0xf bank_mask:0xf
    v_cvt_pk_bf16_f32 v80, v56, v57
    v_mfma_f32_16x16x32_bf16 v[72:75], a[40:43], v[116:119], v[72:75]
    ds_read_b128 v[112:115], v6 offset:24576
    v_cvt_pk_bf16_f32 v81, v58, v59
    v_mfma_f32_16x16x32_bf16 v[68:71], a[36:39], v[116:119], v[68:71]
    v_mul_f32 v96, s43, v104
    v_fmac_f32_dpp v64, v107, v120 row_newbcast:0 row_mask:0xf bank_mask:0xf
    v_mfma_f32_16x16x16_bf16 v[56:59], v[86:87], v[82:83], v[16:19]
    v_fmac_f32_dpp v65, v107, v120 row_newbcast:1 row_mask:0xf bank_mask:0xf
    v_fmac_f32_dpp v66, v107, v120 row_newbcast:2 row_mask:0xf bank_mask:0xf
    v_mfma_f32_16x16x32_bf16 v[76:79], v[116:119], a[44:47], v[76:79]
    s_waitcnt lgkmcnt(3)
    v_fmac_f32_dpp v67, v107, v120 row_newbcast:3 row_mask:0xf bank_mask:0xf
    v_mul_f32_dpp v64, v106, v64 row_newbcast:0 row_mask:0xf bank_mask:0xf
    v_mfma_f32_16x16x32_bf16 v[72:75], a[52:55], v[40:43], v[72:75]
    ds_read_b128 v[116:119], v6 offset:25600
    v_mul_f32_dpp v65, v106, v65 row_newbcast:1 row_mask:0xf bank_mask:0xf
    v_mfma_f32_16x16x32_bf16 v[68:71], a[48:51], v[40:43], v[68:71]
    v_mul_f32_dpp v66, v106, v66 row_newbcast:2 row_mask:0xf bank_mask:0xf
    v_mul_f32_dpp v67, v106, v67 row_newbcast:3 row_mask:0xf bank_mask:0xf
    v_mfma_f32_16x16x32_bf16 v[76:79], v[40:43], a[56:59], v[76:79]
    v_cvt_pk_bf16_f32 v92, v64, v65
    v_cvt_pk_bf16_f32 v93, v66, v67
    v_mfma_f32_16x16x32_bf16 v[72:75], a[64:67], v[44:47], v[72:75]
    ds_read_b128 v[40:43], v6 offset:26624
    v_cndmask_b32 v56, v60, v56, s[28:29]
    v_mfma_f32_16x16x32_bf16 v[68:71], a[60:63], v[44:47], v[68:71]
    ds_read_b64 v[104:105], v98 offset:0
    v_cndmask_b32 v57, v61, v57, s[30:31]
    v_mfma_f32_16x16x32_bf16 v[76:79], v[44:47], a[68:71], v[76:79]
    s_waitcnt lgkmcnt(4)
    ds_read_b64 v[106:107], v99 offset:0
    v_mfma_f32_16x16x32_bf16 v[72:75], a[76:79], v[48:51], v[72:75]
    ds_read_b128 v[44:47], v6 offset:27648
    v_cndmask_b32 v58, v62, v58, s[32:33]
    v_mfma_f32_16x16x32_bf16 v[68:71], a[72:75], v[48:51], v[68:71]
    v_cndmask_b32 v59, v63, v59, s[34:35]
    v_max3_f32 v60, v56, v57, v58
    v_mfma_f32_16x16x32_bf16 v[76:79], v[48:51], a[80:83], v[76:79]
    v_max_f32 v61, v60, v59
    v_max_f32 v60, v60, v59
    v_mfma_f32_16x16x32_bf16 v[72:75], a[88:91], v[52:55], v[72:75]
    ds_read_b128 v[48:51], v6 offset:28672
    v_mfma_f32_16x16x32_bf16 v[68:71], a[84:87], v[52:55], v[68:71]
    v_permlane32_swap_b32 v60, v61
    v_mfma_f32_16x16x32_bf16 v[76:79], v[52:55], a[92:95], v[76:79]
    s_waitcnt lgkmcnt(5)
    v_max_f32 v62, v60, v61
    v_max_f32 v60, v60, v61
    v_mfma_f32_16x16x32_bf16 v[72:75], a[100:103], v[112:115], v[72:75]
    ds_read_b128 v[52:55], v6 offset:29696
    v_mfma_f32_16x16x32_bf16 v[68:71], a[96:99], v[112:115], v[68:71]
    v_permlane16_swap_b32 v60, v62
    v_mfma_f32_16x16x32_bf16 v[76:79], v[112:115], a[104:107], v[76:79]
    v_max_f32 v60, v60, v62
    v_mul_f32 v60, -v60, v97
    v_mfma_f32_16x16x32_bf16 v[72:75], a[112:115], v[116:119], v[72:75]
    ds_read_b128 v[112:115], v6 offset:30720
    v_fma_f32 v56, v56, v97, v60
    v_mfma_f32_16x16x32_bf16 v[68:71], a[108:111], v[116:119], v[68:71]
    v_fma_f32 v57, v57, v97, v60
    v_fma_f32 v58, v58, v97, v60
    v_mfma_f32_16x16x32_bf16 v[76:79], v[116:119], a[116:119], v[76:79]
    s_waitcnt lgkmcnt(3)
    v_fma_f32 v59, v59, v97, v60
    v_mfma_f32_16x16x32_bf16 v[72:75], a[124:127], v[40:43], v[72:75]
    ds_read_b128 v[116:119], v6 offset:31744
    v_mfma_f32_16x16x32_bf16 v[68:71], a[120:123], v[40:43], v[68:71]
    v_exp_f32 v56, v56
    v_mfma_f32_16x16x32_bf16 v[76:79], v[40:43], a[128:131], v[76:79]
    s_add_u32 s75, s61, 65536
    v_exp_f32 v57, v57
    v_mfma_f32_16x16x32_bf16 v[72:75], a[136:139], v[44:47], v[72:75]
    buffer_load_dwordx4 v[88:91], v6, s[8:11], s75 offen sc1
    v_mfma_f32_16x16x32_bf16 v[68:71], a[132:135], v[44:47], v[68:71]
    v_exp_f32 v58, v58
    v_mfma_f32_16x16x32_bf16 v[76:79], v[44:47], a[140:143], v[76:79]
    s_waitcnt lgkmcnt(3)
    v_exp_f32 v59, v59
    v_mfma_f32_16x16x32_bf16 v[72:75], a[148:151], v[48:51], v[72:75]
    v_cvt_pk_bf16_f32 v0, v56, v57
    v_cvt_pk_bf16_f32 v1, v58, v59
    v_mfma_f32_16x16x32_bf16 v[68:71], a[144:147], v[48:51], v[68:71]
    v_and_b32 v62, v0, v20
    v_and_b32 v63, v1, v21
    v_mfma_f32_16x16x16_bf16 v[56:59], v[22:23], v[0:1], 0
    v_xor_b32 v60, v0, v62
    v_xor_b32 v61, v1, v63
    v_mfma_f32_16x16x32_bf16 v[76:79], v[48:51], a[152:155], v[76:79]
    s_waitcnt lgkmcnt(0) vmcnt(1)
    s_barrier
    v_mfma_f32_16x16x32_bf16 v[64:67], v[92:95], v[60:63], 0
    s_lshl_b32 s73, s37, 16
    s_add_u32 s73, s73, 64512
    s_mov_b32 m0, 162816
    v_mfma_f32_16x16x32_bf16 v[72:75], a[160:163], v[52:55], v[72:75]
    ds_read_b128 v[40:43], v6 offset:0
    v_mfma_f32_16x16x32_bf16 v[68:71], a[156:159], v[52:55], v[68:71]
    ds_read_b128 v[44:47], v6 offset:1024
    v_mfma_f32_16x16x32_bf16 v[76:79], v[52:55], a[164:167], v[76:79]
    buffer_load_dwordx4 v6, s[8:11], s73 offen sc1 lds
    v_mfma_f32_16x16x32_bf16 v[72:75], a[172:175], v[112:115], v[72:75]
    ds_read_b128 v[48:51], v6 offset:2048
    v_mfma_f32_16x16x32_bf16 v[68:71], a[168:171], v[112:115], v[68:71]
    ds_read_b128 v[52:55], v6 offset:3072
    v_mfma_f32_16x16x32_bf16 v[76:79], v[112:115], a[176:179], v[76:79]
    v_rcp_f32 v56, v56
    v_mfma_f32_16x16x32_bf16 v[72:75], a[184:187], v[116:119], v[72:75]
    ds_read_b128 v[112:115], v6 offset:4096
    v_mul_f32 v64, v56, v64
    v_mfma_f32_16x16x32_bf16 v[68:71], a[180:183], v[116:119], v[68:71]
    v_mul_f32 v65, v56, v65
    v_mul_f32 v66, v56, v66
    v_mfma_f32_16x16x32_bf16 v[76:79], v[116:119], a[188:191], v[76:79]
    s_waitcnt lgkmcnt(3)
    v_mul_f32 v67, v56, v67
    v_cvt_pk_bf16_f32 v1, v66, v67
    v_cvt_pk_bf16_f32 v0, v64, v65
    v_mfma_f32_16x16x32_bf16 v[60:63], a[4:7], v[40:43], 0
    ds_read_b128 v[116:119], v6 offset:5120
    s_waitcnt lgkmcnt(15)
    v_mfma_f32_16x16x32_bf16 v[56:59], a[0:3], v[40:43], 0
    ds_read_b128 v[24:27], v6 offset:6144
    v_fmac_f32_dpp v72, v13, v109 row_newbcast:0 row_mask:0xf bank_mask:0xf
    v_mfma_f32_16x16x32_bf16 v[64:67], v[40:43], a[8:11], 0
    v_fmac_f32_dpp v73, v13, v109 row_newbcast:1 row_mask:0xf bank_mask:0xf
    v_fmac_f32_dpp v74, v13, v109 row_newbcast:2 row_mask:0xf bank_mask:0xf
    v_mfma_f32_16x16x32_bf16 v[60:63], a[16:19], v[44:47], v[60:63]
    ds_read_b128 v[28:31], v6 offset:7168
    v_fmac_f32_dpp v75, v13, v109 row_newbcast:3 row_mask:0xf bank_mask:0xf
    v_mfma_f32_16x16x32_bf16 v[56:59], a[12:15], v[44:47], v[56:59]
    ds_read_b128 v[32:35], v6 offset:8192
    v_mul_f32 v72, v108, v72
    v_mfma_f32_16x16x32_bf16 v[64:67], v[44:47], a[20:23], v[64:67]
    s_waitcnt lgkmcnt(5)
    v_mul_f32 v73, v108, v73
    v_mul_f32 v74, v108, v74
    v_mfma_f32_16x16x32_bf16 v[60:63], a[28:31], v[48:51], v[60:63]
    ds_read_b128 v[36:39], v6 offset:9216
    v_mul_f32 v75, v108, v75
    v_mfma_f32_16x16x32_bf16 v[56:59], a[24:27], v[48:51], v[56:59]
    ds_read_b128 v[40:43], v6 offset:10240
    v_cvt_pk_bf16_f32 v86, v72, v73
    v_mfma_f32_16x16x32_bf16 v[64:67], v[48:51], a[32:35], v[64:67]
    v_cvt_pk_bf16_f32 v87, v74, v75
    v_fmac_f32_dpp v68, v12, v109 row_newbcast:0 row_mask:0xf bank_mask:0xf
    v_mfma_f32_16x16x32_bf16 v[60:63], a[40:43], v[52:55], v[60:63]
    ds_read_b128 v[44:47], v6 offset:11264
    v_fmac_f32_dpp v69, v12, v109 row_newbcast:1 row_mask:0xf bank_mask:0xf
    v_mfma_f32_16x16x16_bf16 v[72:75], v[86:87], v[80:81], v[16:19]
    v_fmac_f32_dpp v70, v12, v109 row_newbcast:2 row_mask:0xf bank_mask:0xf
    v_fmac_f32_dpp v71, v12, v109 row_newbcast:3 row_mask:0xf bank_mask:0xf
    v_mfma_f32_16x16x32_bf16 v[56:59], a[36:39], v[52:55], v[56:59]
    ds_read_b128 v[48:51], v6 offset:12288
    v_cvt_pk_bf16_f32 v82, v68, v69
    v_mfma_f32_16x16x32_bf16 v[64:67], v[52:55], a[44:47], v[64:67]
    s_waitcnt lgkmcnt(7)
    v_cvt_pk_bf16_f32 v83, v70, v71
    v_mul_f32 v97, s43, v108
    v_mfma_f32_16x16x16_bf16 v[68:71], v[84:85], v[80:81], v[16:19]
    v_fmac_f32_dpp v76, v111, v120 row_newbcast:0 row_mask:0xf bank_mask:0xf
    v_fmac_f32_dpp v77, v111, v120 row_newbcast:1 row_mask:0xf bank_mask:0xf
    v_mfma_f32_16x16x32_bf16 v[60:63], a[52:55], v[112:115], v[60:63]
    ds_read_b128 v[52:55], v6 offset:13312
    v_fmac_f32_dpp v78, v111, v120 row_newbcast:2 row_mask:0xf bank_mask:0xf
    v_mfma_f32_16x16x32_bf16 v[56:59], a[48:51], v[112:115], v[56:59]
    v_fmac_f32_dpp v79, v111, v120 row_newbcast:3 row_mask:0xf bank_mask:0xf
    v_mul_f32_dpp v76, v110, v76 row_newbcast:0 row_mask:0xf bank_mask:0xf
    v_mfma_f32_16x16x32_bf16 v[64:67], v[112:115], a[56:59], v[64:67]
    v_mul_f32_dpp v77, v110, v77 row_newbcast:1 row_mask:0xf bank_mask:0xf
    v_mul_f32_dpp v78, v110, v78 row_newbcast:2 row_mask:0xf bank_mask:0xf
    v_mfma_f32_16x16x32_bf16 v[60:63], a[64:67], v[116:119], v[60:63]
    ds_read_b128 v[112:115], v6 offset:14336
    v_mul_f32_dpp v79, v110, v79 row_newbcast:3 row_mask:0xf bank_mask:0xf
    v_mfma_f32_16x16x32_bf16 v[56:59], a[60:63], v[116:119], v[56:59]
    v_cvt_pk_bf16_f32 v94, v76, v77
    v_cvt_pk_bf16_f32 v95, v78, v79
    v_mfma_f32_16x16x32_bf16 v[64:67], v[116:119], a[68:71], v[64:67]
    s_waitcnt lgkmcnt(7)
    v_cndmask_b32 v68, v72, v68, s[28:29]
    v_cndmask_b32 v69, v73, v69, s[30:31]
    v_mfma_f32_16x16x32_bf16 v[60:63], a[76:79], v[24:27], v[60:63]
    ds_read_b128 v[116:119], v6 offset:15360
    v_cndmask_b32 v70, v74, v70, s[32:33]
    v_mfma_f32_16x16x32_bf16 v[56:59], a[72:75], v[24:27], v[56:59]
    v_cndmask_b32 v71, v75, v71, s[34:35]
    v_max3_f32 v72, v68, v69, v70
    v_mfma_f32_16x16x32_bf16 v[64:67], v[24:27], a[80:83], v[64:67]
    v_max_f32 v73, v72, v71
    v_max_f32 v72, v72, v71
    v_mfma_f32_16x16x32_bf16 v[60:63], a[88:91], v[28:31], v[60:63]
    s_nop 0
    v_permlane32_swap_b32 v72, v73
    v_mfma_f32_16x16x32_bf16 v[56:59], a[84:87], v[28:31], v[56:59]
    s_waitcnt lgkmcnt(6)
    v_max_f32 v74, v72, v73
    v_max_f32 v72, v72, v73
    v_mfma_f32_16x16x32_bf16 v[60:63], a[100:103], v[32:35], v[60:63]
    s_nop 0
    v_permlane16_swap_b32 v72, v74
    v_mfma_f32_16x16x32_bf16 v[56:59], a[96:99], v[32:35], v[56:59]
    v_max_f32 v72, v72, v74
    v_mul_f32 v72, -v72, v96
    v_mfma_f32_16x16x32_bf16 v[60:63], a[112:115], v[36:39], v[60:63]
    v_fma_f32 v68, v68, v96, v72
    v_fma_f32 v69, v69, v96, v72
    v_mfma_f32_16x16x32_bf16 v[56:59], a[108:111], v[36:39], v[56:59]
    s_waitcnt lgkmcnt(4)
    v_fma_f32 v70, v70, v96, v72
    v_fma_f32 v71, v71, v96, v72
    v_mfma_f32_16x16x32_bf16 v[60:63], a[124:127], v[40:43], v[60:63]
    v_exp_f32 v68, v68
    v_mfma_f32_16x16x32_bf16 v[56:59], a[120:123], v[40:43], v[56:59]
    v_exp_f32 v69, v69
    v_mfma_f32_16x16x32_bf16 v[60:63], a[136:139], v[44:47], v[60:63]
    v_exp_f32 v70, v70
    v_mfma_f32_16x16x32_bf16 v[56:59], a[132:135], v[44:47], v[56:59]
    s_waitcnt lgkmcnt(3)
    v_exp_f32 v71, v71
    v_mfma_f32_16x16x32_bf16 v[60:63], a[148:151], v[48:51], v[60:63]
    v_cvt_pk_bf16_f32 v2, v68, v69
    v_cvt_pk_bf16_f32 v3, v70, v71
    v_mfma_f32_16x16x32_bf16 v[56:59], a[144:147], v[48:51], v[56:59]
    s_waitcnt lgkmcnt(2)
    v_and_b32 v72, v2, v20
    v_and_b32 v73, v3, v21
    v_mfma_f32_16x16x16_bf16 v[68:71], v[22:23], v[2:3], 0
    v_xor_b32 v74, v2, v72
    v_xor_b32 v75, v3, v73
    v_mfma_f32_16x16x32_bf16 v[60:63], a[160:163], v[52:55], v[60:63]
    s_add_u32 s80, s65, 98304
    v_mfma_f32_16x16x32_bf16 v[76:79], v[92:95], v[72:75], 0
    s_waitcnt vmcnt(1)
    v_cmp_eq_u32 vcc, -1, v91
    v_mfma_f32_16x16x32_bf16 v[56:59], a[156:159], v[52:55], v[56:59]
    s_waitcnt lgkmcnt(1)
    v_rcp_f32 v68, v68
    v_mfma_f32_16x16x32_bf16 v[60:63], a[172:175], v[112:115], v[60:63]
    s_cbranch_vccnz L_retry_159
L_back_160:
    v_mfma_f32_16x16x32_bf16 v[56:59], a[168:171], v[112:115], v[56:59]
    s_waitcnt lgkmcnt(0)
    v_mul_f32 v76, v68, v76
    v_mul_f32 v77, v68, v77
    v_mfma_f32_16x16x32_bf16 v[60:63], a[184:187], v[116:119], v[60:63]
    v_mul_f32 v78, v68, v78
    v_mul_f32 v79, v68, v79
    v_mfma_f32_16x16x32_bf16 v[56:59], a[180:183], v[116:119], v[56:59]
    v_cvt_pk_bf16_f32 v3, v78, v79
    v_cvt_pk_bf16_f32 v2, v76, v77
    v_mfma_f32_16x16x32_bf16 v[64:67], v[28:31], a[92:95], v[64:67]
    v_permlane16_swap_b32 v1, v3
    v_mfma_f32_16x16x32_bf16 v[64:67], v[32:35], a[104:107], v[64:67]
    v_permlane16_swap_b32 v0, v2
    v_mfma_f32_16x16x32_bf16 v[64:67], v[36:39], a[116:119], v[64:67]
    v_and_b32 v3, -2, v3
    v_fmac_f32_dpp v60, v13, v105 row_newbcast:0 row_mask:0xf bank_mask:0xf
    v_mfma_f32_16x16x32_bf16 v[64:67], v[40:43], a[128:131], v[64:67]
    buffer_store_dwordx4 v[0:3], v8, s[8:11], s80 offen sc1
    v_mfma_f32_16x16x32_bf16 v[64:67], v[44:47], a[140:143], v[64:67]
    v_fmac_f32_dpp v61, v13, v105 row_newbcast:1 row_mask:0xf bank_mask:0xf
    v_fmac_f32_dpp v62, v13, v105 row_newbcast:2 row_mask:0xf bank_mask:0xf
    v_mfma_f32_16x16x32_bf16 v[64:67], v[48:51], a[152:155], v[64:67]
    v_fmac_f32_dpp v63, v13, v105 row_newbcast:3 row_mask:0xf bank_mask:0xf
    v_mul_f32 v60, v104, v60
    v_mfma_f32_16x16x32_bf16 v[64:67], v[52:55], a[164:167], v[64:67]
    v_mul_f32 v61, v104, v61
    v_mul_f32 v62, v104, v62
    v_mfma_f32_16x16x32_bf16 v[64:67], v[112:115], a[176:179], v[64:67]
    v_mul_f32 v63, v104, v63
    v_cvt_pk_bf16_f32 v84, v60, v61
    v_mfma_f32_16x16x32_bf16 v[64:67], v[116:119], a[188:191], v[64:67]
    v_cvt_pk_bf16_f32 v85, v62, v63
    v_fmac_f32_dpp v56, v12, v105 row_newbcast:0 row_mask:0xf bank_mask:0xf
    v_fmac_f32_dpp v57, v12, v105 row_newbcast:1 row_mask:0xf bank_mask:0xf
    v_mfma_f32_16x16x16_bf16 v[72:75], v[84:85], v[82:83], v[16:19]
    v_fmac_f32_dpp v58, v12, v105 row_newbcast:2 row_mask:0xf bank_mask:0xf
    v_fmac_f32_dpp v59, v12, v105 row_newbcast:3 row_mask:0xf bank_mask:0xf
    v_mfma_f32_16x16x16_bf16 v[68:71], v[86:87], v[82:83], v[16:19]
    v_cvt_pk_bf16_f32 v80, v56, v57
    v_cvt_pk_bf16_f32 v81, v58, v59
    v_mul_f32 v96, s43, v104
    v_add_f32 v60, s42, v16
    v_add_f32 v61, s42, v17
    v_add_f32 v62, s42, v18
    v_add_f32 v63, s42, v19
    v_mfma_f32_16x16x16_bf16 v[56:59], v[84:85], v[80:81], v[16:19]
    v_cndmask_b32 v68, v72, v68, s[28:29]
    v_cndmask_b32 v69, v73, v69, s[30:31]
    v_mfma_f32_16x16x16_bf16 v[60:63], v[88:89], v[80:81], v[60:63]
    v_cndmask_b32 v70, v74, v70, s[32:33]
    v_cndmask_b32 v71, v75, v71, s[34:35]
    v_max3_f32 v72, v68, v69, v70
    v_max_f32 v73, v72, v71
    v_max_f32 v72, v72, v71
    v_fmac_f32_dpp v64, v107, v120 row_newbcast:0 row_mask:0xf bank_mask:0xf
    v_fmac_f32_dpp v65, v107, v120 row_newbcast:1 row_mask:0xf bank_mask:0xf
    v_permlane32_swap_b32 v72, v73
    v_cndmask_b32 v56, v60, v56, s[28:29]
    v_cndmask_b32 v57, v61, v57, s[30:31]
    v_cndmask_b32 v58, v62, v58, s[32:33]
    v_cndmask_b32 v59, v63, v59, s[34:35]
    v_max3_f32 v60, v56, v57, v58
    v_max_f32 v61, v60, v59
    v_max_f32 v60, v60, v59
    v_max_f32 v74, v72, v73
    v_max_f32 v72, v72, v73
    v_permlane32_swap_b32 v60, v61
    v_max_f32 v62, v60, v61
    v_max_f32 v60, v60, v61
    v_permlane16_swap_b32 v72, v74
    v_max_f32 v72, v72, v74
    v_permlane16_swap_b32 v60, v62
    v_max_f32 v60, v60, v62
    v_mul_f32 v60, -v60, v96
    v_fma_f32 v56, v56, v96, v60
    v_fma_f32 v57, v57, v96, v60
    v_fma_f32 v58, v58, v96, v60
    v_fma_f32 v59, v59, v96, v60
    v_mul_f32 v72, -v72, v97
    v_exp_f32 v56, v56
    v_fma_f32 v68, v68, v97, v72
    v_exp_f32 v57, v57
    v_fma_f32 v69, v69, v97, v72
    v_exp_f32 v58, v58
    v_fma_f32 v70, v70, v97, v72
    v_exp_f32 v59, v59
    v_fma_f32 v71, v71, v97, v72
    v_cvt_pk_bf16_f32 v2, v56, v57
    v_exp_f32 v68, v68
    v_cvt_pk_bf16_f32 v3, v58, v59
    v_exp_f32 v69, v69
    v_and_b32 v62, v2, v20
    v_exp_f32 v70, v70
    v_and_b32 v63, v3, v21
    v_mfma_f32_16x16x16_bf16 v[56:59], v[22:23], v[2:3], 0
    s_add_u32 s84, s66, 65536
    s_mov_b64 exec, s[54:55]
    buffer_load_dwordx4 v[24:27], v6, s[8:11], s84 offen offset:0 sc1
    buffer_load_dwordx4 v[28:31], v6, s[8:11], s84 offen offset:1024 sc1
    s_mov_b64 exec, -1
    v_exp_f32 v71, v71
    v_cvt_pk_bf16_f32 v0, v68, v69
    v_xor_b32 v60, v2, v62
    v_cvt_pk_bf16_f32 v1, v70, v71
    v_xor_b32 v61, v3, v63
    v_and_b32 v74, v0, v20
    s_add_u32 s82, s65, 65536
    v_and_b32 v75, v1, v21
    v_mfma_f32_16x16x16_bf16 v[68:71], v[22:23], v[0:1], 0
    s_mov_b64 exec, s[54:55]
    buffer_load_dwordx4 v[32:35], v6, s[8:11], s84 offen offset:2048 sc1
    buffer_load_dwordx4 v[36:39], v6, s[8:11], s84 offen offset:3072 sc1
    s_mov_b64 exec, -1
    s_add_u32 s85, s66, 69632
    v_xor_b32 v72, v0, v74
    v_xor_b32 v73, v1, v75
    v_fmac_f32_dpp v66, v107, v120 row_newbcast:2 row_mask:0xf bank_mask:0xf
    v_fmac_f32_dpp v67, v107, v120 row_newbcast:3 row_mask:0xf bank_mask:0xf
    v_mul_f32_dpp v64, v106, v64 row_newbcast:0 row_mask:0xf bank_mask:0xf
    v_mul_f32_dpp v65, v106, v65 row_newbcast:1 row_mask:0xf bank_mask:0xf
    v_mul_f32_dpp v66, v106, v66 row_newbcast:2 row_mask:0xf bank_mask:0xf
    v_add_u32 v5, 32768, v6
    s_mov_b64 exec, s[54:55]
    buffer_load_dwordx4 v[40:43], v6, s[8:11], s85 offen offset:0 sc1
    buffer_load_dwordx4 v[44:47], v6, s[8:11], s85 offen offset:1024 sc1
    s_mov_b64 exec, -1
    ds_read_b128 v[80:83], v5 offset:0
    ds_read_b128 v[84:87], v5 offset:1024
    ds_read_b128 v[96:99], v5 offset:2048
    v_mul_f32_dpp v67, v106, v67 row_newbcast:3 row_mask:0xf bank_mask:0xf
    v_cvt_pk_bf16_f32 v92, v64, v65
    v_cvt_pk_bf16_f32 v93, v66, v67
    s_mov_b64 exec, s[54:55]
    buffer_load_dwordx4 v[48:51], v6, s[8:11], s85 offen offset:2048 sc1
    buffer_load_dwordx4 v[52:55], v6, s[8:11], s85 offen offset:3072 sc1
    s_mov_b64 exec, -1
    v_mfma_f32_16x16x32_bf16 v[64:67], v[90:93], v[60:63], 0
    v_rcp_f32 v56, v56
    v_mfma_f32_16x16x32_bf16 v[76:79], v[92:95], v[72:75], 0
    v_rcp_f32 v68, v68
    v_mfma_f32_16x16x16_bf16 v[104:107], v[14:15], v[100:101], 0
    v_mfma_f32_16x16x16_bf16 v[108:111], v[14:15], v[102:103], 0
    s_nop 2
    v_mul_f32 v64, v56, v64
    v_mul_f32 v65, v56, v65
    v_mul_f32 v66, v56, v66
    v_mul_f32 v67, v56, v67
    v_mul_f32 v76, v68, v76
    v_cvt_pk_bf16_f32 v3, v66, v67
    v_mul_f32 v77, v68, v77
    v_cvt_pk_bf16_f32 v2, v64, v65
    v_mul_f32 v78, v68, v78
    v_mul_f32 v79, v68, v79
    v_cvt_pk_bf16_f32 v1, v78, v79
    v_cvt_pk_bf16_f32 v0, v76, v77
    v_mfma_f32_16x16x16_bf16 v[112:115], v[14:15], v[124:125], 0
    v_permlane16_swap_b32 v1, v3
    v_permlane16_swap_b32 v0, v2
    v_and_b32 v3, -2, v3
    buffer_store_dwordx4 v[0:3], v8, s[8:11], s82 offen sc1
    v_mfma_f32_16x16x16_bf16 v[116:119], v[14:15], v[126:127], 0
    s_cmp_lt_u32 s36, 2
    s_cbranch_scc1 L_lo_161
    s_waitcnt vmcnt(5)
    v_bitop3_b32 v4, v27, v31, v35 bitop3:0xfe
    v_bitop3_b32 v4, v4, v39, 1 bitop3:0xa8
    v_cmp_ne_u32 vcc, 0, v4
    ds_read_b128 v[72:75], v5 offset:3072
    ds_read_b128 v[76:79], v5 offset:4096
    ds_read_b128 v[88:91], v5 offset:5120
    ds_read_b128 v[92:95], v5 offset:6144
    s_cbranch_vccnz L_retry_175
L_back_176:
    s_waitcnt lgkmcnt(6)
    v_mfma_f32_16x16x32_bf16 v[104:107], v[80:83], v[24:27], v[104:107]
    ds_read_b128 v[100:103], v5 offset:7168
    s_waitcnt lgkmcnt(5)
    v_mfma_f32_16x16x32_bf16 v[108:111], v[84:87], v[24:27], v[108:111]
    ds_read_b128 v[80:83], v5 offset:8192
    s_add_u32 s101, s66, 73728
    v_mfma_f32_16x16x32_bf16 v[112:115], v[96:99], v[24:27], v[112:115]
    ds_read_b128 v[84:87], v5 offset:9216
    s_waitcnt lgkmcnt(5)
    buffer_load_dwordx4 v[56:59], v6, s[8:11], s101 offen offset:0 sc1
    v_mfma_f32_16x16x32_bf16 v[116:119], v[72:75], v[24:27], v[116:119]
    ds_read_b128 v[96:99], v5 offset:10240
    v_mfma_f32_16x16x32_bf16 v[104:107], v[76:79], v[28:31], v[104:107]
    ds_read_b128 v[72:75], v5 offset:11264
    s_waitcnt lgkmcnt(5)
    buffer_load_dwordx4 v[60:63], v6, s[8:11], s101 offen offset:1024 sc1
    v_mfma_f32_16x16x32_bf16 v[108:111], v[88:91], v[28:31], v[108:111]
    ds_read_b128 v[76:79], v5 offset:12288
    v_mfma_f32_16x16x32_bf16 v[112:115], v[92:95], v[28:31], v[112:115]
    ds_read_b128 v[88:91], v5 offset:13312
    s_waitcnt lgkmcnt(5)
    buffer_load_dwordx4 v[64:67], v6, s[8:11], s101 offen offset:2048 sc1
    v_mfma_f32_16x16x32_bf16 v[116:119], v[100:103], v[28:31], v[116:119]
    ds_read_b128 v[92:95], v5 offset:14336
    v_mfma_f32_16x16x32_bf16 v[104:107], v[80:83], v[32:35], v[104:107]
    ds_read_b128 v[100:103], v5 offset:15360
    s_waitcnt lgkmcnt(5)
    buffer_load_dwordx4 v[68:71], v6, s[8:11], s101 offen offset:3072 sc1
    v_mfma_f32_16x16x32_bf16 v[108:111], v[84:87], v[32:35], v[108:111]
    ds_read_b128 v[80:83], v5 offset:16384
    s_waitcnt vmcnt(5)
    v_mfma_f32_16x16x32_bf16 v[112:115], v[96:99], v[32:35], v[112:115]
    ds_read_b128 v[84:87], v5 offset:17408
    s_waitcnt lgkmcnt(5)
    v_mfma_f32_16x16x32_bf16 v[116:119], v[72:75], v[32:35], v[116:119]
    ds_read_b128 v[96:99], v5 offset:18432
    v_bitop3_b32 v4, v43, v47, v51 bitop3:0xfe
    v_mfma_f32_16x16x32_bf16 v[104:107], v[76:79], v[36:39], v[104:107]
    ds_read_b128 v[72:75], v5 offset:19456
    s_waitcnt lgkmcnt(5)
    v_mfma_f32_16x16x32_bf16 v[108:111], v[88:91], v[36:39], v[108:111]
    ds_read_b128 v[76:79], v5 offset:20480
    v_bitop3_b32 v4, v4, v55, 1 bitop3:0xa8
    v_mfma_f32_16x16x32_bf16 v[112:115], v[92:95], v[36:39], v[112:115]
    ds_read_b128 v[88:91], v5 offset:21504
    s_waitcnt lgkmcnt(5)
    v_mfma_f32_16x16x32_bf16 v[116:119], v[100:103], v[36:39], v[116:119]
    ds_read_b128 v[92:95], v5 offset:22528
    v_cmp_ne_u32 vcc, 0, v4
    s_nop 0
    s_cbranch_vccnz L_retry_177
L_back_178:
    v_mfma_f32_16x16x32_bf16 v[104:107], v[80:83], v[40:43], v[104:107]
    ds_read_b128 v[100:103], v5 offset:23552
    s_waitcnt lgkmcnt(5)
    v_mfma_f32_16x16x32_bf16 v[108:111], v[84:87], v[40:43], v[108:111]
    ds_read_b128 v[80:83], v5 offset:24576
    s_add_u32 s78, s66, 77824
    v_mfma_f32_16x16x32_bf16 v[112:115], v[96:99], v[40:43], v[112:115]
    ds_read_b128 v[84:87], v5 offset:25600
    s_waitcnt lgkmcnt(5)
    buffer_load_dwordx4 v[24:27], v6, s[8:11], s78 offen offset:0 sc1
    v_mfma_f32_16x16x32_bf16 v[116:119], v[72:75], v[40:43], v[116:119]
    ds_read_b128 v[96:99], v5 offset:26624
    v_mfma_f32_16x16x32_bf16 v[104:107], v[76:79], v[44:47], v[104:107]
    ds_read_b128 v[72:75], v5 offset:27648
    s_waitcnt lgkmcnt(5)
    buffer_load_dwordx4 v[28:31], v6, s[8:11], s78 offen offset:1024 sc1
    v_mfma_f32_16x16x32_bf16 v[108:111], v[88:91], v[44:47], v[108:111]
    ds_read_b128 v[76:79], v5 offset:28672
    v_mfma_f32_16x16x32_bf16 v[112:115], v[92:95], v[44:47], v[112:115]
    ds_read_b128 v[88:91], v5 offset:29696
    s_waitcnt lgkmcnt(5)
    buffer_load_dwordx4 v[32:35], v6, s[8:11], s78 offen offset:2048 sc1
    v_mfma_f32_16x16x32_bf16 v[116:119], v[100:103], v[44:47], v[116:119]
    ds_read_b128 v[92:95], v5 offset:30720
    v_mfma_f32_16x16x32_bf16 v[104:107], v[80:83], v[48:51], v[104:107]
    ds_read_b128 v[100:103], v5 offset:31744
    s_waitcnt lgkmcnt(5)
    buffer_load_dwordx4 v[36:39], v6, s[8:11], s78 offen offset:3072 sc1
    v_mfma_f32_16x16x32_bf16 v[108:111], v[84:87], v[48:51], v[108:111]
    ds_read_b128 v[80:83], v5 offset:32768
    v_mfma_f32_16x16x32_bf16 v[112:115], v[96:99], v[48:51], v[112:115]
    ds_read_b128 v[84:87], v5 offset:33792
    s_waitcnt lgkmcnt(5)
    v_mfma_f32_16x16x32_bf16 v[116:119], v[72:75], v[48:51], v[116:119]
    ds_read_b128 v[96:99], v5 offset:34816
    v_mfma_f32_16x16x32_bf16 v[104:107], v[76:79], v[52:55], v[104:107]
    ds_read_b128 v[72:75], v5 offset:35840
    s_waitcnt lgkmcnt(5)
    v_mfma_f32_16x16x32_bf16 v[108:111], v[88:91], v[52:55], v[108:111]
    ds_read_b128 v[76:79], v5 offset:36864
    s_waitcnt vmcnt(4)
    v_mfma_f32_16x16x32_bf16 v[112:115], v[92:95], v[52:55], v[112:115]
    ds_read_b128 v[88:91], v5 offset:37888
    s_waitcnt lgkmcnt(5)
    v_mfma_f32_16x16x32_bf16 v[116:119], v[100:103], v[52:55], v[116:119]
    ds_read_b128 v[92:95], v5 offset:38912
    v_bitop3_b32 v4, v59, v63, v67 bitop3:0xfe
    v_bitop3_b32 v4, v4, v71, 1 bitop3:0xa8
    v_cmp_ne_u32 vcc, 0, v4
    s_nop 0
    s_cbranch_vccnz L_retry_179
L_back_180:
    v_mfma_f32_16x16x32_bf16 v[104:107], v[80:83], v[56:59], v[104:107]
    ds_read_b128 v[100:103], v5 offset:39936
    s_waitcnt lgkmcnt(5)
    v_mfma_f32_16x16x32_bf16 v[108:111], v[84:87], v[56:59], v[108:111]
    ds_read_b128 v[80:83], v5 offset:40960
    v_mfma_f32_16x16x32_bf16 v[112:115], v[96:99], v[56:59], v[112:115]
    ds_read_b128 v[84:87], v5 offset:41984
    s_waitcnt lgkmcnt(5)
    v_mfma_f32_16x16x32_bf16 v[116:119], v[72:75], v[56:59], v[116:119]
    ds_read_b128 v[96:99], v5 offset:43008
    v_mfma_f32_16x16x32_bf16 v[104:107], v[76:79], v[60:63], v[104:107]
    ds_read_b128 v[72:75], v5 offset:44032
    s_waitcnt lgkmcnt(5)
    v_mfma_f32_16x16x32_bf16 v[108:111], v[88:91], v[60:63], v[108:111]
    ds_read_b128 v[76:79], v5 offset:45056
    v_mfma_f32_16x16x32_bf16 v[112:115], v[92:95], v[60:63], v[112:115]
    ds_read_b128 v[88:91], v5 offset:46080
    s_waitcnt lgkmcnt(5)
    v_mfma_f32_16x16x32_bf16 v[116:119], v[100:103], v[60:63], v[116:119]
    ds_read_b128 v[92:95], v5 offset:47104
    v_mfma_f32_16x16x32_bf16 v[104:107], v[80:83], v[64:67], v[104:107]
    ds_read_b128 v[100:103], v5 offset:48128
    s_waitcnt lgkmcnt(5)
    v_mfma_f32_16x16x32_bf16 v[108:111], v[84:87], v[64:67], v[108:111]
    ds_read_b128 v[80:83], v5 offset:49152
    v_mfma_f32_16x16x32_bf16 v[112:115], v[96:99], v[64:67], v[112:115]
    ds_read_b128 v[84:87], v5 offset:50176
    s_waitcnt lgkmcnt(5)
    v_mfma_f32_16x16x32_bf16 v[116:119], v[72:75], v[64:67], v[116:119]
    ds_read_b128 v[96:99], v5 offset:51200
    v_mfma_f32_16x16x32_bf16 v[104:107], v[76:79], v[68:71], v[104:107]
    ds_read_b128 v[72:75], v5 offset:52224
    s_waitcnt lgkmcnt(5)
    v_mfma_f32_16x16x32_bf16 v[108:111], v[88:91], v[68:71], v[108:111]
    ds_read_b128 v[76:79], v5 offset:53248
    s_waitcnt vmcnt(0)
    v_mfma_f32_16x16x32_bf16 v[112:115], v[92:95], v[68:71], v[112:115]
    ds_read_b128 v[88:91], v5 offset:54272
    s_waitcnt lgkmcnt(5)
    v_mfma_f32_16x16x32_bf16 v[116:119], v[100:103], v[68:71], v[116:119]
    ds_read_b128 v[92:95], v5 offset:55296
    v_bitop3_b32 v4, v27, v31, v35 bitop3:0xfe
    v_bitop3_b32 v4, v4, v39, 1 bitop3:0xa8
    v_cmp_ne_u32 vcc, 0, v4
    s_nop 0
    s_cbranch_vccnz L_retry_181
L_back_182:
    v_mfma_f32_16x16x32_bf16 v[104:107], v[80:83], v[24:27], v[104:107]
    ds_read_b128 v[100:103], v5 offset:56320
    s_waitcnt lgkmcnt(5)
    v_mfma_f32_16x16x32_bf16 v[108:111], v[84:87], v[24:27], v[108:111]
    ds_read_b128 v[80:83], v5 offset:57344
    v_mfma_f32_16x16x32_bf16 v[112:115], v[96:99], v[24:27], v[112:115]
    ds_read_b128 v[84:87], v5 offset:58368
    s_waitcnt lgkmcnt(5)
    v_mfma_f32_16x16x32_bf16 v[116:119], v[72:75], v[24:27], v[116:119]
    ds_read_b128 v[96:99], v5 offset:61440
    v_mfma_f32_16x16x32_bf16 v[104:107], v[76:79], v[28:31], v[104:107]
    ds_read_b128 v[72:75], v5 offset:62464
    s_waitcnt lgkmcnt(5)
    v_mfma_f32_16x16x32_bf16 v[108:111], v[88:91], v[28:31], v[108:111]
    ds_read_b128 v[76:79], v5 offset:59392
    v_mfma_f32_16x16x32_bf16 v[112:115], v[92:95], v[28:31], v[112:115]
    ds_read_b128 v[88:91], v5 offset:60416
    s_waitcnt lgkmcnt(5)
    v_mfma_f32_16x16x32_bf16 v[116:119], v[100:103], v[28:31], v[116:119]
    ds_read_b128 v[92:95], v5 offset:63488
    v_mfma_f32_16x16x32_bf16 v[104:107], v[80:83], v[32:35], v[104:107]
    ds_read_b128 v[100:103], v5 offset:64512
    s_waitcnt lgkmcnt(5)
    v_mfma_f32_16x16x32_bf16 v[108:111], v[84:87], v[32:35], v[108:111]
    v_mfma_f32_16x16x32_bf16 v[104:107], v[96:99], v[36:39], v[104:107]
    s_waitcnt lgkmcnt(3)
    v_mfma_f32_16x16x32_bf16 v[108:111], v[72:75], v[36:39], v[108:111]
    v_mfma_f32_16x16x32_bf16 v[112:115], v[76:79], v[32:35], v[112:115]
    s_waitcnt lgkmcnt(1)
    v_mfma_f32_16x16x32_bf16 v[116:119], v[88:91], v[32:35], v[116:119]
    v_mfma_f32_16x16x32_bf16 v[112:115], v[92:95], v[36:39], v[112:115]
    s_waitcnt lgkmcnt(0)
    v_mfma_f32_16x16x32_bf16 v[116:119], v[100:103], v[36:39], v[116:119]
    s_add_u32 s82, s63, 0
    s_nop 0
    v_cvt_pk_bf16_f32 v103, v110, v111
    v_cvt_pk_bf16_f32 v100, v104, v105
    v_cvt_pk_bf16_f32 v101, v106, v107
    v_cvt_pk_bf16_f32 v102, v108, v109
    v_and_b32 v103, -2, v103
    buffer_store_dwordx4 v[100:103], v6, s[8:11], s82 offen offset:0 sc1
    v_cvt_pk_bf16_f32 v127, v118, v119
    v_cvt_pk_bf16_f32 v124, v112, v113
    v_cvt_pk_bf16_f32 v125, v114, v115
    v_cvt_pk_bf16_f32 v126, v116, v117
    v_and_b32 v127, -2, v127
    buffer_store_dwordx4 v[124:127], v6, s[8:11], s82 offen offset:1024 sc1
    v_cvt_pk_bf16_f32 v103, v110, v111
    s_nop 0
    v_cvt_pk_bf16_f32 v127, v118, v119
    v_mov_b32 v96, 0x3f803f80
    v_mov_b32 v97, 0x3f803f80
    v_mov_b32 v98, 0x3f803f80
    v_mov_b32 v99, 0x3f803f80
    v_mfma_f32_16x16x32_bf16 v[108:111], v[100:103], v[100:103], 0
    v_mfma_f32_16x16x32_bf16 v[108:111], v[124:127], v[124:127], v[108:111]
    v_mfma_f32_16x16x32_bf16 v[104:107], v[96:99], v[100:103], 0
    v_mfma_f32_16x16x32_bf16 v[104:107], v[96:99], v[124:127], v[104:107]
    s_add_u32 s83, s60, 294912
    s_nop 4
    v_cndmask_b32 v108, v108, v109, s[44:45]
    v_cndmask_b32 v108, v108, v110, s[46:47]
    v_cndmask_b32 v108, v108, v111, s[48:49]
    v_and_b32 v105, -2, v108
    s_waitcnt vmcnt(0)
    s_add_u32 s73, s60, 49152
    buffer_load_dwordx4 v[40:43], v7, s[8:11], s73 offen offset:0 sc1
    buffer_load_dwordx4 v[44:47], v7, s[8:11], s73 offen offset:1024 sc1
    buffer_load_dwordx4 v[48:51], v7, s[8:11], s73 offen offset:2048 sc1
    buffer_load_dwordx4 v[52:55], v7, s[8:11], s73 offen offset:3072 sc1
    buffer_store_dwordx2 v[104:105], v10, s[8:11], s83 offen sc1
    s_waitcnt vmcnt(3)
    v_bitop3_b32 v4, v43, v47, 1 bitop3:0xa8
    v_cmp_ne_u32 vcc, 0, v4
    s_nop 0
    s_cbranch_vccnz L_retry_183
L_back_184:
    ds_write_b128 v7, v[40:43] offset:16384
    ds_write_b128 v7, v[44:47] offset:17408
    s_waitcnt vmcnt(1)
    v_bitop3_b32 v4, v51, v55, 1 bitop3:0xa8
    v_cmp_ne_u32 vcc, 0, v4
    s_nop 0
    s_cbranch_vccnz L_retry_185
L_back_186:
    ds_write_b128 v7, v[48:51] offset:18432
    ds_write_b128 v7, v[52:55] offset:19456
    s_waitcnt lgkmcnt(0)
L_join_162:
    s_barrier
    ds_read_b128 v[40:43], v6 offset:16384
    ds_read_b128 v[44:47], v6 offset:17408
    ds_read_b128 v[48:51], v6 offset:18432
    s_add_u32 s73, s60, 32768
    buffer_load_dwordx4 v[24:27], v7, s[8:11], s73 offen offset:0 sc1
    buffer_load_dwordx4 v[28:31], v7, s[8:11], s73 offen offset:1024 sc1
    v_bfe_u32 v98, v6, 4, 4
    v_lshlrev_b32 v98, 3, v98
    v_and_b32 v99, 0x18, v98
    v_add_u32 v98, 97792, v98
    v_lshrrev_b32 v85, 8, v6
    buffer_load_dwordx4 v[32:35], v7, s[8:11], s73 offen offset:2048 sc1
    v_lshl_add_u32 v99, v85, 5, v99
    v_add_u32 v99, 97792, v99
    s_lshl_b32 s75, s36, 7
    s_add_u32 s75, s75, 97792
    v_lshrrev_b32 v85, 6, v6
    v_lshl_add_u32 v85, v85, 3, s75
    s_add_u32 s74, s60, 294912
    s_add_u32 s74, s74, s4
    buffer_load_dwordx4 v[36:39], v7, s[8:11], s73 offen offset:3072 sc1
    s_waitcnt lgkmcnt(2)
    v_mfma_f32_16x16x32_bf16 v[72:75], a[196:199], v[40:43], 0
    ds_read_b128 v[52:55], v6 offset:19456
    v_mfma_f32_16x16x32_bf16 v[68:71], a[192:195], v[40:43], 0
    ds_read_b128 v[112:115], v6 offset:20480
    v_mfma_f32_16x16x32_bf16 v[76:79], v[40:43], a[200:203], 0
    s_waitcnt lgkmcnt(3)
    buffer_load_dwordx4 v[80:83], v6, s[8:11], s74 offen sc1
    v_mfma_f32_16x16x32_bf16 v[72:75], a[208:211], v[44:47], v[72:75]
    ds_read_b128 v[116:119], v6 offset:21504
    v_mfma_f32_16x16x32_bf16 v[68:71], a[204:207], v[44:47], v[68:71]
    ds_read_b128 v[40:43], v6 offset:22528
    v_mfma_f32_16x16x32_bf16 v[76:79], v[44:47], a[212:215], v[76:79]
    s_waitcnt lgkmcnt(3)
    v_mfma_f32_16x16x32_bf16 v[72:75], a[220:223], v[48:51], v[72:75]
    ds_read_b128 v[44:47], v6 offset:23552
    v_mfma_f32_16x16x32_bf16 v[68:71], a[216:219], v[48:51], v[68:71]
    v_mfma_f32_16x16x32_bf16 v[76:79], v[48:51], a[224:227], v[76:79]
    v_mfma_f32_16x16x32_bf16 v[72:75], a[232:235], v[52:55], v[72:75]
    ds_read_b128 v[48:51], v6 offset:24576
    v_mfma_f32_16x16x32_bf16 v[68:71], a[228:231], v[52:55], v[68:71]
    v_mfma_f32_16x16x32_bf16 v[76:79], v[52:55], a[236:239], v[76:79]
    s_waitcnt lgkmcnt(3)
    v_mfma_f32_16x16x32_bf16 v[72:75], a[244:247], v[112:115], v[72:75]
    ds_read_b128 v[52:55], v6 offset:25600
    v_mfma_f32_16x16x32_bf16 v[68:71], a[240:243], v[112:115], v[68:71]
    v_mfma_f32_16x16x32_bf16 v[76:79], v[112:115], a[248:251], v[76:79]
    v_mfma_f32_16x16x32_bf16 v[72:75], v[128:131], v[116:119], v[72:75]
    ds_read_b128 v[112:115], v6 offset:26624
    v_mfma_f32_16x16x32_bf16 v[68:71], a[252:255], v[116:119], v[68:71]
    v_mfma_f32_16x16x32_bf16 v[76:79], v[116:119], v[132:135], v[76:79]
    s_waitcnt lgkmcnt(3)
    v_mfma_f32_16x16x32_bf16 v[72:75], v[140:143], v[40:43], v[72:75]
    ds_read_b128 v[116:119], v6 offset:27648
    v_mfma_f32_16x16x32_bf16 v[68:71], v[136:139], v[40:43], v[68:71]
    v_mfma_f32_16x16x32_bf16 v[76:79], v[40:43], v[144:147], v[76:79]
    v_mfma_f32_16x16x32_bf16 v[72:75], v[152:155], v[44:47], v[72:75]
    ds_read_b128 v[40:43], v6 offset:28672
    v_mfma_f32_16x16x32_bf16 v[68:71], v[148:151], v[44:47], v[68:71]
    v_mfma_f32_16x16x32_bf16 v[76:79], v[44:47], v[156:159], v[76:79]
    s_waitcnt lgkmcnt(3)
    s_waitcnt vmcnt(1)
    v_bitop3_b32 v4, v27, v31, v35 bitop3:0xfe
    v_mfma_f32_16x16x32_bf16 v[72:75], v[164:167], v[48:51], v[72:75]
    ds_read_b128 v[44:47], v6 offset:29696
    v_bitop3_b32 v4, v4, v39, 1 bitop3:0xa8
    v_mfma_f32_16x16x32_bf16 v[68:71], v[160:163], v[48:51], v[68:71]
    v_cmp_ne_u32 vcc, 0, v4
    v_mfma_f32_16x16x32_bf16 v[76:79], v[48:51], v[168:171], v[76:79]
    s_cbranch_vccnz L_retry_187
L_back_188:
    v_mfma_f32_16x16x32_bf16 v[72:75], v[176:179], v[52:55], v[72:75]
    ds_read_b128 v[48:51], v6 offset:30720
    s_waitcnt vmcnt(0)
    v_mfma_f32_16x16x32_bf16 v[68:71], v[172:175], v[52:55], v[68:71]
    ds_write_b128 v7, v[24:27] offset:0
    v_mfma_f32_16x16x32_bf16 v[76:79], v[52:55], v[180:183], v[76:79]
    s_waitcnt lgkmcnt(4)
    v_bitop3_b32 v5, v81, v83, 1 bitop3:0xa8
    v_cmp_ne_u32 vcc, 0, v5
    v_mfma_f32_16x16x32_bf16 v[72:75], v[188:191], v[112:115], v[72:75]
    ds_read_b128 v[52:55], v6 offset:31744
    s_cbranch_vccnz L_retry_189
L_back_190:
    v_mfma_f32_16x16x32_bf16 v[68:71], v[184:187], v[112:115], v[68:71]
    ds_write_b128 v7, v[28:31] offset:1024
    v_mfma_f32_16x16x32_bf16 v[76:79], v[112:115], v[192:195], v[76:79]
    v_add_f32 v80, v80, v82
    v_add_f32 v81, v81, v83
    v_mfma_f32_16x16x32_bf16 v[72:75], v[200:203], v[116:119], v[72:75]
    ds_write_b128 v7, v[32:35] offset:2048
    v_mfma_f32_16x16x32_bf16 v[68:71], v[196:199], v[116:119], v[68:71]
    v_add_f32_dpp v82, v80, v80 quad_perm:[1,0,3,2] row_mask:0xf bank_mask:0xf
    v_add_f32_dpp v83, v81, v81 quad_perm:[1,0,3,2] row_mask:0xf bank_mask:0xf
    v_mfma_f32_16x16x32_bf16 v[76:79], v[116:119], v[204:207], v[76:79]
    s_waitcnt lgkmcnt(6)
    ds_write_b128 v7, v[36:39] offset:3072
    v_mfma_f32_16x16x32_bf16 v[72:75], v[212:215], v[40:43], v[72:75]
    v_add_f32_dpp v80, v82, v82 quad_perm:[2,3,0,1] row_mask:0xf bank_mask:0xf
    v_add_f32_dpp v81, v83, v83 quad_perm:[2,3,0,1] row_mask:0xf bank_mask:0xf
    v_mfma_f32_16x16x32_bf16 v[68:71], v[208:211], v[40:43], v[68:71]
    v_mul_f32 v80, 0x3b000000, v80
    v_mul_f32 v81, 0x3b000000, v81
    v_fma_f32 v81, -v80, v80, v81
    v_max_f32 v81, 0, v81
    v_cvt_pk_bf16_f32 v80, v81, -v80
    v_lshlrev_b32 v84, 16, v80
    v_add_f32 v84, 0x3727c5ac, v84
    v_cvt_pk_bf16_f32 v84, v84, v84
    v_lshlrev_b32 v84, 16, v84
    v_sqrt_f32 v84, v84
    v_and_b32 v83, 0xffff0000, v80
    v_cvt_pk_bf16_f32 v84, v84, v84
    v_lshlrev_b32 v84, 16, v84
    v_rcp_f32 v82, v84
    s_nop 1
    ds_write_b64 v85, v[82:83]
    v_mfma_f32_16x16x32_bf16 v[76:79], v[40:43], v[216:219], v[76:79]
    s_waitcnt lgkmcnt(0)
    s_barrier
    v_mfma_f32_16x16x32_bf16 v[72:75], v[224:227], v[44:47], v[72:75]
    ds_read_b128 v[112:115], v6 offset:0
    s_add_u32 s73, s60, 16384
    v_mfma_f32_16x16x32_bf16 v[68:71], v[220:223], v[44:47], v[68:71]
    ds_read_b128 v[116:119], v6 offset:1024
    s_lshl_b32 s72, s36, 12
    v_mfma_f32_16x16x32_bf16 v[76:79], v[44:47], v[228:231], v[76:79]
    s_add_u32 m0, s72, 16384
    ds_read_b64 v[108:109], v98 offset:384
    v_mfma_f32_16x16x32_bf16 v[72:75], v[236:239], v[48:51], v[72:75]
    ds_read_b128 v[40:43], v6 offset:2048
    v_mfma_f32_16x16x32_bf16 v[68:71], v[232:235], v[48:51], v[68:71]
    ds_read_b128 v[44:47], v6 offset:3072
    v_mfma_f32_16x16x32_bf16 v[76:79], v[48:51], v[240:243], v[76:79]
    buffer_load_dwordx4 v7, s[8:11], s73 offen offset:0 sc1 lds
    v_mfma_f32_16x16x32_bf16 v[72:75], v[248:251], v[52:55], v[72:75]
    ds_read_b128 v[48:51], v6 offset:4096
    v_mfma_f32_16x16x32_bf16 v[68:71], v[244:247], v[52:55], v[68:71]
    ds_read_b64 v[110:111], v99 offset:384
    v_mfma_f32_16x16x32_bf16 v[76:79], v[52:55], v[252:255], v[76:79]
    s_waitcnt lgkmcnt(5)
    ds_read_b64 v[104:105], v98 offset:256
    v_mfma_f32_16x16x32_bf16 v[60:63], a[196:199], v[112:115], 0
    ds_read_b128 v[52:55], v6 offset:5120
    v_mfma_f32_16x16x32_bf16 v[56:59], a[192:195], v[112:115], 0
    buffer_load_dwordx4 v7, s[8:11], s73 offen offset:1024 sc1 lds
    v_mfma_f32_16x16x32_bf16 v[64:67], v[112:115], a[200:203], 0
    ds_read_b64 v[106:107], v99 offset:256
    v_mfma_f32_16x16x32_bf16 v[60:63], a[208:211], v[116:119], v[60:63]
    ds_read_b128 v[112:115], v6 offset:6144
    v_mfma_f32_16x16x32_bf16 v[56:59], a[204:207], v[116:119], v[56:59]
    v_mfma_f32_16x16x32_bf16 v[64:67], v[116:119], a[212:215], v[64:67]
    s_waitcnt lgkmcnt(6)
    buffer_load_dwordx4 v7, s[8:11], s73 offen offset:2048 sc1 lds
    v_mfma_f32_16x16x32_bf16 v[60:63], a[220:223], v[40:43], v[60:63]
    ds_read_b128 v[116:119], v6 offset:7168
    s_waitcnt lgkmcnt(5)
    v_mfma_f32_16x16x32_bf16 v[56:59], a[216:219], v[40:43], v[56:59]
    v_fmac_f32_dpp v72, v122, v109 row_newbcast:0 row_mask:0xf bank_mask:0xf
    v_fmac_f32_dpp v73, v122, v109 row_newbcast:1 row_mask:0xf bank_mask:0xf
    v_mfma_f32_16x16x32_bf16 v[64:67], v[40:43], a[224:227], v[64:67]
    v_fmac_f32_dpp v74, v122, v109 row_newbcast:2 row_mask:0xf bank_mask:0xf
    v_fmac_f32_dpp v75, v122, v109 row_newbcast:3 row_mask:0xf bank_mask:0xf
    v_mfma_f32_16x16x32_bf16 v[60:63], a[232:235], v[44:47], v[60:63]
    ds_read_b128 v[40:43], v6 offset:8192
    v_mul_f32 v72, v108, v72
    v_mfma_f32_16x16x32_bf16 v[56:59], a[228:231], v[44:47], v[56:59]
    buffer_load_dwordx4 v7, s[8:11], s73 offen offset:3072 sc1 lds
    v_mul_f32 v73, v108, v73
    v_mfma_f32_16x16x32_bf16 v[64:67], v[44:47], a[236:239], v[64:67]
    s_waitcnt lgkmcnt(4)
    v_mul_f32 v74, v108, v74
    v_mul_f32 v75, v108, v75
    v_mfma_f32_16x16x32_bf16 v[60:63], a[244:247], v[48:51], v[60:63]
    ds_read_b128 v[44:47], v6 offset:9216
    v_cvt_pk_bf16_f32 v86, v72, v73
    v_mfma_f32_16x16x32_bf16 v[56:59], a[240:243], v[48:51], v[56:59]
    v_cvt_pk_bf16_f32 v87, v74, v75
    v_fmac_f32_dpp v68, v121, v109 row_newbcast:0 row_mask:0xf bank_mask:0xf
    v_mfma_f32_16x16x32_bf16 v[64:67], v[48:51], a[248:251], v[64:67]
    v_fmac_f32_dpp v69, v121, v109 row_newbcast:1 row_mask:0xf bank_mask:0xf
    v_fmac_f32_dpp v70, v121, v109 row_newbcast:2 row_mask:0xf bank_mask:0xf
    v_mfma_f32_16x16x32_bf16 v[60:63], v[128:131], v[52:55], v[60:63]
    ds_read_b128 v[48:51], v6 offset:10240
    v_fmac_f32_dpp v71, v121, v109 row_newbcast:3 row_mask:0xf bank_mask:0xf
    v_mfma_f32_16x16x32_bf16 v[56:59], a[252:255], v[52:55], v[56:59]
    v_cvt_pk_bf16_f32 v82, v68, v69
    v_cvt_pk_bf16_f32 v83, v70, v71
    v_mfma_f32_16x16x32_bf16 v[64:67], v[52:55], v[132:135], v[64:67]
    s_waitcnt lgkmcnt(3)
    v_mul_f32 v97, s43, v108
    v_fmac_f32_dpp v76, v111, v123 row_newbcast:0 row_mask:0xf bank_mask:0xf
    v_mfma_f32_16x16x32_bf16 v[60:63], v[140:143], v[112:115], v[60:63]
    ds_read_b128 v[52:55], v6 offset:11264
    v_fmac_f32_dpp v77, v111, v123 row_newbcast:1 row_mask:0xf bank_mask:0xf
    v_mfma_f32_16x16x32_bf16 v[56:59], v[136:139], v[112:115], v[56:59]
    v_fmac_f32_dpp v78, v111, v123 row_newbcast:2 row_mask:0xf bank_mask:0xf
    v_fmac_f32_dpp v79, v111, v123 row_newbcast:3 row_mask:0xf bank_mask:0xf
    v_mfma_f32_16x16x32_bf16 v[64:67], v[112:115], v[144:147], v[64:67]
    v_mul_f32_dpp v76, v110, v76 row_newbcast:0 row_mask:0xf bank_mask:0xf
    v_mul_f32_dpp v77, v110, v77 row_newbcast:1 row_mask:0xf bank_mask:0xf
    v_mfma_f32_16x16x32_bf16 v[60:63], v[152:155], v[116:119], v[60:63]
    ds_read_b128 v[112:115], v6 offset:12288
    v_mul_f32_dpp v78, v110, v78 row_newbcast:2 row_mask:0xf bank_mask:0xf
    v_mfma_f32_16x16x32_bf16 v[56:59], v[148:151], v[116:119], v[56:59]
    v_mul_f32_dpp v79, v110, v79 row_newbcast:3 row_mask:0xf bank_mask:0xf
    v_cvt_pk_bf16_f32 v94, v76, v77
    v_mfma_f32_16x16x32_bf16 v[64:67], v[116:119], v[156:159], v[64:67]
    s_waitcnt lgkmcnt(3)
    v_cvt_pk_bf16_f32 v95, v78, v79
    v_mfma_f32_16x16x32_bf16 v[60:63], v[164:167], v[40:43], v[60:63]
    ds_read_b128 v[116:119], v6 offset:13312
    v_mfma_f32_16x16x32_bf16 v[56:59], v[160:163], v[40:43], v[56:59]
    ds_read_b64 v[108:109], v98 offset:128
    v_mfma_f32_16x16x32_bf16 v[64:67], v[40:43], v[168:171], v[64:67]
    ds_read_b64 v[110:111], v99 offset:128
    v_mov_b32 v68, v86
    v_mfma_f32_16x16x32_bf16 v[60:63], v[176:179], v[44:47], v[60:63]
    ds_read_b128 v[40:43], v6 offset:14336
    v_mov_b32 v69, v87
    v_mfma_f32_16x16x32_bf16 v[56:59], v[172:175], v[44:47], v[56:59]
    s_add_u32 s84, s62, 98304
    v_mov_b32 v70, v94
    v_min_u32 v71, -2, v95
    v_mfma_f32_16x16x32_bf16 v[64:67], v[44:47], v[180:183], v[64:67]
    s_waitcnt lgkmcnt(5)
    buffer_store_dwordx4 v[68:71], v6, s[8:11], s84 offen sc1
    v_mfma_f32_16x16x32_bf16 v[60:63], v[188:191], v[48:51], v[60:63]
    ds_read_b128 v[44:47], v6 offset:15360
    v_mfma_f32_16x16x32_bf16 v[56:59], v[184:187], v[48:51], v[56:59]
    v_mfma_f32_16x16x32_bf16 v[64:67], v[48:51], v[192:195], v[64:67]
    v_mfma_f32_16x16x32_bf16 v[60:63], v[200:203], v[52:55], v[60:63]
    v_mfma_f32_16x16x32_bf16 v[56:59], v[196:199], v[52:55], v[56:59]
    v_mfma_f32_16x16x32_bf16 v[64:67], v[52:55], v[204:207], v[64:67]
    s_waitcnt lgkmcnt(5)
    v_mfma_f32_16x16x32_bf16 v[60:63], v[212:215], v[112:115], v[60:63]
    v_mfma_f32_16x16x32_bf16 v[56:59], v[208:211], v[112:115], v[56:59]
    v_mfma_f32_16x16x32_bf16 v[64:67], v[112:115], v[216:219], v[64:67]
    s_waitcnt lgkmcnt(0) vmcnt(1)
    s_barrier
    s_add_u32 s73, s60, 0
    v_mfma_f32_16x16x32_bf16 v[60:63], v[224:227], v[116:119], v[60:63]
    ds_read_b128 v[48:51], v6 offset:16384
    s_lshl_b32 s72, s36, 12
    v_mfma_f32_16x16x32_bf16 v[56:59], v[220:223], v[116:119], v[56:59]
    ds_read_b128 v[52:55], v6 offset:17408
    s_add_u32 m0, s72, 0
    v_mfma_f32_16x16x32_bf16 v[64:67], v[116:119], v[228:231], v[64:67]
    buffer_load_dwordx4 v7, s[8:11], s73 offen offset:0 sc1 lds
    v_mfma_f32_16x16x32_bf16 v[60:63], v[236:239], v[40:43], v[60:63]
    ds_read_b128 v[112:115], v6 offset:18432
    v_mfma_f32_16x16x32_bf16 v[56:59], v[232:235], v[40:43], v[56:59]
    ds_read_b128 v[116:119], v6 offset:19456
    v_mfma_f32_16x16x32_bf16 v[64:67], v[40:43], v[240:243], v[64:67]
    v_mfma_f32_16x16x32_bf16 v[60:63], v[248:251], v[44:47], v[60:63]
    ds_read_b128 v[40:43], v6 offset:20480
    v_mfma_f32_16x16x32_bf16 v[56:59], v[244:247], v[44:47], v[56:59]
    buffer_load_dwordx4 v7, s[8:11], s73 offen offset:1024 sc1 lds
    v_mfma_f32_16x16x32_bf16 v[64:67], v[44:47], v[252:255], v[64:67]
    s_waitcnt lgkmcnt(3)
    s_waitcnt lgkmcnt(15)
    s_nop 0
    v_mfma_f32_16x16x32_bf16 v[72:75], a[196:199], v[48:51], 0
    ds_read_b128 v[44:47], v6 offset:21504
    v_fmac_f32_dpp v60, v122, v105 row_newbcast:0 row_mask:0xf bank_mask:0xf
    v_mfma_f32_16x16x32_bf16 v[68:71], a[192:195], v[48:51], 0
    v_fmac_f32_dpp v61, v122, v105 row_newbcast:1 row_mask:0xf bank_mask:0xf
    v_fmac_f32_dpp v62, v122, v105 row_newbcast:2 row_mask:0xf bank_mask:0xf
    v_mfma_f32_16x16x32_bf16 v[76:79], v[48:51], a[200:203], 0
    buffer_load_dwordx4 v7, s[8:11], s73 offen offset:2048 sc1 lds
    v_fmac_f32_dpp v63, v122, v105 row_newbcast:3 row_mask:0xf bank_mask:0xf
    v_mfma_f32_16x16x32_bf16 v[72:75], a[208:211], v[52:55], v[72:75]
    ds_read_b128 v[48:51], v6 offset:22528
    v_mul_f32 v60, v104, v60
    v_mfma_f32_16x16x32_bf16 v[68:71], a[204:207], v[52:55], v[68:71]
    v_mul_f32 v61, v104, v61
    v_mul_f32 v62, v104, v62
    v_mfma_f32_16x16x32_bf16 v[76:79], v[52:55], a[212:215], v[76:79]
    s_waitcnt lgkmcnt(3)
    v_mul_f32 v63, v104, v63
    v_cvt_pk_bf16_f32 v84, v60, v61
    v_mfma_f32_16x16x32_bf16 v[72:75], a[220:223], v[112:115], v[72:75]
    ds_read_b128 v[52:55], v6 offset:23552
    v_cvt_pk_bf16_f32 v85, v62, v63
    v_mfma_f32_16x16x32_bf16 v[68:71], a[216:219], v[112:115], v[68:71]
    buffer_load_dwordx4 v7, s[8:11], s73 offen offset:3072 sc1 lds
    v_fmac_f32_dpp v56, v121, v105 row_newbcast:0 row_mask:0xf bank_mask:0xf
    v_mfma_f32_16x16x16_bf16 v[60:63], v[84:85], v[82:83], v[16:19]
    v_fmac_f32_dpp v57, v121, v105 row_newbcast:1 row_mask:0xf bank_mask:0xf
    v_fmac_f32_dpp v58, v121, v105 row_newbcast:2 row_mask:0xf bank_mask:0xf
    v_mfma_f32_16x16x32_bf16 v[76:79], v[112:115], a[224:227], v[76:79]
    v_fmac_f32_dpp v59, v121, v105 row_newbcast:3 row_mask:0xf bank_mask:0xf
    v_cvt_pk_bf16_f32 v80, v56, v57
    v_mfma_f32_16x16x32_bf16 v[72:75], a[232:235], v[116:119], v[72:75]
    ds_read_b128 v[112:115], v6 offset:24576
    v_cvt_pk_bf16_f32 v81, v58, v59
    v_mfma_f32_16x16x32_bf16 v[68:71], a[228:231], v[116:119], v[68:71]
    v_mul_f32 v96, s43, v104
    v_fmac_f32_dpp v64, v107, v123 row_newbcast:0 row_mask:0xf bank_mask:0xf
    v_mfma_f32_16x16x16_bf16 v[56:59], v[86:87], v[82:83], v[16:19]
    v_fmac_f32_dpp v65, v107, v123 row_newbcast:1 row_mask:0xf bank_mask:0xf
    v_fmac_f32_dpp v66, v107, v123 row_newbcast:2 row_mask:0xf bank_mask:0xf
    v_mfma_f32_16x16x32_bf16 v[76:79], v[116:119], a[236:239], v[76:79]
    s_waitcnt lgkmcnt(3)
    v_fmac_f32_dpp v67, v107, v123 row_newbcast:3 row_mask:0xf bank_mask:0xf
    v_mul_f32_dpp v64, v106, v64 row_newbcast:0 row_mask:0xf bank_mask:0xf
    v_mfma_f32_16x16x32_bf16 v[72:75], a[244:247], v[40:43], v[72:75]
    ds_read_b128 v[116:119], v6 offset:25600
    v_mul_f32_dpp v65, v106, v65 row_newbcast:1 row_mask:0xf bank_mask:0xf
    v_mfma_f32_16x16x32_bf16 v[68:71], a[240:243], v[40:43], v[68:71]
    v_mul_f32_dpp v66, v106, v66 row_newbcast:2 row_mask:0xf bank_mask:0xf
    v_mul_f32_dpp v67, v106, v67 row_newbcast:3 row_mask:0xf bank_mask:0xf
    v_mfma_f32_16x16x32_bf16 v[76:79], v[40:43], a[248:251], v[76:79]
    v_cvt_pk_bf16_f32 v92, v64, v65
    v_cvt_pk_bf16_f32 v93, v66, v67
    v_mfma_f32_16x16x32_bf16 v[72:75], v[128:131], v[44:47], v[72:75]
    ds_read_b128 v[40:43], v6 offset:26624
    v_cndmask_b32 v56, v60, v56, s[28:29]
    v_mfma_f32_16x16x32_bf16 v[68:71], a[252:255], v[44:47], v[68:71]
    ds_read_b64 v[104:105], v98 offset:0
    v_cndmask_b32 v57, v61, v57, s[30:31]
    v_mfma_f32_16x16x32_bf16 v[76:79], v[44:47], v[132:135], v[76:79]
    s_waitcnt lgkmcnt(4)
    ds_read_b64 v[106:107], v99 offset:0
    v_mfma_f32_16x16x32_bf16 v[72:75], v[140:143], v[48:51], v[72:75]
    ds_read_b128 v[44:47], v6 offset:27648
    v_cndmask_b32 v58, v62, v58, s[32:33]
    v_mfma_f32_16x16x32_bf16 v[68:71], v[136:139], v[48:51], v[68:71]
    v_cndmask_b32 v59, v63, v59, s[34:35]
    v_max3_f32 v60, v56, v57, v58
    v_mfma_f32_16x16x32_bf16 v[76:79], v[48:51], v[144:147], v[76:79]
    v_max_f32 v61, v60, v59
    v_max_f32 v60, v60, v59
    v_mfma_f32_16x16x32_bf16 v[72:75], v[152:155], v[52:55], v[72:75]
    ds_read_b128 v[48:51], v6 offset:28672
    v_mfma_f32_16x16x32_bf16 v[68:71], v[148:151], v[52:55], v[68:71]
    v_permlane32_swap_b32 v60, v61
    v_mfma_f32_16x16x32_bf16 v[76:79], v[52:55], v[156:159], v[76:79]
    s_waitcnt lgkmcnt(5)
    v_max_f32 v62, v60, v61
    v_max_f32 v60, v60, v61
    v_mfma_f32_16x16x32_bf16 v[72:75], v[164:167], v[112:115], v[72:75]
    ds_read_b128 v[52:55], v6 offset:29696
    v_mfma_f32_16x16x32_bf16 v[68:71], v[160:163], v[112:115], v[68:71]
    v_permlane16_swap_b32 v60, v62
    v_mfma_f32_16x16x32_bf16 v[76:79], v[112:115], v[168:171], v[76:79]
    v_max_f32 v60, v60, v62
    v_mul_f32 v60, -v60, v97
    v_mfma_f32_16x16x32_bf16 v[72:75], v[176:179], v[116:119], v[72:75]
    ds_read_b128 v[112:115], v6 offset:30720
    v_fma_f32 v56, v56, v97, v60
    v_mfma_f32_16x16x32_bf16 v[68:71], v[172:175], v[116:119], v[68:71]
    v_fma_f32 v57, v57, v97, v60
    v_fma_f32 v58, v58, v97, v60
    v_mfma_f32_16x16x32_bf16 v[76:79], v[116:119], v[180:183], v[76:79]
    s_waitcnt lgkmcnt(3)
    v_fma_f32 v59, v59, v97, v60
    v_mfma_f32_16x16x32_bf16 v[72:75], v[188:191], v[40:43], v[72:75]
    ds_read_b128 v[116:119], v6 offset:31744
    v_mfma_f32_16x16x32_bf16 v[68:71], v[184:187], v[40:43], v[68:71]
    v_exp_f32 v56, v56
    v_mfma_f32_16x16x32_bf16 v[76:79], v[40:43], v[192:195], v[76:79]
    s_add_u32 s75, s61, 98304
    v_exp_f32 v57, v57
    v_mfma_f32_16x16x32_bf16 v[72:75], v[200:203], v[44:47], v[72:75]
    buffer_load_dwordx4 v[88:91], v6, s[8:11], s75 offen sc1
    v_mfma_f32_16x16x32_bf16 v[68:71], v[196:199], v[44:47], v[68:71]
    v_exp_f32 v58, v58
    v_mfma_f32_16x16x32_bf16 v[76:79], v[44:47], v[204:207], v[76:79]
    s_waitcnt lgkmcnt(3)
    v_exp_f32 v59, v59
    v_mfma_f32_16x16x32_bf16 v[72:75], v[212:215], v[48:51], v[72:75]
    v_cvt_pk_bf16_f32 v0, v56, v57
    v_cvt_pk_bf16_f32 v1, v58, v59
    v_mfma_f32_16x16x32_bf16 v[68:71], v[208:211], v[48:51], v[68:71]
    v_and_b32 v62, v0, v20
    v_and_b32 v63, v1, v21
    v_mfma_f32_16x16x16_bf16 v[56:59], v[22:23], v[0:1], 0
    v_xor_b32 v60, v0, v62
    v_xor_b32 v61, v1, v63
    v_mfma_f32_16x16x32_bf16 v[76:79], v[48:51], v[216:219], v[76:79]
    s_waitcnt lgkmcnt(0) vmcnt(1)
    s_barrier
    v_mfma_f32_16x16x32_bf16 v[64:67], v[92:95], v[60:63], 0
    s_nop 1
    v_mfma_f32_16x16x32_bf16 v[72:75], v[224:227], v[52:55], v[72:75]
    ds_read_b128 v[40:43], v6 offset:0
    v_mfma_f32_16x16x32_bf16 v[68:71], v[220:223], v[52:55], v[68:71]
    ds_read_b128 v[44:47], v6 offset:1024
    v_mfma_f32_16x16x32_bf16 v[76:79], v[52:55], v[228:231], v[76:79]
    v_rcp_f32 v56, v56
    v_mfma_f32_16x16x32_bf16 v[72:75], v[236:239], v[112:115], v[72:75]
    ds_read_b128 v[48:51], v6 offset:2048
    v_mul_f32 v64, v56, v64
    v_mfma_f32_16x16x32_bf16 v[68:71], v[232:235], v[112:115], v[68:71]
    ds_read_b128 v[52:55], v6 offset:3072
    v_mul_f32 v65, v56, v65
    v_mfma_f32_16x16x32_bf16 v[76:79], v[112:115], v[240:243], v[76:79]
    v_mul_f32 v66, v56, v66
    v_mul_f32 v67, v56, v67
    v_mfma_f32_16x16x32_bf16 v[72:75], v[248:251], v[116:119], v[72:75]
    ds_read_b128 v[112:115], v6 offset:4096
    v_cvt_pk_bf16_f32 v1, v66, v67
    v_mfma_f32_16x16x32_bf16 v[68:71], v[244:247], v[116:119], v[68:71]
    v_cvt_pk_bf16_f32 v0, v64, v65
    v_mfma_f32_16x16x32_bf16 v[76:79], v[116:119], v[252:255], v[76:79]
    s_waitcnt lgkmcnt(3)
    s_waitcnt lgkmcnt(15)
    v_mfma_f32_16x16x32_bf16 v[60:63], a[196:199], v[40:43], 0
    ds_read_b128 v[116:119], v6 offset:5120
    v_fmac_f32_dpp v72, v122, v109 row_newbcast:0 row_mask:0xf bank_mask:0xf
    v_mfma_f32_16x16x32_bf16 v[56:59], a[192:195], v[40:43], 0
    ds_read_b128 v[24:27], v6 offset:6144
    v_fmac_f32_dpp v73, v122, v109 row_newbcast:1 row_mask:0xf bank_mask:0xf
    v_mfma_f32_16x16x32_bf16 v[64:67], v[40:43], a[200:203], 0
    v_fmac_f32_dpp v74, v122, v109 row_newbcast:2 row_mask:0xf bank_mask:0xf
    v_fmac_f32_dpp v75, v122, v109 row_newbcast:3 row_mask:0xf bank_mask:0xf
    v_mfma_f32_16x16x32_bf16 v[60:63], a[208:211], v[44:47], v[60:63]
    ds_read_b128 v[28:31], v6 offset:7168
    v_mul_f32 v72, v108, v72
    v_mfma_f32_16x16x32_bf16 v[56:59], a[204:207], v[44:47], v[56:59]
    ds_read_b128 v[32:35], v6 offset:8192
    v_mul_f32 v73, v108, v73
    v_mfma_f32_16x16x32_bf16 v[64:67], v[44:47], a[212:215], v[64:67]
    s_waitcnt lgkmcnt(5)
    v_mul_f32 v74, v108, v74
    v_mul_f32 v75, v108, v75
    v_mfma_f32_16x16x32_bf16 v[60:63], a[220:223], v[48:51], v[60:63]
    ds_read_b128 v[36:39], v6 offset:9216
    v_cvt_pk_bf16_f32 v86, v72, v73
    v_mfma_f32_16x16x32_bf16 v[56:59], a[216:219], v[48:51], v[56:59]
    ds_read_b128 v[40:43], v6 offset:10240
    v_cvt_pk_bf16_f32 v87, v74, v75
    v_mfma_f32_16x16x32_bf16 v[64:67], v[48:51], a[224:227], v[64:67]
    v_fmac_f32_dpp v68, v121, v109 row_newbcast:0 row_mask:0xf bank_mask:0xf
    v_fmac_f32_dpp v69, v121, v109 row_newbcast:1 row_mask:0xf bank_mask:0xf
    v_mfma_f32_16x16x16_bf16 v[72:75], v[86:87], v[80:81], v[16:19]
    v_fmac_f32_dpp v70, v121, v109 row_newbcast:2 row_mask:0xf bank_mask:0xf
    v_fmac_f32_dpp v71, v121, v109 row_newbcast:3 row_mask:0xf bank_mask:0xf
    v_mfma_f32_16x16x32_bf16 v[60:63], a[232:235], v[52:55], v[60:63]
    ds_read_b128 v[44:47], v6 offset:11264
    v_cvt_pk_bf16_f32 v82, v68, v69
    v_mfma_f32_16x16x32_bf16 v[56:59], a[228:231], v[52:55], v[56:59]
    ds_read_b128 v[48:51], v6 offset:12288
    v_cvt_pk_bf16_f32 v83, v70, v71
    v_mfma_f32_16x16x32_bf16 v[64:67], v[52:55], a[236:239], v[64:67]
    s_waitcnt lgkmcnt(7)
    v_mul_f32 v97, s43, v108
    v_fmac_f32_dpp v76, v111, v123 row_newbcast:0 row_mask:0xf bank_mask:0xf
    v_mfma_f32_16x16x16_bf16 v[68:71], v[84:85], v[80:81], v[16:19]
    v_fmac_f32_dpp v77, v111, v123 row_newbcast:1 row_mask:0xf bank_mask:0xf
    v_fmac_f32_dpp v78, v111, v123 row_newbcast:2 row_mask:0xf bank_mask:0xf
    v_mfma_f32_16x16x32_bf16 v[60:63], a[244:247], v[112:115], v[60:63]
    ds_read_b128 v[52:55], v6 offset:13312
    v_fmac_f32_dpp v79, v111, v123 row_newbcast:3 row_mask:0xf bank_mask:0xf
    v_mfma_f32_16x16x32_bf16 v[56:59], a[240:243], v[112:115], v[56:59]
    v_mul_f32_dpp v76, v110, v76 row_newbcast:0 row_mask:0xf bank_mask:0xf
    v_mul_f32_dpp v77, v110, v77 row_newbcast:1 row_mask:0xf bank_mask:0xf
    v_mfma_f32_16x16x32_bf16 v[64:67], v[112:115], a[248:251], v[64:67]
    v_mul_f32_dpp v78, v110, v78 row_newbcast:2 row_mask:0xf bank_mask:0xf
    v_mul_f32_dpp v79, v110, v79 row_newbcast:3 row_mask:0xf bank_mask:0xf
    v_mfma_f32_16x16x32_bf16 v[60:63], v[128:131], v[116:119], v[60:63]
    ds_read_b128 v[112:115], v6 offset:14336
    v_cvt_pk_bf16_f32 v94, v76, v77
    v_mfma_f32_16x16x32_bf16 v[56:59], a[252:255], v[116:119], v[56:59]
    v_cvt_pk_bf16_f32 v95, v78, v79
    v_cndmask_b32 v68, v72, v68, s[28:29]
    v_mfma_f32_16x16x32_bf16 v[64:67], v[116:119], v[132:135], v[64:67]
    s_waitcnt lgkmcnt(7)
    v_cndmask_b32 v69, v73, v69, s[30:31]
    v_cndmask_b32 v70, v74, v70, s[32:33]
    v_mfma_f32_16x16x32_bf16 v[60:63], v[140:143], v[24:27], v[60:63]
    ds_read_b128 v[116:119], v6 offset:15360
    v_cndmask_b32 v71, v75, v71, s[34:35]
    v_mfma_f32_16x16x32_bf16 v[56:59], v[136:139], v[24:27], v[56:59]
    v_max3_f32 v72, v68, v69, v70
    v_max_f32 v73, v72, v71
    v_mfma_f32_16x16x32_bf16 v[64:67], v[24:27], v[144:147], v[64:67]
    v_max_f32 v72, v72, v71
    s_nop 0
    v_mfma_f32_16x16x32_bf16 v[60:63], v[152:155], v[28:31], v[60:63]
    v_permlane32_swap_b32 v72, v73
    v_mfma_f32_16x16x32_bf16 v[56:59], v[148:151], v[28:31], v[56:59]
    s_waitcnt lgkmcnt(6)
    v_max_f32 v74, v72, v73
    v_max_f32 v72, v72, v73
    v_mfma_f32_16x16x32_bf16 v[60:63], v[164:167], v[32:35], v[60:63]
    s_nop 0
    v_permlane16_swap_b32 v72, v74
    v_mfma_f32_16x16x32_bf16 v[56:59], v[160:163], v[32:35], v[56:59]
    v_max_f32 v72, v72, v74
    v_mul_f32 v72, -v72, v96
    v_mfma_f32_16x16x32_bf16 v[60:63], v[176:179], v[36:39], v[60:63]
    v_fma_f32 v68, v68, v96, v72
    v_fma_f32 v69, v69, v96, v72
    v_mfma_f32_16x16x32_bf16 v[56:59], v[172:175], v[36:39], v[56:59]
    s_waitcnt lgkmcnt(4)
    v_fma_f32 v70, v70, v96, v72
    v_fma_f32 v71, v71, v96, v72
    v_mfma_f32_16x16x32_bf16 v[60:63], v[188:191], v[40:43], v[60:63]
    v_exp_f32 v68, v68
    v_mfma_f32_16x16x32_bf16 v[56:59], v[184:187], v[40:43], v[56:59]
    v_exp_f32 v69, v69
    v_mfma_f32_16x16x32_bf16 v[60:63], v[200:203], v[44:47], v[60:63]
    v_exp_f32 v70, v70
    v_mfma_f32_16x16x32_bf16 v[56:59], v[196:199], v[44:47], v[56:59]
    s_waitcnt lgkmcnt(3)
    v_exp_f32 v71, v71
    v_mfma_f32_16x16x32_bf16 v[60:63], v[212:215], v[48:51], v[60:63]
    v_cvt_pk_bf16_f32 v2, v68, v69
    v_cvt_pk_bf16_f32 v3, v70, v71
    v_mfma_f32_16x16x32_bf16 v[56:59], v[208:211], v[48:51], v[56:59]
    s_waitcnt lgkmcnt(2)
    v_and_b32 v72, v2, v20
    v_and_b32 v73, v3, v21
    v_mfma_f32_16x16x16_bf16 v[68:71], v[22:23], v[2:3], 0
    v_xor_b32 v74, v2, v72
    v_xor_b32 v75, v3, v73
    v_mfma_f32_16x16x32_bf16 v[60:63], v[224:227], v[52:55], v[60:63]
    s_add_u32 s86, s65, 98304
    v_mfma_f32_16x16x32_bf16 v[76:79], v[92:95], v[72:75], 0
    s_nop 2
    v_mfma_f32_16x16x32_bf16 v[56:59], v[220:223], v[52:55], v[56:59]
    s_waitcnt lgkmcnt(1)
    v_rcp_f32 v68, v68
    v_mfma_f32_16x16x32_bf16 v[60:63], v[236:239], v[112:115], v[60:63]
    s_waitcnt vmcnt(0)
    v_mul_f32 v76, v68, v76
    v_mul_f32 v77, v68, v77
    v_mfma_f32_16x16x32_bf16 v[56:59], v[232:235], v[112:115], v[56:59]
    s_waitcnt lgkmcnt(0)
    v_mul_f32 v78, v68, v78
    v_mul_f32 v79, v68, v79
    v_mfma_f32_16x16x32_bf16 v[60:63], v[248:251], v[116:119], v[60:63]
    v_cvt_pk_bf16_f32 v3, v78, v79
    v_cvt_pk_bf16_f32 v2, v76, v77
    v_mfma_f32_16x16x32_bf16 v[56:59], v[244:247], v[116:119], v[56:59]
    v_permlane16_swap_b32 v1, v3
    v_mfma_f32_16x16x32_bf16 v[64:67], v[28:31], v[156:159], v[64:67]
    v_permlane16_swap_b32 v0, v2
    v_mfma_f32_16x16x32_bf16 v[64:67], v[32:35], v[168:171], v[64:67]
    v_or_b32 v3, 1, v3
    v_fmac_f32_dpp v60, v122, v105 row_newbcast:0 row_mask:0xf bank_mask:0xf
    v_mfma_f32_16x16x32_bf16 v[64:67], v[36:39], v[180:183], v[64:67]
    buffer_store_dwordx4 v[0:3], v8, s[8:11], s86 offen sc1
    v_mfma_f32_16x16x32_bf16 v[64:67], v[40:43], v[192:195], v[64:67]
    v_fmac_f32_dpp v61, v122, v105 row_newbcast:1 row_mask:0xf bank_mask:0xf
    v_fmac_f32_dpp v62, v122, v105 row_newbcast:2 row_mask:0xf bank_mask:0xf
    v_mfma_f32_16x16x32_bf16 v[64:67], v[44:47], v[204:207], v[64:67]
    v_fmac_f32_dpp v63, v122, v105 row_newbcast:3 row_mask:0xf bank_mask:0xf
    v_mul_f32 v60, v104, v60
    v_mfma_f32_16x16x32_bf16 v[64:67], v[48:51], v[216:219], v[64:67]
    v_mul_f32 v61, v104, v61
    v_mul_f32 v62, v104, v62
    v_mfma_f32_16x16x32_bf16 v[64:67], v[52:55], v[228:231], v[64:67]
    v_mul_f32 v63, v104, v63
    v_cvt_pk_bf16_f32 v84, v60, v61
    v_mfma_f32_16x16x32_bf16 v[64:67], v[112:115], v[240:243], v[64:67]
    v_cvt_pk_bf16_f32 v85, v62, v63
    v_fmac_f32_dpp v56, v121, v105 row_newbcast:0 row_mask:0xf bank_mask:0xf
    v_mfma_f32_16x16x32_bf16 v[64:67], v[116:119], v[252:255], v[64:67]
    v_fmac_f32_dpp v57, v121, v105 row_newbcast:1 row_mask:0xf bank_mask:0xf
    v_fmac_f32_dpp v58, v121, v105 row_newbcast:2 row_mask:0xf bank_mask:0xf
    v_mfma_f32_16x16x16_bf16 v[72:75], v[84:85], v[82:83], v[16:19]
    v_fmac_f32_dpp v59, v121, v105 row_newbcast:3 row_mask:0xf bank_mask:0xf
    v_cvt_pk_bf16_f32 v80, v56, v57
    v_mfma_f32_16x16x16_bf16 v[68:71], v[86:87], v[82:83], v[16:19]
    v_cvt_pk_bf16_f32 v81, v58, v59
    v_mul_f32 v96, s43, v104
    v_cmp_eq_u32 vcc, -1, v91
    v_fmac_f32_dpp v64, v107, v123 row_newbcast:0 row_mask:0xf bank_mask:0xf
    s_cbranch_vccnz L_retry_191
L_back_192:
    v_add_f32 v60, s42, v16
    v_add_f32 v61, s42, v17
    v_add_f32 v62, s42, v18
    v_add_f32 v63, s42, v19
    v_mfma_f32_16x16x16_bf16 v[56:59], v[84:85], v[80:81], v[16:19]
    v_cndmask_b32 v68, v72, v68, s[28:29]
    v_cndmask_b32 v69, v73, v69, s[30:31]
    v_mfma_f32_16x16x16_bf16 v[60:63], v[88:89], v[80:81], v[60:63]
    v_cndmask_b32 v70, v74, v70, s[32:33]
    v_cndmask_b32 v71, v75, v71, s[34:35]
    v_max3_f32 v72, v68, v69, v70
    v_max_f32 v73, v72, v71
    v_max_f32 v72, v72, v71
    v_fmac_f32_dpp v65, v107, v123 row_newbcast:1 row_mask:0xf bank_mask:0xf
    v_fmac_f32_dpp v66, v107, v123 row_newbcast:2 row_mask:0xf bank_mask:0xf
    v_permlane32_swap_b32 v72, v73
    v_cndmask_b32 v56, v60, v56, s[28:29]
    v_cndmask_b32 v57, v61, v57, s[30:31]
    v_cndmask_b32 v58, v62, v58, s[32:33]
    v_cndmask_b32 v59, v63, v59, s[34:35]
    v_max3_f32 v60, v56, v57, v58
    v_max_f32 v61, v60, v59
    v_max_f32 v60, v60, v59
    v_max_f32 v74, v72, v73
    v_max_f32 v72, v72, v73
    v_permlane32_swap_b32 v60, v61
    v_max_f32 v62, v60, v61
    v_max_f32 v60, v60, v61
    v_permlane16_swap_b32 v72, v74
    v_max_f32 v72, v72, v74
    v_permlane16_swap_b32 v60, v62
    v_max_f32 v60, v60, v62
    v_mul_f32 v60, -v60, v96
    v_fma_f32 v56, v56, v96, v60
    v_fma_f32 v57, v57, v96, v60
    v_fma_f32 v58, v58, v96, v60
    v_fma_f32 v59, v59, v96, v60
    v_mul_f32 v72, -v72, v97
    v_exp_f32 v56, v56
    v_fma_f32 v68, v68, v97, v72
    v_exp_f32 v57, v57
    v_fma_f32 v69, v69, v97, v72
    v_exp_f32 v58, v58
    v_fma_f32 v70, v70, v97, v72
    v_exp_f32 v59, v59
    v_fma_f32 v71, v71, v97, v72
    v_cvt_pk_bf16_f32 v2, v56, v57
    v_exp_f32 v68, v68
    v_cvt_pk_bf16_f32 v3, v58, v59
    v_exp_f32 v69, v69
    s_add_u32 s89, s66, 65536
    s_mov_b64 exec, s[54:55]
    buffer_load_dwordx4 v[24:27], v6, s[8:11], s89 offen offset:0 sc1
    buffer_load_dwordx4 v[28:31], v6, s[8:11], s89 offen offset:1024 sc1
    s_mov_b64 exec, -1
    v_and_b32 v62, v2, v20
    v_exp_f32 v70, v70
    v_and_b32 v63, v3, v21
    v_mfma_f32_16x16x16_bf16 v[56:59], v[22:23], v[2:3], 0
    v_exp_f32 v71, v71
    v_cvt_pk_bf16_f32 v0, v68, v69
    s_mov_b64 exec, s[54:55]
    buffer_load_dwordx4 v[32:35], v6, s[8:11], s89 offen offset:2048 sc1
    buffer_load_dwordx4 v[36:39], v6, s[8:11], s89 offen offset:3072 sc1
    s_mov_b64 exec, -1
    s_add_u32 s94, s66, 69632
    v_xor_b32 v60, v2, v62
    v_cvt_pk_bf16_f32 v1, v70, v71
    v_xor_b32 v61, v3, v63
    v_and_b32 v74, v0, v20
    s_add_u32 s88, s65, 65536
    v_and_b32 v75, v1, v21
    v_mfma_f32_16x16x16_bf16 v[68:71], v[22:23], v[0:1], 0
    s_mov_b64 exec, s[54:55]
    buffer_load_dwordx4 v[40:43], v6, s[8:11], s94 offen offset:0 sc1
    buffer_load_dwordx4 v[44:47], v6, s[8:11], s94 offen offset:1024 sc1
    s_mov_b64 exec, -1
    v_xor_b32 v72, v0, v74
    v_xor_b32 v73, v1, v75
    v_fmac_f32_dpp v67, v107, v123 row_newbcast:3 row_mask:0xf bank_mask:0xf
    v_mul_f32_dpp v64, v106, v64 row_newbcast:0 row_mask:0xf bank_mask:0xf
    v_mul_f32_dpp v65, v106, v65 row_newbcast:1 row_mask:0xf bank_mask:0xf
    v_mul_f32_dpp v66, v106, v66 row_newbcast:2 row_mask:0xf bank_mask:0xf
    v_add_u32 v5, 98304, v6
    ds_read_b128 v[80:83], v5 offset:0
    ds_read_b128 v[84:87], v5 offset:1024
    ds_read_b128 v[96:99], v5 offset:2048
    s_mov_b64 exec, s[54:55]
    buffer_load_dwordx4 v[48:51], v6, s[8:11], s94 offen offset:2048 sc1
    buffer_load_dwordx4 v[52:55], v6, s[8:11], s94 offen offset:3072 sc1
    s_mov_b64 exec, -1
    v_mul_f32_dpp v67, v106, v67 row_newbcast:3 row_mask:0xf bank_mask:0xf
    v_cvt_pk_bf16_f32 v92, v64, v65
    v_cvt_pk_bf16_f32 v93, v66, v67
    v_mfma_f32_16x16x16_bf16 v[104:107], v[14:15], v[100:101], 0
    s_nop 0
    v_mfma_f32_16x16x32_bf16 v[64:67], v[90:93], v[60:63], 0
    v_rcp_f32 v56, v56
    v_mfma_f32_16x16x32_bf16 v[76:79], v[92:95], v[72:75], 0
    v_rcp_f32 v68, v68
    v_mfma_f32_16x16x16_bf16 v[108:111], v[14:15], v[102:103], 0
    v_mfma_f32_16x16x16_bf16 v[112:115], v[14:15], v[124:125], 0
    s_nop 2
    v_mul_f32 v64, v56, v64
    v_mul_f32 v65, v56, v65
    v_mul_f32 v66, v56, v66
    v_mul_f32 v67, v56, v67
    v_mul_f32 v76, v68, v76
    v_cvt_pk_bf16_f32 v3, v66, v67
    v_mul_f32 v77, v68, v77
    v_cvt_pk_bf16_f32 v2, v64, v65
    v_mul_f32 v78, v68, v78
    v_mul_f32 v79, v68, v79
    v_cvt_pk_bf16_f32 v1, v78, v79
    v_cvt_pk_bf16_f32 v0, v76, v77
    v_mfma_f32_16x16x16_bf16 v[116:119], v[14:15], v[126:127], 0
    v_permlane16_swap_b32 v1, v3
    v_permlane16_swap_b32 v0, v2
    v_or_b32 v3, 1, v3
    buffer_store_dwordx4 v[0:3], v8, s[8:11], s88 offen sc1
    s_cmp_lt_u32 s36, 2
    s_cbranch_scc1 L_lo_193
    s_waitcnt vmcnt(5)
    v_bitop3_b32 v4, v27, v31, v35 bitop3:0x80
    v_bitop3_b32 v4, v4, v39, 1 bitop3:0x80
    v_cmp_ne_u32 vcc, 1, v4
    ds_read_b128 v[72:75], v5 offset:3072
    ds_read_b128 v[76:79], v5 offset:4096
    ds_read_b128 v[88:91], v5 offset:5120
    ds_read_b128 v[92:95], v5 offset:6144
    s_cbranch_vccnz L_retry_203
L_back_204:
    s_waitcnt lgkmcnt(6)
    v_mfma_f32_16x16x32_bf16 v[104:107], v[80:83], v[24:27], v[104:107]
    ds_read_b128 v[100:103], v5 offset:7168
    s_waitcnt lgkmcnt(5)
    v_mfma_f32_16x16x32_bf16 v[108:111], v[84:87], v[24:27], v[108:111]
    ds_read_b128 v[80:83], v5 offset:8192
    s_add_u32 s81, s66, 73728
    v_mfma_f32_16x16x32_bf16 v[112:115], v[96:99], v[24:27], v[112:115]
    ds_read_b128 v[84:87], v5 offset:9216
    s_waitcnt lgkmcnt(5)
    buffer_load_dwordx4 v[56:59], v6, s[8:11], s81 offen offset:0 sc1
    v_mfma_f32_16x16x32_bf16 v[116:119], v[72:75], v[24:27], v[116:119]
    ds_read_b128 v[96:99], v5 offset:10240
    v_mfma_f32_16x16x32_bf16 v[104:107], v[76:79], v[28:31], v[104:107]
    ds_read_b128 v[72:75], v5 offset:11264
    s_waitcnt lgkmcnt(5)
    buffer_load_dwordx4 v[60:63], v6, s[8:11], s81 offen offset:1024 sc1
    v_mfma_f32_16x16x32_bf16 v[108:111], v[88:91], v[28:31], v[108:111]
    ds_read_b128 v[76:79], v5 offset:12288
    v_mfma_f32_16x16x32_bf16 v[112:115], v[92:95], v[28:31], v[112:115]
    ds_read_b128 v[88:91], v5 offset:13312
    s_waitcnt lgkmcnt(5)
    buffer_load_dwordx4 v[64:67], v6, s[8:11], s81 offen offset:2048 sc1
    v_mfma_f32_16x16x32_bf16 v[116:119], v[100:103], v[28:31], v[116:119]
    ds_read_b128 v[92:95], v5 offset:14336
    v_mfma_f32_16x16x32_bf16 v[104:107], v[80:83], v[32:35], v[104:107]
    ds_read_b128 v[100:103], v5 offset:15360
    s_waitcnt lgkmcnt(5)
    buffer_load_dwordx4 v[68:71], v6, s[8:11], s81 offen offset:3072 sc1
    v_mfma_f32_16x16x32_bf16 v[108:111], v[84:87], v[32:35], v[108:111]
    ds_read_b128 v[80:83], v5 offset:16384
    s_waitcnt vmcnt(5)
    v_mfma_f32_16x16x32_bf16 v[112:115], v[96:99], v[32:35], v[112:115]
    ds_read_b128 v[84:87], v5 offset:17408
    s_waitcnt lgkmcnt(5)
    v_mfma_f32_16x16x32_bf16 v[116:119], v[72:75], v[32:35], v[116:119]
    ds_read_b128 v[96:99], v5 offset:18432
    v_bitop3_b32 v4, v43, v47, v51 bitop3:0x80
    v_mfma_f32_16x16x32_bf16 v[104:107], v[76:79], v[36:39], v[104:107]
    ds_read_b128 v[72:75], v5 offset:19456
    s_waitcnt lgkmcnt(5)
    v_mfma_f32_16x16x32_bf16 v[108:111], v[88:91], v[36:39], v[108:111]
    ds_read_b128 v[76:79], v5 offset:20480
    v_bitop3_b32 v4, v4, v55, 1 bitop3:0x80
    v_mfma_f32_16x16x32_bf16 v[112:115], v[92:95], v[36:39], v[112:115]
    ds_read_b128 v[88:91], v5 offset:21504
    s_waitcnt lgkmcnt(5)
    v_mfma_f32_16x16x32_bf16 v[116:119], v[100:103], v[36:39], v[116:119]
    ds_read_b128 v[92:95], v5 offset:22528
    v_cmp_ne_u32 vcc, 1, v4
    s_nop 0
    s_cbranch_vccnz L_retry_205
L_back_206:
    v_mfma_f32_16x16x32_bf16 v[104:107], v[80:83], v[40:43], v[104:107]
    ds_read_b128 v[100:103], v5 offset:23552
    s_waitcnt lgkmcnt(5)
    v_mfma_f32_16x16x32_bf16 v[108:111], v[84:87], v[40:43], v[108:111]
    ds_read_b128 v[80:83], v5 offset:24576
    s_add_u32 s82, s66, 77824
    v_mfma_f32_16x16x32_bf16 v[112:115], v[96:99], v[40:43], v[112:115]
    ds_read_b128 v[84:87], v5 offset:25600
    s_waitcnt lgkmcnt(5)
    buffer_load_dwordx4 v[24:27], v6, s[8:11], s82 offen offset:0 sc1
    v_mfma_f32_16x16x32_bf16 v[116:119], v[72:75], v[40:43], v[116:119]
    ds_read_b128 v[96:99], v5 offset:26624
    v_mfma_f32_16x16x32_bf16 v[104:107], v[76:79], v[44:47], v[104:107]
    ds_read_b128 v[72:75], v5 offset:27648
    s_waitcnt lgkmcnt(5)
    buffer_load_dwordx4 v[28:31], v6, s[8:11], s82 offen offset:1024 sc1
    v_mfma_f32_16x16x32_bf16 v[108:111], v[88:91], v[44:47], v[108:111]
    ds_read_b128 v[76:79], v5 offset:28672
    v_mfma_f32_16x16x32_bf16 v[112:115], v[92:95], v[44:47], v[112:115]
    ds_read_b128 v[88:91], v5 offset:29696
    s_waitcnt lgkmcnt(5)
    buffer_load_dwordx4 v[32:35], v6, s[8:11], s82 offen offset:2048 sc1
    v_mfma_f32_16x16x32_bf16 v[116:119], v[100:103], v[44:47], v[116:119]
    ds_read_b128 v[92:95], v5 offset:30720
    v_mfma_f32_16x16x32_bf16 v[104:107], v[80:83], v[48:51], v[104:107]
    ds_read_b128 v[100:103], v5 offset:31744
    s_waitcnt lgkmcnt(5)
    buffer_load_dwordx4 v[36:39], v6, s[8:11], s82 offen offset:3072 sc1
    v_mfma_f32_16x16x32_bf16 v[108:111], v[84:87], v[48:51], v[108:111]
    ds_read_b128 v[80:83], v5 offset:32768
    v_mfma_f32_16x16x32_bf16 v[112:115], v[96:99], v[48:51], v[112:115]
    ds_read_b128 v[84:87], v5 offset:33792
    s_waitcnt lgkmcnt(5)
    v_mfma_f32_16x16x32_bf16 v[116:119], v[72:75], v[48:51], v[116:119]
    ds_read_b128 v[96:99], v5 offset:34816
    v_mfma_f32_16x16x32_bf16 v[104:107], v[76:79], v[52:55], v[104:107]
    ds_read_b128 v[72:75], v5 offset:35840
    s_waitcnt lgkmcnt(5)
    v_mfma_f32_16x16x32_bf16 v[108:111], v[88:91], v[52:55], v[108:111]
    ds_read_b128 v[76:79], v5 offset:36864
    s_waitcnt vmcnt(4)
    v_mfma_f32_16x16x32_bf16 v[112:115], v[92:95], v[52:55], v[112:115]
    ds_read_b128 v[88:91], v5 offset:37888
    s_waitcnt lgkmcnt(5)
    v_mfma_f32_16x16x32_bf16 v[116:119], v[100:103], v[52:55], v[116:119]
    ds_read_b128 v[92:95], v5 offset:38912
    v_bitop3_b32 v4, v59, v63, v67 bitop3:0x80
    v_bitop3_b32 v4, v4, v71, 1 bitop3:0x80
    v_cmp_ne_u32 vcc, 1, v4
    s_nop 0
    s_cbranch_vccnz L_retry_207
L_back_208:
    v_mfma_f32_16x16x32_bf16 v[104:107], v[80:83], v[56:59], v[104:107]
    ds_read_b128 v[100:103], v5 offset:39936
    s_waitcnt lgkmcnt(5)
    v_mfma_f32_16x16x32_bf16 v[108:111], v[84:87], v[56:59], v[108:111]
    ds_read_b128 v[80:83], v5 offset:40960
    v_mfma_f32_16x16x32_bf16 v[112:115], v[96:99], v[56:59], v[112:115]
    ds_read_b128 v[84:87], v5 offset:41984
    s_waitcnt lgkmcnt(5)
    v_mfma_f32_16x16x32_bf16 v[116:119], v[72:75], v[56:59], v[116:119]
    ds_read_b128 v[96:99], v5 offset:43008
    v_mfma_f32_16x16x32_bf16 v[104:107], v[76:79], v[60:63], v[104:107]
    ds_read_b128 v[72:75], v5 offset:44032
    s_waitcnt lgkmcnt(5)
    v_mfma_f32_16x16x32_bf16 v[108:111], v[88:91], v[60:63], v[108:111]
    ds_read_b128 v[76:79], v5 offset:45056
    v_mfma_f32_16x16x32_bf16 v[112:115], v[92:95], v[60:63], v[112:115]
    ds_read_b128 v[88:91], v5 offset:46080
    s_waitcnt lgkmcnt(5)
    v_mfma_f32_16x16x32_bf16 v[116:119], v[100:103], v[60:63], v[116:119]
    ds_read_b128 v[92:95], v5 offset:47104
    v_mfma_f32_16x16x32_bf16 v[104:107], v[80:83], v[64:67], v[104:107]
    ds_read_b128 v[100:103], v5 offset:48128
    s_waitcnt lgkmcnt(5)
    v_mfma_f32_16x16x32_bf16 v[108:111], v[84:87], v[64:67], v[108:111]
    ds_read_b128 v[80:83], v5 offset:49152
    v_mfma_f32_16x16x32_bf16 v[112:115], v[96:99], v[64:67], v[112:115]
    ds_read_b128 v[84:87], v5 offset:50176
    s_waitcnt lgkmcnt(5)
    v_mfma_f32_16x16x32_bf16 v[116:119], v[72:75], v[64:67], v[116:119]
    ds_read_b128 v[96:99], v5 offset:51200
    v_mfma_f32_16x16x32_bf16 v[104:107], v[76:79], v[68:71], v[104:107]
    ds_read_b128 v[72:75], v5 offset:52224
    s_waitcnt lgkmcnt(5)
    v_mfma_f32_16x16x32_bf16 v[108:111], v[88:91], v[68:71], v[108:111]
    ds_read_b128 v[76:79], v5 offset:53248
    s_waitcnt vmcnt(0)
    v_mfma_f32_16x16x32_bf16 v[112:115], v[92:95], v[68:71], v[112:115]
    ds_read_b128 v[88:91], v5 offset:54272
    s_waitcnt lgkmcnt(5)
    v_mfma_f32_16x16x32_bf16 v[116:119], v[100:103], v[68:71], v[116:119]
    ds_read_b128 v[92:95], v5 offset:55296
    v_bitop3_b32 v4, v27, v31, v35 bitop3:0x80
    v_bitop3_b32 v4, v4, v39, 1 bitop3:0x80
    v_cmp_ne_u32 vcc, 1, v4
    s_nop 0
    s_cbranch_vccnz L_retry_209
L_back_210:
    v_mfma_f32_16x16x32_bf16 v[104:107], v[80:83], v[24:27], v[104:107]
    ds_read_b128 v[100:103], v5 offset:56320
    s_waitcnt lgkmcnt(5)
    v_mfma_f32_16x16x32_bf16 v[108:111], v[84:87], v[24:27], v[108:111]
    ds_read_b128 v[80:83], v5 offset:57344
    v_mfma_f32_16x16x32_bf16 v[112:115], v[96:99], v[24:27], v[112:115]
    ds_read_b128 v[84:87], v5 offset:58368
    s_waitcnt lgkmcnt(5)
    v_mfma_f32_16x16x32_bf16 v[116:119], v[72:75], v[24:27], v[116:119]
    ds_read_b128 v[96:99], v5 offset:61440
    v_mfma_f32_16x16x32_bf16 v[104:107], v[76:79], v[28:31], v[104:107]
    ds_read_b128 v[72:75], v5 offset:62464
    s_waitcnt lgkmcnt(5)
    v_mfma_f32_16x16x32_bf16 v[108:111], v[88:91], v[28:31], v[108:111]
    ds_read_b128 v[76:79], v5 offset:59392
    v_mfma_f32_16x16x32_bf16 v[112:115], v[92:95], v[28:31], v[112:115]
    ds_read_b128 v[88:91], v5 offset:60416
    s_waitcnt lgkmcnt(5)
    v_mfma_f32_16x16x32_bf16 v[116:119], v[100:103], v[28:31], v[116:119]
    ds_read_b128 v[92:95], v5 offset:63488
    v_mfma_f32_16x16x32_bf16 v[104:107], v[80:83], v[32:35], v[104:107]
    ds_read_b128 v[100:103], v5 offset:64512
    s_waitcnt lgkmcnt(5)
    v_mfma_f32_16x16x32_bf16 v[108:111], v[84:87], v[32:35], v[108:111]
    v_mfma_f32_16x16x32_bf16 v[104:107], v[96:99], v[36:39], v[104:107]
    s_waitcnt lgkmcnt(3)
    v_mfma_f32_16x16x32_bf16 v[108:111], v[72:75], v[36:39], v[108:111]
    v_mfma_f32_16x16x32_bf16 v[112:115], v[76:79], v[32:35], v[112:115]
    s_waitcnt lgkmcnt(1)
    v_mfma_f32_16x16x32_bf16 v[116:119], v[88:91], v[32:35], v[116:119]
    v_mfma_f32_16x16x32_bf16 v[112:115], v[92:95], v[36:39], v[112:115]
    s_waitcnt lgkmcnt(0)
    v_mfma_f32_16x16x32_bf16 v[116:119], v[100:103], v[36:39], v[116:119]
    s_nop 1
    v_cvt_pk_bf16_f32 v103, v110, v111
    v_cvt_pk_bf16_f32 v100, v104, v105
    v_cvt_pk_bf16_f32 v101, v106, v107
    v_cvt_pk_bf16_f32 v102, v108, v109
    buffer_store_dwordx4 v[100:103], v11, s[12:15], 0 offen offset:0
    s_nop 0
    v_cvt_pk_bf16_f32 v127, v118, v119
    v_cvt_pk_bf16_f32 v124, v112, v113
    v_cvt_pk_bf16_f32 v125, v114, v115
    v_cvt_pk_bf16_f32 v126, v116, v117
    buffer_store_dwordx4 v[124:127], v11, s[12:15], 0 offen offset:64
    s_or_b32 s72, s2, s36
    s_cbranch_scc1 L_end
    v_mov_b32 v0, s5
    s_mov_b32 s72, 540672
    s_mov_b64 exec, 1
    buffer_store_dword v0, v6, s[8:11], s72 offen sc1
    s_endpgm
L_retry_107:
    s_add_u32 s73, s61, 0x20000
    s_mov_b32 exec_lo, 0xff00ff00
    s_mov_b32 exec_hi, 0xff00ff00
    buffer_load_dwordx4 v[80:83], v6, s[8:11], s61 offen sc1
    s_mov_b32 exec_lo, 0
    s_mov_b32 exec_hi, -1
    buffer_load_dwordx4 v[84:87], v6, s[8:11], s73 offen sc1
    s_mov_b32 exec_lo, -1
    s_sub_u32 s41, s41, 1
    s_cbranch_scc1 L_end
    s_waitcnt vmcnt(0)
    v_xor_b32 v4, v82, v74
    v_xor_b32 v3, v84, v74
    v_or_b32 v4, v4, v3
    v_cmp_ne_u32 vcc, 0, v4
    s_nop 0
    s_cbranch_vccnz L_retry_107
    s_branch L_back_108
L_retry_109:
    s_add_u32 s83, s66, 65536
    buffer_load_dwordx4 v[24:27], v6, s[8:11], s83 offen offset:0 sc1
    buffer_load_dwordx4 v[28:31], v6, s[8:11], s83 offen offset:1024 sc1
    buffer_load_dwordx4 v[32:35], v6, s[8:11], s83 offen offset:2048 sc1
    buffer_load_dwordx4 v[36:39], v6, s[8:11], s83 offen offset:3072 sc1
    s_add_u32 s84, s66, 69632
    buffer_load_dwordx4 v[40:43], v6, s[8:11], s84 offen offset:0 sc1
    buffer_load_dwordx4 v[44:47], v6, s[8:11], s84 offen offset:1024 sc1
    buffer_load_dwordx4 v[48:51], v6, s[8:11], s84 offen offset:2048 sc1
    buffer_load_dwordx4 v[52:55], v6, s[8:11], s84 offen offset:3072 sc1
    s_add_u32 s85, s66, 73728
    buffer_load_dwordx4 v[56:59], v6, s[8:11], s85 offen offset:0 sc1
    buffer_load_dwordx4 v[60:63], v6, s[8:11], s85 offen offset:1024 sc1
    buffer_load_dwordx4 v[64:67], v6, s[8:11], s85 offen offset:2048 sc1
    buffer_load_dwordx4 v[68:71], v6, s[8:11], s85 offen offset:3072 sc1
    s_sub_u32 s41, s41, 1
    s_cbranch_scc1 L_end
    s_waitcnt vmcnt(8)
    v_bitop3_b32 v4, v27, v31, v35 bitop3:0xfe
    v_bitop3_b32 v4, v4, v39, 1 bitop3:0xa8
    v_cmp_ne_u32 vcc, 0, v4
    s_nop 0
    s_cbranch_vccnz L_retry_109
    s_branch L_back_110
L_retry_111:
    s_add_u32 s87, s66, 69632
    buffer_load_dwordx4 v[40:43], v6, s[8:11], s87 offen offset:0 sc1
    buffer_load_dwordx4 v[44:47], v6, s[8:11], s87 offen offset:1024 sc1
    buffer_load_dwordx4 v[48:51], v6, s[8:11], s87 offen offset:2048 sc1
    buffer_load_dwordx4 v[52:55], v6, s[8:11], s87 offen offset:3072 sc1
    s_sub_u32 s41, s41, 1
    s_cbranch_scc1 L_end
    s_waitcnt vmcnt(0)
    v_bitop3_b32 v4, v43, v47, v51 bitop3:0xfe
    v_bitop3_b32 v4, v4, v55, 1 bitop3:0xa8
    v_cmp_ne_u32 vcc, 0, v4
    s_nop 0
    s_cbranch_vccnz L_retry_111
    s_branch L_back_112
L_retry_113:
    s_add_u32 s88, s66, 73728
    buffer_load_dwordx4 v[56:59], v6, s[8:11], s88 offen offset:0 sc1
    buffer_load_dwordx4 v[60:63], v6, s[8:11], s88 offen offset:1024 sc1
    buffer_load_dwordx4 v[64:67], v6, s[8:11], s88 offen offset:2048 sc1
    buffer_load_dwordx4 v[68:71], v6, s[8:11], s88 offen offset:3072 sc1
    s_sub_u32 s41, s41, 1
    s_cbranch_scc1 L_end
    s_waitcnt vmcnt(0)
    v_bitop3_b32 v4, v59, v63, v67 bitop3:0xfe
    v_bitop3_b32 v4, v4, v71, 1 bitop3:0xa8
    v_cmp_ne_u32 vcc, 0, v4
    s_nop 0
    s_cbranch_vccnz L_retry_113
    s_branch L_back_114
L_retry_115:
    s_add_u32 s89, s66, 77824
    buffer_load_dwordx4 v[24:27], v6, s[8:11], s89 offen offset:0 sc1
    buffer_load_dwordx4 v[28:31], v6, s[8:11], s89 offen offset:1024 sc1
    buffer_load_dwordx4 v[32:35], v6, s[8:11], s89 offen offset:2048 sc1
    buffer_load_dwordx4 v[36:39], v6, s[8:11], s89 offen offset:3072 sc1
    s_sub_u32 s41, s41, 1
    s_cbranch_scc1 L_end
    s_waitcnt vmcnt(0)
    v_bitop3_b32 v4, v27, v31, v35 bitop3:0xfe
    v_bitop3_b32 v4, v4, v39, 1 bitop3:0xa8
    v_cmp_ne_u32 vcc, 0, v4
    s_nop 0
    s_cbranch_vccnz L_retry_115
    s_branch L_back_116
L_retry_117:
    s_add_u32 s73, s60, 49152
    buffer_load_dwordx4 v[40:43], v7, s[8:11], s73 offen offset:0 sc1
    buffer_load_dwordx4 v[44:47], v7, s[8:11], s73 offen offset:1024 sc1
    buffer_load_dwordx4 v[48:51], v7, s[8:11], s73 offen offset:2048 sc1
    buffer_load_dwordx4 v[52:55], v7, s[8:11], s73 offen offset:3072 sc1
    s_sub_u32 s41, s41, 1
    s_cbranch_scc1 L_end
    s_waitcnt vmcnt(0)
    v_bitop3_b32 v4, v43, v47, 1 bitop3:0xa8
    v_cmp_ne_u32 vcc, 0, v4
    s_nop 0
    s_cbranch_vccnz L_retry_117
    s_branch L_back_118
L_retry_119:
    buffer_load_dwordx4 v[48:51], v7, s[8:11], s73 offen offset:2048 sc1
    buffer_load_dwordx4 v[52:55], v7, s[8:11], s73 offen offset:3072 sc1
    s_sub_u32 s41, s41, 1
    s_cbranch_scc1 L_end
    s_waitcnt vmcnt(0)
    v_bitop3_b32 v4, v51, v55, 1 bitop3:0xa8
    v_cmp_ne_u32 vcc, 0, v4
    s_nop 0
    s_cbranch_vccnz L_retry_119
    s_branch L_back_120
L_retry_121:
    s_add_u32 s73, s60, 32768
    buffer_load_dwordx4 v[24:27], v7, s[8:11], s73 offen offset:0 sc1
    buffer_load_dwordx4 v[28:31], v7, s[8:11], s73 offen offset:1024 sc1
    buffer_load_dwordx4 v[32:35], v7, s[8:11], s73 offen offset:2048 sc1
    buffer_load_dwordx4 v[36:39], v7, s[8:11], s73 offen offset:3072 sc1
    s_sub_u32 s41, s41, 1
    s_cbranch_scc1 L_end
    s_waitcnt vmcnt(0)
    v_bitop3_b32 v4, v27, v31, v35 bitop3:0xfe
    v_bitop3_b32 v4, v4, v39, 1 bitop3:0xa8
    v_cmp_ne_u32 vcc, 0, v4
    s_nop 0
    s_cbranch_vccnz L_retry_121
    s_branch L_back_122
L_retry_123:
    s_add_u32 s74, s60, 294912
    s_add_u32 s74, s74, s4
    buffer_load_dwordx4 v[80:83], v6, s[8:11], s74 offen sc1
    s_sub_u32 s41, s41, 1
    s_cbranch_scc1 L_end
    s_waitcnt vmcnt(0)
    v_bitop3_b32 v5, v81, v83, 1 bitop3:0xa8
    v_cmp_ne_u32 vcc, 0, v5
    s_nop 0
    s_cbranch_vccnz L_retry_123
    s_branch L_back_124
L_retry_125:
    s_add_u32 s75, s61, 32768
    buffer_load_dwordx4 v[88:91], v6, s[8:11], s75 offen sc1
    s_sub_u32 s41, s41, 1
    s_cbranch_scc1 L_end
    s_waitcnt vmcnt(0)
    v_cmp_eq_u32 vcc, -1, v91
    s_nop 0
    s_cbranch_vccnz L_retry_125
    s_branch L_back_126
L_retry_127:
    s_lshl_b32 s77, s37, 9
    s_add_u32 s77, s77, 532480
    v_lshrrev_b32 v94, 1, v6
    buffer_load_dwordx2 v[92:93], v94, s[8:11], s77 offen sc1
    s_sub_u32 s41, s41, 1
    s_cbranch_scc1 L_end
    s_waitcnt vmcnt(0)
    v_xor_b32 v94, s5, v92
    v_xor_b32 v95, s6, v93
    v_lshrrev_b32 v95, 8, v95
    v_or_b32 v94, v94, v95
    v_cmp_ne_u32 vcc, 0, v94
    s_nop 0
    s_cbranch_vccnz L_retry_127
    s_branch L_back_128
L_retry_131:
    s_add_u32 s82, s66, 65536
    buffer_load_dwordx4 v[24:27], v6, s[8:11], s82 offen offset:0 sc1
    buffer_load_dwordx4 v[28:31], v6, s[8:11], s82 offen offset:1024 sc1
    buffer_load_dwordx4 v[32:35], v6, s[8:11], s82 offen offset:2048 sc1
    buffer_load_dwordx4 v[36:39], v6, s[8:11], s82 offen offset:3072 sc1
    s_sub_u32 s41, s41, 1
    s_cbranch_scc1 L_end
    s_waitcnt vmcnt(0)
    v_bitop3_b32 v4, v27, v31, v35 bitop3:0x80
    v_bitop3_b32 v4, v4, v39, 1 bitop3:0x80
    v_cmp_ne_u32 vcc, 1, v4
    s_nop 0
    s_cbranch_vccnz L_retry_131
    s_branch L_back_132
L_retry_133:
    s_add_u32 s85, s66, 69632
    buffer_load_dwordx4 v[40:43], v6, s[8:11], s85 offen offset:0 sc1
    buffer_load_dwordx4 v[44:47], v6, s[8:11], s85 offen offset:1024 sc1
    buffer_load_dwordx4 v[48:51], v6, s[8:11], s85 offen offset:2048 sc1
    buffer_load_dwordx4 v[52:55], v6, s[8:11], s85 offen offset:3072 sc1
    s_sub_u32 s41, s41, 1
    s_cbranch_scc1 L_end
    s_waitcnt vmcnt(0)
    v_bitop3_b32 v4, v43, v47, v51 bitop3:0x80
    v_bitop3_b32 v4, v4, v55, 1 bitop3:0x80
    v_cmp_ne_u32 vcc, 1, v4
    s_nop 0
    s_cbranch_vccnz L_retry_133
    s_branch L_back_134
L_retry_135:
    s_add_u32 s86, s66, 73728
    buffer_load_dwordx4 v[56:59], v6, s[8:11], s86 offen offset:0 sc1
    buffer_load_dwordx4 v[60:63], v6, s[8:11], s86 offen offset:1024 sc1
    buffer_load_dwordx4 v[64:67], v6, s[8:11], s86 offen offset:2048 sc1
    buffer_load_dwordx4 v[68:71], v6, s[8:11], s86 offen offset:3072 sc1
    s_sub_u32 s41, s41, 1
    s_cbranch_scc1 L_end
    s_waitcnt vmcnt(0)
    v_bitop3_b32 v4, v59, v63, v67 bitop3:0x80
    v_bitop3_b32 v4, v4, v71, 1 bitop3:0x80
    v_cmp_ne_u32 vcc, 1, v4
    s_nop 0
    s_cbranch_vccnz L_retry_135
    s_branch L_back_136
L_retry_137:
    s_add_u32 s87, s66, 77824
    buffer_load_dwordx4 v[24:27], v6, s[8:11], s87 offen offset:0 sc1
    buffer_load_dwordx4 v[28:31], v6, s[8:11], s87 offen offset:1024 sc1
    buffer_load_dwordx4 v[32:35], v6, s[8:11], s87 offen offset:2048 sc1
    buffer_load_dwordx4 v[36:39], v6, s[8:11], s87 offen offset:3072 sc1
    s_sub_u32 s41, s41, 1
    s_cbranch_scc1 L_end
    s_waitcnt vmcnt(0)
    v_bitop3_b32 v4, v27, v31, v35 bitop3:0x80
    v_bitop3_b32 v4, v4, v39, 1 bitop3:0x80
    v_cmp_ne_u32 vcc, 1, v4
    s_nop 0
    s_cbranch_vccnz L_retry_137
    s_branch L_back_138
L_retry_139:
    s_add_u32 s73, s60, 49152
    buffer_load_dwordx4 v[40:43], v7, s[8:11], s73 offen offset:0 sc1
    buffer_load_dwordx4 v[44:47], v7, s[8:11], s73 offen offset:1024 sc1
    buffer_load_dwordx4 v[48:51], v7, s[8:11], s73 offen offset:2048 sc1
    buffer_load_dwordx4 v[52:55], v7, s[8:11], s73 offen offset:3072 sc1
    s_sub_u32 s41, s41, 1
    s_cbranch_scc1 L_end
    s_waitcnt vmcnt(0)
    v_bitop3_b32 v4, v43, v47, 1 bitop3:0x80
    v_cmp_ne_u32 vcc, 1, v4
    s_nop 0
    s_cbranch_vccnz L_retry_139
    s_branch L_back_140
L_retry_141:
    buffer_load_dwordx4 v[48:51], v7, s[8:11], s73 offen offset:2048 sc1
    buffer_load_dwordx4 v[52:55], v7, s[8:11], s73 offen offset:3072 sc1
    s_sub_u32 s41, s41, 1
    s_cbranch_scc1 L_end
    s_waitcnt vmcnt(0)
    v_bitop3_b32 v4, v51, v55, 1 bitop3:0x80
    v_cmp_ne_u32 vcc, 1, v4
    s_nop 0
    s_cbranch_vccnz L_retry_141
    s_branch L_back_142
L_lo_129:
    ds_read_b128 v[72:75], v5 offset:3072
    ds_read_b128 v[76:79], v5 offset:4096
    ds_read_b128 v[88:91], v5 offset:5120
    ds_read_b128 v[92:95], v5 offset:6144
    s_waitcnt vmcnt(0)
    s_add_u32 s80, s66, 65536
    buffer_load_dwordx4 v[24:27], v6, s[8:11], s80 offen offset:0 sc1
    buffer_load_dwordx4 v[28:31], v6, s[8:11], s80 offen offset:1024 sc1
    buffer_load_dwordx4 v[32:35], v6, s[8:11], s80 offen offset:2048 sc1
    buffer_load_dwordx4 v[36:39], v6, s[8:11], s80 offen offset:3072 sc1
    s_add_u32 s81, s66, 69632
    buffer_load_dwordx4 v[40:43], v6, s[8:11], s81 offen offset:0 sc1
    buffer_load_dwordx4 v[44:47], v6, s[8:11], s81 offen offset:1024 sc1
    buffer_load_dwordx4 v[48:51], v6, s[8:11], s81 offen offset:2048 sc1
    buffer_load_dwordx4 v[52:55], v6, s[8:11], s81 offen offset:3072 sc1
    s_waitcnt vmcnt(4)
    v_bitop3_b32 v4, v27, v31, v35 bitop3:0x80
    v_bitop3_b32 v4, v4, v39, 1 bitop3:0x80
    v_cmp_ne_u32 vcc, 1, v4
    s_nop 0
    s_cbranch_vccnz L_retry_131
L_back_132:
    s_waitcnt lgkmcnt(6)
    v_mfma_f32_16x16x32_bf16 v[104:107], v[80:83], v[24:27], v[104:107]
    ds_read_b128 v[100:103], v5 offset:7168
    s_waitcnt lgkmcnt(5)
    v_mfma_f32_16x16x32_bf16 v[108:111], v[84:87], v[24:27], v[108:111]
    ds_read_b128 v[80:83], v5 offset:8192
    s_add_u32 s83, s66, 73728
    v_mfma_f32_16x16x32_bf16 v[112:115], v[96:99], v[24:27], v[112:115]
    ds_read_b128 v[84:87], v5 offset:9216
    s_waitcnt lgkmcnt(5)
    buffer_load_dwordx4 v[56:59], v6, s[8:11], s83 offen offset:0 sc1
    v_mfma_f32_16x16x32_bf16 v[116:119], v[72:75], v[24:27], v[116:119]
    ds_read_b128 v[96:99], v5 offset:10240
    v_mfma_f32_16x16x32_bf16 v[104:107], v[76:79], v[28:31], v[104:107]
    ds_read_b128 v[72:75], v5 offset:11264
    s_waitcnt lgkmcnt(5)
    buffer_load_dwordx4 v[60:63], v6, s[8:11], s83 offen offset:1024 sc1
    v_mfma_f32_16x16x32_bf16 v[108:111], v[88:91], v[28:31], v[108:111]
    ds_read_b128 v[76:79], v5 offset:12288
    v_mfma_f32_16x16x32_bf16 v[112:115], v[92:95], v[28:31], v[112:115]
    ds_read_b128 v[88:91], v5 offset:13312
    s_waitcnt lgkmcnt(5)
    buffer_load_dwordx4 v[64:67], v6, s[8:11], s83 offen offset:2048 sc1
    v_mfma_f32_16x16x32_bf16 v[116:119], v[100:103], v[28:31], v[116:119]
    ds_read_b128 v[92:95], v5 offset:14336
    v_mfma_f32_16x16x32_bf16 v[104:107], v[80:83], v[32:35], v[104:107]
    ds_read_b128 v[100:103], v5 offset:15360
    s_waitcnt lgkmcnt(5)
    buffer_load_dwordx4 v[68:71], v6, s[8:11], s83 offen offset:3072 sc1
    v_mfma_f32_16x16x32_bf16 v[108:111], v[84:87], v[32:35], v[108:111]
    ds_read_b128 v[80:83], v5 offset:16384
    s_waitcnt vmcnt(4)
    v_mfma_f32_16x16x32_bf16 v[112:115], v[96:99], v[32:35], v[112:115]
    ds_read_b128 v[84:87], v5 offset:17408
    s_waitcnt lgkmcnt(5)
    v_mfma_f32_16x16x32_bf16 v[116:119], v[72:75], v[32:35], v[116:119]
    ds_read_b128 v[96:99], v5 offset:18432
    v_bitop3_b32 v4, v43, v47, v51 bitop3:0x80
    v_mfma_f32_16x16x32_bf16 v[104:107], v[76:79], v[36:39], v[104:107]
    ds_read_b128 v[72:75], v5 offset:19456
    s_waitcnt lgkmcnt(5)
    v_mfma_f32_16x16x32_bf16 v[108:111], v[88:91], v[36:39], v[108:111]
    ds_read_b128 v[76:79], v5 offset:20480
    v_bitop3_b32 v4, v4, v55, 1 bitop3:0x80
    v_mfma_f32_16x16x32_bf16 v[112:115], v[92:95], v[36:39], v[112:115]
    ds_read_b128 v[88:91], v5 offset:21504
    s_waitcnt lgkmcnt(5)
    v_mfma_f32_16x16x32_bf16 v[116:119], v[100:103], v[36:39], v[116:119]
    ds_read_b128 v[92:95], v5 offset:22528
    v_cmp_ne_u32 vcc, 1, v4
    s_nop 0
    s_cbranch_vccnz L_retry_133
L_back_134:
    v_mfma_f32_16x16x32_bf16 v[104:107], v[80:83], v[40:43], v[104:107]
    ds_read_b128 v[100:103], v5 offset:23552
    s_waitcnt lgkmcnt(5)
    v_mfma_f32_16x16x32_bf16 v[108:111], v[84:87], v[40:43], v[108:111]
    ds_read_b128 v[80:83], v5 offset:24576
    s_add_u32 s84, s66, 77824
    v_mfma_f32_16x16x32_bf16 v[112:115], v[96:99], v[40:43], v[112:115]
    ds_read_b128 v[84:87], v5 offset:25600
    s_waitcnt lgkmcnt(5)
    buffer_load_dwordx4 v[24:27], v6, s[8:11], s84 offen offset:0 sc1
    v_mfma_f32_16x16x32_bf16 v[116:119], v[72:75], v[40:43], v[116:119]
    ds_read_b128 v[96:99], v5 offset:26624
    v_mfma_f32_16x16x32_bf16 v[104:107], v[76:79], v[44:47], v[104:107]
    ds_read_b128 v[72:75], v5 offset:27648
    s_waitcnt lgkmcnt(5)
    buffer_load_dwordx4 v[28:31], v6, s[8:11], s84 offen offset:1024 sc1
    v_mfma_f32_16x16x32_bf16 v[108:111], v[88:91], v[44:47], v[108:111]
    ds_read_b128 v[76:79], v5 offset:28672
    v_mfma_f32_16x16x32_bf16 v[112:115], v[92:95], v[44:47], v[112:115]
    ds_read_b128 v[88:91], v5 offset:29696
    s_waitcnt lgkmcnt(5)
    buffer_load_dwordx4 v[32:35], v6, s[8:11], s84 offen offset:2048 sc1
    v_mfma_f32_16x16x32_bf16 v[116:119], v[100:103], v[44:47], v[116:119]
    ds_read_b128 v[92:95], v5 offset:30720
    v_mfma_f32_16x16x32_bf16 v[104:107], v[80:83], v[48:51], v[104:107]
    ds_read_b128 v[100:103], v5 offset:31744
    s_waitcnt lgkmcnt(5)
    buffer_load_dwordx4 v[36:39], v6, s[8:11], s84 offen offset:3072 sc1
    v_mfma_f32_16x16x32_bf16 v[108:111], v[84:87], v[48:51], v[108:111]
    ds_read_b128 v[80:83], v5 offset:32768
    v_mfma_f32_16x16x32_bf16 v[112:115], v[96:99], v[48:51], v[112:115]
    ds_read_b128 v[84:87], v5 offset:33792
    s_waitcnt lgkmcnt(5)
    v_mfma_f32_16x16x32_bf16 v[116:119], v[72:75], v[48:51], v[116:119]
    ds_read_b128 v[96:99], v5 offset:34816
    v_mfma_f32_16x16x32_bf16 v[104:107], v[76:79], v[52:55], v[104:107]
    ds_read_b128 v[72:75], v5 offset:35840
    s_waitcnt lgkmcnt(5)
    v_mfma_f32_16x16x32_bf16 v[108:111], v[88:91], v[52:55], v[108:111]
    ds_read_b128 v[76:79], v5 offset:36864
    s_waitcnt vmcnt(4)
    v_mfma_f32_16x16x32_bf16 v[112:115], v[92:95], v[52:55], v[112:115]
    ds_read_b128 v[88:91], v5 offset:37888
    s_waitcnt lgkmcnt(5)
    v_mfma_f32_16x16x32_bf16 v[116:119], v[100:103], v[52:55], v[116:119]
    ds_read_b128 v[92:95], v5 offset:38912
    v_bitop3_b32 v4, v59, v63, v67 bitop3:0x80
    v_bitop3_b32 v4, v4, v71, 1 bitop3:0x80
    v_cmp_ne_u32 vcc, 1, v4
    s_nop 0
    s_cbranch_vccnz L_retry_135
L_back_136:
    v_mfma_f32_16x16x32_bf16 v[104:107], v[80:83], v[56:59], v[104:107]
    ds_read_b128 v[100:103], v5 offset:39936
    s_waitcnt lgkmcnt(5)
    v_mfma_f32_16x16x32_bf16 v[108:111], v[84:87], v[56:59], v[108:111]
    ds_read_b128 v[80:83], v5 offset:40960
    v_mfma_f32_16x16x32_bf16 v[112:115], v[96:99], v[56:59], v[112:115]
    ds_read_b128 v[84:87], v5 offset:41984
    s_waitcnt lgkmcnt(5)
    v_mfma_f32_16x16x32_bf16 v[116:119], v[72:75], v[56:59], v[116:119]
    ds_read_b128 v[96:99], v5 offset:43008
    v_mfma_f32_16x16x32_bf16 v[104:107], v[76:79], v[60:63], v[104:107]
    ds_read_b128 v[72:75], v5 offset:44032
    s_waitcnt lgkmcnt(5)
    v_mfma_f32_16x16x32_bf16 v[108:111], v[88:91], v[60:63], v[108:111]
    ds_read_b128 v[76:79], v5 offset:45056
    v_mfma_f32_16x16x32_bf16 v[112:115], v[92:95], v[60:63], v[112:115]
    ds_read_b128 v[88:91], v5 offset:46080
    s_waitcnt lgkmcnt(5)
    v_mfma_f32_16x16x32_bf16 v[116:119], v[100:103], v[60:63], v[116:119]
    ds_read_b128 v[92:95], v5 offset:47104
    v_mfma_f32_16x16x32_bf16 v[104:107], v[80:83], v[64:67], v[104:107]
    ds_read_b128 v[100:103], v5 offset:48128
    s_waitcnt lgkmcnt(5)
    v_mfma_f32_16x16x32_bf16 v[108:111], v[84:87], v[64:67], v[108:111]
    ds_read_b128 v[80:83], v5 offset:49152
    v_mfma_f32_16x16x32_bf16 v[112:115], v[96:99], v[64:67], v[112:115]
    ds_read_b128 v[84:87], v5 offset:50176
    s_waitcnt lgkmcnt(5)
    v_mfma_f32_16x16x32_bf16 v[116:119], v[72:75], v[64:67], v[116:119]
    ds_read_b128 v[96:99], v5 offset:51200
    v_mfma_f32_16x16x32_bf16 v[104:107], v[76:79], v[68:71], v[104:107]
    ds_read_b128 v[72:75], v5 offset:52224
    s_waitcnt lgkmcnt(5)
    v_mfma_f32_16x16x32_bf16 v[108:111], v[88:91], v[68:71], v[108:111]
    ds_read_b128 v[76:79], v5 offset:53248
    s_waitcnt vmcnt(0)
    v_mfma_f32_16x16x32_bf16 v[112:115], v[92:95], v[68:71], v[112:115]
    ds_read_b128 v[88:91], v5 offset:54272
    s_waitcnt lgkmcnt(5)
    v_mfma_f32_16x16x32_bf16 v[116:119], v[100:103], v[68:71], v[116:119]
    ds_read_b128 v[92:95], v5 offset:55296
    v_bitop3_b32 v4, v27, v31, v35 bitop3:0x80
    v_bitop3_b32 v4, v4, v39, 1 bitop3:0x80
    v_cmp_ne_u32 vcc, 1, v4
    s_nop 0
    s_cbranch_vccnz L_retry_137
L_back_138:
    v_mfma_f32_16x16x32_bf16 v[104:107], v[80:83], v[24:27], v[104:107]
    ds_read_b128 v[100:103], v5 offset:56320
    s_waitcnt lgkmcnt(5)
    v_mfma_f32_16x16x32_bf16 v[108:111], v[84:87], v[24:27], v[108:111]
    ds_read_b128 v[80:83], v5 offset:57344
    v_mfma_f32_16x16x32_bf16 v[112:115], v[96:99], v[24:27], v[112:115]
    ds_read_b128 v[84:87], v5 offset:58368
    s_waitcnt lgkmcnt(5)
    v_mfma_f32_16x16x32_bf16 v[116:119], v[72:75], v[24:27], v[116:119]
    ds_read_b128 v[96:99], v5 offset:61440
    s_add_u32 s73, s60, 49152
    v_mfma_f32_16x16x32_bf16 v[104:107], v[76:79], v[28:31], v[104:107]
    ds_read_b128 v[72:75], v5 offset:62464
    s_waitcnt lgkmcnt(5)
    buffer_load_dwordx4 v[40:43], v7, s[8:11], s73 offen offset:0 sc1
    v_mfma_f32_16x16x32_bf16 v[108:111], v[88:91], v[28:31], v[108:111]
    ds_read_b128 v[76:79], v5 offset:59392
    v_mfma_f32_16x16x32_bf16 v[112:115], v[92:95], v[28:31], v[112:115]
    ds_read_b128 v[88:91], v5 offset:60416
    s_waitcnt lgkmcnt(5)
    buffer_load_dwordx4 v[44:47], v7, s[8:11], s73 offen offset:1024 sc1
    v_mfma_f32_16x16x32_bf16 v[116:119], v[100:103], v[28:31], v[116:119]
    ds_read_b128 v[92:95], v5 offset:63488
    v_mfma_f32_16x16x32_bf16 v[104:107], v[80:83], v[32:35], v[104:107]
    ds_read_b128 v[100:103], v5 offset:64512
    s_waitcnt lgkmcnt(5)
    buffer_load_dwordx4 v[48:51], v7, s[8:11], s73 offen offset:2048 sc1
    v_mfma_f32_16x16x32_bf16 v[108:111], v[84:87], v[32:35], v[108:111]
    v_mfma_f32_16x16x32_bf16 v[104:107], v[96:99], v[36:39], v[104:107]
    s_waitcnt lgkmcnt(3)
    buffer_load_dwordx4 v[52:55], v7, s[8:11], s73 offen offset:3072 sc1
    v_mfma_f32_16x16x32_bf16 v[108:111], v[72:75], v[36:39], v[108:111]
    v_mfma_f32_16x16x32_bf16 v[112:115], v[76:79], v[32:35], v[112:115]
    s_waitcnt lgkmcnt(1)
    v_mfma_f32_16x16x32_bf16 v[116:119], v[88:91], v[32:35], v[116:119]
    v_mfma_f32_16x16x32_bf16 v[112:115], v[92:95], v[36:39], v[112:115]
    s_waitcnt lgkmcnt(0)
    v_mfma_f32_16x16x32_bf16 v[116:119], v[100:103], v[36:39], v[116:119]
    s_add_u32 s88, s63, 0
    s_nop 0
    v_cvt_pk_bf16_f32 v103, v110, v111
    v_cvt_pk_bf16_f32 v100, v104, v105
    v_cvt_pk_bf16_f32 v101, v106, v107
    v_cvt_pk_bf16_f32 v102, v108, v109
    buffer_store_dwordx4 v[100:103], v6, s[8:11], s88 offen offset:0 sc1
    s_nop 0
    v_cvt_pk_bf16_f32 v127, v118, v119
    v_cvt_pk_bf16_f32 v124, v112, v113
    v_cvt_pk_bf16_f32 v125, v114, v115
    v_cvt_pk_bf16_f32 v126, v116, v117
    buffer_store_dwordx4 v[124:127], v6, s[8:11], s88 offen offset:1024 sc1
    v_mov_b32 v96, 0x3f803f80
    v_mov_b32 v97, 0x3f803f80
    v_mov_b32 v98, 0x3f803f80
    v_mov_b32 v99, 0x3f803f80
    v_mfma_f32_16x16x32_bf16 v[108:111], v[100:103], v[100:103], 0
    v_mfma_f32_16x16x32_bf16 v[108:111], v[124:127], v[124:127], v[108:111]
    v_mfma_f32_16x16x32_bf16 v[104:107], v[96:99], v[100:103], 0
    v_mfma_f32_16x16x32_bf16 v[104:107], v[96:99], v[124:127], v[104:107]
    s_waitcnt vmcnt(4)
    v_bitop3_b32 v4, v43, v47, 1 bitop3:0x80
    v_cmp_ne_u32 vcc, 1, v4
    s_nop 0
    s_cbranch_vccnz L_retry_139
L_back_140:
    ds_write_b128 v7, v[40:43] offset:16384
    ds_write_b128 v7, v[44:47] offset:17408
    s_waitcnt vmcnt(2)
    v_bitop3_b32 v4, v51, v55, 1 bitop3:0x80
    v_cmp_ne_u32 vcc, 1, v4
    s_nop 0
    s_cbranch_vccnz L_retry_141
L_back_142:
    ds_write_b128 v7, v[48:51] offset:18432
    ds_write_b128 v7, v[52:55] offset:19456
    s_add_u32 s89, s60, 294912
    v_cndmask_b32 v108, v108, v109, s[44:45]
    v_cndmask_b32 v108, v108, v110, s[46:47]
    v_cndmask_b32 v108, v108, v111, s[48:49]
    v_or_b32 v105, 1, v108
    s_waitcnt vmcnt(0)
    buffer_store_dwordx2 v[104:105], v10, s[8:11], s89 offen sc1
    s_waitcnt lgkmcnt(0)
    s_branch L_join_130
L_retry_143:
    s_add_u32 s94, s66, 65536
    buffer_load_dwordx4 v[24:27], v6, s[8:11], s94 offen offset:0 sc1
    buffer_load_dwordx4 v[28:31], v6, s[8:11], s94 offen offset:1024 sc1
    buffer_load_dwordx4 v[32:35], v6, s[8:11], s94 offen offset:2048 sc1
    buffer_load_dwordx4 v[36:39], v6, s[8:11], s94 offen offset:3072 sc1
    s_sub_u32 s41, s41, 1
    s_cbranch_scc1 L_end
    s_waitcnt vmcnt(0)
    v_bitop3_b32 v4, v27, v31, v35 bitop3:0x80
    v_bitop3_b32 v4, v4, v39, 1 bitop3:0x80
    v_cmp_ne_u32 vcc, 1, v4
    s_nop 0
    s_cbranch_vccnz L_retry_143
    s_branch L_back_144
L_retry_145:
    s_add_u32 s97, s66, 69632
    buffer_load_dwordx4 v[40:43], v6, s[8:11], s97 offen offset:0 sc1
    buffer_load_dwordx4 v[44:47], v6, s[8:11], s97 offen offset:1024 sc1
    buffer_load_dwordx4 v[48:51], v6, s[8:11], s97 offen offset:2048 sc1
    buffer_load_dwordx4 v[52:55], v6, s[8:11], s97 offen offset:3072 sc1
    s_sub_u32 s41, s41, 1
    s_cbranch_scc1 L_end
    s_waitcnt vmcnt(0)
    v_bitop3_b32 v4, v43, v47, v51 bitop3:0x80
    v_bitop3_b32 v4, v4, v55, 1 bitop3:0x80
    v_cmp_ne_u32 vcc, 1, v4
    s_nop 0
    s_cbranch_vccnz L_retry_145
    s_branch L_back_146
L_retry_147:
    s_add_u32 s98, s66, 73728
    buffer_load_dwordx4 v[56:59], v6, s[8:11], s98 offen offset:0 sc1
    buffer_load_dwordx4 v[60:63], v6, s[8:11], s98 offen offset:1024 sc1
    buffer_load_dwordx4 v[64:67], v6, s[8:11], s98 offen offset:2048 sc1
    buffer_load_dwordx4 v[68:71], v6, s[8:11], s98 offen offset:3072 sc1
    s_sub_u32 s41, s41, 1
    s_cbranch_scc1 L_end
    s_waitcnt vmcnt(0)
    v_bitop3_b32 v4, v59, v63, v67 bitop3:0x80
    v_bitop3_b32 v4, v4, v71, 1 bitop3:0x80
    v_cmp_ne_u32 vcc, 1, v4
    s_nop 0
    s_cbranch_vccnz L_retry_147
    s_branch L_back_148
L_retry_149:
    s_add_u32 s99, s66, 77824
    buffer_load_dwordx4 v[24:27], v6, s[8:11], s99 offen offset:0 sc1
    buffer_load_dwordx4 v[28:31], v6, s[8:11], s99 offen offset:1024 sc1
    buffer_load_dwordx4 v[32:35], v6, s[8:11], s99 offen offset:2048 sc1
    buffer_load_dwordx4 v[36:39], v6, s[8:11], s99 offen offset:3072 sc1
    s_sub_u32 s41, s41, 1
    s_cbranch_scc1 L_end
    s_waitcnt vmcnt(0)
    v_bitop3_b32 v4, v27, v31, v35 bitop3:0x80
    v_bitop3_b32 v4, v4, v39, 1 bitop3:0x80
    v_cmp_ne_u32 vcc, 1, v4
    s_nop 0
    s_cbranch_vccnz L_retry_149
    s_branch L_back_150
L_retry_151:
    s_add_u32 s73, s60, 49152
    buffer_load_dwordx4 v[40:43], v7, s[8:11], s73 offen offset:0 sc1
    buffer_load_dwordx4 v[44:47], v7, s[8:11], s73 offen offset:1024 sc1
    buffer_load_dwordx4 v[48:51], v7, s[8:11], s73 offen offset:2048 sc1
    buffer_load_dwordx4 v[52:55], v7, s[8:11], s73 offen offset:3072 sc1
    s_sub_u32 s41, s41, 1
    s_cbranch_scc1 L_end
    s_waitcnt vmcnt(0)
    v_bitop3_b32 v4, v43, v47, 1 bitop3:0x80
    v_cmp_ne_u32 vcc, 1, v4
    s_nop 0
    s_cbranch_vccnz L_retry_151
    s_branch L_back_152
L_retry_153:
    buffer_load_dwordx4 v[48:51], v7, s[8:11], s73 offen offset:2048 sc1
    buffer_load_dwordx4 v[52:55], v7, s[8:11], s73 offen offset:3072 sc1
    s_sub_u32 s41, s41, 1
    s_cbranch_scc1 L_end
    s_waitcnt vmcnt(0)
    v_bitop3_b32 v4, v51, v55, 1 bitop3:0x80
    v_cmp_ne_u32 vcc, 1, v4
    s_nop 0
    s_cbranch_vccnz L_retry_153
    s_branch L_back_154
L_retry_155:
    s_add_u32 s73, s60, 32768
    buffer_load_dwordx4 v[24:27], v7, s[8:11], s73 offen offset:0 sc1
    buffer_load_dwordx4 v[28:31], v7, s[8:11], s73 offen offset:1024 sc1
    buffer_load_dwordx4 v[32:35], v7, s[8:11], s73 offen offset:2048 sc1
    buffer_load_dwordx4 v[36:39], v7, s[8:11], s73 offen offset:3072 sc1
    s_sub_u32 s41, s41, 1
    s_cbranch_scc1 L_end
    s_waitcnt vmcnt(0)
    v_bitop3_b32 v4, v27, v31, v35 bitop3:0x80
    v_bitop3_b32 v4, v4, v39, 1 bitop3:0x80
    v_cmp_ne_u32 vcc, 1, v4
    s_nop 0
    s_cbranch_vccnz L_retry_155
    s_branch L_back_156
L_retry_157:
    s_add_u32 s74, s60, 294912
    s_add_u32 s74, s74, s4
    buffer_load_dwordx4 v[80:83], v6, s[8:11], s74 offen sc1
    s_sub_u32 s41, s41, 1
    s_cbranch_scc1 L_end
    s_waitcnt vmcnt(0)
    v_bitop3_b32 v5, v81, v83, 1 bitop3:0x80
    v_cmp_ne_u32 vcc, 1, v5
    s_nop 0
    s_cbranch_vccnz L_retry_157
    s_branch L_back_158
L_retry_159:
    s_add_u32 s75, s61, 65536
    buffer_load_dwordx4 v[88:91], v6, s[8:11], s75 offen sc1
    s_sub_u32 s41, s41, 1
    s_cbranch_scc1 L_end
    s_waitcnt vmcnt(0)
    v_cmp_eq_u32 vcc, -1, v91
    s_nop 0
    s_cbranch_vccnz L_retry_159
    s_branch L_back_160
L_retry_163:
    s_add_u32 s88, s66, 65536
    buffer_load_dwordx4 v[24:27], v6, s[8:11], s88 offen offset:0 sc1
    buffer_load_dwordx4 v[28:31], v6, s[8:11], s88 offen offset:1024 sc1
    buffer_load_dwordx4 v[32:35], v6, s[8:11], s88 offen offset:2048 sc1
    buffer_load_dwordx4 v[36:39], v6, s[8:11], s88 offen offset:3072 sc1
    s_sub_u32 s41, s41, 1
    s_cbranch_scc1 L_end
    s_waitcnt vmcnt(0)
    v_bitop3_b32 v4, v27, v31, v35 bitop3:0xfe
    v_bitop3_b32 v4, v4, v39, 1 bitop3:0xa8
    v_cmp_ne_u32 vcc, 0, v4
    s_nop 0
    s_cbranch_vccnz L_retry_163
    s_branch L_back_164
L_retry_165:
    s_add_u32 s95, s66, 69632
    buffer_load_dwordx4 v[40:43], v6, s[8:11], s95 offen offset:0 sc1
    buffer_load_dwordx4 v[44:47], v6, s[8:11], s95 offen offset:1024 sc1
    buffer_load_dwordx4 v[48:51], v6, s[8:11], s95 offen offset:2048 sc1
    buffer_load_dwordx4 v[52:55], v6, s[8:11], s95 offen offset:3072 sc1
    s_sub_u32 s41, s41, 1
    s_cbranch_scc1 L_end
    s_waitcnt vmcnt(0)
    v_bitop3_b32 v4, v43, v47, v51 bitop3:0xfe
    v_bitop3_b32 v4, v4, v55, 1 bitop3:0xa8
    v_cmp_ne_u32 vcc, 0, v4
    s_nop 0
    s_cbranch_vccnz L_retry_165
    s_branch L_back_166
L_retry_167:
    s_add_u32 s96, s66, 73728
    buffer_load_dwordx4 v[56:59], v6, s[8:11], s96 offen offset:0 sc1
    buffer_load_dwordx4 v[60:63], v6, s[8:11], s96 offen offset:1024 sc1
    buffer_load_dwordx4 v[64:67], v6, s[8:11], s96 offen offset:2048 sc1
    buffer_load_dwordx4 v[68:71], v6, s[8:11], s96 offen offset:3072 sc1
    s_sub_u32 s41, s41, 1
    s_cbranch_scc1 L_end
    s_waitcnt vmcnt(0)
    v_bitop3_b32 v4, v59, v63, v67 bitop3:0xfe
    v_bitop3_b32 v4, v4, v71, 1 bitop3:0xa8
    v_cmp_ne_u32 vcc, 0, v4
    s_nop 0
    s_cbranch_vccnz L_retry_167
    s_branch L_back_168
L_retry_169:
    s_add_u32 s97, s66, 77824
    buffer_load_dwordx4 v[24:27], v6, s[8:11], s97 offen offset:0 sc1
    buffer_load_dwordx4 v[28:31], v6, s[8:11], s97 offen offset:1024 sc1
    buffer_load_dwordx4 v[32:35], v6, s[8:11], s97 offen offset:2048 sc1
    buffer_load_dwordx4 v[36:39], v6, s[8:11], s97 offen offset:3072 sc1
    s_sub_u32 s41, s41, 1
    s_cbranch_scc1 L_end
    s_waitcnt vmcnt(0)
    v_bitop3_b32 v4, v27, v31, v35 bitop3:0xfe
    v_bitop3_b32 v4, v4, v39, 1 bitop3:0xa8
    v_cmp_ne_u32 vcc, 0, v4
    s_nop 0
    s_cbranch_vccnz L_retry_169
    s_branch L_back_170
L_retry_171:
    s_add_u32 s73, s60, 49152
    buffer_load_dwordx4 v[40:43], v7, s[8:11], s73 offen offset:0 sc1
    buffer_load_dwordx4 v[44:47], v7, s[8:11], s73 offen offset:1024 sc1
    buffer_load_dwordx4 v[48:51], v7, s[8:11], s73 offen offset:2048 sc1
    buffer_load_dwordx4 v[52:55], v7, s[8:11], s73 offen offset:3072 sc1
    s_sub_u32 s41, s41, 1
    s_cbranch_scc1 L_end
    s_waitcnt vmcnt(0)
    v_bitop3_b32 v4, v43, v47, 1 bitop3:0xa8
    v_cmp_ne_u32 vcc, 0, v4
    s_nop 0
    s_cbranch_vccnz L_retry_171
    s_branch L_back_172
L_retry_173:
    buffer_load_dwordx4 v[48:51], v7, s[8:11], s73 offen offset:2048 sc1
    buffer_load_dwordx4 v[52:55], v7, s[8:11], s73 offen offset:3072 sc1
    s_sub_u32 s41, s41, 1
    s_cbranch_scc1 L_end
    s_waitcnt vmcnt(0)
    v_bitop3_b32 v4, v51, v55, 1 bitop3:0xa8
    v_cmp_ne_u32 vcc, 0, v4
    s_nop 0
    s_cbranch_vccnz L_retry_173
    s_branch L_back_174
L_lo_161:
    ds_read_b128 v[72:75], v5 offset:3072
    ds_read_b128 v[76:79], v5 offset:4096
    ds_read_b128 v[88:91], v5 offset:5120
    ds_read_b128 v[92:95], v5 offset:6144
    s_waitcnt vmcnt(0)
    s_add_u32 s86, s66, 65536
    buffer_load_dwordx4 v[24:27], v6, s[8:11], s86 offen offset:0 sc1
    buffer_load_dwordx4 v[28:31], v6, s[8:11], s86 offen offset:1024 sc1
    buffer_load_dwordx4 v[32:35], v6, s[8:11], s86 offen offset:2048 sc1
    buffer_load_dwordx4 v[36:39], v6, s[8:11], s86 offen offset:3072 sc1
    s_add_u32 s87, s66, 69632
    buffer_load_dwordx4 v[40:43], v6, s[8:11], s87 offen offset:0 sc1
    buffer_load_dwordx4 v[44:47], v6, s[8:11], s87 offen offset:1024 sc1
    buffer_load_dwordx4 v[48:51], v6, s[8:11], s87 offen offset:2048 sc1
    buffer_load_dwordx4 v[52:55], v6, s[8:11], s87 offen offset:3072 sc1
    s_waitcnt vmcnt(4)
    v_bitop3_b32 v4, v27, v31, v35 bitop3:0xfe
    v_bitop3_b32 v4, v4, v39, 1 bitop3:0xa8
    v_cmp_ne_u32 vcc, 0, v4
    s_nop 0
    s_cbranch_vccnz L_retry_163
L_back_164:
    s_waitcnt lgkmcnt(6)
    v_mfma_f32_16x16x32_bf16 v[104:107], v[80:83], v[24:27], v[104:107]
    ds_read_b128 v[100:103], v5 offset:7168
    s_waitcnt lgkmcnt(5)
    v_mfma_f32_16x16x32_bf16 v[108:111], v[84:87], v[24:27], v[108:111]
    ds_read_b128 v[80:83], v5 offset:8192
    s_add_u32 s89, s66, 73728
    v_mfma_f32_16x16x32_bf16 v[112:115], v[96:99], v[24:27], v[112:115]
    ds_read_b128 v[84:87], v5 offset:9216
    s_waitcnt lgkmcnt(5)
    buffer_load_dwordx4 v[56:59], v6, s[8:11], s89 offen offset:0 sc1
    v_mfma_f32_16x16x32_bf16 v[116:119], v[72:75], v[24:27], v[116:119]
    ds_read_b128 v[96:99], v5 offset:10240
    v_mfma_f32_16x16x32_bf16 v[104:107], v[76:79], v[28:31], v[104:107]
    ds_read_b128 v[72:75], v5 offset:11264
    s_waitcnt lgkmcnt(5)
    buffer_load_dwordx4 v[60:63], v6, s[8:11], s89 offen offset:1024 sc1
    v_mfma_f32_16x16x32_bf16 v[108:111], v[88:91], v[28:31], v[108:111]
    ds_read_b128 v[76:79], v5 offset:12288
    v_mfma_f32_16x16x32_bf16 v[112:115], v[92:95], v[28:31], v[112:115]
    ds_read_b128 v[88:91], v5 offset:13312
    s_waitcnt lgkmcnt(5)
    buffer_load_dwordx4 v[64:67], v6, s[8:11], s89 offen offset:2048 sc1
    v_mfma_f32_16x16x32_bf16 v[116:119], v[100:103], v[28:31], v[116:119]
    ds_read_b128 v[92:95], v5 offset:14336
    v_mfma_f32_16x16x32_bf16 v[104:107], v[80:83], v[32:35], v[104:107]
    ds_read_b128 v[100:103], v5 offset:15360
    s_waitcnt lgkmcnt(5)
    buffer_load_dwordx4 v[68:71], v6, s[8:11], s89 offen offset:3072 sc1
    v_mfma_f32_16x16x32_bf16 v[108:111], v[84:87], v[32:35], v[108:111]
    ds_read_b128 v[80:83], v5 offset:16384
    s_waitcnt vmcnt(4)
    v_mfma_f32_16x16x32_bf16 v[112:115], v[96:99], v[32:35], v[112:115]
    ds_read_b128 v[84:87], v5 offset:17408
    s_waitcnt lgkmcnt(5)
    v_mfma_f32_16x16x32_bf16 v[116:119], v[72:75], v[32:35], v[116:119]
    ds_read_b128 v[96:99], v5 offset:18432
    v_bitop3_b32 v4, v43, v47, v51 bitop3:0xfe
    v_mfma_f32_16x16x32_bf16 v[104:107], v[76:79], v[36:39], v[104:107]
    ds_read_b128 v[72:75], v5 offset:19456
    s_waitcnt lgkmcnt(5)
    v_mfma_f32_16x16x32_bf16 v[108:111], v[88:91], v[36:39], v[108:111]
    ds_read_b128 v[76:79], v5 offset:20480
    v_bitop3_b32 v4, v4, v55, 1 bitop3:0xa8
    v_mfma_f32_16x16x32_bf16 v[112:115], v[92:95], v[36:39], v[112:115]
    ds_read_b128 v[88:91], v5 offset:21504
    s_waitcnt lgkmcnt(5)
    v_mfma_f32_16x16x32_bf16 v[116:119], v[100:103], v[36:39], v[116:119]
    ds_read_b128 v[92:95], v5 offset:22528
    v_cmp_ne_u32 vcc, 0, v4
    s_nop 0
    s_cbranch_vccnz L_retry_165
L_back_166:
    v_mfma_f32_16x16x32_bf16 v[104:107], v[80:83], v[40:43], v[104:107]
    ds_read_b128 v[100:103], v5 offset:23552
    s_waitcnt lgkmcnt(5)
    v_mfma_f32_16x16x32_bf16 v[108:111], v[84:87], v[40:43], v[108:111]
    ds_read_b128 v[80:83], v5 offset:24576
    s_add_u32 s94, s66, 77824
    v_mfma_f32_16x16x32_bf16 v[112:115], v[96:99], v[40:43], v[112:115]
    ds_read_b128 v[84:87], v5 offset:25600
    s_waitcnt lgkmcnt(5)
    buffer_load_dwordx4 v[24:27], v6, s[8:11], s94 offen offset:0 sc1
    v_mfma_f32_16x16x32_bf16 v[116:119], v[72:75], v[40:43], v[116:119]
    ds_read_b128 v[96:99], v5 offset:26624
    v_mfma_f32_16x16x32_bf16 v[104:107], v[76:79], v[44:47], v[104:107]
    ds_read_b128 v[72:75], v5 offset:27648
    s_waitcnt lgkmcnt(5)
    buffer_load_dwordx4 v[28:31], v6, s[8:11], s94 offen offset:1024 sc1
    v_mfma_f32_16x16x32_bf16 v[108:111], v[88:91], v[44:47], v[108:111]
    ds_read_b128 v[76:79], v5 offset:28672
    v_mfma_f32_16x16x32_bf16 v[112:115], v[92:95], v[44:47], v[112:115]
    ds_read_b128 v[88:91], v5 offset:29696
    s_waitcnt lgkmcnt(5)
    buffer_load_dwordx4 v[32:35], v6, s[8:11], s94 offen offset:2048 sc1
    v_mfma_f32_16x16x32_bf16 v[116:119], v[100:103], v[44:47], v[116:119]
    ds_read_b128 v[92:95], v5 offset:30720
    v_mfma_f32_16x16x32_bf16 v[104:107], v[80:83], v[48:51], v[104:107]
    ds_read_b128 v[100:103], v5 offset:31744
    s_waitcnt lgkmcnt(5)
    buffer_load_dwordx4 v[36:39], v6, s[8:11], s94 offen offset:3072 sc1
    v_mfma_f32_16x16x32_bf16 v[108:111], v[84:87], v[48:51], v[108:111]
    ds_read_b128 v[80:83], v5 offset:32768
    v_mfma_f32_16x16x32_bf16 v[112:115], v[96:99], v[48:51], v[112:115]
    ds_read_b128 v[84:87], v5 offset:33792
    s_waitcnt lgkmcnt(5)
    v_mfma_f32_16x16x32_bf16 v[116:119], v[72:75], v[48:51], v[116:119]
    ds_read_b128 v[96:99], v5 offset:34816
    v_mfma_f32_16x16x32_bf16 v[104:107], v[76:79], v[52:55], v[104:107]
    ds_read_b128 v[72:75], v5 offset:35840
    s_waitcnt lgkmcnt(5)
    v_mfma_f32_16x16x32_bf16 v[108:111], v[88:91], v[52:55], v[108:111]
    ds_read_b128 v[76:79], v5 offset:36864
    s_waitcnt vmcnt(4)
    v_mfma_f32_16x16x32_bf16 v[112:115], v[92:95], v[52:55], v[112:115]
    ds_read_b128 v[88:91], v5 offset:37888
    s_waitcnt lgkmcnt(5)
    v_mfma_f32_16x16x32_bf16 v[116:119], v[100:103], v[52:55], v[116:119]
    ds_read_b128 v[92:95], v5 offset:38912
    v_bitop3_b32 v4, v59, v63, v67 bitop3:0xfe
    v_bitop3_b32 v4, v4, v71, 1 bitop3:0xa8
    v_cmp_ne_u32 vcc, 0, v4
    s_nop 0
    s_cbranch_vccnz L_retry_167
L_back_168:
    v_mfma_f32_16x16x32_bf16 v[104:107], v[80:83], v[56:59], v[104:107]
    ds_read_b128 v[100:103], v5 offset:39936
    s_waitcnt lgkmcnt(5)
    v_mfma_f32_16x16x32_bf16 v[108:111], v[84:87], v[56:59], v[108:111]
    ds_read_b128 v[80:83], v5 offset:40960
    v_mfma_f32_16x16x32_bf16 v[112:115], v[96:99], v[56:59], v[112:115]
    ds_read_b128 v[84:87], v5 offset:41984
    s_waitcnt lgkmcnt(5)
    v_mfma_f32_16x16x32_bf16 v[116:119], v[72:75], v[56:59], v[116:119]
    ds_read_b128 v[96:99], v5 offset:43008
    v_mfma_f32_16x16x32_bf16 v[104:107], v[76:79], v[60:63], v[104:107]
    ds_read_b128 v[72:75], v5 offset:44032
    s_waitcnt lgkmcnt(5)
    v_mfma_f32_16x16x32_bf16 v[108:111], v[88:91], v[60:63], v[108:111]
    ds_read_b128 v[76:79], v5 offset:45056
    v_mfma_f32_16x16x32_bf16 v[112:115], v[92:95], v[60:63], v[112:115]
    ds_read_b128 v[88:91], v5 offset:46080
    s_waitcnt lgkmcnt(5)
    v_mfma_f32_16x16x32_bf16 v[116:119], v[100:103], v[60:63], v[116:119]
    ds_read_b128 v[92:95], v5 offset:47104
    v_mfma_f32_16x16x32_bf16 v[104:107], v[80:83], v[64:67], v[104:107]
    ds_read_b128 v[100:103], v5 offset:48128
    s_waitcnt lgkmcnt(5)
    v_mfma_f32_16x16x32_bf16 v[108:111], v[84:87], v[64:67], v[108:111]
    ds_read_b128 v[80:83], v5 offset:49152
    v_mfma_f32_16x16x32_bf16 v[112:115], v[96:99], v[64:67], v[112:115]
    ds_read_b128 v[84:87], v5 offset:50176
    s_waitcnt lgkmcnt(5)
    v_mfma_f32_16x16x32_bf16 v[116:119], v[72:75], v[64:67], v[116:119]
    ds_read_b128 v[96:99], v5 offset:51200
    v_mfma_f32_16x16x32_bf16 v[104:107], v[76:79], v[68:71], v[104:107]
    ds_read_b128 v[72:75], v5 offset:52224
    s_waitcnt lgkmcnt(5)
    v_mfma_f32_16x16x32_bf16 v[108:111], v[88:91], v[68:71], v[108:111]
    ds_read_b128 v[76:79], v5 offset:53248
    s_waitcnt vmcnt(0)
    v_mfma_f32_16x16x32_bf16 v[112:115], v[92:95], v[68:71], v[112:115]
    ds_read_b128 v[88:91], v5 offset:54272
    s_waitcnt lgkmcnt(5)
    v_mfma_f32_16x16x32_bf16 v[116:119], v[100:103], v[68:71], v[116:119]
    ds_read_b128 v[92:95], v5 offset:55296
    v_bitop3_b32 v4, v27, v31, v35 bitop3:0xfe
    v_bitop3_b32 v4, v4, v39, 1 bitop3:0xa8
    v_cmp_ne_u32 vcc, 0, v4
    s_nop 0
    s_cbranch_vccnz L_retry_169
L_back_170:
    v_mfma_f32_16x16x32_bf16 v[104:107], v[80:83], v[24:27], v[104:107]
    ds_read_b128 v[100:103], v5 offset:56320
    s_waitcnt lgkmcnt(5)
    v_mfma_f32_16x16x32_bf16 v[108:111], v[84:87], v[24:27], v[108:111]
    ds_read_b128 v[80:83], v5 offset:57344
    v_mfma_f32_16x16x32_bf16 v[112:115], v[96:99], v[24:27], v[112:115]
    ds_read_b128 v[84:87], v5 offset:58368
    s_waitcnt lgkmcnt(5)
    v_mfma_f32_16x16x32_bf16 v[116:119], v[72:75], v[24:27], v[116:119]
    ds_read_b128 v[96:99], v5 offset:61440
    s_add_u32 s73, s60, 49152
    v_mfma_f32_16x16x32_bf16 v[104:107], v[76:79], v[28:31], v[104:107]
    ds_read_b128 v[72:75], v5 offset:62464
    s_waitcnt lgkmcnt(5)
    buffer_load_dwordx4 v[40:43], v7, s[8:11], s73 offen offset:0 sc1
    v_mfma_f32_16x16x32_bf16 v[108:111], v[88:91], v[28:31], v[108:111]
    ds_read_b128 v[76:79], v5 offset:59392
    v_mfma_f32_16x16x32_bf16 v[112:115], v[92:95], v[28:31], v[112:115]
    ds_read_b128 v[88:91], v5 offset:60416
    s_waitcnt lgkmcnt(5)
    buffer_load_dwordx4 v[44:47], v7, s[8:11], s73 offen offset:1024 sc1
    v_mfma_f32_16x16x32_bf16 v[116:119], v[100:103], v[28:31], v[116:119]
    ds_read_b128 v[92:95], v5 offset:63488
    v_mfma_f32_16x16x32_bf16 v[104:107], v[80:83], v[32:35], v[104:107]
    ds_read_b128 v[100:103], v5 offset:64512
    s_waitcnt lgkmcnt(5)
    buffer_load_dwordx4 v[48:51], v7, s[8:11], s73 offen offset:2048 sc1
    v_mfma_f32_16x16x32_bf16 v[108:111], v[84:87], v[32:35], v[108:111]
    v_mfma_f32_16x16x32_bf16 v[104:107], v[96:99], v[36:39], v[104:107]
    s_waitcnt lgkmcnt(3)
    buffer_load_dwordx4 v[52:55], v7, s[8:11], s73 offen offset:3072 sc1
    v_mfma_f32_16x16x32_bf16 v[108:111], v[72:75], v[36:39], v[108:111]
    v_mfma_f32_16x16x32_bf16 v[112:115], v[76:79], v[32:35], v[112:115]
    s_waitcnt lgkmcnt(1)
    v_mfma_f32_16x16x32_bf16 v[116:119], v[88:91], v[32:35], v[116:119]
    v_mfma_f32_16x16x32_bf16 v[112:115], v[92:95], v[36:39], v[112:115]
    s_waitcnt lgkmcnt(0)
    v_mfma_f32_16x16x32_bf16 v[116:119], v[100:103], v[36:39], v[116:119]
    s_add_u32 s98, s63, 0
    s_nop 0
    v_cvt_pk_bf16_f32 v103, v110, v111
    v_cvt_pk_bf16_f32 v100, v104, v105
    v_cvt_pk_bf16_f32 v101, v106, v107
    v_cvt_pk_bf16_f32 v102, v108, v109
    buffer_store_dwordx4 v[100:103], v6, s[8:11], s98 offen offset:0 sc1
    s_nop 0
    v_cvt_pk_bf16_f32 v127, v118, v119
    v_cvt_pk_bf16_f32 v124, v112, v113
    v_cvt_pk_bf16_f32 v125, v114, v115
    v_cvt_pk_bf16_f32 v126, v116, v117
    buffer_store_dwordx4 v[124:127], v6, s[8:11], s98 offen offset:1024 sc1
    v_mov_b32 v96, 0x3f803f80
    v_mov_b32 v97, 0x3f803f80
    v_mov_b32 v98, 0x3f803f80
    v_mov_b32 v99, 0x3f803f80
    v_mfma_f32_16x16x32_bf16 v[108:111], v[100:103], v[100:103], 0
    v_mfma_f32_16x16x32_bf16 v[108:111], v[124:127], v[124:127], v[108:111]
    v_mfma_f32_16x16x32_bf16 v[104:107], v[96:99], v[100:103], 0
    v_mfma_f32_16x16x32_bf16 v[104:107], v[96:99], v[124:127], v[104:107]
    s_waitcnt vmcnt(4)
    v_bitop3_b32 v4, v43, v47, 1 bitop3:0xa8
    v_cmp_ne_u32 vcc, 0, v4
    s_nop 0
    s_cbranch_vccnz L_retry_171
L_back_172:
    ds_write_b128 v7, v[40:43] offset:16384
    ds_write_b128 v7, v[44:47] offset:17408
    s_waitcnt vmcnt(2)
    v_bitop3_b32 v4, v51, v55, 1 bitop3:0xa8
    v_cmp_ne_u32 vcc, 0, v4
    s_nop 0
    s_cbranch_vccnz L_retry_173
L_back_174:
    ds_write_b128 v7, v[48:51] offset:18432
    ds_write_b128 v7, v[52:55] offset:19456
    s_add_u32 s99, s60, 294912
    v_cndmask_b32 v108, v108, v109, s[44:45]
    v_cndmask_b32 v108, v108, v110, s[46:47]
    v_cndmask_b32 v108, v108, v111, s[48:49]
    v_and_b32 v105, -2, v108
    s_waitcnt vmcnt(0)
    buffer_store_dwordx2 v[104:105], v10, s[8:11], s99 offen sc1
    s_waitcnt lgkmcnt(0)
    s_branch L_join_162
L_retry_175:
    s_add_u32 s100, s66, 65536
    buffer_load_dwordx4 v[24:27], v6, s[8:11], s100 offen offset:0 sc1
    buffer_load_dwordx4 v[28:31], v6, s[8:11], s100 offen offset:1024 sc1
    buffer_load_dwordx4 v[32:35], v6, s[8:11], s100 offen offset:2048 sc1
    buffer_load_dwordx4 v[36:39], v6, s[8:11], s100 offen offset:3072 sc1
    s_sub_u32 s41, s41, 1
    s_cbranch_scc1 L_end
    s_waitcnt vmcnt(0)
    v_bitop3_b32 v4, v27, v31, v35 bitop3:0xfe
    v_bitop3_b32 v4, v4, v39, 1 bitop3:0xa8
    v_cmp_ne_u32 vcc, 0, v4
    s_nop 0
    s_cbranch_vccnz L_retry_175
    s_branch L_back_176
L_retry_177:
    s_add_u32 s79, s66, 69632
    buffer_load_dwordx4 v[40:43], v6, s[8:11], s79 offen offset:0 sc1
    buffer_load_dwordx4 v[44:47], v6, s[8:11], s79 offen offset:1024 sc1
    buffer_load_dwordx4 v[48:51], v6, s[8:11], s79 offen offset:2048 sc1
    buffer_load_dwordx4 v[52:55], v6, s[8:11], s79 offen offset:3072 sc1
    s_sub_u32 s41, s41, 1
    s_cbranch_scc1 L_end
    s_waitcnt vmcnt(0)
    v_bitop3_b32 v4, v43, v47, v51 bitop3:0xfe
    v_bitop3_b32 v4, v4, v55, 1 bitop3:0xa8
    v_cmp_ne_u32 vcc, 0, v4
    s_nop 0
    s_cbranch_vccnz L_retry_177
    s_branch L_back_178
L_retry_179:
    s_add_u32 s80, s66, 73728
    buffer_load_dwordx4 v[56:59], v6, s[8:11], s80 offen offset:0 sc1
    buffer_load_dwordx4 v[60:63], v6, s[8:11], s80 offen offset:1024 sc1
    buffer_load_dwordx4 v[64:67], v6, s[8:11], s80 offen offset:2048 sc1
    buffer_load_dwordx4 v[68:71], v6, s[8:11], s80 offen offset:3072 sc1
    s_sub_u32 s41, s41, 1
    s_cbranch_scc1 L_end
    s_waitcnt vmcnt(0)
    v_bitop3_b32 v4, v59, v63, v67 bitop3:0xfe
    v_bitop3_b32 v4, v4, v71, 1 bitop3:0xa8
    v_cmp_ne_u32 vcc, 0, v4
    s_nop 0
    s_cbranch_vccnz L_retry_179
    s_branch L_back_180
L_retry_181:
    s_add_u32 s81, s66, 77824
    buffer_load_dwordx4 v[24:27], v6, s[8:11], s81 offen offset:0 sc1
    buffer_load_dwordx4 v[28:31], v6, s[8:11], s81 offen offset:1024 sc1
    buffer_load_dwordx4 v[32:35], v6, s[8:11], s81 offen offset:2048 sc1
    buffer_load_dwordx4 v[36:39], v6, s[8:11], s81 offen offset:3072 sc1
    s_sub_u32 s41, s41, 1
    s_cbranch_scc1 L_end
    s_waitcnt vmcnt(0)
    v_bitop3_b32 v4, v27, v31, v35 bitop3:0xfe
    v_bitop3_b32 v4, v4, v39, 1 bitop3:0xa8
    v_cmp_ne_u32 vcc, 0, v4
    s_nop 0
    s_cbranch_vccnz L_retry_181
    s_branch L_back_182
L_retry_183:
    s_add_u32 s73, s60, 49152
    buffer_load_dwordx4 v[40:43], v7, s[8:11], s73 offen offset:0 sc1
    buffer_load_dwordx4 v[44:47], v7, s[8:11], s73 offen offset:1024 sc1
    buffer_load_dwordx4 v[48:51], v7, s[8:11], s73 offen offset:2048 sc1
    buffer_load_dwordx4 v[52:55], v7, s[8:11], s73 offen offset:3072 sc1
    s_sub_u32 s41, s41, 1
    s_cbranch_scc1 L_end
    s_waitcnt vmcnt(0)
    v_bitop3_b32 v4, v43, v47, 1 bitop3:0xa8
    v_cmp_ne_u32 vcc, 0, v4
    s_nop 0
    s_cbranch_vccnz L_retry_183
    s_branch L_back_184
L_retry_185:
    buffer_load_dwordx4 v[48:51], v7, s[8:11], s73 offen offset:2048 sc1
    buffer_load_dwordx4 v[52:55], v7, s[8:11], s73 offen offset:3072 sc1
    s_sub_u32 s41, s41, 1
    s_cbranch_scc1 L_end
    s_waitcnt vmcnt(0)
    v_bitop3_b32 v4, v51, v55, 1 bitop3:0xa8
    v_cmp_ne_u32 vcc, 0, v4
    s_nop 0
    s_cbranch_vccnz L_retry_185
    s_branch L_back_186
L_retry_187:
    s_add_u32 s73, s60, 32768
    buffer_load_dwordx4 v[24:27], v7, s[8:11], s73 offen offset:0 sc1
    buffer_load_dwordx4 v[28:31], v7, s[8:11], s73 offen offset:1024 sc1
    buffer_load_dwordx4 v[32:35], v7, s[8:11], s73 offen offset:2048 sc1
    buffer_load_dwordx4 v[36:39], v7, s[8:11], s73 offen offset:3072 sc1
    s_sub_u32 s41, s41, 1
    s_cbranch_scc1 L_end
    s_waitcnt vmcnt(0)
    v_bitop3_b32 v4, v27, v31, v35 bitop3:0xfe
    v_bitop3_b32 v4, v4, v39, 1 bitop3:0xa8
    v_cmp_ne_u32 vcc, 0, v4
    s_nop 0
    s_cbranch_vccnz L_retry_187
    s_branch L_back_188
L_retry_189:
    s_add_u32 s74, s60, 294912
    s_add_u32 s74, s74, s4
    buffer_load_dwordx4 v[80:83], v6, s[8:11], s74 offen sc1
    s_sub_u32 s41, s41, 1
    s_cbranch_scc1 L_end
    s_waitcnt vmcnt(0)
    v_bitop3_b32 v5, v81, v83, 1 bitop3:0xa8
    v_cmp_ne_u32 vcc, 0, v5
    s_nop 0
    s_cbranch_vccnz L_retry_189
    s_branch L_back_190
L_retry_191:
    s_add_u32 s75, s61, 98304
    buffer_load_dwordx4 v[88:91], v6, s[8:11], s75 offen sc1
    s_sub_u32 s41, s41, 1
    s_cbranch_scc1 L_end
    s_waitcnt vmcnt(0)
    v_cmp_eq_u32 vcc, -1, v91
    s_nop 0
    s_cbranch_vccnz L_retry_191
    s_branch L_back_192
L_retry_195:
    s_add_u32 s97, s66, 65536
    buffer_load_dwordx4 v[24:27], v6, s[8:11], s97 offen offset:0 sc1
    buffer_load_dwordx4 v[28:31], v6, s[8:11], s97 offen offset:1024 sc1
    buffer_load_dwordx4 v[32:35], v6, s[8:11], s97 offen offset:2048 sc1
    buffer_load_dwordx4 v[36:39], v6, s[8:11], s97 offen offset:3072 sc1
    s_sub_u32 s41, s41, 1
    s_cbranch_scc1 L_end
    s_waitcnt vmcnt(0)
    v_bitop3_b32 v4, v27, v31, v35 bitop3:0x80
    v_bitop3_b32 v4, v4, v39, 1 bitop3:0x80
    v_cmp_ne_u32 vcc, 1, v4
    s_nop 0
    s_cbranch_vccnz L_retry_195
    s_branch L_back_196
L_retry_197:
    s_add_u32 s100, s66, 69632
    buffer_load_dwordx4 v[40:43], v6, s[8:11], s100 offen offset:0 sc1
    buffer_load_dwordx4 v[44:47], v6, s[8:11], s100 offen offset:1024 sc1
    buffer_load_dwordx4 v[48:51], v6, s[8:11], s100 offen offset:2048 sc1
    buffer_load_dwordx4 v[52:55], v6, s[8:11], s100 offen offset:3072 sc1
    s_sub_u32 s41, s41, 1
    s_cbranch_scc1 L_end
    s_waitcnt vmcnt(0)
    v_bitop3_b32 v4, v43, v47, v51 bitop3:0x80
    v_bitop3_b32 v4, v4, v55, 1 bitop3:0x80
    v_cmp_ne_u32 vcc, 1, v4
    s_nop 0
    s_cbranch_vccnz L_retry_197
    s_branch L_back_198
L_retry_199:
    s_add_u32 s101, s66, 73728
    buffer_load_dwordx4 v[56:59], v6, s[8:11], s101 offen offset:0 sc1
    buffer_load_dwordx4 v[60:63], v6, s[8:11], s101 offen offset:1024 sc1
    buffer_load_dwordx4 v[64:67], v6, s[8:11], s101 offen offset:2048 sc1
    buffer_load_dwordx4 v[68:71], v6, s[8:11], s101 offen offset:3072 sc1
    s_sub_u32 s41, s41, 1
    s_cbranch_scc1 L_end
    s_waitcnt vmcnt(0)
    v_bitop3_b32 v4, v59, v63, v67 bitop3:0x80
    v_bitop3_b32 v4, v4, v71, 1 bitop3:0x80
    v_cmp_ne_u32 vcc, 1, v4
    s_nop 0
    s_cbranch_vccnz L_retry_199
    s_branch L_back_200
L_retry_201:
    s_add_u32 s78, s66, 77824
    buffer_load_dwordx4 v[24:27], v6, s[8:11], s78 offen offset:0 sc1
    buffer_load_dwordx4 v[28:31], v6, s[8:11], s78 offen offset:1024 sc1
    buffer_load_dwordx4 v[32:35], v6, s[8:11], s78 offen offset:2048 sc1
    buffer_load_dwordx4 v[36:39], v6, s[8:11], s78 offen offset:3072 sc1
    s_sub_u32 s41, s41, 1
    s_cbranch_scc1 L_end
    s_waitcnt vmcnt(0)
    v_bitop3_b32 v4, v27, v31, v35 bitop3:0x80
    v_bitop3_b32 v4, v4, v39, 1 bitop3:0x80
    v_cmp_ne_u32 vcc, 1, v4
    s_nop 0
    s_cbranch_vccnz L_retry_201
    s_branch L_back_202
L_lo_193:
    ds_read_b128 v[72:75], v5 offset:3072
    ds_read_b128 v[76:79], v5 offset:4096
    ds_read_b128 v[88:91], v5 offset:5120
    ds_read_b128 v[92:95], v5 offset:6144
    s_waitcnt vmcnt(0)
    s_add_u32 s95, s66, 65536
    buffer_load_dwordx4 v[24:27], v6, s[8:11], s95 offen offset:0 sc1
    buffer_load_dwordx4 v[28:31], v6, s[8:11], s95 offen offset:1024 sc1
    buffer_load_dwordx4 v[32:35], v6, s[8:11], s95 offen offset:2048 sc1
    buffer_load_dwordx4 v[36:39], v6, s[8:11], s95 offen offset:3072 sc1
    s_add_u32 s96, s66, 69632
    buffer_load_dwordx4 v[40:43], v6, s[8:11], s96 offen offset:0 sc1
    buffer_load_dwordx4 v[44:47], v6, s[8:11], s96 offen offset:1024 sc1
    buffer_load_dwordx4 v[48:51], v6, s[8:11], s96 offen offset:2048 sc1
    buffer_load_dwordx4 v[52:55], v6, s[8:11], s96 offen offset:3072 sc1
    s_waitcnt vmcnt(4)
    v_bitop3_b32 v4, v27, v31, v35 bitop3:0x80
    v_bitop3_b32 v4, v4, v39, 1 bitop3:0x80
    v_cmp_ne_u32 vcc, 1, v4
    s_nop 0
    s_cbranch_vccnz L_retry_195
L_back_196:
    s_waitcnt lgkmcnt(6)
    v_mfma_f32_16x16x32_bf16 v[104:107], v[80:83], v[24:27], v[104:107]
    ds_read_b128 v[100:103], v5 offset:7168
    s_waitcnt lgkmcnt(5)
    v_mfma_f32_16x16x32_bf16 v[108:111], v[84:87], v[24:27], v[108:111]
    ds_read_b128 v[80:83], v5 offset:8192
    s_add_u32 s98, s66, 73728
    v_mfma_f32_16x16x32_bf16 v[112:115], v[96:99], v[24:27], v[112:115]
    ds_read_b128 v[84:87], v5 offset:9216
    s_waitcnt lgkmcnt(5)
    buffer_load_dwordx4 v[56:59], v6, s[8:11], s98 offen offset:0 sc1
    v_mfma_f32_16x16x32_bf16 v[116:119], v[72:75], v[24:27], v[116:119]
    ds_read_b128 v[96:99], v5 offset:10240
    v_mfma_f32_16x16x32_bf16 v[104:107], v[76:79], v[28:31], v[104:107]
    ds_read_b128 v[72:75], v5 offset:11264
    s_waitcnt lgkmcnt(5)
    buffer_load_dwordx4 v[60:63], v6, s[8:11], s98 offen offset:1024 sc1
    v_mfma_f32_16x16x32_bf16 v[108:111], v[88:91], v[28:31], v[108:111]
    ds_read_b128 v[76:79], v5 offset:12288
    v_mfma_f32_16x16x32_bf16 v[112:115], v[92:95], v[28:31], v[112:115]
    ds_read_b128 v[88:91], v5 offset:13312
    s_waitcnt lgkmcnt(5)
    buffer_load_dwordx4 v[64:67], v6, s[8:11], s98 offen offset:2048 sc1
    v_mfma_f32_16x16x32_bf16 v[116:119], v[100:103], v[28:31], v[116:119]
    ds_read_b128 v[92:95], v5 offset:14336
    v_mfma_f32_16x16x32_bf16 v[104:107], v[80:83], v[32:35], v[104:107]
    ds_read_b128 v[100:103], v5 offset:15360
    s_waitcnt lgkmcnt(5)
    buffer_load_dwordx4 v[68:71], v6, s[8:11], s98 offen offset:3072 sc1
    v_mfma_f32_16x16x32_bf16 v[108:111], v[84:87], v[32:35], v[108:111]
    ds_read_b128 v[80:83], v5 offset:16384
    s_waitcnt vmcnt(4)
    v_mfma_f32_16x16x32_bf16 v[112:115], v[96:99], v[32:35], v[112:115]
    ds_read_b128 v[84:87], v5 offset:17408
    s_waitcnt lgkmcnt(5)
    v_mfma_f32_16x16x32_bf16 v[116:119], v[72:75], v[32:35], v[116:119]
    ds_read_b128 v[96:99], v5 offset:18432
    v_bitop3_b32 v4, v43, v47, v51 bitop3:0x80
    v_mfma_f32_16x16x32_bf16 v[104:107], v[76:79], v[36:39], v[104:107]
    ds_read_b128 v[72:75], v5 offset:19456
    s_waitcnt lgkmcnt(5)
    v_mfma_f32_16x16x32_bf16 v[108:111], v[88:91], v[36:39], v[108:111]
    ds_read_b128 v[76:79], v5 offset:20480
    v_bitop3_b32 v4, v4, v55, 1 bitop3:0x80
    v_mfma_f32_16x16x32_bf16 v[112:115], v[92:95], v[36:39], v[112:115]
    ds_read_b128 v[88:91], v5 offset:21504
    s_waitcnt lgkmcnt(5)
    v_mfma_f32_16x16x32_bf16 v[116:119], v[100:103], v[36:39], v[116:119]
    ds_read_b128 v[92:95], v5 offset:22528
    v_cmp_ne_u32 vcc, 1, v4
    s_nop 0
    s_cbranch_vccnz L_retry_197
L_back_198:
    v_mfma_f32_16x16x32_bf16 v[104:107], v[80:83], v[40:43], v[104:107]
    ds_read_b128 v[100:103], v5 offset:23552
    s_waitcnt lgkmcnt(5)
    v_mfma_f32_16x16x32_bf16 v[108:111], v[84:87], v[40:43], v[108:111]
    ds_read_b128 v[80:83], v5 offset:24576
    s_add_u32 s99, s66, 77824
    v_mfma_f32_16x16x32_bf16 v[112:115], v[96:99], v[40:43], v[112:115]
    ds_read_b128 v[84:87], v5 offset:25600
    s_waitcnt lgkmcnt(5)
    buffer_load_dwordx4 v[24:27], v6, s[8:11], s99 offen offset:0 sc1
    v_mfma_f32_16x16x32_bf16 v[116:119], v[72:75], v[40:43], v[116:119]
    ds_read_b128 v[96:99], v5 offset:26624
    v_mfma_f32_16x16x32_bf16 v[104:107], v[76:79], v[44:47], v[104:107]
    ds_read_b128 v[72:75], v5 offset:27648
    s_waitcnt lgkmcnt(5)
    buffer_load_dwordx4 v[28:31], v6, s[8:11], s99 offen offset:1024 sc1
    v_mfma_f32_16x16x32_bf16 v[108:111], v[88:91], v[44:47], v[108:111]
    ds_read_b128 v[76:79], v5 offset:28672
    v_mfma_f32_16x16x32_bf16 v[112:115], v[92:95], v[44:47], v[112:115]
    ds_read_b128 v[88:91], v5 offset:29696
    s_waitcnt lgkmcnt(5)
    buffer_load_dwordx4 v[32:35], v6, s[8:11], s99 offen offset:2048 sc1
    v_mfma_f32_16x16x32_bf16 v[116:119], v[100:103], v[44:47], v[116:119]
    ds_read_b128 v[92:95], v5 offset:30720
    v_mfma_f32_16x16x32_bf16 v[104:107], v[80:83], v[48:51], v[104:107]
    ds_read_b128 v[100:103], v5 offset:31744
    s_waitcnt lgkmcnt(5)
    buffer_load_dwordx4 v[36:39], v6, s[8:11], s99 offen offset:3072 sc1
    v_mfma_f32_16x16x32_bf16 v[108:111], v[84:87], v[48:51], v[108:111]
    ds_read_b128 v[80:83], v5 offset:32768
    v_mfma_f32_16x16x32_bf16 v[112:115], v[96:99], v[48:51], v[112:115]
    ds_read_b128 v[84:87], v5 offset:33792
    s_waitcnt lgkmcnt(5)
    v_mfma_f32_16x16x32_bf16 v[116:119], v[72:75], v[48:51], v[116:119]
    ds_read_b128 v[96:99], v5 offset:34816
    v_mfma_f32_16x16x32_bf16 v[104:107], v[76:79], v[52:55], v[104:107]
    ds_read_b128 v[72:75], v5 offset:35840
    s_waitcnt lgkmcnt(5)
    v_mfma_f32_16x16x32_bf16 v[108:111], v[88:91], v[52:55], v[108:111]
    ds_read_b128 v[76:79], v5 offset:36864
    s_waitcnt vmcnt(4)
    v_mfma_f32_16x16x32_bf16 v[112:115], v[92:95], v[52:55], v[112:115]
    ds_read_b128 v[88:91], v5 offset:37888
    s_waitcnt lgkmcnt(5)
    v_mfma_f32_16x16x32_bf16 v[116:119], v[100:103], v[52:55], v[116:119]
    ds_read_b128 v[92:95], v5 offset:38912
    v_bitop3_b32 v4, v59, v63, v67 bitop3:0x80
    v_bitop3_b32 v4, v4, v71, 1 bitop3:0x80
    v_cmp_ne_u32 vcc, 1, v4
    s_nop 0
    s_cbranch_vccnz L_retry_199
L_back_200:
    v_mfma_f32_16x16x32_bf16 v[104:107], v[80:83], v[56:59], v[104:107]
    ds_read_b128 v[100:103], v5 offset:39936
    s_waitcnt lgkmcnt(5)
    v_mfma_f32_16x16x32_bf16 v[108:111], v[84:87], v[56:59], v[108:111]
    ds_read_b128 v[80:83], v5 offset:40960
    v_mfma_f32_16x16x32_bf16 v[112:115], v[96:99], v[56:59], v[112:115]
    ds_read_b128 v[84:87], v5 offset:41984
    s_waitcnt lgkmcnt(5)
    v_mfma_f32_16x16x32_bf16 v[116:119], v[72:75], v[56:59], v[116:119]
    ds_read_b128 v[96:99], v5 offset:43008
    v_mfma_f32_16x16x32_bf16 v[104:107], v[76:79], v[60:63], v[104:107]
    ds_read_b128 v[72:75], v5 offset:44032
    s_waitcnt lgkmcnt(5)
    v_mfma_f32_16x16x32_bf16 v[108:111], v[88:91], v[60:63], v[108:111]
    ds_read_b128 v[76:79], v5 offset:45056
    v_mfma_f32_16x16x32_bf16 v[112:115], v[92:95], v[60:63], v[112:115]
    ds_read_b128 v[88:91], v5 offset:46080
    s_waitcnt lgkmcnt(5)
    v_mfma_f32_16x16x32_bf16 v[116:119], v[100:103], v[60:63], v[116:119]
    ds_read_b128 v[92:95], v5 offset:47104
    v_mfma_f32_16x16x32_bf16 v[104:107], v[80:83], v[64:67], v[104:107]
    ds_read_b128 v[100:103], v5 offset:48128
    s_waitcnt lgkmcnt(5)
    v_mfma_f32_16x16x32_bf16 v[108:111], v[84:87], v[64:67], v[108:111]
    ds_read_b128 v[80:83], v5 offset:49152
    v_mfma_f32_16x16x32_bf16 v[112:115], v[96:99], v[64:67], v[112:115]
    ds_read_b128 v[84:87], v5 offset:50176
    s_waitcnt lgkmcnt(5)
    v_mfma_f32_16x16x32_bf16 v[116:119], v[72:75], v[64:67], v[116:119]
    ds_read_b128 v[96:99], v5 offset:51200
    v_mfma_f32_16x16x32_bf16 v[104:107], v[76:79], v[68:71], v[104:107]
    ds_read_b128 v[72:75], v5 offset:52224
    s_waitcnt lgkmcnt(5)
    v_mfma_f32_16x16x32_bf16 v[108:111], v[88:91], v[68:71], v[108:111]
    ds_read_b128 v[76:79], v5 offset:53248
    s_waitcnt vmcnt(0)
    v_mfma_f32_16x16x32_bf16 v[112:115], v[92:95], v[68:71], v[112:115]
    ds_read_b128 v[88:91], v5 offset:54272
    s_waitcnt lgkmcnt(5)
    v_mfma_f32_16x16x32_bf16 v[116:119], v[100:103], v[68:71], v[116:119]
    ds_read_b128 v[92:95], v5 offset:55296
    v_bitop3_b32 v4, v27, v31, v35 bitop3:0x80
    v_bitop3_b32 v4, v4, v39, 1 bitop3:0x80
    v_cmp_ne_u32 vcc, 1, v4
    s_nop 0
    s_cbranch_vccnz L_retry_201
L_back_202:
    v_mfma_f32_16x16x32_bf16 v[104:107], v[80:83], v[24:27], v[104:107]
    ds_read_b128 v[100:103], v5 offset:56320
    s_waitcnt lgkmcnt(5)
    v_mfma_f32_16x16x32_bf16 v[108:111], v[84:87], v[24:27], v[108:111]
    ds_read_b128 v[80:83], v5 offset:57344
    v_mfma_f32_16x16x32_bf16 v[112:115], v[96:99], v[24:27], v[112:115]
    ds_read_b128 v[84:87], v5 offset:58368
    s_waitcnt lgkmcnt(5)
    v_mfma_f32_16x16x32_bf16 v[116:119], v[72:75], v[24:27], v[116:119]
    ds_read_b128 v[96:99], v5 offset:61440
    v_mfma_f32_16x16x32_bf16 v[104:107], v[76:79], v[28:31], v[104:107]
    ds_read_b128 v[72:75], v5 offset:62464
    s_waitcnt lgkmcnt(5)
    v_mfma_f32_16x16x32_bf16 v[108:111], v[88:91], v[28:31], v[108:111]
    ds_read_b128 v[76:79], v5 offset:59392
    v_mfma_f32_16x16x32_bf16 v[112:115], v[92:95], v[28:31], v[112:115]
    ds_read_b128 v[88:91], v5 offset:60416
    s_waitcnt lgkmcnt(5)
    v_mfma_f32_16x16x32_bf16 v[116:119], v[100:103], v[28:31], v[116:119]
    ds_read_b128 v[92:95], v5 offset:63488
    v_mfma_f32_16x16x32_bf16 v[104:107], v[80:83], v[32:35], v[104:107]
    ds_read_b128 v[100:103], v5 offset:64512
    s_waitcnt lgkmcnt(5)
    v_mfma_f32_16x16x32_bf16 v[108:111], v[84:87], v[32:35], v[108:111]
    v_mfma_f32_16x16x32_bf16 v[104:107], v[96:99], v[36:39], v[104:107]
    s_waitcnt lgkmcnt(3)
    v_mfma_f32_16x16x32_bf16 v[108:111], v[72:75], v[36:39], v[108:111]
    v_mfma_f32_16x16x32_bf16 v[112:115], v[76:79], v[32:35], v[112:115]
    s_waitcnt lgkmcnt(1)
    v_mfma_f32_16x16x32_bf16 v[116:119], v[88:91], v[32:35], v[116:119]
    v_mfma_f32_16x16x32_bf16 v[112:115], v[92:95], v[36:39], v[112:115]
    s_waitcnt lgkmcnt(0)
    v_mfma_f32_16x16x32_bf16 v[116:119], v[100:103], v[36:39], v[116:119]
    s_nop 1
    v_cvt_pk_bf16_f32 v103, v110, v111
    v_cvt_pk_bf16_f32 v100, v104, v105
    v_cvt_pk_bf16_f32 v101, v106, v107
    v_cvt_pk_bf16_f32 v102, v108, v109
    buffer_store_dwordx4 v[100:103], v11, s[12:15], 0 offen offset:0
    s_nop 0
    v_cvt_pk_bf16_f32 v127, v118, v119
    v_cvt_pk_bf16_f32 v124, v112, v113
    v_cvt_pk_bf16_f32 v125, v114, v115
    v_cvt_pk_bf16_f32 v126, v116, v117
    buffer_store_dwordx4 v[124:127], v11, s[12:15], 0 offen offset:64
    s_or_b32 s72, s2, s36
    s_cbranch_scc1 L_end
    v_mov_b32 v0, s5
    s_mov_b32 s72, 540672
    s_mov_b64 exec, 1
    buffer_store_dword v0, v6, s[8:11], s72 offen sc1
    s_endpgm
L_retry_203:
    s_add_u32 s80, s66, 65536
    buffer_load_dwordx4 v[24:27], v6, s[8:11], s80 offen offset:0 sc1
    buffer_load_dwordx4 v[28:31], v6, s[8:11], s80 offen offset:1024 sc1
    buffer_load_dwordx4 v[32:35], v6, s[8:11], s80 offen offset:2048 sc1
    buffer_load_dwordx4 v[36:39], v6, s[8:11], s80 offen offset:3072 sc1
    s_sub_u32 s41, s41, 1
    s_cbranch_scc1 L_end
    s_waitcnt vmcnt(0)
    v_bitop3_b32 v4, v27, v31, v35 bitop3:0x80
    v_bitop3_b32 v4, v4, v39, 1 bitop3:0x80
    v_cmp_ne_u32 vcc, 1, v4
    s_nop 0
    s_cbranch_vccnz L_retry_203
    s_branch L_back_204
L_retry_205:
    s_add_u32 s83, s66, 69632
    buffer_load_dwordx4 v[40:43], v6, s[8:11], s83 offen offset:0 sc1
    buffer_load_dwordx4 v[44:47], v6, s[8:11], s83 offen offset:1024 sc1
    buffer_load_dwordx4 v[48:51], v6, s[8:11], s83 offen offset:2048 sc1
    buffer_load_dwordx4 v[52:55], v6, s[8:11], s83 offen offset:3072 sc1
    s_sub_u32 s41, s41, 1
    s_cbranch_scc1 L_end
    s_waitcnt vmcnt(0)
    v_bitop3_b32 v4, v43, v47, v51 bitop3:0x80
    v_bitop3_b32 v4, v4, v55, 1 bitop3:0x80
    v_cmp_ne_u32 vcc, 1, v4
    s_nop 0
    s_cbranch_vccnz L_retry_205
    s_branch L_back_206
L_retry_207:
    s_add_u32 s84, s66, 73728
    buffer_load_dwordx4 v[56:59], v6, s[8:11], s84 offen offset:0 sc1
    buffer_load_dwordx4 v[60:63], v6, s[8:11], s84 offen offset:1024 sc1
    buffer_load_dwordx4 v[64:67], v6, s[8:11], s84 offen offset:2048 sc1
    buffer_load_dwordx4 v[68:71], v6, s[8:11], s84 offen offset:3072 sc1
    s_sub_u32 s41, s41, 1
    s_cbranch_scc1 L_end
    s_waitcnt vmcnt(0)
    v_bitop3_b32 v4, v59, v63, v67 bitop3:0x80
    v_bitop3_b32 v4, v4, v71, 1 bitop3:0x80
    v_cmp_ne_u32 vcc, 1, v4
    s_nop 0
    s_cbranch_vccnz L_retry_207
    s_branch L_back_208
L_retry_209:
    s_add_u32 s85, s66, 77824
    buffer_load_dwordx4 v[24:27], v6, s[8:11], s85 offen offset:0 sc1
    buffer_load_dwordx4 v[28:31], v6, s[8:11], s85 offen offset:1024 sc1
    buffer_load_dwordx4 v[32:35], v6, s[8:11], s85 offen offset:2048 sc1
    buffer_load_dwordx4 v[36:39], v6, s[8:11], s85 offen offset:3072 sc1
    s_sub_u32 s41, s41, 1
    s_cbranch_scc1 L_end
    s_waitcnt vmcnt(0)
    v_bitop3_b32 v4, v27, v31, v35 bitop3:0x80
    v_bitop3_b32 v4, v4, v39, 1 bitop3:0x80
    v_cmp_ne_u32 vcc, 1, v4
    s_nop 0
    s_cbranch_vccnz L_retry_209
    s_branch L_back_210
.section .rodata,"a"
.p2align 6
.amdhsa_kernel interleave_layers__sliding_local_dilated__sliding_local_dilated__prompt_kernel
  .amdhsa_next_free_vgpr 512
  .amdhsa_next_free_sgpr 102
  .amdhsa_accum_offset 256
  .amdhsa_group_segment_fixed_size 0
  .amdhsa_kernarg_size 72
  .amdhsa_user_sgpr_count 2
  .amdhsa_user_sgpr_kernarg_segment_ptr 1
  .amdhsa_system_sgpr_workgroup_id_x 1
  .amdhsa_float_denorm_mode_32 3
.end_amdhsa_kernel
```
